```python
import torch

def _softmax(x, axis=-1):
    return torch.softmax(x, dim=axis)

def _gelu(x):
    return torch.nn.functional.gelu(x, approximate='tanh')

def _silu(x):
    return torch.nn.functional.silu(x)

def _sigmoid(x):
    return torch.sigmoid(x)

def _layernorm(x, axis=-1, eps=1e-05):
    m = x.mean(dim=axis, keepdim=True)
    v = x.var(dim=axis, keepdim=True, unbiased=False)
    return (x - m) / torch.sqrt(v + eps)

def _scatter_add(tgt, idx, src, axis=0):
    return tgt.clone().index_add_(axis, idx, src)

def _segment_sum(src, seg, n):
    out = torch.zeros((n,) + src.shape[1:], dtype=src.dtype)
    return out.index_add_(0, seg, src)

def _pad(x, pw):
    flat = tuple((v for pair in reversed(pw) for v in pair))
    return torch.nn.functional.pad(x, flat)
kernel_name = 'parallel_sum__compressed_kv_cla__mixer_gmlp__prompt'

def setup_inputs():

    _w = lambda a: (lambda t: t.to(torch.bfloat16) if t.is_floating_point() else t)(torch.as_tensor(a))

    def _A_setup():
        B, H, Sq, Sk, D, M = (1, 32, 2048, 2048, 128, 512)
        Dc = 4 * D
        return {'x': _w((lambda *s: torch.randn(*s, dtype=torch.bfloat16) * 0.05)(B, Sq, M)), 'c_kv': _w((lambda *s: torch.randn(*s, dtype=torch.bfloat16) * 1.6)(B, Sk, Dc)), 'w_q': _w((lambda *s: torch.randn(*s, dtype=torch.bfloat16) * 1.6)(M, H, D) * M ** (-0.5)), 'w_uk': _w((lambda *s: torch.randn(*s, dtype=torch.bfloat16) * 1.6)(Dc, H, D) * Dc ** (-0.5)), 'w_uv': _w((lambda *s: torch.randn(*s, dtype=torch.bfloat16) * 1.6)(Dc, H, D) * Dc ** (-0.5)), 'w_o': _w((lambda *s: torch.randn(*s, dtype=torch.bfloat16) * 1.6)(H, D, M) * (H * D) ** (-0.5))}
    _A_in = _A_setup()

    def _B_setup():
        B, S, D, F = (1, 2048, 512, 1376)
        Fh = F // 2
        return {'x': _w((lambda *s: torch.randn(*s, dtype=torch.bfloat16) * 0.05)(B, S, D)), 'w_in': _w((lambda *s: torch.randn(*s, dtype=torch.bfloat16) * 0.4)(D, 2 * Fh)), 'w_sp': _w(0.01 * (lambda *s: torch.randn(*s, dtype=torch.bfloat16) * 0.4)(S, S)), 'b_sp': _w(1.0 + 0.01 * (lambda *s: torch.randn(*s, dtype=torch.bfloat16) * 0.05)(S)), 'w_out': _w((lambda *s: torch.randn(*s, dtype=torch.bfloat16) * 0.05)(Fh, D))}
    _B_in = _B_setup()
    return {'A_x': _A_in['x'], 'A_c_kv': _A_in['c_kv'], 'A_w_q': _A_in['w_q'], 'A_w_uk': _A_in['w_uk'], 'A_w_uv': _A_in['w_uv'], 'A_w_o': _A_in['w_o'], 'B_x': _B_in['x'], 'B_w_in': _B_in['w_in'], 'B_w_sp': _B_in['w_sp'], 'B_b_sp': _B_in['b_sp'], 'B_w_out': _B_in['w_out']}

def reference(A_x, A_c_kv, A_w_q, A_w_uk, A_w_uv, A_w_o, B_x, B_w_in, B_w_sp, B_b_sp, B_w_out):

    def _A_ref(x, c_kv, w_q, w_uk, w_uv, w_o):
        B, Sq, M = (x.shape[0], x.shape[1], x.shape[2])
        Sk = c_kv.shape[1]
        H, D = (w_q.shape[1], w_q.shape[2])
        q = torch.einsum('bqm,mhd->bhqd', x, w_q)
        k = torch.einsum('bkc,chd->bhkd', c_kv, w_uk)
        v = torch.einsum('bkc,chd->bhkd', c_kv, w_uv)
        scores = torch.einsum('bhqd,bhkd->bhqk', q, k) * D ** (-0.5)
        off = Sk - Sq
        qi = torch.arange(Sq)[:, None]
        kj = torch.arange(Sk)[None, :]
        cmask = kj <= qi + off
        scores = torch.where(cmask[None, None], scores, -1000000000.0)
        p = _softmax(scores, axis=-1)
        ctx = torch.einsum('bhqk,bhkd->bhqd', p, v)
        return torch.einsum('bhqd,hdm->bqm', ctx, w_o)

    def _B_ref(x, w_in, w_sp, b_sp, w_out):
        B, S, D = x.shape
        F = w_in.shape[-1]
        Fh = F // 2
        z = _gelu(torch.einsum('bsd,df->bsf', x, w_in))
        z1 = z[..., :Fh].clone()
        z2 = _layernorm(z[..., Fh:], axis=-1)
        g = torch.einsum('ts,bsf->btf', w_sp, z2) + b_sp[None, :, None]
        return torch.einsum('bsf,fd->bsd', z1 * g, w_out)
    x = A_x
    xn = _layernorm(x, axis=-1)
    return x + _A_ref(xn, A_c_kv, A_w_q, A_w_uk, A_w_uv, A_w_o) + _B_ref(xn, B_w_in, B_w_sp, B_b_sp, B_w_out)
```

```asm
; @launch grid=(256,1,1) block=(512,1,1) lds=163840
.amdgcn_target "amdgcn-amd-amdhsa--gfx950"
.text
.globl parallel_sum__compressed_kv_cla__mixer_gmlp__prompt_kernel
.p2align 8
.type parallel_sum__compressed_kv_cla__mixer_gmlp__prompt_kernel,@function
parallel_sum__compressed_kv_cla__mixer_gmlp__prompt_kernel:
    s_cmp_ge_u32 s2, 256
    s_cbranch_scc1 parallel_sum__compressed_kv_cla__mixer_gmlp__prompt_kernel_end
    s_load_dwordx4 s[8:11], s[0:1], 96
    s_load_dwordx4 s[24:27], s[0:1], 0
    s_load_dwordx4 s[28:31], s[0:1], 24
    s_load_dwordx2 s[64:65], s[0:1], 16
    s_load_dwordx2 s[66:67], s[0:1], 56
    v_and_b32 v1, 63, v0
    v_lshrrev_b32_e64 v2, 6, v0
    s_nop 0
    v_readfirstlane_b32 s3, v2
    v_lshlrev_b32 v2, 4, v1
    s_and_b32 s12, s2, 7
    s_lshr_b32 s13, s2, 3
    s_and_b32 s62, s13, 7
    s_bfe_u32 s57, s13, 0x10003
    s_lshr_b32 s13, s13, 4
    s_lshl_b32 s63, s12, 1
    s_add_u32 s63, s63, s13
    s_add_u32 s60, s63, 16
    v_lshrrev_b32 v4, 3, v1
    v_lshlrev_b32 v4, 10, v4
    v_and_b32 v5, 7, v1
    v_lshrrev_b32 v6, 4, v1
    v_xor_b32_e64 v5, v5, v6
    v_lshl_add_u32 v10, v5, 4, v4
    v_xor_b32 v11, 64, v10
    v_and_b32 v5, 15, v1
    v_lshrrev_b32 v4, 1, v5
    v_and_b32 v5, 1, v5
    s_and_b32 s12, s3, 1
    s_lshl_b32 s13, s12, 2
    v_or_b32 v7, s13, v6
    v_xor_b32 v4, v4, v7
    v_lshlrev_b32_e64 v4, 5, v4
    v_lshl_add_u32 v4, v5, 4, v4
    v_lshl_add_u32 v12, v6, 13, v4
    v_lshrrev_b32 v4, 5, v1
    v_and_b32 v5, 31, v1
    v_lshrrev_b32 v6, 1, v5
    v_and_b32 v5, 1, v5
    s_and_b32 s13, s3, 2
    s_lshl_b32 s13, s13, 1
    v_or_b32 v7, s13, v4
    v_xor_b32 v6, v6, v7
    v_lshlrev_b32_e64 v6, 5, v6
    v_lshl_add_u32 v6, v5, 4, v6
    v_lshl_add_u32 v30, v4, 13, v6
    v_xor_b32_e64 v31, 64, v30
    s_lshl_b32 s54, s62, 7
    s_and_b32 s13, s3, 3
    s_lshl_b32 s13, s13, 5
    s_add_u32 s54, s54, s13
    s_lshr_b32 s13, s3, 2
    s_lshl_b32 s13, s13, 10
    s_add_u32 s54, s54, s13
    s_lshl_b32 s54, s54, 10
    s_lshl_b32 s55, s3, 15
    s_lshl_b32 s13, s63, 9
    s_add_u32 s55, s55, s13
    s_lshl_b32 s56, s3, 12
    s_lshl_b32 s48, s3, 11
    s_lshl_b32 s49, s3, 10
    s_lshl_b32 s61, s2, 3
    s_add_u32 s61, s61, s3
    s_waitcnt lgkmcnt(0)
    s_mov_b32 s16, s26
    s_and_b32 s17, s27, 0xffff
    s_mov_b32 s18, 0x200000
    s_mov_b32 s19, 0x00020000
    s_mov_b64 s[52:53], s[26:27]
    s_cmp_eq_u32 s57, 0
    s_cselect_b32 s28, s28, s30
    s_cselect_b32 s29, s29, s31
    s_mov_b32 s20, s28
    s_and_b32 s21, s29, 0xffff
    s_mov_b32 s22, 0x400000
    s_mov_b32 s23, 0x00020000
    s_mov_b32 s4, s10
    s_and_b32 s5, s11, 0xffff
    s_mov_b32 s6, 0x10000000
    s_mov_b32 s7, 0x00020000
    s_mov_b32 s28, s8
    s_and_b32 s29, s9, 0xffff
    s_mov_b32 s30, 0x100
    s_mov_b32 s31, 0x00020000
    s_mov_b32 s24, s24
    s_and_b32 s25, s25, 0xffff
    s_mov_b32 s26, 0x200000
    s_mov_b32 s27, 0x00020000
    s_add_u32 m0, s48, 98304
    s_add_u32 s12, s55, 0
    buffer_load_dwordx4 v30, s[20:23], s12 offen lds
    s_add_u32 m0, s48, 99328
    s_add_u32 s12, s55, 16384
    buffer_load_dwordx4 v31, s[20:23], s12 offen lds
    s_add_u32 m0, s56, 0
    s_add_u32 s12, s54, 0
    buffer_load_dwordx4 v10, s[16:19], s12 offen lds
    s_add_u32 m0, s56, 1024
    s_add_u32 s12, s54, 8192
    buffer_load_dwordx4 v11, s[16:19], s12 offen lds
    s_add_u32 m0, s56, 2048
    s_add_u32 s12, s54, 16384
    buffer_load_dwordx4 v10, s[16:19], s12 offen lds
    s_add_u32 m0, s56, 3072
    s_add_u32 s12, s54, 24576
    buffer_load_dwordx4 v11, s[16:19], s12 offen lds
    s_lshl_b32 s12, s61, 10
    buffer_load_dwordx4 v[32:35], v2, s[24:27], s12 offen
    s_or_b32 s12, s2, s3
    s_cbranch_scc1 parallel_sum__compressed_kv_cla__mixer_gmlp__prompt_kernel_noinit
    v_lshlrev_b32 v8, 8, v1
    v_mov_b32 v9, 0
    s_mov_b32 s12, 117440512
    buffer_store_dword v9, v8, s[4:7], s12 offen sc1
    s_mov_b32 s12, 117456896
    buffer_store_dword v9, v8, s[4:7], s12 offen sc1
    s_mov_b32 s12, 117473280
    buffer_store_dword v9, v8, s[4:7], s12 offen sc1
    s_mov_b32 s12, 117489664
    buffer_store_dword v9, v8, s[4:7], s12 offen sc1
    s_mov_b32 s12, 117506048
    buffer_store_dword v9, v8, s[4:7], s12 offen sc1
parallel_sum__compressed_kv_cla__mixer_gmlp__prompt_kernel_noinit:
    s_barrier
    s_add_u32 m0, s48, 114688
    s_add_u32 s12, s55, 262144
    buffer_load_dwordx4 v30, s[20:23], s12 offen lds
    s_add_u32 m0, s48, 115712
    s_add_u32 s12, s55, 278528
    buffer_load_dwordx4 v31, s[20:23], s12 offen lds
    s_cmp_lg_u32 s3, 7
    s_cbranch_scc1 parallel_sum__compressed_kv_cla__mixer_gmlp__prompt_kernel_nocode
    s_getpc_b64 s[14:15]
parallel_sum__compressed_kv_cla__mixer_gmlp__prompt_kernel_pc:
    s_lshr_b32 s12, s2, 3
    s_lshl_b32 s12, s12, 13
    v_lshlrev_b32 v8, 7, v1
    v_add_u32 v8, s12, v8
    v_min_u32 v8, parallel_sum__compressed_kv_cla__mixer_gmlp__prompt_kernel_end - parallel_sum__compressed_kv_cla__mixer_gmlp__prompt_kernel_pc, v8
    global_load_dword v28, v8, s[14:15]
parallel_sum__compressed_kv_cla__mixer_gmlp__prompt_kernel_nocode:
    v_and_b32 v4, 15, v1
    v_lshrrev_b32 v5, 4, v1
    v_lshrrev_b32 v6, 1, v4
    v_xor_b32 v6, v6, v5
    v_lshlrev_b32_e64 v6, 4, v6
    v_lshl_add_u32 v6, v4, 7, v6
    s_and_b32 s12, s3, 1
    s_lshl_b32 s12, s12, 13
    v_add_u32 v14, s12, v6
    v_xor_b32 v15, 64, v14
    v_add_u32 v16, 65536, v14
    v_add_u32 v17, 65536, v15
    v_lshrrev_b32 v6, 2, v4
    v_and_b32 v7, 1, v5
    v_lshl_or_b32 v7, v7, 2, v6
    v_lshl_add_u32 v6, v5, 3, v6
    v_lshlrev_b32 v6, 9, v6
    v_and_b32 v3, 3, v1
    v_lshl_add_u32 v6, v3, 3, v6
    v_add_u32 v6, 98304, v6
    s_lshr_b32 s13, s3, 1
    s_lshl_b32 s12, s13, 2
    s_add_u32 s14, s12, 0
    v_xor_b32 v3, s14, v7
    v_lshl_add_u32 v18, v3, 5, v6
    s_add_u32 s14, s12, 1
    v_xor_b32 v3, s14, v7
    v_lshl_add_u32 v19, v3, 5, v6
    s_add_u32 s14, s12, 2
    v_xor_b32 v3, s14, v7
    v_lshl_add_u32 v20, v3, 5, v6
    s_add_u32 s14, s12, 3
    v_xor_b32 v3, s14, v7
    v_lshl_add_u32 v21, v3, 5, v6
    s_lshl_b32 s58, s63, 1
    s_lshr_b32 s12, s13, 1
    s_add_u32 s58, s58, s12
    s_lshl_b32 s58, s58, 6
    s_lshl_b32 s12, s62, 2
    s_add_u32 s58, s58, s12
    s_and_b32 s12, s3, 1
    s_lshl_b32 s12, s12, 1
    s_add_u32 s58, s58, s12
    s_lshl_b32 s58, s58, 13
    s_and_b32 s13, s13, 1
    s_cmp_eq_u32 s57, 0
    s_movk_i32 s59, 1024
    s_cselect_b32 s59, 2048, s59
    s_mov_b32 s12, 18874368
    s_cselect_b32 s12, 2097152, s12
    s_cselect_b64 vcc, -1, 0
    s_add_u32 s58, s58, s12
    s_mul_i32 s12, s13, s59
    s_lshl_b32 s12, s12, 1
    s_add_u32 s58, s58, s12
    v_and_b32 v6, 1, v5
    v_lshrrev_b32 v7, 1, v5
    v_lshl_add_u32 v3, v7, 5, v4
    v_lshlrev_b32_e64 v3, 4, v3
    v_lshl_add_u32 v3, v6, 10, v3
    v_lshl_add_u32 v27, v6, 5, v4
    v_lshlrev_b32_e64 v27, 4, v27
    v_lshl_add_u32 v27, v7, 12, v27
    v_cndmask_b32 v27, v27, v3, vcc
    s_add_u32 m0, s48, 131072
    s_add_u32 s12, s55, 524288
    buffer_load_dwordx4 v30, s[20:23], s12 offen lds
    s_add_u32 m0, s48, 132096
    s_add_u32 s12, s55, 540672
    buffer_load_dwordx4 v31, s[20:23], s12 offen lds
    s_add_u32 m0, s56, 32768
    s_add_u32 s12, s54, 128
    buffer_load_dwordx4 v10, s[16:19], s12 offen lds
    s_add_u32 m0, s56, 33792
    s_add_u32 s12, s54, 8320
    buffer_load_dwordx4 v11, s[16:19], s12 offen lds
    s_add_u32 m0, s56, 34816
    s_add_u32 s12, s54, 16512
    buffer_load_dwordx4 v10, s[16:19], s12 offen lds
    s_add_u32 m0, s56, 35840
    s_add_u32 s12, s54, 24704
    buffer_load_dwordx4 v11, s[16:19], s12 offen lds
    s_and_b32 s12, s2, 7
    s_lshr_b32 s13, s2, 3
    s_and_b32 s14, s13, 3
    s_lshl_b32 s12, s12, 2
    s_add_u32 s32, s12, s14
    s_lshr_b32 s33, s13, 2
    s_sub_u32 s12, 15, s33
    s_cmp_ge_u32 s3, 4
    s_cselect_b32 s34, s33, s12
    s_and_b32 s13, s3, 3
    s_lshl_b32 s12, s34, 2
    s_add_u32 s39, s12, s13
    s_lshl_b32 s35, s39, 1
    s_lshl_b32 s12, s33, 1
    s_sub_u32 s38, 32, s12
    s_mul_i32 s37, s32, 3
    s_sub_u32 s12, s37, 2
    s_cmp_ge_u32 s32, 15
    s_cselect_b32 s36, 1, 0
    s_cselect_b32 s37, s12, s37
    s_min_u32 s37, s37, 86
    s_lshl_b32 s46, s3, 16
    s_lshl_b32 s12, s32, 8
    s_add_u32 s46, s46, s12
    s_mul_i32 s47, s3, 22016
    s_lshl_b32 s12, s37, 5
    s_add_u32 s47, s47, s12
    s_lshl_b32 s50, s35, 14
    s_lshl_b32 s12, s32, 19
    s_add_u32 s42, s12, 2097152
    s_add_u32 s43, s12, 18866176
    v_lshrrev_b32 v4, 3, v1
    v_and_b32 v5, 7, v1
    v_lshrrev_b32 v6, 1, v5
    v_and_b32 v5, 1, v5
    v_bfe_u32 v7, v1, 4, 1
    s_and_b32 s12, s3, 1
    s_lshl_b32 s12, s12, 1
    v_or_b32 v7, s12, v7
    v_xor_b32 v6, v6, v7
    v_lshlrev_b32_e64 v6, 5, v6
    v_lshl_add_u32 v6, v5, 4, v6
    v_mul_u32_u24 v4, 2752, v4
    v_add_u32 v13, v4, v6
    s_waitcnt vmcnt(8) lgkmcnt(0)
    v_lshlrev_b32_e64 v40, 16, v32
    v_and_b32 v41, 0xffff0000, v32
    v_lshlrev_b32_e64 v42, 16, v33
    v_and_b32 v43, 0xffff0000, v33
    v_lshlrev_b32_e64 v44, 16, v34
    v_and_b32 v45, 0xffff0000, v34
    v_lshlrev_b32_e64 v46, 16, v35
    v_and_b32 v47, 0xffff0000, v35
    v_add_f32 v36, v40, v41
    v_add_f32 v36, v36, v42
    v_add_f32 v36, v36, v43
    v_add_f32 v36, v36, v44
    v_add_f32 v36, v36, v45
    v_add_f32 v36, v36, v46
    v_add_f32 v36, v36, v47
    s_nop 1
    v_add_f32 v36, v36, v36 quad_perm:[1,0,3,2] row_mask:0xf bank_mask:0xf
    s_nop 1
    v_add_f32 v36, v36, v36 quad_perm:[2,3,0,1] row_mask:0xf bank_mask:0xf
    s_nop 1
    v_add_f32 v36, v36, v36 row_half_mirror row_mask:0xf bank_mask:0xf
    s_nop 1
    v_add_f32 v36, v36, v36 row_mirror row_mask:0xf bank_mask:0xf
    v_mov_b32 v37, v36
    s_nop 1
    v_permlane16_swap_b32 v36, v37
    v_add_f32 v36, v36, v37
    v_mov_b32 v37, v36
    s_nop 1
    v_permlane32_swap_b32 v36, v37
    v_add_f32_e64 v36, v36, v37
    v_mul_f32 v36, 0x3b000000, v36
    v_sub_f32 v40, v40, v36
    v_sub_f32 v41, v41, v36
    v_sub_f32 v42, v42, v36
    v_sub_f32 v43, v43, v36
    v_sub_f32 v44, v44, v36
    v_sub_f32 v45, v45, v36
    v_sub_f32 v46, v46, v36
    v_sub_f32 v47, v47, v36
    v_mul_f32 v38, v40, v40
    v_fmac_f32 v38, v41, v41
    v_fmac_f32 v38, v42, v42
    v_fmac_f32 v38, v43, v43
    v_fmac_f32 v38, v44, v44
    v_fmac_f32 v38, v45, v45
    v_fmac_f32_e64 v38, v46, v46
    v_fmac_f32 v38, v47, v47
    s_nop 1
    v_add_f32 v38, v38, v38 quad_perm:[1,0,3,2] row_mask:0xf bank_mask:0xf
    s_nop 1
    v_add_f32 v38, v38, v38 quad_perm:[2,3,0,1] row_mask:0xf bank_mask:0xf
    s_nop 1
    v_add_f32 v38, v38, v38 row_half_mirror row_mask:0xf bank_mask:0xf
    s_nop 1
    v_add_f32 v38, v38, v38 row_mirror row_mask:0xf bank_mask:0xf
    v_mov_b32 v37, v38
    s_nop 1
    v_permlane16_swap_b32 v38, v37
    v_add_f32 v38, v38, v37
    v_mov_b32 v37, v38
    s_nop 1
    v_permlane32_swap_b32 v38, v37
    v_add_f32_e64 v38, v38, v37
    v_mov_b32 v37, 0x3727c5ac
    v_fmac_f32 v37, 0x3b000000, v38
    v_rsq_f32 v37, v37
    s_nop 0
    v_mul_f32 v40, v40, v37
    v_mul_f32 v41, v41, v37
    v_mul_f32 v42, v42, v37
    v_mul_f32 v43, v43, v37
    v_mul_f32 v44, v44, v37
    v_mul_f32 v45, v45, v37
    v_mul_f32 v46, v46, v37
    v_mul_f32 v47, v47, v37
    v_cvt_pk_bf16_f32 v96, v40, v41
    v_cvt_pk_bf16_f32 v97, v42, v43
    v_cvt_pk_bf16_f32 v98, v44, v45
    v_cvt_pk_bf16_f32 v99, v46, v47
    s_lshl_b32 s12, s3, 4
    s_add_u32 s12, s12, 65536
    v_lshlrev_b32 v4, 7, v1
    v_add_u32_e64 v4, s12, v4
    ds_write_b128 v4, v[96:99]
    v_lshrrev_b32 v5, 5, v1
    v_lshlrev_b32 v5, 10, v5
    v_bfe_u32 v4, v1, 3, 2
    v_lshl_add_u32 v5, v4, 8, v5
    v_and_b32_e64 v4, 7, v1
    v_lshl_add_u32 v3, v4, 4, v5
    s_lshr_b32 s45, s2, 1
    s_lshl_b32 s45, s45, 14
    s_and_b32 s13, s2, 1
    s_lshl_b32 s13, s13, 7
    s_add_u32 s45, s45, s13
    s_lshl_b32 s13, s3, 11
    s_add_u32 s45, s45, s13
    v_add_u32 v22, s49, v2
    v_add_u32 v22, 65536, v22
    s_lshr_b32 s12, s2, 3
    s_and_b32 s13, s2, 7
    s_cmp_eq_u32 s3, 2
    s_cselect_b64 s[8:9], s[66:67], s[64:65]
    s_mov_b32 s10, 4194304
    s_cselect_b32 s10, 1409024, s10
    s_cmp_eq_u32 s3, 3
    s_cselect_b64 s[8:9], s[52:53], s[8:9]
    s_cselect_b32 s10, 2097152, s10
    s_and_b32 s9, s9, 0xffff
    s_mov_b32 s11, 0x00020000
    s_lshl_b32 s14, s3, 5
    s_add_u32 s14, s14, s12
    s_lshl_b32 s14, s14, 16
    s_lshl_b32 s15, s13, 10
    s_add_u32 s14, s14, s15
    s_lshl_b32 s15, s13, 5
    s_add_u32 s15, s15, s12
    s_lshl_b32 s15, s15, 13
    s_cmp_ge_u32 s3, 2
    s_cselect_b32 s51, s15, s14
    s_cselect_b64 vcc, -1, 0
    s_lshr_b32 s15, s15, 1
    s_or_b32 s15, s15, 1048576
    s_cmp_eq_u32 s3, 3
    s_cselect_b32 s51, s15, s51
    v_lshlrev_b32 v8, 7, v1
    v_lshrrev_b32 v4, 3, v1
    v_lshlrev_b32 v4, 13, v4
    v_and_b32 v5, 7, v1
    v_lshl_add_u32 v29, v5, 7, v4
    v_cndmask_b32 v29, v29, v8, vcc
    s_waitcnt lgkmcnt(0)
    s_barrier
    ds_read_b128 v[22:25], v22
    ds_read_b128 v[32:35], v14 offset:0
    ds_read_b64_tr_b16 v[64:65], v18 offset:0
    ds_read_b64_tr_b16 v[66:67], v18 offset:2048
    ds_read_b64_tr_b16 v[68:69], v19 offset:0
    ds_read_b64_tr_b16 v[70:71], v19 offset:2048
    ds_read_b64_tr_b16 v[72:73], v20 offset:0
    ds_read_b64_tr_b16 v[74:75], v20 offset:2048
    ds_read_b64_tr_b16 v[76:77], v21 offset:0
    ds_read_b64_tr_b16 v[78:79], v21 offset:2048
    ds_read_b128 v[36:39], v14 offset:2048
    ds_read_b128 v[40:43], v14 offset:4096
    ds_read_b128 v[44:47], v14 offset:6144
    ds_read_b128 v[48:51], v14 offset:16384
    ds_read_b128 v[52:55], v14 offset:18432
    ds_read_b128 v[56:59], v14 offset:20480
    ds_read_b128 v[60:63], v14 offset:22528
    s_cmp_eq_u32 s57, 0
    s_cbranch_scc0 parallel_sum__compressed_kv_cla__mixer_gmlp__prompt_kernel_kv_v
    s_waitcnt vmcnt(6) lgkmcnt(0)
    s_barrier
    v_mfma_f32_16x16x32_bf16 v[128:131], v[64:67], v[32:35], 0
    ds_read_b128 v[80:83], v15 offset:0
    buffer_store_dwordx4 v[22:25], v3, s[4:7], s45 offen sc1
    v_mfma_f32_16x16x32_bf16 v[132:135], v[68:71], v[32:35], 0
    ds_read_b64_tr_b16 v[112:113], v18 offset:16384
    v_mfma_f32_16x16x32_bf16 v[136:139], v[72:75], v[32:35], 0
    ds_read_b64_tr_b16 v[114:115], v18 offset:18432
    v_mfma_f32_16x16x32_bf16 v[140:143], v[76:79], v[32:35], 0
    ds_read_b64_tr_b16 v[116:117], v19 offset:16384
    v_mfma_f32_16x16x32_bf16 v[144:147], v[64:67], v[36:39], 0
    ds_read_b64_tr_b16 v[118:119], v19 offset:18432
    v_mfma_f32_16x16x32_bf16 v[148:151], v[68:71], v[36:39], 0
    ds_read_b64_tr_b16 v[120:121], v20 offset:16384
    v_mfma_f32_16x16x32_bf16 v[152:155], v[72:75], v[36:39], 0
    ds_read_b64_tr_b16 v[122:123], v20 offset:18432
    v_mfma_f32_16x16x32_bf16 v[156:159], v[76:79], v[36:39], 0
    ds_read_b64_tr_b16 v[124:125], v21 offset:16384
    v_mfma_f32_16x16x32_bf16 v[160:163], v[64:67], v[40:43], 0
    ds_read_b64_tr_b16 v[126:127], v21 offset:18432
    s_add_u32 m0, s48, 147456
    s_add_u32 s12, s55, 786432
    buffer_load_dwordx4 v30, s[20:23], s12 offen lds
    v_mfma_f32_16x16x32_bf16 v[164:167], v[68:71], v[40:43], 0
    ds_read_b128 v[84:87], v15 offset:2048
    v_mfma_f32_16x16x32_bf16 v[168:171], v[72:75], v[40:43], 0
    ds_read_b128 v[88:91], v15 offset:4096
    s_add_u32 m0, s48, 148480
    s_add_u32 s12, s55, 802816
    buffer_load_dwordx4 v31, s[20:23], s12 offen lds
    v_mfma_f32_16x16x32_bf16 v[172:175], v[76:79], v[40:43], 0
    ds_read_b128 v[92:95], v15 offset:6144
    v_mfma_f32_16x16x32_bf16 v[176:179], v[64:67], v[44:47], 0
    ds_read_b128 v[96:99], v15 offset:16384
    s_add_u32 m0, s56, 65536
    s_add_u32 s12, s54, 256
    buffer_load_dwordx4 v10, s[16:19], s12 offen lds
    v_mfma_f32_16x16x32_bf16 v[180:183], v[68:71], v[44:47], 0
    ds_read_b128 v[100:103], v15 offset:18432
    v_mfma_f32_16x16x32_bf16 v[184:187], v[72:75], v[44:47], 0
    ds_read_b128 v[104:107], v15 offset:20480
    s_add_u32 m0, s56, 66560
    s_add_u32 s12, s54, 8448
    buffer_load_dwordx4 v11, s[16:19], s12 offen lds
    v_mfma_f32_16x16x32_bf16 v[188:191], v[76:79], v[44:47], 0
    ds_read_b128 v[108:111], v15 offset:22528
    v_mfma_f32_16x16x32_bf16 v[192:195], v[64:67], v[48:51], 0
    s_add_u32 m0, s56, 67584
    s_add_u32 s12, s54, 16640
    buffer_load_dwordx4 v10, s[16:19], s12 offen lds
    v_mfma_f32_16x16x32_bf16 v[196:199], v[68:71], v[48:51], 0
    v_mfma_f32_16x16x32_bf16 v[200:203], v[72:75], v[48:51], 0
    s_add_u32 m0, s56, 68608
    s_add_u32 s12, s54, 24832
    buffer_load_dwordx4 v11, s[16:19], s12 offen lds
    v_mfma_f32_16x16x32_bf16 v[204:207], v[76:79], v[48:51], 0
    v_mfma_f32_16x16x32_bf16 v[208:211], v[64:67], v[52:55], 0
    s_add_u32 m0, s48, 98304
    s_add_u32 s12, s55, 1048576
    buffer_load_dwordx4 v30, s[20:23], s12 offen lds
    v_mfma_f32_16x16x32_bf16 v[212:215], v[68:71], v[52:55], 0
    v_mfma_f32_16x16x32_bf16 v[216:219], v[72:75], v[52:55], 0
    s_add_u32 m0, s48, 99328
    s_add_u32 s12, s55, 1064960
    buffer_load_dwordx4 v31, s[20:23], s12 offen lds
    v_mfma_f32_16x16x32_bf16 v[220:223], v[76:79], v[52:55], 0
    v_mfma_f32_16x16x32_bf16 v[224:227], v[64:67], v[56:59], 0
    v_mfma_f32_16x16x32_bf16 v[228:231], v[68:71], v[56:59], 0
    v_mfma_f32_16x16x32_bf16 v[232:235], v[72:75], v[56:59], 0
    v_mfma_f32_16x16x32_bf16 v[236:239], v[76:79], v[56:59], 0
    v_mfma_f32_16x16x32_bf16 v[240:243], v[64:67], v[60:63], 0
    v_mfma_f32_16x16x32_bf16 v[244:247], v[68:71], v[60:63], 0
    v_mfma_f32_16x16x32_bf16 v[248:251], v[72:75], v[60:63], 0
    v_mfma_f32_16x16x32_bf16 v[252:255], v[76:79], v[60:63], 0
    s_waitcnt vmcnt(9) lgkmcnt(0)
    s_barrier
    v_mfma_f32_16x16x32_bf16 v[128:131], v[112:115], v[80:83], v[128:131]
    ds_read_b128 v[32:35], v14 offset:32768
    v_mfma_f32_16x16x32_bf16 v[132:135], v[116:119], v[80:83], v[132:135]
    ds_read_b64_tr_b16 v[64:65], v18 offset:32768
    v_mfma_f32_16x16x32_bf16 v[136:139], v[120:123], v[80:83], v[136:139]
    ds_read_b64_tr_b16 v[66:67], v18 offset:34816
    v_mfma_f32_16x16x32_bf16 v[140:143], v[124:127], v[80:83], v[140:143]
    ds_read_b64_tr_b16 v[68:69], v19 offset:32768
    v_mfma_f32_16x16x32_bf16 v[144:147], v[112:115], v[84:87], v[144:147]
    ds_read_b64_tr_b16 v[70:71], v19 offset:34816
    v_mfma_f32_16x16x32_bf16 v[148:151], v[116:119], v[84:87], v[148:151]
    ds_read_b64_tr_b16 v[72:73], v20 offset:32768
    v_mfma_f32_16x16x32_bf16 v[152:155], v[120:123], v[84:87], v[152:155]
    ds_read_b64_tr_b16 v[74:75], v20 offset:34816
    v_mfma_f32_16x16x32_bf16 v[156:159], v[124:127], v[84:87], v[156:159]
    ds_read_b64_tr_b16 v[76:77], v21 offset:32768
    v_mfma_f32_16x16x32_bf16 v[160:163], v[112:115], v[88:91], v[160:163]
    ds_read_b64_tr_b16 v[78:79], v21 offset:34816
    v_mfma_f32_16x16x32_bf16 v[164:167], v[116:119], v[88:91], v[164:167]
    ds_read_b128 v[36:39], v14 offset:34816
    v_mfma_f32_16x16x32_bf16 v[168:171], v[120:123], v[88:91], v[168:171]
    ds_read_b128 v[40:43], v14 offset:36864
    v_mfma_f32_16x16x32_bf16 v[172:175], v[124:127], v[88:91], v[172:175]
    ds_read_b128 v[44:47], v14 offset:38912
    v_mfma_f32_16x16x32_bf16 v[176:179], v[112:115], v[92:95], v[176:179]
    ds_read_b128 v[48:51], v14 offset:49152
    v_mfma_f32_16x16x32_bf16 v[180:183], v[116:119], v[92:95], v[180:183]
    ds_read_b128 v[52:55], v14 offset:51200
    v_mfma_f32_16x16x32_bf16 v[184:187], v[120:123], v[92:95], v[184:187]
    ds_read_b128 v[56:59], v14 offset:53248
    v_mfma_f32_16x16x32_bf16 v[188:191], v[124:127], v[92:95], v[188:191]
    ds_read_b128 v[60:63], v14 offset:55296
    v_mfma_f32_16x16x32_bf16 v[192:195], v[112:115], v[96:99], v[192:195]
    s_add_u32 m0, s48, 114688
    s_add_u32 s12, s55, 1310720
    buffer_load_dwordx4 v30, s[20:23], s12 offen lds
    v_mfma_f32_16x16x32_bf16 v[196:199], v[116:119], v[96:99], v[196:199]
    v_mfma_f32_16x16x32_bf16 v[200:203], v[120:123], v[96:99], v[200:203]
    s_add_u32 m0, s48, 115712
    s_add_u32 s12, s55, 1327104
    buffer_load_dwordx4 v31, s[20:23], s12 offen lds
    v_mfma_f32_16x16x32_bf16 v[204:207], v[124:127], v[96:99], v[204:207]
    v_mfma_f32_16x16x32_bf16 v[208:211], v[112:115], v[100:103], v[208:211]
    s_add_u32 m0, s56, 0
    s_add_u32 s12, s54, 384
    buffer_load_dwordx4 v10, s[16:19], s12 offen lds
    v_mfma_f32_16x16x32_bf16 v[212:215], v[116:119], v[100:103], v[212:215]
    v_mfma_f32_16x16x32_bf16 v[216:219], v[120:123], v[100:103], v[216:219]
    s_add_u32 m0, s56, 1024
    s_add_u32 s12, s54, 8576
    buffer_load_dwordx4 v11, s[16:19], s12 offen lds
    v_mfma_f32_16x16x32_bf16 v[220:223], v[124:127], v[100:103], v[220:223]
    v_mfma_f32_16x16x32_bf16 v[224:227], v[112:115], v[104:107], v[224:227]
    v_mfma_f32_16x16x32_bf16 v[228:231], v[116:119], v[104:107], v[228:231]
    v_mfma_f32_16x16x32_bf16 v[232:235], v[120:123], v[104:107], v[232:235]
    v_mfma_f32_16x16x32_bf16 v[236:239], v[124:127], v[104:107], v[236:239]
    v_mfma_f32_16x16x32_bf16 v[240:243], v[112:115], v[108:111], v[240:243]
    v_mfma_f32_16x16x32_bf16 v[244:247], v[116:119], v[108:111], v[244:247]
    v_mfma_f32_16x16x32_bf16 v[248:251], v[120:123], v[108:111], v[248:251]
    v_mfma_f32_16x16x32_bf16 v[252:255], v[124:127], v[108:111], v[252:255]
    s_waitcnt vmcnt(10) lgkmcnt(0)
    s_barrier
    v_mfma_f32_16x16x32_bf16 v[128:131], v[64:67], v[32:35], v[128:131]
    ds_read_b128 v[80:83], v15 offset:32768
    v_mfma_f32_16x16x32_bf16 v[132:135], v[68:71], v[32:35], v[132:135]
    ds_read_b64_tr_b16 v[112:113], v18 offset:49152
    v_mfma_f32_16x16x32_bf16 v[136:139], v[72:75], v[32:35], v[136:139]
    ds_read_b64_tr_b16 v[114:115], v18 offset:51200
    v_mfma_f32_16x16x32_bf16 v[140:143], v[76:79], v[32:35], v[140:143]
    ds_read_b64_tr_b16 v[116:117], v19 offset:49152
    v_mfma_f32_16x16x32_bf16 v[144:147], v[64:67], v[36:39], v[144:147]
    ds_read_b64_tr_b16 v[118:119], v19 offset:51200
    v_mfma_f32_16x16x32_bf16 v[148:151], v[68:71], v[36:39], v[148:151]
    ds_read_b64_tr_b16 v[120:121], v20 offset:49152
    v_mfma_f32_16x16x32_bf16 v[152:155], v[72:75], v[36:39], v[152:155]
    ds_read_b64_tr_b16 v[122:123], v20 offset:51200
    v_mfma_f32_16x16x32_bf16 v[156:159], v[76:79], v[36:39], v[156:159]
    ds_read_b64_tr_b16 v[124:125], v21 offset:49152
    v_mfma_f32_16x16x32_bf16 v[160:163], v[64:67], v[40:43], v[160:163]
    ds_read_b64_tr_b16 v[126:127], v21 offset:51200
    v_mfma_f32_16x16x32_bf16 v[164:167], v[68:71], v[40:43], v[164:167]
    ds_read_b128 v[84:87], v15 offset:34816
    v_mfma_f32_16x16x32_bf16 v[168:171], v[72:75], v[40:43], v[168:171]
    ds_read_b128 v[88:91], v15 offset:36864
    v_mfma_f32_16x16x32_bf16 v[172:175], v[76:79], v[40:43], v[172:175]
    ds_read_b128 v[92:95], v15 offset:38912
    v_mfma_f32_16x16x32_bf16 v[176:179], v[64:67], v[44:47], v[176:179]
    ds_read_b128 v[96:99], v15 offset:49152
    v_mfma_f32_16x16x32_bf16 v[180:183], v[68:71], v[44:47], v[180:183]
    ds_read_b128 v[100:103], v15 offset:51200
    v_mfma_f32_16x16x32_bf16 v[184:187], v[72:75], v[44:47], v[184:187]
    ds_read_b128 v[104:107], v15 offset:53248
    v_mfma_f32_16x16x32_bf16 v[188:191], v[76:79], v[44:47], v[188:191]
    ds_read_b128 v[108:111], v15 offset:55296
    v_mfma_f32_16x16x32_bf16 v[192:195], v[64:67], v[48:51], v[192:195]
    s_add_u32 m0, s48, 131072
    s_add_u32 s12, s55, 1572864
    buffer_load_dwordx4 v30, s[20:23], s12 offen lds
    v_mfma_f32_16x16x32_bf16 v[196:199], v[68:71], v[48:51], v[196:199]
    v_mfma_f32_16x16x32_bf16 v[200:203], v[72:75], v[48:51], v[200:203]
    s_add_u32 m0, s48, 132096
    s_add_u32 s12, s55, 1589248
    buffer_load_dwordx4 v31, s[20:23], s12 offen lds
    v_mfma_f32_16x16x32_bf16 v[204:207], v[76:79], v[48:51], v[204:207]
    v_mfma_f32_16x16x32_bf16 v[208:211], v[64:67], v[52:55], v[208:211]
    s_add_u32 m0, s56, 2048
    s_add_u32 s12, s54, 16768
    buffer_load_dwordx4 v10, s[16:19], s12 offen lds
    v_mfma_f32_16x16x32_bf16 v[212:215], v[68:71], v[52:55], v[212:215]
    v_mfma_f32_16x16x32_bf16 v[216:219], v[72:75], v[52:55], v[216:219]
    s_add_u32 m0, s56, 3072
    s_add_u32 s12, s54, 24960
    buffer_load_dwordx4 v11, s[16:19], s12 offen lds
    v_mfma_f32_16x16x32_bf16 v[220:223], v[76:79], v[52:55], v[220:223]
    v_mfma_f32_16x16x32_bf16 v[224:227], v[64:67], v[56:59], v[224:227]
    s_or_b32 s12, s2, s3
    s_cbranch_scc1 flag_1
    v_mov_b32 v8, 0
    v_mov_b32 v9, 1
    buffer_store_dword v9, v8, s[28:31], 0 offen sc1
flag_1:
    v_mfma_f32_16x16x32_bf16 v[228:231], v[68:71], v[56:59], v[228:231]
    v_mfma_f32_16x16x32_bf16 v[232:235], v[72:75], v[56:59], v[232:235]
    v_mfma_f32_16x16x32_bf16 v[236:239], v[76:79], v[56:59], v[236:239]
    v_mfma_f32_16x16x32_bf16 v[240:243], v[64:67], v[60:63], v[240:243]
    v_mfma_f32_16x16x32_bf16 v[244:247], v[68:71], v[60:63], v[244:247]
    v_mfma_f32_16x16x32_bf16 v[248:251], v[72:75], v[60:63], v[248:251]
    v_mfma_f32_16x16x32_bf16 v[252:255], v[76:79], v[60:63], v[252:255]
    s_waitcnt vmcnt(8) lgkmcnt(0)
    s_barrier
    v_mfma_f32_16x16x32_bf16 v[128:131], v[112:115], v[80:83], v[128:131]
    ds_read_b128 v[32:35], v16 offset:0
    v_mfma_f32_16x16x32_bf16 v[132:135], v[116:119], v[80:83], v[132:135]
    ds_read_b64_tr_b16 v[64:65], v18 offset:0
    v_mfma_f32_16x16x32_bf16 v[136:139], v[120:123], v[80:83], v[136:139]
    ds_read_b64_tr_b16 v[66:67], v18 offset:2048
    v_mfma_f32_16x16x32_bf16 v[140:143], v[124:127], v[80:83], v[140:143]
    ds_read_b64_tr_b16 v[68:69], v19 offset:0
    v_mfma_f32_16x16x32_bf16 v[144:147], v[112:115], v[84:87], v[144:147]
    ds_read_b64_tr_b16 v[70:71], v19 offset:2048
    v_mfma_f32_16x16x32_bf16 v[148:151], v[116:119], v[84:87], v[148:151]
    ds_read_b64_tr_b16 v[72:73], v20 offset:0
    v_mfma_f32_16x16x32_bf16 v[152:155], v[120:123], v[84:87], v[152:155]
    ds_read_b64_tr_b16 v[74:75], v20 offset:2048
    v_mfma_f32_16x16x32_bf16 v[156:159], v[124:127], v[84:87], v[156:159]
    ds_read_b64_tr_b16 v[76:77], v21 offset:0
    v_mfma_f32_16x16x32_bf16 v[160:163], v[112:115], v[88:91], v[160:163]
    ds_read_b64_tr_b16 v[78:79], v21 offset:2048
    v_mfma_f32_16x16x32_bf16 v[164:167], v[116:119], v[88:91], v[164:167]
    ds_read_b128 v[36:39], v16 offset:2048
    v_mfma_f32_16x16x32_bf16 v[168:171], v[120:123], v[88:91], v[168:171]
    ds_read_b128 v[40:43], v16 offset:4096
    v_mfma_f32_16x16x32_bf16 v[172:175], v[124:127], v[88:91], v[172:175]
    ds_read_b128 v[44:47], v16 offset:6144
    v_mfma_f32_16x16x32_bf16 v[176:179], v[112:115], v[92:95], v[176:179]
    ds_read_b128 v[48:51], v16 offset:16384
    v_mfma_f32_16x16x32_bf16 v[180:183], v[116:119], v[92:95], v[180:183]
    ds_read_b128 v[52:55], v16 offset:18432
    v_mfma_f32_16x16x32_bf16 v[184:187], v[120:123], v[92:95], v[184:187]
    ds_read_b128 v[56:59], v16 offset:20480
    v_mfma_f32_16x16x32_bf16 v[188:191], v[124:127], v[92:95], v[188:191]
    ds_read_b128 v[60:63], v16 offset:22528
    v_mfma_f32_16x16x32_bf16 v[192:195], v[112:115], v[96:99], v[192:195]
    s_add_u32 m0, s48, 147456
    s_add_u32 s12, s55, 1835008
    buffer_load_dwordx4 v30, s[20:23], s12 offen lds
    v_mfma_f32_16x16x32_bf16 v[196:199], v[116:119], v[96:99], v[196:199]
    v_mfma_f32_16x16x32_bf16 v[200:203], v[120:123], v[96:99], v[200:203]
    s_add_u32 m0, s48, 148480
    s_add_u32 s12, s55, 1851392
    buffer_load_dwordx4 v31, s[20:23], s12 offen lds
    v_mfma_f32_16x16x32_bf16 v[204:207], v[124:127], v[96:99], v[204:207]
    v_mfma_f32_16x16x32_bf16 v[208:211], v[112:115], v[100:103], v[208:211]
    s_add_u32 m0, s56, 32768
    s_add_u32 s12, s54, 512
    buffer_load_dwordx4 v10, s[16:19], s12 offen lds
    v_mfma_f32_16x16x32_bf16 v[212:215], v[116:119], v[100:103], v[212:215]
    v_mfma_f32_16x16x32_bf16 v[216:219], v[120:123], v[100:103], v[216:219]
    s_add_u32 m0, s56, 33792
    s_add_u32 s12, s54, 8704
    buffer_load_dwordx4 v11, s[16:19], s12 offen lds
    v_mfma_f32_16x16x32_bf16 v[220:223], v[124:127], v[100:103], v[220:223]
    v_mfma_f32_16x16x32_bf16 v[224:227], v[112:115], v[104:107], v[224:227]
    s_cmp_ge_u32 s3, 3
    s_cbranch_scc1 warm_2
    buffer_load_dword v28, v29, s[8:11], s51 offen
warm_2:
    v_mfma_f32_16x16x32_bf16 v[228:231], v[116:119], v[104:107], v[228:231]
    v_mfma_f32_16x16x32_bf16 v[232:235], v[120:123], v[104:107], v[232:235]
    v_mfma_f32_16x16x32_bf16 v[236:239], v[124:127], v[104:107], v[236:239]
    v_mfma_f32_16x16x32_bf16 v[240:243], v[112:115], v[108:111], v[240:243]
    v_mfma_f32_16x16x32_bf16 v[244:247], v[116:119], v[108:111], v[244:247]
    v_mfma_f32_16x16x32_bf16 v[248:251], v[120:123], v[108:111], v[248:251]
    v_mfma_f32_16x16x32_bf16 v[252:255], v[124:127], v[108:111], v[252:255]
    s_waitcnt vmcnt(10) lgkmcnt(0)
    s_barrier
    v_mfma_f32_16x16x32_bf16 v[128:131], v[64:67], v[32:35], v[128:131]
    ds_read_b128 v[80:83], v17 offset:0
    v_mfma_f32_16x16x32_bf16 v[132:135], v[68:71], v[32:35], v[132:135]
    ds_read_b64_tr_b16 v[112:113], v18 offset:16384
    v_mfma_f32_16x16x32_bf16 v[136:139], v[72:75], v[32:35], v[136:139]
    ds_read_b64_tr_b16 v[114:115], v18 offset:18432
    v_mfma_f32_16x16x32_bf16 v[140:143], v[76:79], v[32:35], v[140:143]
    ds_read_b64_tr_b16 v[116:117], v19 offset:16384
    v_mfma_f32_16x16x32_bf16 v[144:147], v[64:67], v[36:39], v[144:147]
    ds_read_b64_tr_b16 v[118:119], v19 offset:18432
    v_mfma_f32_16x16x32_bf16 v[148:151], v[68:71], v[36:39], v[148:151]
    ds_read_b64_tr_b16 v[120:121], v20 offset:16384
    v_mfma_f32_16x16x32_bf16 v[152:155], v[72:75], v[36:39], v[152:155]
    ds_read_b64_tr_b16 v[122:123], v20 offset:18432
    v_mfma_f32_16x16x32_bf16 v[156:159], v[76:79], v[36:39], v[156:159]
    ds_read_b64_tr_b16 v[124:125], v21 offset:16384
    v_mfma_f32_16x16x32_bf16 v[160:163], v[64:67], v[40:43], v[160:163]
    ds_read_b64_tr_b16 v[126:127], v21 offset:18432
    v_mfma_f32_16x16x32_bf16 v[164:167], v[68:71], v[40:43], v[164:167]
    ds_read_b128 v[84:87], v17 offset:2048
    v_mfma_f32_16x16x32_bf16 v[168:171], v[72:75], v[40:43], v[168:171]
    ds_read_b128 v[88:91], v17 offset:4096
    v_mfma_f32_16x16x32_bf16 v[172:175], v[76:79], v[40:43], v[172:175]
    ds_read_b128 v[92:95], v17 offset:6144
    v_mfma_f32_16x16x32_bf16 v[176:179], v[64:67], v[44:47], v[176:179]
    ds_read_b128 v[96:99], v17 offset:16384
    v_mfma_f32_16x16x32_bf16 v[180:183], v[68:71], v[44:47], v[180:183]
    ds_read_b128 v[100:103], v17 offset:18432
    v_mfma_f32_16x16x32_bf16 v[184:187], v[72:75], v[44:47], v[184:187]
    ds_read_b128 v[104:107], v17 offset:20480
    v_mfma_f32_16x16x32_bf16 v[188:191], v[76:79], v[44:47], v[188:191]
    ds_read_b128 v[108:111], v17 offset:22528
    v_mfma_f32_16x16x32_bf16 v[192:195], v[64:67], v[48:51], v[192:195]
    s_add_u32 m0, s48, 98304
    s_add_u32 s12, s55, 2097152
    buffer_load_dwordx4 v30, s[20:23], s12 offen lds
    v_mfma_f32_16x16x32_bf16 v[196:199], v[68:71], v[48:51], v[196:199]
    v_mfma_f32_16x16x32_bf16 v[200:203], v[72:75], v[48:51], v[200:203]
    s_add_u32 m0, s48, 99328
    s_add_u32 s12, s55, 2113536
    buffer_load_dwordx4 v31, s[20:23], s12 offen lds
    v_mfma_f32_16x16x32_bf16 v[204:207], v[76:79], v[48:51], v[204:207]
    v_mfma_f32_16x16x32_bf16 v[208:211], v[64:67], v[52:55], v[208:211]
    s_add_u32 m0, s56, 34816
    s_add_u32 s12, s54, 16896
    buffer_load_dwordx4 v10, s[16:19], s12 offen lds
    v_mfma_f32_16x16x32_bf16 v[212:215], v[68:71], v[52:55], v[212:215]
    v_mfma_f32_16x16x32_bf16 v[216:219], v[72:75], v[52:55], v[216:219]
    s_add_u32 m0, s56, 35840
    s_add_u32 s12, s54, 25088
    buffer_load_dwordx4 v11, s[16:19], s12 offen lds
    v_mfma_f32_16x16x32_bf16 v[220:223], v[76:79], v[52:55], v[220:223]
    v_mfma_f32_16x16x32_bf16 v[224:227], v[64:67], v[56:59], v[224:227]
    v_mov_b32_e64 v8, 0
    buffer_load_dword v26, v8, s[28:31], 0 offen sc1
    v_mfma_f32_16x16x32_bf16 v[228:231], v[68:71], v[56:59], v[228:231]
    v_mfma_f32_16x16x32_bf16 v[232:235], v[72:75], v[56:59], v[232:235]
    v_mfma_f32_16x16x32_bf16 v[236:239], v[76:79], v[56:59], v[236:239]
    v_mfma_f32_16x16x32_bf16 v[240:243], v[64:67], v[60:63], v[240:243]
    v_mfma_f32_16x16x32_bf16 v[244:247], v[68:71], v[60:63], v[244:247]
    v_mfma_f32_16x16x32_bf16 v[248:251], v[72:75], v[60:63], v[248:251]
    v_mfma_f32_16x16x32_bf16 v[252:255], v[76:79], v[60:63], v[252:255]
    s_waitcnt vmcnt(9) lgkmcnt(0)
    s_barrier
    v_mfma_f32_16x16x32_bf16 v[128:131], v[112:115], v[80:83], v[128:131]
    ds_read_b128 v[32:35], v14 offset:0
    v_mfma_f32_16x16x32_bf16 v[132:135], v[116:119], v[80:83], v[132:135]
    ds_read_b64_tr_b16 v[64:65], v18 offset:32768
    v_mfma_f32_16x16x32_bf16 v[136:139], v[120:123], v[80:83], v[136:139]
    ds_read_b64_tr_b16 v[66:67], v18 offset:34816
    v_mfma_f32_16x16x32_bf16 v[140:143], v[124:127], v[80:83], v[140:143]
    ds_read_b64_tr_b16 v[68:69], v19 offset:32768
    v_mfma_f32_16x16x32_bf16 v[144:147], v[112:115], v[84:87], v[144:147]
    ds_read_b64_tr_b16 v[70:71], v19 offset:34816
    v_mfma_f32_16x16x32_bf16 v[148:151], v[116:119], v[84:87], v[148:151]
    ds_read_b64_tr_b16 v[72:73], v20 offset:32768
    v_mfma_f32_16x16x32_bf16 v[152:155], v[120:123], v[84:87], v[152:155]
    ds_read_b64_tr_b16 v[74:75], v20 offset:34816
    v_mfma_f32_16x16x32_bf16 v[156:159], v[124:127], v[84:87], v[156:159]
    ds_read_b64_tr_b16 v[76:77], v21 offset:32768
    v_mfma_f32_16x16x32_bf16 v[160:163], v[112:115], v[88:91], v[160:163]
    ds_read_b64_tr_b16 v[78:79], v21 offset:34816
    v_mfma_f32_16x16x32_bf16 v[164:167], v[116:119], v[88:91], v[164:167]
    ds_read_b128 v[36:39], v14 offset:2048
    v_mfma_f32_16x16x32_bf16 v[168:171], v[120:123], v[88:91], v[168:171]
    ds_read_b128 v[40:43], v14 offset:4096
    v_mfma_f32_16x16x32_bf16 v[172:175], v[124:127], v[88:91], v[172:175]
    ds_read_b128 v[44:47], v14 offset:6144
    v_mfma_f32_16x16x32_bf16 v[176:179], v[112:115], v[92:95], v[176:179]
    ds_read_b128 v[48:51], v14 offset:16384
    v_mfma_f32_16x16x32_bf16 v[180:183], v[116:119], v[92:95], v[180:183]
    ds_read_b128 v[52:55], v14 offset:18432
    v_mfma_f32_16x16x32_bf16 v[184:187], v[120:123], v[92:95], v[184:187]
    ds_read_b128 v[56:59], v14 offset:20480
    v_mfma_f32_16x16x32_bf16 v[188:191], v[124:127], v[92:95], v[188:191]
    ds_read_b128 v[60:63], v14 offset:22528
    v_mfma_f32_16x16x32_bf16 v[192:195], v[112:115], v[96:99], v[192:195]
    s_add_u32 m0, s48, 114688
    s_add_u32 s12, s55, 2359296
    buffer_load_dwordx4 v30, s[20:23], s12 offen lds
    v_mfma_f32_16x16x32_bf16 v[196:199], v[116:119], v[96:99], v[196:199]
    v_mfma_f32_16x16x32_bf16 v[200:203], v[120:123], v[96:99], v[200:203]
    s_add_u32 m0, s48, 115712
    s_add_u32 s12, s55, 2375680
    buffer_load_dwordx4 v31, s[20:23], s12 offen lds
    v_mfma_f32_16x16x32_bf16 v[204:207], v[124:127], v[96:99], v[204:207]
    v_mfma_f32_16x16x32_bf16 v[208:211], v[112:115], v[100:103], v[208:211]
    s_add_u32 m0, s56, 65536
    s_add_u32 s12, s54, 640
    buffer_load_dwordx4 v10, s[16:19], s12 offen lds
    v_mfma_f32_16x16x32_bf16 v[212:215], v[116:119], v[100:103], v[212:215]
    v_mfma_f32_16x16x32_bf16 v[216:219], v[120:123], v[100:103], v[216:219]
    s_add_u32 m0, s56, 66560
    s_add_u32 s12, s54, 8832
    buffer_load_dwordx4 v11, s[16:19], s12 offen lds
    v_mfma_f32_16x16x32_bf16 v[220:223], v[124:127], v[100:103], v[220:223]
    v_mfma_f32_16x16x32_bf16 v[224:227], v[112:115], v[104:107], v[224:227]
    v_mfma_f32_16x16x32_bf16 v[228:231], v[116:119], v[104:107], v[228:231]
    v_mfma_f32_16x16x32_bf16 v[232:235], v[120:123], v[104:107], v[232:235]
    v_mfma_f32_16x16x32_bf16 v[236:239], v[124:127], v[104:107], v[236:239]
    v_mfma_f32_16x16x32_bf16 v[240:243], v[112:115], v[108:111], v[240:243]
    v_mfma_f32_16x16x32_bf16 v[244:247], v[116:119], v[108:111], v[244:247]
    v_mfma_f32_16x16x32_bf16 v[248:251], v[120:123], v[108:111], v[248:251]
    v_mfma_f32_16x16x32_bf16 v[252:255], v[124:127], v[108:111], v[252:255]
    s_waitcnt vmcnt(11) lgkmcnt(0)
    s_barrier
    v_mfma_f32_16x16x32_bf16 v[128:131], v[64:67], v[32:35], v[128:131]
    ds_read_b128 v[80:83], v15 offset:0
    v_mfma_f32_16x16x32_bf16 v[132:135], v[68:71], v[32:35], v[132:135]
    ds_read_b64_tr_b16 v[112:113], v18 offset:49152
    v_mfma_f32_16x16x32_bf16 v[136:139], v[72:75], v[32:35], v[136:139]
    ds_read_b64_tr_b16 v[114:115], v18 offset:51200
    v_mfma_f32_16x16x32_bf16 v[140:143], v[76:79], v[32:35], v[140:143]
    ds_read_b64_tr_b16 v[116:117], v19 offset:49152
    v_mfma_f32_16x16x32_bf16 v[144:147], v[64:67], v[36:39], v[144:147]
    ds_read_b64_tr_b16 v[118:119], v19 offset:51200
    v_mfma_f32_16x16x32_bf16 v[148:151], v[68:71], v[36:39], v[148:151]
    ds_read_b64_tr_b16 v[120:121], v20 offset:49152
    v_mfma_f32_16x16x32_bf16 v[152:155], v[72:75], v[36:39], v[152:155]
    ds_read_b64_tr_b16 v[122:123], v20 offset:51200
    v_mfma_f32_16x16x32_bf16 v[156:159], v[76:79], v[36:39], v[156:159]
    ds_read_b64_tr_b16 v[124:125], v21 offset:49152
    v_mfma_f32_16x16x32_bf16 v[160:163], v[64:67], v[40:43], v[160:163]
    ds_read_b64_tr_b16 v[126:127], v21 offset:51200
    v_mfma_f32_16x16x32_bf16 v[164:167], v[68:71], v[40:43], v[164:167]
    ds_read_b128 v[84:87], v15 offset:2048
    v_mfma_f32_16x16x32_bf16 v[168:171], v[72:75], v[40:43], v[168:171]
    ds_read_b128 v[88:91], v15 offset:4096
    v_mfma_f32_16x16x32_bf16 v[172:175], v[76:79], v[40:43], v[172:175]
    ds_read_b128 v[92:95], v15 offset:6144
    v_mfma_f32_16x16x32_bf16 v[176:179], v[64:67], v[44:47], v[176:179]
    ds_read_b128 v[96:99], v15 offset:16384
    v_mfma_f32_16x16x32_bf16 v[180:183], v[68:71], v[44:47], v[180:183]
    ds_read_b128 v[100:103], v15 offset:18432
    v_mfma_f32_16x16x32_bf16 v[184:187], v[72:75], v[44:47], v[184:187]
    ds_read_b128 v[104:107], v15 offset:20480
    v_mfma_f32_16x16x32_bf16 v[188:191], v[76:79], v[44:47], v[188:191]
    ds_read_b128 v[108:111], v15 offset:22528
    v_mfma_f32_16x16x32_bf16 v[192:195], v[64:67], v[48:51], v[192:195]
    s_add_u32 m0, s48, 131072
    s_add_u32 s12, s55, 2621440
    buffer_load_dwordx4 v30, s[20:23], s12 offen lds
    v_mfma_f32_16x16x32_bf16 v[196:199], v[68:71], v[48:51], v[196:199]
    v_mfma_f32_16x16x32_bf16 v[200:203], v[72:75], v[48:51], v[200:203]
    s_add_u32 m0, s48, 132096
    s_add_u32 s12, s55, 2637824
    buffer_load_dwordx4 v31, s[20:23], s12 offen lds
    v_mfma_f32_16x16x32_bf16 v[204:207], v[76:79], v[48:51], v[204:207]
    v_mfma_f32_16x16x32_bf16 v[208:211], v[64:67], v[52:55], v[208:211]
    s_add_u32 m0, s56, 67584
    s_add_u32 s12, s54, 17024
    buffer_load_dwordx4 v10, s[16:19], s12 offen lds
    v_mfma_f32_16x16x32_bf16 v[212:215], v[68:71], v[52:55], v[212:215]
    v_mfma_f32_16x16x32_bf16 v[216:219], v[72:75], v[52:55], v[216:219]
    s_add_u32 m0, s56, 68608
    s_add_u32 s12, s54, 25216
    buffer_load_dwordx4 v11, s[16:19], s12 offen lds
    v_mfma_f32_16x16x32_bf16 v[220:223], v[76:79], v[52:55], v[220:223]
    v_mfma_f32_16x16x32_bf16 v[224:227], v[64:67], v[56:59], v[224:227]
    v_mfma_f32_16x16x32_bf16 v[228:231], v[68:71], v[56:59], v[228:231]
    v_mfma_f32_16x16x32_bf16 v[232:235], v[72:75], v[56:59], v[232:235]
    v_mfma_f32_16x16x32_bf16 v[236:239], v[76:79], v[56:59], v[236:239]
    v_mfma_f32_16x16x32_bf16 v[240:243], v[64:67], v[60:63], v[240:243]
    v_mfma_f32_16x16x32_bf16 v[244:247], v[68:71], v[60:63], v[244:247]
    v_mfma_f32_16x16x32_bf16 v[248:251], v[72:75], v[60:63], v[248:251]
    v_mfma_f32_16x16x32_bf16 v[252:255], v[76:79], v[60:63], v[252:255]
    s_waitcnt vmcnt(9) lgkmcnt(0)
    s_barrier
    v_mfma_f32_16x16x32_bf16 v[128:131], v[112:115], v[80:83], v[128:131]
    ds_read_b128 v[32:35], v14 offset:32768
    v_mfma_f32_16x16x32_bf16 v[132:135], v[116:119], v[80:83], v[132:135]
    ds_read_b64_tr_b16 v[64:65], v18 offset:0
    v_mfma_f32_16x16x32_bf16 v[136:139], v[120:123], v[80:83], v[136:139]
    ds_read_b64_tr_b16 v[66:67], v18 offset:2048
    v_mfma_f32_16x16x32_bf16 v[140:143], v[124:127], v[80:83], v[140:143]
    ds_read_b64_tr_b16 v[68:69], v19 offset:0
    v_mfma_f32_16x16x32_bf16 v[144:147], v[112:115], v[84:87], v[144:147]
    ds_read_b64_tr_b16 v[70:71], v19 offset:2048
    v_mfma_f32_16x16x32_bf16 v[148:151], v[116:119], v[84:87], v[148:151]
    ds_read_b64_tr_b16 v[72:73], v20 offset:0
    v_mfma_f32_16x16x32_bf16 v[152:155], v[120:123], v[84:87], v[152:155]
    ds_read_b64_tr_b16 v[74:75], v20 offset:2048
    v_mfma_f32_16x16x32_bf16 v[156:159], v[124:127], v[84:87], v[156:159]
    ds_read_b64_tr_b16 v[76:77], v21 offset:0
    v_mfma_f32_16x16x32_bf16 v[160:163], v[112:115], v[88:91], v[160:163]
    ds_read_b64_tr_b16 v[78:79], v21 offset:2048
    v_mfma_f32_16x16x32_bf16 v[164:167], v[116:119], v[88:91], v[164:167]
    ds_read_b128 v[36:39], v14 offset:34816
    v_mfma_f32_16x16x32_bf16 v[168:171], v[120:123], v[88:91], v[168:171]
    ds_read_b128 v[40:43], v14 offset:36864
    v_mfma_f32_16x16x32_bf16 v[172:175], v[124:127], v[88:91], v[172:175]
    ds_read_b128 v[44:47], v14 offset:38912
    v_mfma_f32_16x16x32_bf16 v[176:179], v[112:115], v[92:95], v[176:179]
    ds_read_b128 v[48:51], v14 offset:49152
    v_mfma_f32_16x16x32_bf16 v[180:183], v[116:119], v[92:95], v[180:183]
    ds_read_b128 v[52:55], v14 offset:51200
    v_mfma_f32_16x16x32_bf16 v[184:187], v[120:123], v[92:95], v[184:187]
    ds_read_b128 v[56:59], v14 offset:53248
    v_mfma_f32_16x16x32_bf16 v[188:191], v[124:127], v[92:95], v[188:191]
    ds_read_b128 v[60:63], v14 offset:55296
    v_mfma_f32_16x16x32_bf16 v[192:195], v[112:115], v[96:99], v[192:195]
    s_add_u32 m0, s48, 147456
    s_add_u32 s12, s55, 2883584
    buffer_load_dwordx4 v30, s[20:23], s12 offen lds
    v_mfma_f32_16x16x32_bf16 v[196:199], v[116:119], v[96:99], v[196:199]
    v_mfma_f32_16x16x32_bf16 v[200:203], v[120:123], v[96:99], v[200:203]
    s_add_u32 m0, s48, 148480
    s_add_u32 s12, s55, 2899968
    buffer_load_dwordx4 v31, s[20:23], s12 offen lds
    v_mfma_f32_16x16x32_bf16 v[204:207], v[124:127], v[96:99], v[204:207]
    v_mfma_f32_16x16x32_bf16 v[208:211], v[112:115], v[100:103], v[208:211]
    s_add_u32 m0, s56, 0
    s_add_u32 s12, s54, 768
    buffer_load_dwordx4 v10, s[16:19], s12 offen lds
    v_mfma_f32_16x16x32_bf16 v[212:215], v[116:119], v[100:103], v[212:215]
    v_mfma_f32_16x16x32_bf16 v[216:219], v[120:123], v[100:103], v[216:219]
    s_add_u32 m0, s56, 1024
    s_add_u32 s12, s54, 8960
    buffer_load_dwordx4 v11, s[16:19], s12 offen lds
    v_mfma_f32_16x16x32_bf16 v[220:223], v[124:127], v[100:103], v[220:223]
    v_mfma_f32_16x16x32_bf16 v[224:227], v[112:115], v[104:107], v[224:227]
    v_mfma_f32_16x16x32_bf16 v[228:231], v[116:119], v[104:107], v[228:231]
    v_mfma_f32_16x16x32_bf16 v[232:235], v[120:123], v[104:107], v[232:235]
    v_mfma_f32_16x16x32_bf16 v[236:239], v[124:127], v[104:107], v[236:239]
    v_mfma_f32_16x16x32_bf16 v[240:243], v[112:115], v[108:111], v[240:243]
    v_mfma_f32_16x16x32_bf16 v[244:247], v[116:119], v[108:111], v[244:247]
    v_mfma_f32_16x16x32_bf16 v[248:251], v[120:123], v[108:111], v[248:251]
    v_mfma_f32_16x16x32_bf16 v[252:255], v[124:127], v[108:111], v[252:255]
    s_waitcnt vmcnt(10) lgkmcnt(0)
    s_barrier
    s_cmp_lg_u32 s3, 0
    s_cbranch_scc1 initd_4
    s_mov_b32 s15, 0x20000
initw_3:
    v_cmp_eq_u32 vcc, 0, v26
    s_cbranch_vccz initd_4
    s_sleep 8
    v_mov_b32_e64 v8, 0
    buffer_load_dword v26, v8, s[28:31], 0 offen sc1
    s_waitcnt vmcnt(0)
    s_sub_u32 s15, s15, 1
    s_cmp_lg_u32 s15, 0
    s_cbranch_scc1 initw_3
initd_4:
    s_lshr_b32 s13, s2, 4
    s_cmp_lg_u32 s3, 0
    s_cbranch_scc1 sig_5
    s_lshl_b32 s14, s13, 8
    s_add_u32 s14, s14, 117440512
    v_mov_b32_e64 v8, 0
    v_mov_b32 v9, 1
    s_mov_b64 exec, 1
    buffer_atomic_add v9, v8, s[4:7], s14 offen sc1
    s_mov_b64 exec, -1
sig_5:
    v_mfma_f32_16x16x32_bf16 v[128:131], v[64:67], v[32:35], v[128:131]
    ds_read_b128 v[80:83], v15 offset:32768
    v_mfma_f32_16x16x32_bf16 v[132:135], v[68:71], v[32:35], v[132:135]
    ds_read_b64_tr_b16 v[112:113], v18 offset:16384
    v_mfma_f32_16x16x32_bf16 v[136:139], v[72:75], v[32:35], v[136:139]
    ds_read_b64_tr_b16 v[114:115], v18 offset:18432
    v_mfma_f32_16x16x32_bf16 v[140:143], v[76:79], v[32:35], v[140:143]
    ds_read_b64_tr_b16 v[116:117], v19 offset:16384
    v_mfma_f32_16x16x32_bf16 v[144:147], v[64:67], v[36:39], v[144:147]
    ds_read_b64_tr_b16 v[118:119], v19 offset:18432
    v_mfma_f32_16x16x32_bf16 v[148:151], v[68:71], v[36:39], v[148:151]
    ds_read_b64_tr_b16 v[120:121], v20 offset:16384
    v_mfma_f32_16x16x32_bf16 v[152:155], v[72:75], v[36:39], v[152:155]
    ds_read_b64_tr_b16 v[122:123], v20 offset:18432
    v_mfma_f32_16x16x32_bf16 v[156:159], v[76:79], v[36:39], v[156:159]
    ds_read_b64_tr_b16 v[124:125], v21 offset:16384
    v_mfma_f32_16x16x32_bf16 v[160:163], v[64:67], v[40:43], v[160:163]
    ds_read_b64_tr_b16 v[126:127], v21 offset:18432
    v_mfma_f32_16x16x32_bf16 v[164:167], v[68:71], v[40:43], v[164:167]
    ds_read_b128 v[84:87], v15 offset:34816
    v_mfma_f32_16x16x32_bf16 v[168:171], v[72:75], v[40:43], v[168:171]
    ds_read_b128 v[88:91], v15 offset:36864
    v_mfma_f32_16x16x32_bf16 v[172:175], v[76:79], v[40:43], v[172:175]
    ds_read_b128 v[92:95], v15 offset:38912
    v_mfma_f32_16x16x32_bf16 v[176:179], v[64:67], v[44:47], v[176:179]
    ds_read_b128 v[96:99], v15 offset:49152
    v_mfma_f32_16x16x32_bf16 v[180:183], v[68:71], v[44:47], v[180:183]
    ds_read_b128 v[100:103], v15 offset:51200
    v_mfma_f32_16x16x32_bf16 v[184:187], v[72:75], v[44:47], v[184:187]
    ds_read_b128 v[104:107], v15 offset:53248
    v_mfma_f32_16x16x32_bf16 v[188:191], v[76:79], v[44:47], v[188:191]
    ds_read_b128 v[108:111], v15 offset:55296
    v_mfma_f32_16x16x32_bf16 v[192:195], v[64:67], v[48:51], v[192:195]
    s_add_u32 m0, s48, 98304
    s_add_u32 s12, s55, 3145728
    buffer_load_dwordx4 v30, s[20:23], s12 offen lds
    v_mfma_f32_16x16x32_bf16 v[196:199], v[68:71], v[48:51], v[196:199]
    v_mfma_f32_16x16x32_bf16 v[200:203], v[72:75], v[48:51], v[200:203]
    s_add_u32 m0, s48, 99328
    s_add_u32 s12, s55, 3162112
    buffer_load_dwordx4 v31, s[20:23], s12 offen lds
    v_mfma_f32_16x16x32_bf16 v[204:207], v[76:79], v[48:51], v[204:207]
    v_mfma_f32_16x16x32_bf16 v[208:211], v[64:67], v[52:55], v[208:211]
    s_add_u32 m0, s56, 2048
    s_add_u32 s12, s54, 17152
    buffer_load_dwordx4 v10, s[16:19], s12 offen lds
    v_mfma_f32_16x16x32_bf16 v[212:215], v[68:71], v[52:55], v[212:215]
    v_mfma_f32_16x16x32_bf16 v[216:219], v[72:75], v[52:55], v[216:219]
    s_add_u32 m0, s56, 3072
    s_add_u32 s12, s54, 25344
    buffer_load_dwordx4 v11, s[16:19], s12 offen lds
    v_mfma_f32_16x16x32_bf16 v[220:223], v[76:79], v[52:55], v[220:223]
    v_mfma_f32_16x16x32_bf16 v[224:227], v[64:67], v[56:59], v[224:227]
    v_mfma_f32_16x16x32_bf16 v[228:231], v[68:71], v[56:59], v[228:231]
    v_mfma_f32_16x16x32_bf16 v[232:235], v[72:75], v[56:59], v[232:235]
    v_mfma_f32_16x16x32_bf16 v[236:239], v[76:79], v[56:59], v[236:239]
    v_mfma_f32_16x16x32_bf16 v[240:243], v[64:67], v[60:63], v[240:243]
    v_mfma_f32_16x16x32_bf16 v[244:247], v[68:71], v[60:63], v[244:247]
    v_mfma_f32_16x16x32_bf16 v[248:251], v[72:75], v[60:63], v[248:251]
    v_mfma_f32_16x16x32_bf16 v[252:255], v[76:79], v[60:63], v[252:255]
    s_waitcnt vmcnt(8) lgkmcnt(0)
    s_barrier
    v_mfma_f32_16x16x32_bf16 v[128:131], v[112:115], v[80:83], v[128:131]
    ds_read_b128 v[32:35], v16 offset:0
    v_mfma_f32_16x16x32_bf16 v[132:135], v[116:119], v[80:83], v[132:135]
    ds_read_b64_tr_b16 v[64:65], v18 offset:32768
    v_mfma_f32_16x16x32_bf16 v[136:139], v[120:123], v[80:83], v[136:139]
    ds_read_b64_tr_b16 v[66:67], v18 offset:34816
    v_mfma_f32_16x16x32_bf16 v[140:143], v[124:127], v[80:83], v[140:143]
    ds_read_b64_tr_b16 v[68:69], v19 offset:32768
    v_mfma_f32_16x16x32_bf16 v[144:147], v[112:115], v[84:87], v[144:147]
    ds_read_b64_tr_b16 v[70:71], v19 offset:34816
    v_mfma_f32_16x16x32_bf16 v[148:151], v[116:119], v[84:87], v[148:151]
    ds_read_b64_tr_b16 v[72:73], v20 offset:32768
    v_mfma_f32_16x16x32_bf16 v[152:155], v[120:123], v[84:87], v[152:155]
    ds_read_b64_tr_b16 v[74:75], v20 offset:34816
    v_mfma_f32_16x16x32_bf16 v[156:159], v[124:127], v[84:87], v[156:159]
    ds_read_b64_tr_b16 v[76:77], v21 offset:32768
    v_mfma_f32_16x16x32_bf16 v[160:163], v[112:115], v[88:91], v[160:163]
    ds_read_b64_tr_b16 v[78:79], v21 offset:34816
    v_mfma_f32_16x16x32_bf16 v[164:167], v[116:119], v[88:91], v[164:167]
    ds_read_b128 v[36:39], v16 offset:2048
    v_mfma_f32_16x16x32_bf16 v[168:171], v[120:123], v[88:91], v[168:171]
    ds_read_b128 v[40:43], v16 offset:4096
    v_mfma_f32_16x16x32_bf16 v[172:175], v[124:127], v[88:91], v[172:175]
    ds_read_b128 v[44:47], v16 offset:6144
    v_mfma_f32_16x16x32_bf16 v[176:179], v[112:115], v[92:95], v[176:179]
    ds_read_b128 v[48:51], v16 offset:16384
    v_mfma_f32_16x16x32_bf16 v[180:183], v[116:119], v[92:95], v[180:183]
    ds_read_b128 v[52:55], v16 offset:18432
    v_mfma_f32_16x16x32_bf16 v[184:187], v[120:123], v[92:95], v[184:187]
    ds_read_b128 v[56:59], v16 offset:20480
    v_mfma_f32_16x16x32_bf16 v[188:191], v[124:127], v[92:95], v[188:191]
    ds_read_b128 v[60:63], v16 offset:22528
    v_mfma_f32_16x16x32_bf16 v[192:195], v[112:115], v[96:99], v[192:195]
    s_add_u32 m0, s48, 114688
    s_add_u32 s12, s55, 3407872
    buffer_load_dwordx4 v30, s[20:23], s12 offen lds
    v_mfma_f32_16x16x32_bf16 v[196:199], v[116:119], v[96:99], v[196:199]
    v_mfma_f32_16x16x32_bf16 v[200:203], v[120:123], v[96:99], v[200:203]
    s_add_u32 m0, s48, 115712
    s_add_u32 s12, s55, 3424256
    buffer_load_dwordx4 v31, s[20:23], s12 offen lds
    v_mfma_f32_16x16x32_bf16 v[204:207], v[124:127], v[96:99], v[204:207]
    v_mfma_f32_16x16x32_bf16 v[208:211], v[112:115], v[100:103], v[208:211]
    s_add_u32 m0, s56, 32768
    s_add_u32 s12, s54, 896
    buffer_load_dwordx4 v10, s[16:19], s12 offen lds
    v_mfma_f32_16x16x32_bf16 v[212:215], v[116:119], v[100:103], v[212:215]
    v_mfma_f32_16x16x32_bf16 v[216:219], v[120:123], v[100:103], v[216:219]
    s_add_u32 m0, s56, 33792
    s_add_u32 s12, s54, 9088
    buffer_load_dwordx4 v11, s[16:19], s12 offen lds
    v_mfma_f32_16x16x32_bf16 v[220:223], v[124:127], v[100:103], v[220:223]
    v_mfma_f32_16x16x32_bf16 v[224:227], v[112:115], v[104:107], v[224:227]
    v_mfma_f32_16x16x32_bf16 v[228:231], v[116:119], v[104:107], v[228:231]
    v_mfma_f32_16x16x32_bf16 v[232:235], v[120:123], v[104:107], v[232:235]
    v_mfma_f32_16x16x32_bf16 v[236:239], v[124:127], v[104:107], v[236:239]
    v_mfma_f32_16x16x32_bf16 v[240:243], v[112:115], v[108:111], v[240:243]
    v_mfma_f32_16x16x32_bf16 v[244:247], v[116:119], v[108:111], v[244:247]
    v_mfma_f32_16x16x32_bf16 v[248:251], v[120:123], v[108:111], v[248:251]
    v_mfma_f32_16x16x32_bf16 v[252:255], v[124:127], v[108:111], v[252:255]
    s_waitcnt vmcnt(10) lgkmcnt(0)
    s_barrier
    v_mfma_f32_16x16x32_bf16 v[128:131], v[64:67], v[32:35], v[128:131]
    ds_read_b128 v[80:83], v17 offset:0
    v_mfma_f32_16x16x32_bf16 v[132:135], v[68:71], v[32:35], v[132:135]
    ds_read_b64_tr_b16 v[112:113], v18 offset:49152
    v_mfma_f32_16x16x32_bf16 v[136:139], v[72:75], v[32:35], v[136:139]
    ds_read_b64_tr_b16 v[114:115], v18 offset:51200
    v_mfma_f32_16x16x32_bf16 v[140:143], v[76:79], v[32:35], v[140:143]
    ds_read_b64_tr_b16 v[116:117], v19 offset:49152
    v_mfma_f32_16x16x32_bf16 v[144:147], v[64:67], v[36:39], v[144:147]
    ds_read_b64_tr_b16 v[118:119], v19 offset:51200
    v_mfma_f32_16x16x32_bf16 v[148:151], v[68:71], v[36:39], v[148:151]
    ds_read_b64_tr_b16 v[120:121], v20 offset:49152
    v_mfma_f32_16x16x32_bf16 v[152:155], v[72:75], v[36:39], v[152:155]
    ds_read_b64_tr_b16 v[122:123], v20 offset:51200
    v_mfma_f32_16x16x32_bf16 v[156:159], v[76:79], v[36:39], v[156:159]
    ds_read_b64_tr_b16 v[124:125], v21 offset:49152
    v_mfma_f32_16x16x32_bf16 v[160:163], v[64:67], v[40:43], v[160:163]
    ds_read_b64_tr_b16 v[126:127], v21 offset:51200
    v_mfma_f32_16x16x32_bf16 v[164:167], v[68:71], v[40:43], v[164:167]
    ds_read_b128 v[84:87], v17 offset:2048
    v_mfma_f32_16x16x32_bf16 v[168:171], v[72:75], v[40:43], v[168:171]
    ds_read_b128 v[88:91], v17 offset:4096
    v_mfma_f32_16x16x32_bf16 v[172:175], v[76:79], v[40:43], v[172:175]
    ds_read_b128 v[92:95], v17 offset:6144
    v_mfma_f32_16x16x32_bf16 v[176:179], v[64:67], v[44:47], v[176:179]
    ds_read_b128 v[96:99], v17 offset:16384
    v_mfma_f32_16x16x32_bf16 v[180:183], v[68:71], v[44:47], v[180:183]
    ds_read_b128 v[100:103], v17 offset:18432
    v_mfma_f32_16x16x32_bf16 v[184:187], v[72:75], v[44:47], v[184:187]
    ds_read_b128 v[104:107], v17 offset:20480
    v_mfma_f32_16x16x32_bf16 v[188:191], v[76:79], v[44:47], v[188:191]
    ds_read_b128 v[108:111], v17 offset:22528
    v_mfma_f32_16x16x32_bf16 v[192:195], v[64:67], v[48:51], v[192:195]
    s_add_u32 m0, s48, 131072
    s_add_u32 s12, s55, 3670016
    buffer_load_dwordx4 v30, s[20:23], s12 offen lds
    v_mfma_f32_16x16x32_bf16 v[196:199], v[68:71], v[48:51], v[196:199]
    v_mfma_f32_16x16x32_bf16 v[200:203], v[72:75], v[48:51], v[200:203]
    s_add_u32 m0, s48, 132096
    s_add_u32 s12, s55, 3686400
    buffer_load_dwordx4 v31, s[20:23], s12 offen lds
    v_mfma_f32_16x16x32_bf16 v[204:207], v[76:79], v[48:51], v[204:207]
    v_mfma_f32_16x16x32_bf16 v[208:211], v[64:67], v[52:55], v[208:211]
    s_add_u32 m0, s56, 34816
    s_add_u32 s12, s54, 17280
    buffer_load_dwordx4 v10, s[16:19], s12 offen lds
    v_mfma_f32_16x16x32_bf16 v[212:215], v[68:71], v[52:55], v[212:215]
    v_mfma_f32_16x16x32_bf16 v[216:219], v[72:75], v[52:55], v[216:219]
    s_add_u32 m0, s56, 35840
    s_add_u32 s12, s54, 25472
    buffer_load_dwordx4 v11, s[16:19], s12 offen lds
    v_mfma_f32_16x16x32_bf16 v[220:223], v[76:79], v[52:55], v[220:223]
    v_mfma_f32_16x16x32_bf16 v[224:227], v[64:67], v[56:59], v[224:227]
    v_mfma_f32_16x16x32_bf16 v[228:231], v[68:71], v[56:59], v[228:231]
    v_mfma_f32_16x16x32_bf16 v[232:235], v[72:75], v[56:59], v[232:235]
    v_mfma_f32_16x16x32_bf16 v[236:239], v[76:79], v[56:59], v[236:239]
    v_mfma_f32_16x16x32_bf16 v[240:243], v[64:67], v[60:63], v[240:243]
    v_mfma_f32_16x16x32_bf16 v[244:247], v[68:71], v[60:63], v[244:247]
    v_mfma_f32_16x16x32_bf16 v[248:251], v[72:75], v[60:63], v[248:251]
    v_mfma_f32_16x16x32_bf16 v[252:255], v[76:79], v[60:63], v[252:255]
    s_waitcnt vmcnt(8) lgkmcnt(0)
    s_barrier
    v_mfma_f32_16x16x32_bf16 v[128:131], v[112:115], v[80:83], v[128:131]
    ds_read_b128 v[32:35], v14 offset:0
    v_mfma_f32_16x16x32_bf16 v[132:135], v[116:119], v[80:83], v[132:135]
    ds_read_b64_tr_b16 v[64:65], v18 offset:0
    v_mfma_f32_16x16x32_bf16 v[136:139], v[120:123], v[80:83], v[136:139]
    ds_read_b64_tr_b16 v[66:67], v18 offset:2048
    v_mfma_f32_16x16x32_bf16 v[140:143], v[124:127], v[80:83], v[140:143]
    ds_read_b64_tr_b16 v[68:69], v19 offset:0
    v_mfma_f32_16x16x32_bf16 v[144:147], v[112:115], v[84:87], v[144:147]
    ds_read_b64_tr_b16 v[70:71], v19 offset:2048
    v_mfma_f32_16x16x32_bf16 v[148:151], v[116:119], v[84:87], v[148:151]
    ds_read_b64_tr_b16 v[72:73], v20 offset:0
    v_mfma_f32_16x16x32_bf16 v[152:155], v[120:123], v[84:87], v[152:155]
    ds_read_b64_tr_b16 v[74:75], v20 offset:2048
    v_mfma_f32_16x16x32_bf16 v[156:159], v[124:127], v[84:87], v[156:159]
    ds_read_b64_tr_b16 v[76:77], v21 offset:0
    v_mfma_f32_16x16x32_bf16 v[160:163], v[112:115], v[88:91], v[160:163]
    ds_read_b64_tr_b16 v[78:79], v21 offset:2048
    v_mfma_f32_16x16x32_bf16 v[164:167], v[116:119], v[88:91], v[164:167]
    ds_read_b128 v[36:39], v14 offset:2048
    v_mfma_f32_16x16x32_bf16 v[168:171], v[120:123], v[88:91], v[168:171]
    ds_read_b128 v[40:43], v14 offset:4096
    v_mfma_f32_16x16x32_bf16 v[172:175], v[124:127], v[88:91], v[172:175]
    ds_read_b128 v[44:47], v14 offset:6144
    v_mfma_f32_16x16x32_bf16 v[176:179], v[112:115], v[92:95], v[176:179]
    ds_read_b128 v[48:51], v14 offset:16384
    v_mfma_f32_16x16x32_bf16 v[180:183], v[116:119], v[92:95], v[180:183]
    ds_read_b128 v[52:55], v14 offset:18432
    v_mfma_f32_16x16x32_bf16 v[184:187], v[120:123], v[92:95], v[184:187]
    ds_read_b128 v[56:59], v14 offset:20480
    v_mfma_f32_16x16x32_bf16 v[188:191], v[124:127], v[92:95], v[188:191]
    ds_read_b128 v[60:63], v14 offset:22528
    v_mfma_f32_16x16x32_bf16 v[192:195], v[112:115], v[96:99], v[192:195]
    s_add_u32 m0, s48, 147456
    s_add_u32 s12, s55, 3932160
    buffer_load_dwordx4 v30, s[20:23], s12 offen lds
    v_mfma_f32_16x16x32_bf16 v[196:199], v[116:119], v[96:99], v[196:199]
    v_mfma_f32_16x16x32_bf16 v[200:203], v[120:123], v[96:99], v[200:203]
    s_add_u32 m0, s48, 148480
    s_add_u32 s12, s55, 3948544
    buffer_load_dwordx4 v31, s[20:23], s12 offen lds
    v_mfma_f32_16x16x32_bf16 v[204:207], v[124:127], v[96:99], v[204:207]
    v_mfma_f32_16x16x32_bf16 v[208:211], v[112:115], v[100:103], v[208:211]
    v_mfma_f32_16x16x32_bf16 v[212:215], v[116:119], v[100:103], v[212:215]
    v_mfma_f32_16x16x32_bf16 v[216:219], v[120:123], v[100:103], v[216:219]
    v_mfma_f32_16x16x32_bf16 v[220:223], v[124:127], v[100:103], v[220:223]
    v_mfma_f32_16x16x32_bf16 v[224:227], v[112:115], v[104:107], v[224:227]
    v_mfma_f32_16x16x32_bf16 v[228:231], v[116:119], v[104:107], v[228:231]
    v_mfma_f32_16x16x32_bf16 v[232:235], v[120:123], v[104:107], v[232:235]
    v_mfma_f32_16x16x32_bf16 v[236:239], v[124:127], v[104:107], v[236:239]
    v_mfma_f32_16x16x32_bf16 v[240:243], v[112:115], v[108:111], v[240:243]
    v_mfma_f32_16x16x32_bf16 v[244:247], v[116:119], v[108:111], v[244:247]
    v_mfma_f32_16x16x32_bf16 v[248:251], v[120:123], v[108:111], v[248:251]
    v_mfma_f32_16x16x32_bf16 v[252:255], v[124:127], v[108:111], v[252:255]
    s_waitcnt vmcnt(8) lgkmcnt(0)
    s_barrier
    s_mov_b32 s16, s64
    s_and_b32 s17, s65, 0xffff
    s_mov_b32 s18, 0x400000
    s_mov_b32 s19, 0x00020000
    s_mov_b32 s20, s66
    s_and_b32 s21, s67, 0xffff
    s_mov_b32 s22, 0x158000
    s_mov_b32 s23, 0x00020000
    s_add_u32 s13, s34, 0
    s_lshl_b32 s14, s13, 8
    s_add_u32 s14, s14, 117440512
    v_and_b32 v8, 0, v1
    v_lshlrev_b32_e64 v8, 8, v8
    buffer_load_dword v26, v8, s[4:7], s14 offen sc1
    v_mfma_f32_16x16x32_bf16 v[128:131], v[64:67], v[32:35], v[128:131]
    ds_read_b128 v[80:83], v15 offset:0
    v_mfma_f32_16x16x32_bf16 v[132:135], v[68:71], v[32:35], v[132:135]
    ds_read_b64_tr_b16 v[112:113], v18 offset:16384
    v_mfma_f32_16x16x32_bf16 v[136:139], v[72:75], v[32:35], v[136:139]
    ds_read_b64_tr_b16 v[114:115], v18 offset:18432
    v_mfma_f32_16x16x32_bf16 v[140:143], v[76:79], v[32:35], v[140:143]
    ds_read_b64_tr_b16 v[116:117], v19 offset:16384
    v_mfma_f32_16x16x32_bf16 v[144:147], v[64:67], v[36:39], v[144:147]
    ds_read_b64_tr_b16 v[118:119], v19 offset:18432
    v_mfma_f32_16x16x32_bf16 v[148:151], v[68:71], v[36:39], v[148:151]
    ds_read_b64_tr_b16 v[120:121], v20 offset:16384
    v_mfma_f32_16x16x32_bf16 v[152:155], v[72:75], v[36:39], v[152:155]
    ds_read_b64_tr_b16 v[122:123], v20 offset:18432
    v_mfma_f32_16x16x32_bf16 v[156:159], v[76:79], v[36:39], v[156:159]
    ds_read_b64_tr_b16 v[124:125], v21 offset:16384
    v_mfma_f32_16x16x32_bf16 v[160:163], v[64:67], v[40:43], v[160:163]
    ds_read_b64_tr_b16 v[126:127], v21 offset:18432
    v_mfma_f32_16x16x32_bf16 v[164:167], v[68:71], v[40:43], v[164:167]
    ds_read_b128 v[84:87], v15 offset:2048
    v_mfma_f32_16x16x32_bf16 v[168:171], v[72:75], v[40:43], v[168:171]
    ds_read_b128 v[88:91], v15 offset:4096
    v_mfma_f32_16x16x32_bf16 v[172:175], v[76:79], v[40:43], v[172:175]
    ds_read_b128 v[92:95], v15 offset:6144
    v_mfma_f32_16x16x32_bf16 v[176:179], v[64:67], v[44:47], v[176:179]
    ds_read_b128 v[96:99], v15 offset:16384
    v_mfma_f32_16x16x32_bf16 v[180:183], v[68:71], v[44:47], v[180:183]
    ds_read_b128 v[100:103], v15 offset:18432
    v_mfma_f32_16x16x32_bf16 v[184:187], v[72:75], v[44:47], v[184:187]
    ds_read_b128 v[104:107], v15 offset:20480
    v_mfma_f32_16x16x32_bf16 v[188:191], v[76:79], v[44:47], v[188:191]
    ds_read_b128 v[108:111], v15 offset:22528
    v_mfma_f32_16x16x32_bf16 v[192:195], v[64:67], v[48:51], v[192:195]
    s_add_u32 m0, s48, 65536
    s_add_u32 s12, s46, 0
    buffer_load_dwordx4 v12, s[16:19], s12 offen lds
    v_mfma_f32_16x16x32_bf16 v[196:199], v[68:71], v[48:51], v[196:199]
    v_mfma_f32_16x16x32_bf16 v[200:203], v[72:75], v[48:51], v[200:203]
    s_add_u32 m0, s48, 66560
    s_add_u32 s12, s46, 32768
    buffer_load_dwordx4 v12, s[16:19], s12 offen lds
    v_mfma_f32_16x16x32_bf16 v[204:207], v[76:79], v[48:51], v[204:207]
    v_mfma_f32_16x16x32_bf16 v[208:211], v[64:67], v[52:55], v[208:211]
    s_add_u32 m0, s49, 81920
    s_add_u32 s12, s47, 0
    buffer_load_dwordx4 v13, s[20:23], s12 offen lds
    v_mfma_f32_16x16x32_bf16 v[212:215], v[68:71], v[52:55], v[212:215]
    v_mfma_f32_16x16x32_bf16 v[216:219], v[72:75], v[52:55], v[216:219]
    s_add_u32 m0, s48, 90112
    s_add_u32 s12, s46, 524288
    buffer_load_dwordx4 v12, s[16:19], s12 offen lds
    v_mfma_f32_16x16x32_bf16 v[220:223], v[76:79], v[52:55], v[220:223]
    v_mfma_f32_16x16x32_bf16 v[224:227], v[64:67], v[56:59], v[224:227]
    s_add_u32 m0, s48, 91136
    s_add_u32 s12, s46, 557056
    buffer_load_dwordx4 v12, s[16:19], s12 offen lds
    v_mfma_f32_16x16x32_bf16 v[228:231], v[68:71], v[56:59], v[228:231]
    v_mfma_f32_16x16x32_bf16 v[232:235], v[72:75], v[56:59], v[232:235]
    s_add_u32 m0, s49, 106496
    s_add_u32 s12, s47, 176128
    buffer_load_dwordx4 v13, s[20:23], s12 offen lds
    v_mfma_f32_16x16x32_bf16 v[236:239], v[76:79], v[56:59], v[236:239]
    v_mfma_f32_16x16x32_bf16 v[240:243], v[64:67], v[60:63], v[240:243]
    v_mfma_f32_16x16x32_bf16 v[244:247], v[68:71], v[60:63], v[244:247]
    v_mfma_f32_16x16x32_bf16 v[248:251], v[72:75], v[60:63], v[248:251]
    v_mfma_f32_16x16x32_bf16 v[252:255], v[76:79], v[60:63], v[252:255]
    s_waitcnt vmcnt(9) lgkmcnt(0)
    s_barrier
    v_mfma_f32_16x16x32_bf16 v[128:131], v[112:115], v[80:83], v[128:131]
    ds_read_b128 v[32:35], v14 offset:32768
    v_mfma_f32_16x16x32_bf16 v[132:135], v[116:119], v[80:83], v[132:135]
    ds_read_b64_tr_b16 v[64:65], v18 offset:32768
    v_mfma_f32_16x16x32_bf16 v[136:139], v[120:123], v[80:83], v[136:139]
    ds_read_b64_tr_b16 v[66:67], v18 offset:34816
    v_mfma_f32_16x16x32_bf16 v[140:143], v[124:127], v[80:83], v[140:143]
    ds_read_b64_tr_b16 v[68:69], v19 offset:32768
    v_mfma_f32_16x16x32_bf16 v[144:147], v[112:115], v[84:87], v[144:147]
    ds_read_b64_tr_b16 v[70:71], v19 offset:34816
    v_mfma_f32_16x16x32_bf16 v[148:151], v[116:119], v[84:87], v[148:151]
    ds_read_b64_tr_b16 v[72:73], v20 offset:32768
    v_mfma_f32_16x16x32_bf16 v[152:155], v[120:123], v[84:87], v[152:155]
    ds_read_b64_tr_b16 v[74:75], v20 offset:34816
    v_mfma_f32_16x16x32_bf16 v[156:159], v[124:127], v[84:87], v[156:159]
    ds_read_b64_tr_b16 v[76:77], v21 offset:32768
    v_mfma_f32_16x16x32_bf16 v[160:163], v[112:115], v[88:91], v[160:163]
    ds_read_b64_tr_b16 v[78:79], v21 offset:34816
    v_mfma_f32_16x16x32_bf16 v[164:167], v[116:119], v[88:91], v[164:167]
    ds_read_b128 v[36:39], v14 offset:34816
    v_mfma_f32_16x16x32_bf16 v[168:171], v[120:123], v[88:91], v[168:171]
    ds_read_b128 v[40:43], v14 offset:36864
    v_mfma_f32_16x16x32_bf16 v[172:175], v[124:127], v[88:91], v[172:175]
    ds_read_b128 v[44:47], v14 offset:38912
    v_mfma_f32_16x16x32_bf16 v[176:179], v[112:115], v[92:95], v[176:179]
    ds_read_b128 v[48:51], v14 offset:49152
    v_mfma_f32_16x16x32_bf16 v[180:183], v[116:119], v[92:95], v[180:183]
    ds_read_b128 v[52:55], v14 offset:51200
    v_mfma_f32_16x16x32_bf16 v[184:187], v[120:123], v[92:95], v[184:187]
    ds_read_b128 v[56:59], v14 offset:53248
    v_mfma_f32_16x16x32_bf16 v[188:191], v[124:127], v[92:95], v[188:191]
    ds_read_b128 v[60:63], v14 offset:55296
    v_mfma_f32_16x16x32_bf16 v[192:195], v[112:115], v[96:99], v[192:195]
    v_mfma_f32_16x16x32_bf16 v[196:199], v[116:119], v[96:99], v[196:199]
    v_mfma_f32_16x16x32_bf16 v[200:203], v[120:123], v[96:99], v[200:203]
    v_mfma_f32_16x16x32_bf16 v[204:207], v[124:127], v[96:99], v[204:207]
    v_mfma_f32_16x16x32_bf16 v[208:211], v[112:115], v[100:103], v[208:211]
    v_mfma_f32_16x16x32_bf16 v[212:215], v[116:119], v[100:103], v[212:215]
    v_mfma_f32_16x16x32_bf16 v[216:219], v[120:123], v[100:103], v[216:219]
    v_mfma_f32_16x16x32_bf16 v[220:223], v[124:127], v[100:103], v[220:223]
    v_mfma_f32_16x16x32_bf16 v[224:227], v[112:115], v[104:107], v[224:227]
    v_mfma_f32_16x16x32_bf16 v[228:231], v[116:119], v[104:107], v[228:231]
    v_mfma_f32_16x16x32_bf16 v[232:235], v[120:123], v[104:107], v[232:235]
    v_mfma_f32_16x16x32_bf16 v[236:239], v[124:127], v[104:107], v[236:239]
    v_mfma_f32_16x16x32_bf16 v[240:243], v[112:115], v[108:111], v[240:243]
    v_mfma_f32_16x16x32_bf16 v[244:247], v[116:119], v[108:111], v[244:247]
    v_mfma_f32_16x16x32_bf16 v[248:251], v[120:123], v[108:111], v[248:251]
    v_mfma_f32_16x16x32_bf16 v[252:255], v[124:127], v[108:111], v[252:255]
    s_waitcnt vmcnt(7) lgkmcnt(0)
    s_barrier
    v_mfma_f32_16x16x32_bf16 v[128:131], v[64:67], v[32:35], v[128:131]
    ds_read_b128 v[80:83], v15 offset:32768
    v_mfma_f32_16x16x32_bf16 v[132:135], v[68:71], v[32:35], v[132:135]
    ds_read_b64_tr_b16 v[112:113], v18 offset:49152
    v_mfma_f32_16x16x32_bf16 v[136:139], v[72:75], v[32:35], v[136:139]
    ds_read_b64_tr_b16 v[114:115], v18 offset:51200
    v_mfma_f32_16x16x32_bf16 v[140:143], v[76:79], v[32:35], v[140:143]
    ds_read_b64_tr_b16 v[116:117], v19 offset:49152
    v_mfma_f32_16x16x32_bf16 v[144:147], v[64:67], v[36:39], v[144:147]
    ds_read_b64_tr_b16 v[118:119], v19 offset:51200
    v_mfma_f32_16x16x32_bf16 v[148:151], v[68:71], v[36:39], v[148:151]
    ds_read_b64_tr_b16 v[120:121], v20 offset:49152
    v_mfma_f32_16x16x32_bf16 v[152:155], v[72:75], v[36:39], v[152:155]
    ds_read_b64_tr_b16 v[122:123], v20 offset:51200
    v_mfma_f32_16x16x32_bf16 v[156:159], v[76:79], v[36:39], v[156:159]
    ds_read_b64_tr_b16 v[124:125], v21 offset:49152
    v_mfma_f32_16x16x32_bf16 v[160:163], v[64:67], v[40:43], v[160:163]
    ds_read_b64_tr_b16 v[126:127], v21 offset:51200
    v_mfma_f32_16x16x32_bf16 v[164:167], v[68:71], v[40:43], v[164:167]
    ds_read_b128 v[84:87], v15 offset:34816
    v_mfma_f32_16x16x32_bf16 v[168:171], v[72:75], v[40:43], v[168:171]
    ds_read_b128 v[88:91], v15 offset:36864
    v_mfma_f32_16x16x32_bf16 v[172:175], v[76:79], v[40:43], v[172:175]
    ds_read_b128 v[92:95], v15 offset:38912
    v_mfma_f32_16x16x32_bf16 v[176:179], v[64:67], v[44:47], v[176:179]
    ds_read_b128 v[96:99], v15 offset:49152
    v_mfma_f32_16x16x32_bf16 v[180:183], v[68:71], v[44:47], v[180:183]
    ds_read_b128 v[100:103], v15 offset:51200
    v_mfma_f32_16x16x32_bf16 v[184:187], v[72:75], v[44:47], v[184:187]
    ds_read_b128 v[104:107], v15 offset:53248
    v_mfma_f32_16x16x32_bf16 v[188:191], v[76:79], v[44:47], v[188:191]
    ds_read_b128 v[108:111], v15 offset:55296
    v_mfma_f32_16x16x32_bf16 v[192:195], v[64:67], v[48:51], v[192:195]
    s_add_u32 m0, s48, 114688
    s_add_u32 s12, s46, 1048576
    buffer_load_dwordx4 v12, s[16:19], s12 offen lds
    v_mfma_f32_16x16x32_bf16 v[196:199], v[68:71], v[48:51], v[196:199]
    v_mfma_f32_16x16x32_bf16 v[200:203], v[72:75], v[48:51], v[200:203]
    s_add_u32 m0, s48, 115712
    s_add_u32 s12, s46, 1081344
    buffer_load_dwordx4 v12, s[16:19], s12 offen lds
    v_mfma_f32_16x16x32_bf16 v[204:207], v[76:79], v[48:51], v[204:207]
    v_mfma_f32_16x16x32_bf16 v[208:211], v[64:67], v[52:55], v[208:211]
    s_add_u32 m0, s49, 131072
    s_add_u32 s12, s47, 352256
    buffer_load_dwordx4 v13, s[20:23], s12 offen lds
    v_mfma_f32_16x16x32_bf16 v[212:215], v[68:71], v[52:55], v[212:215]
    v_mfma_f32_16x16x32_bf16 v[216:219], v[72:75], v[52:55], v[216:219]
    v_mfma_f32_16x16x32_bf16 v[220:223], v[76:79], v[52:55], v[220:223]
    v_mfma_f32_16x16x32_bf16 v[224:227], v[64:67], v[56:59], v[224:227]
    v_mfma_f32_16x16x32_bf16 v[228:231], v[68:71], v[56:59], v[228:231]
    v_mfma_f32_16x16x32_bf16 v[232:235], v[72:75], v[56:59], v[232:235]
    v_mfma_f32_16x16x32_bf16 v[236:239], v[76:79], v[56:59], v[236:239]
    v_mfma_f32_16x16x32_bf16 v[240:243], v[64:67], v[60:63], v[240:243]
    v_mfma_f32_16x16x32_bf16 v[244:247], v[68:71], v[60:63], v[244:247]
    v_mfma_f32_16x16x32_bf16 v[248:251], v[72:75], v[60:63], v[248:251]
    v_mfma_f32_16x16x32_bf16 v[252:255], v[76:79], v[60:63], v[252:255]
    s_waitcnt vmcnt(6) lgkmcnt(0)
    s_barrier
    s_waitcnt vmcnt(9)
    s_add_u32 s13, s34, 0
    s_mov_b32 s15, 0x20000
poll_6:
    v_cmp_gt_u32 vcc, 16, v26
    s_cbranch_vccz polld_7
    s_sleep 2
    s_lshl_b32 s14, s13, 8
    s_add_u32 s14, s14, 117440512
    v_and_b32 v8, 0, v1
    v_lshlrev_b32 v8, 8, v8
    buffer_load_dword v26, v8, s[4:7], s14 offen sc1
    s_waitcnt vmcnt(0)
    s_sub_u32 s15, s15, 1
    s_cmp_lg_u32 s15, 0
    s_cbranch_scc1 poll_6
polld_7:
    v_mfma_f32_16x16x32_bf16 v[128:131], v[112:115], v[80:83], v[128:131]
    s_add_u32 s12, s50, 0
    buffer_load_dwordx4 v[64:67], v2, s[4:7], s12 offen offset:0 sc1
    v_mfma_f32_16x16x32_bf16 v[132:135], v[116:119], v[80:83], v[132:135]
    v_mfma_f32_16x16x32_bf16 v[136:139], v[120:123], v[80:83], v[136:139]
    s_add_u32 s12, s50, 16384
    buffer_load_dwordx4 v[68:71], v2, s[4:7], s12 offen offset:0 sc1
    v_mfma_f32_16x16x32_bf16 v[140:143], v[124:127], v[80:83], v[140:143]
    v_mfma_f32_16x16x32_bf16 v[144:147], v[112:115], v[84:87], v[144:147]
    s_add_u32 s12, s50, 0
    buffer_load_dwordx4 v[72:75], v2, s[4:7], s12 offen offset:1024 sc1
    v_mfma_f32_16x16x32_bf16 v[148:151], v[116:119], v[84:87], v[148:151]
    v_mfma_f32_16x16x32_bf16 v[152:155], v[120:123], v[84:87], v[152:155]
    s_add_u32 s12, s50, 16384
    buffer_load_dwordx4 v[76:79], v2, s[4:7], s12 offen offset:1024 sc1
    v_mfma_f32_16x16x32_bf16 v[156:159], v[124:127], v[84:87], v[156:159]
    v_mfma_f32_16x16x32_bf16 v[160:163], v[112:115], v[88:91], v[160:163]
    v_mfma_f32_16x16x32_bf16 v[164:167], v[116:119], v[88:91], v[164:167]
    v_mfma_f32_16x16x32_bf16 v[168:171], v[120:123], v[88:91], v[168:171]
    v_mfma_f32_16x16x32_bf16 v[172:175], v[124:127], v[88:91], v[172:175]
    v_mfma_f32_16x16x32_bf16 v[176:179], v[112:115], v[92:95], v[176:179]
    v_mfma_f32_16x16x32_bf16 v[180:183], v[116:119], v[92:95], v[180:183]
    v_mfma_f32_16x16x32_bf16 v[184:187], v[120:123], v[92:95], v[184:187]
    v_mfma_f32_16x16x32_bf16 v[188:191], v[124:127], v[92:95], v[188:191]
    v_mfma_f32_16x16x32_bf16 v[192:195], v[112:115], v[96:99], v[192:195]
    v_mfma_f32_16x16x32_bf16 v[196:199], v[116:119], v[96:99], v[196:199]
    v_mfma_f32_16x16x32_bf16 v[200:203], v[120:123], v[96:99], v[200:203]
    v_mfma_f32_16x16x32_bf16 v[204:207], v[124:127], v[96:99], v[204:207]
    v_mfma_f32_16x16x32_bf16 v[208:211], v[112:115], v[100:103], v[208:211]
    v_mfma_f32_16x16x32_bf16 v[212:215], v[116:119], v[100:103], v[212:215]
    v_mfma_f32_16x16x32_bf16 v[216:219], v[120:123], v[100:103], v[216:219]
    v_mfma_f32_16x16x32_bf16 v[220:223], v[124:127], v[100:103], v[220:223]
    v_mfma_f32_16x16x32_bf16 v[224:227], v[112:115], v[104:107], v[224:227]
    v_mfma_f32_16x16x32_bf16 v[228:231], v[116:119], v[104:107], v[228:231]
    v_mfma_f32_16x16x32_bf16 v[232:235], v[120:123], v[104:107], v[232:235]
    v_mfma_f32_16x16x32_bf16 v[236:239], v[124:127], v[104:107], v[236:239]
    v_mfma_f32_16x16x32_bf16 v[240:243], v[112:115], v[108:111], v[240:243]
    v_mfma_f32_16x16x32_bf16 v[244:247], v[116:119], v[108:111], v[244:247]
    v_mfma_f32_16x16x32_bf16 v[248:251], v[120:123], v[108:111], v[248:251]
    v_mfma_f32_16x16x32_bf16 v[252:255], v[124:127], v[108:111], v[252:255]
    s_add_u32 s12, s50, 0
    buffer_load_dwordx4 v[80:83], v2, s[4:7], s12 offen offset:2048 sc1
    s_add_u32 s12, s50, 16384
    buffer_load_dwordx4 v[84:87], v2, s[4:7], s12 offen offset:2048 sc1
    v_mov_b32 v10, v27
    v_cvt_pk_bf16_f32 v88, v128, v129
    v_cvt_pk_bf16_f32 v89, v130, v131
    v_cvt_pk_bf16_f32 v90, v132, v133
    v_cvt_pk_bf16_f32 v91, v134, v135
    v_cvt_pk_bf16_f32 v92, v144, v145
    v_cvt_pk_bf16_f32 v93, v146, v147
    v_cvt_pk_bf16_f32 v94, v148, v149
    v_cvt_pk_bf16_f32 v95, v150, v151
    v_cvt_pk_bf16_f32 v96, v136, v137
    v_cvt_pk_bf16_f32 v97, v138, v139
    v_cvt_pk_bf16_f32 v98, v140, v141
    v_cvt_pk_bf16_f32 v99, v142, v143
    v_cvt_pk_bf16_f32 v100, v152, v153
    v_cvt_pk_bf16_f32 v101, v154, v155
    v_cvt_pk_bf16_f32 v102, v156, v157
    v_cvt_pk_bf16_f32 v103, v158, v159
    v_cvt_pk_bf16_f32 v104, v160, v161
    v_cvt_pk_bf16_f32 v105, v162, v163
    v_cvt_pk_bf16_f32 v106, v164, v165
    v_cvt_pk_bf16_f32 v107, v166, v167
    v_cvt_pk_bf16_f32 v108, v176, v177
    v_cvt_pk_bf16_f32 v109, v178, v179
    v_cvt_pk_bf16_f32 v110, v180, v181
    v_cvt_pk_bf16_f32 v111, v182, v183
    v_cvt_pk_bf16_f32 v112, v168, v169
    v_cvt_pk_bf16_f32 v113, v170, v171
    v_cvt_pk_bf16_f32 v114, v172, v173
    v_cvt_pk_bf16_f32 v115, v174, v175
    v_cvt_pk_bf16_f32 v116, v184, v185
    v_cvt_pk_bf16_f32 v117, v186, v187
    v_cvt_pk_bf16_f32 v118, v188, v189
    v_cvt_pk_bf16_f32 v119, v190, v191
    v_cvt_pk_bf16_f32 v20, v192, v193
    v_cvt_pk_bf16_f32 v21, v194, v195
    v_cvt_pk_bf16_f32 v22, v196, v197
    v_cvt_pk_bf16_f32 v23, v198, v199
    v_cvt_pk_bf16_f32 v24, v208, v209
    v_cvt_pk_bf16_f32 v25, v210, v211
    v_cvt_pk_bf16_f32 v26, v212, v213
    v_cvt_pk_bf16_f32 v27, v214, v215
    v_cvt_pk_bf16_f32 v28, v200, v201
    v_cvt_pk_bf16_f32 v29, v202, v203
    v_cvt_pk_bf16_f32 v30, v204, v205
    v_cvt_pk_bf16_f32 v31, v206, v207
    v_cvt_pk_bf16_f32 v32, v216, v217
    v_cvt_pk_bf16_f32 v33, v218, v219
    v_cvt_pk_bf16_f32 v34, v220, v221
    v_cvt_pk_bf16_f32 v35, v222, v223
    v_cvt_pk_bf16_f32 v36, v224, v225
    v_cvt_pk_bf16_f32 v37, v226, v227
    v_cvt_pk_bf16_f32 v38, v228, v229
    v_cvt_pk_bf16_f32 v39, v230, v231
    v_cvt_pk_bf16_f32 v40, v240, v241
    v_cvt_pk_bf16_f32 v41, v242, v243
    v_cvt_pk_bf16_f32 v42, v244, v245
    v_cvt_pk_bf16_f32 v43, v246, v247
    v_cvt_pk_bf16_f32 v44, v232, v233
    v_cvt_pk_bf16_f32 v45, v234, v235
    v_cvt_pk_bf16_f32 v46, v236, v237
    v_cvt_pk_bf16_f32 v47, v238, v239
    v_cvt_pk_bf16_f32 v48, v248, v249
    v_cvt_pk_bf16_f32 v49, v250, v251
    v_cvt_pk_bf16_f32 v50, v252, v253
    v_cvt_pk_bf16_f32 v51, v254, v255
    s_branch parallel_sum__compressed_kv_cla__mixer_gmlp__prompt_kernel_kv_done
parallel_sum__compressed_kv_cla__mixer_gmlp__prompt_kernel_kv_v:
    s_waitcnt vmcnt(6) lgkmcnt(0)
    s_barrier
    v_mfma_f32_16x16x32_bf16 v[128:131], v[32:35], v[64:67], 0
    ds_read_b128 v[80:83], v15 offset:0
    buffer_store_dwordx4 v[22:25], v3, s[4:7], s45 offen sc1
    v_mfma_f32_16x16x32_bf16 v[132:135], v[32:35], v[68:71], 0
    ds_read_b64_tr_b16 v[112:113], v18 offset:16384
    v_mfma_f32_16x16x32_bf16 v[136:139], v[32:35], v[72:75], 0
    ds_read_b64_tr_b16 v[114:115], v18 offset:18432
    v_mfma_f32_16x16x32_bf16 v[140:143], v[32:35], v[76:79], 0
    ds_read_b64_tr_b16 v[116:117], v19 offset:16384
    v_mfma_f32_16x16x32_bf16 v[144:147], v[36:39], v[64:67], 0
    ds_read_b64_tr_b16 v[118:119], v19 offset:18432
    v_mfma_f32_16x16x32_bf16 v[148:151], v[36:39], v[68:71], 0
    ds_read_b64_tr_b16 v[120:121], v20 offset:16384
    v_mfma_f32_16x16x32_bf16 v[152:155], v[36:39], v[72:75], 0
    ds_read_b64_tr_b16 v[122:123], v20 offset:18432
    v_mfma_f32_16x16x32_bf16 v[156:159], v[36:39], v[76:79], 0
    ds_read_b64_tr_b16 v[124:125], v21 offset:16384
    v_mfma_f32_16x16x32_bf16 v[160:163], v[40:43], v[64:67], 0
    ds_read_b64_tr_b16 v[126:127], v21 offset:18432
    s_add_u32 m0, s48, 147456
    s_add_u32 s12, s55, 786432
    buffer_load_dwordx4 v30, s[20:23], s12 offen lds
    v_mfma_f32_16x16x32_bf16 v[164:167], v[40:43], v[68:71], 0
    ds_read_b128 v[84:87], v15 offset:2048
    v_mfma_f32_16x16x32_bf16 v[168:171], v[40:43], v[72:75], 0
    ds_read_b128 v[88:91], v15 offset:4096
    s_add_u32 m0, s48, 148480
    s_add_u32 s12, s55, 802816
    buffer_load_dwordx4 v31, s[20:23], s12 offen lds
    v_mfma_f32_16x16x32_bf16 v[172:175], v[40:43], v[76:79], 0
    ds_read_b128 v[92:95], v15 offset:6144
    v_mfma_f32_16x16x32_bf16 v[176:179], v[44:47], v[64:67], 0
    ds_read_b128 v[96:99], v15 offset:16384
    s_add_u32 m0, s56, 65536
    s_add_u32 s12, s54, 256
    buffer_load_dwordx4 v10, s[16:19], s12 offen lds
    v_mfma_f32_16x16x32_bf16 v[180:183], v[44:47], v[68:71], 0
    ds_read_b128 v[100:103], v15 offset:18432
    v_mfma_f32_16x16x32_bf16 v[184:187], v[44:47], v[72:75], 0
    ds_read_b128 v[104:107], v15 offset:20480
    s_add_u32 m0, s56, 66560
    s_add_u32 s12, s54, 8448
    buffer_load_dwordx4 v11, s[16:19], s12 offen lds
    v_mfma_f32_16x16x32_bf16 v[188:191], v[44:47], v[76:79], 0
    ds_read_b128 v[108:111], v15 offset:22528
    v_mfma_f32_16x16x32_bf16 v[192:195], v[48:51], v[64:67], 0
    s_add_u32 m0, s56, 67584
    s_add_u32 s12, s54, 16640
    buffer_load_dwordx4 v10, s[16:19], s12 offen lds
    v_mfma_f32_16x16x32_bf16 v[196:199], v[48:51], v[68:71], 0
    v_mfma_f32_16x16x32_bf16 v[200:203], v[48:51], v[72:75], 0
    s_add_u32 m0, s56, 68608
    s_add_u32 s12, s54, 24832
    buffer_load_dwordx4 v11, s[16:19], s12 offen lds
    v_mfma_f32_16x16x32_bf16 v[204:207], v[48:51], v[76:79], 0
    v_mfma_f32_16x16x32_bf16 v[208:211], v[52:55], v[64:67], 0
    s_add_u32 m0, s48, 98304
    s_add_u32 s12, s55, 1048576
    buffer_load_dwordx4 v30, s[20:23], s12 offen lds
    v_mfma_f32_16x16x32_bf16 v[212:215], v[52:55], v[68:71], 0
    v_mfma_f32_16x16x32_bf16 v[216:219], v[52:55], v[72:75], 0
    s_add_u32 m0, s48, 99328
    s_add_u32 s12, s55, 1064960
    buffer_load_dwordx4 v31, s[20:23], s12 offen lds
    v_mfma_f32_16x16x32_bf16 v[220:223], v[52:55], v[76:79], 0
    v_mfma_f32_16x16x32_bf16 v[224:227], v[56:59], v[64:67], 0
    v_mfma_f32_16x16x32_bf16 v[228:231], v[56:59], v[68:71], 0
    v_mfma_f32_16x16x32_bf16 v[232:235], v[56:59], v[72:75], 0
    v_mfma_f32_16x16x32_bf16 v[236:239], v[56:59], v[76:79], 0
    v_mfma_f32_16x16x32_bf16 v[240:243], v[60:63], v[64:67], 0
    v_mfma_f32_16x16x32_bf16 v[244:247], v[60:63], v[68:71], 0
    v_mfma_f32_16x16x32_bf16 v[248:251], v[60:63], v[72:75], 0
    v_mfma_f32_16x16x32_bf16 v[252:255], v[60:63], v[76:79], 0
    s_waitcnt vmcnt(9) lgkmcnt(0)
    s_barrier
    v_mfma_f32_16x16x32_bf16 v[128:131], v[80:83], v[112:115], v[128:131]
    ds_read_b128 v[32:35], v14 offset:32768
    v_mfma_f32_16x16x32_bf16 v[132:135], v[80:83], v[116:119], v[132:135]
    ds_read_b64_tr_b16 v[64:65], v18 offset:32768
    v_mfma_f32_16x16x32_bf16 v[136:139], v[80:83], v[120:123], v[136:139]
    ds_read_b64_tr_b16 v[66:67], v18 offset:34816
    v_mfma_f32_16x16x32_bf16 v[140:143], v[80:83], v[124:127], v[140:143]
    ds_read_b64_tr_b16 v[68:69], v19 offset:32768
    v_mfma_f32_16x16x32_bf16 v[144:147], v[84:87], v[112:115], v[144:147]
    ds_read_b64_tr_b16 v[70:71], v19 offset:34816
    v_mfma_f32_16x16x32_bf16 v[148:151], v[84:87], v[116:119], v[148:151]
    ds_read_b64_tr_b16 v[72:73], v20 offset:32768
    v_mfma_f32_16x16x32_bf16 v[152:155], v[84:87], v[120:123], v[152:155]
    ds_read_b64_tr_b16 v[74:75], v20 offset:34816
    v_mfma_f32_16x16x32_bf16 v[156:159], v[84:87], v[124:127], v[156:159]
    ds_read_b64_tr_b16 v[76:77], v21 offset:32768
    v_mfma_f32_16x16x32_bf16 v[160:163], v[88:91], v[112:115], v[160:163]
    ds_read_b64_tr_b16 v[78:79], v21 offset:34816
    v_mfma_f32_16x16x32_bf16 v[164:167], v[88:91], v[116:119], v[164:167]
    ds_read_b128 v[36:39], v14 offset:34816
    v_mfma_f32_16x16x32_bf16 v[168:171], v[88:91], v[120:123], v[168:171]
    ds_read_b128 v[40:43], v14 offset:36864
    v_mfma_f32_16x16x32_bf16 v[172:175], v[88:91], v[124:127], v[172:175]
    ds_read_b128 v[44:47], v14 offset:38912
    v_mfma_f32_16x16x32_bf16 v[176:179], v[92:95], v[112:115], v[176:179]
    ds_read_b128 v[48:51], v14 offset:49152
    v_mfma_f32_16x16x32_bf16 v[180:183], v[92:95], v[116:119], v[180:183]
    ds_read_b128 v[52:55], v14 offset:51200
    v_mfma_f32_16x16x32_bf16 v[184:187], v[92:95], v[120:123], v[184:187]
    ds_read_b128 v[56:59], v14 offset:53248
    v_mfma_f32_16x16x32_bf16 v[188:191], v[92:95], v[124:127], v[188:191]
    ds_read_b128 v[60:63], v14 offset:55296
    v_mfma_f32_16x16x32_bf16 v[192:195], v[96:99], v[112:115], v[192:195]
    s_add_u32 m0, s48, 114688
    s_add_u32 s12, s55, 1310720
    buffer_load_dwordx4 v30, s[20:23], s12 offen lds
    v_mfma_f32_16x16x32_bf16 v[196:199], v[96:99], v[116:119], v[196:199]
    v_mfma_f32_16x16x32_bf16 v[200:203], v[96:99], v[120:123], v[200:203]
    s_add_u32 m0, s48, 115712
    s_add_u32 s12, s55, 1327104
    buffer_load_dwordx4 v31, s[20:23], s12 offen lds
    v_mfma_f32_16x16x32_bf16 v[204:207], v[96:99], v[124:127], v[204:207]
    v_mfma_f32_16x16x32_bf16 v[208:211], v[100:103], v[112:115], v[208:211]
    s_add_u32 m0, s56, 0
    s_add_u32 s12, s54, 384
    buffer_load_dwordx4 v10, s[16:19], s12 offen lds
    v_mfma_f32_16x16x32_bf16 v[212:215], v[100:103], v[116:119], v[212:215]
    v_mfma_f32_16x16x32_bf16 v[216:219], v[100:103], v[120:123], v[216:219]
    s_add_u32 m0, s56, 1024
    s_add_u32 s12, s54, 8576
    buffer_load_dwordx4 v11, s[16:19], s12 offen lds
    v_mfma_f32_16x16x32_bf16 v[220:223], v[100:103], v[124:127], v[220:223]
    v_mfma_f32_16x16x32_bf16 v[224:227], v[104:107], v[112:115], v[224:227]
    v_mfma_f32_16x16x32_bf16 v[228:231], v[104:107], v[116:119], v[228:231]
    v_mfma_f32_16x16x32_bf16 v[232:235], v[104:107], v[120:123], v[232:235]
    v_mfma_f32_16x16x32_bf16 v[236:239], v[104:107], v[124:127], v[236:239]
    v_mfma_f32_16x16x32_bf16 v[240:243], v[108:111], v[112:115], v[240:243]
    v_mfma_f32_16x16x32_bf16 v[244:247], v[108:111], v[116:119], v[244:247]
    v_mfma_f32_16x16x32_bf16 v[248:251], v[108:111], v[120:123], v[248:251]
    v_mfma_f32_16x16x32_bf16 v[252:255], v[108:111], v[124:127], v[252:255]
    s_waitcnt vmcnt(10) lgkmcnt(0)
    s_barrier
    v_mfma_f32_16x16x32_bf16 v[128:131], v[32:35], v[64:67], v[128:131]
    ds_read_b128 v[80:83], v15 offset:32768
    v_mfma_f32_16x16x32_bf16 v[132:135], v[32:35], v[68:71], v[132:135]
    ds_read_b64_tr_b16 v[112:113], v18 offset:49152
    v_mfma_f32_16x16x32_bf16 v[136:139], v[32:35], v[72:75], v[136:139]
    ds_read_b64_tr_b16 v[114:115], v18 offset:51200
    v_mfma_f32_16x16x32_bf16 v[140:143], v[32:35], v[76:79], v[140:143]
    ds_read_b64_tr_b16 v[116:117], v19 offset:49152
    v_mfma_f32_16x16x32_bf16 v[144:147], v[36:39], v[64:67], v[144:147]
    ds_read_b64_tr_b16 v[118:119], v19 offset:51200
    v_mfma_f32_16x16x32_bf16 v[148:151], v[36:39], v[68:71], v[148:151]
    ds_read_b64_tr_b16 v[120:121], v20 offset:49152
    v_mfma_f32_16x16x32_bf16 v[152:155], v[36:39], v[72:75], v[152:155]
    ds_read_b64_tr_b16 v[122:123], v20 offset:51200
    v_mfma_f32_16x16x32_bf16 v[156:159], v[36:39], v[76:79], v[156:159]
    ds_read_b64_tr_b16 v[124:125], v21 offset:49152
    v_mfma_f32_16x16x32_bf16 v[160:163], v[40:43], v[64:67], v[160:163]
    ds_read_b64_tr_b16 v[126:127], v21 offset:51200
    v_mfma_f32_16x16x32_bf16 v[164:167], v[40:43], v[68:71], v[164:167]
    ds_read_b128 v[84:87], v15 offset:34816
    v_mfma_f32_16x16x32_bf16 v[168:171], v[40:43], v[72:75], v[168:171]
    ds_read_b128 v[88:91], v15 offset:36864
    v_mfma_f32_16x16x32_bf16 v[172:175], v[40:43], v[76:79], v[172:175]
    ds_read_b128 v[92:95], v15 offset:38912
    v_mfma_f32_16x16x32_bf16 v[176:179], v[44:47], v[64:67], v[176:179]
    ds_read_b128 v[96:99], v15 offset:49152
    v_mfma_f32_16x16x32_bf16 v[180:183], v[44:47], v[68:71], v[180:183]
    ds_read_b128 v[100:103], v15 offset:51200
    v_mfma_f32_16x16x32_bf16 v[184:187], v[44:47], v[72:75], v[184:187]
    ds_read_b128 v[104:107], v15 offset:53248
    v_mfma_f32_16x16x32_bf16 v[188:191], v[44:47], v[76:79], v[188:191]
    ds_read_b128 v[108:111], v15 offset:55296
    v_mfma_f32_16x16x32_bf16 v[192:195], v[48:51], v[64:67], v[192:195]
    s_add_u32 m0, s48, 131072
    s_add_u32 s12, s55, 1572864
    buffer_load_dwordx4 v30, s[20:23], s12 offen lds
    v_mfma_f32_16x16x32_bf16 v[196:199], v[48:51], v[68:71], v[196:199]
    v_mfma_f32_16x16x32_bf16 v[200:203], v[48:51], v[72:75], v[200:203]
    s_add_u32 m0, s48, 132096
    s_add_u32 s12, s55, 1589248
    buffer_load_dwordx4 v31, s[20:23], s12 offen lds
    v_mfma_f32_16x16x32_bf16 v[204:207], v[48:51], v[76:79], v[204:207]
    v_mfma_f32_16x16x32_bf16 v[208:211], v[52:55], v[64:67], v[208:211]
    s_add_u32 m0, s56, 2048
    s_add_u32 s12, s54, 16768
    buffer_load_dwordx4 v10, s[16:19], s12 offen lds
    v_mfma_f32_16x16x32_bf16 v[212:215], v[52:55], v[68:71], v[212:215]
    v_mfma_f32_16x16x32_bf16 v[216:219], v[52:55], v[72:75], v[216:219]
    s_add_u32 m0, s56, 3072
    s_add_u32 s12, s54, 24960
    buffer_load_dwordx4 v11, s[16:19], s12 offen lds
    v_mfma_f32_16x16x32_bf16 v[220:223], v[52:55], v[76:79], v[220:223]
    v_mfma_f32_16x16x32_bf16 v[224:227], v[56:59], v[64:67], v[224:227]
    s_or_b32 s12, s2, s3
    s_cbranch_scc1 flag_8
    v_mov_b32 v8, 0
    v_mov_b32 v9, 1
    buffer_store_dword v9, v8, s[28:31], 0 offen sc1
flag_8:
    v_mfma_f32_16x16x32_bf16 v[228:231], v[56:59], v[68:71], v[228:231]
    v_mfma_f32_16x16x32_bf16 v[232:235], v[56:59], v[72:75], v[232:235]
    v_mfma_f32_16x16x32_bf16 v[236:239], v[56:59], v[76:79], v[236:239]
    v_mfma_f32_16x16x32_bf16 v[240:243], v[60:63], v[64:67], v[240:243]
    v_mfma_f32_16x16x32_bf16 v[244:247], v[60:63], v[68:71], v[244:247]
    v_mfma_f32_16x16x32_bf16 v[248:251], v[60:63], v[72:75], v[248:251]
    v_mfma_f32_16x16x32_bf16 v[252:255], v[60:63], v[76:79], v[252:255]
    s_waitcnt vmcnt(8) lgkmcnt(0)
    s_barrier
    v_mfma_f32_16x16x32_bf16 v[128:131], v[80:83], v[112:115], v[128:131]
    ds_read_b128 v[32:35], v16 offset:0
    v_mfma_f32_16x16x32_bf16 v[132:135], v[80:83], v[116:119], v[132:135]
    ds_read_b64_tr_b16 v[64:65], v18 offset:0
    v_mfma_f32_16x16x32_bf16 v[136:139], v[80:83], v[120:123], v[136:139]
    ds_read_b64_tr_b16 v[66:67], v18 offset:2048
    v_mfma_f32_16x16x32_bf16 v[140:143], v[80:83], v[124:127], v[140:143]
    ds_read_b64_tr_b16 v[68:69], v19 offset:0
    v_mfma_f32_16x16x32_bf16 v[144:147], v[84:87], v[112:115], v[144:147]
    ds_read_b64_tr_b16 v[70:71], v19 offset:2048
    v_mfma_f32_16x16x32_bf16 v[148:151], v[84:87], v[116:119], v[148:151]
    ds_read_b64_tr_b16 v[72:73], v20 offset:0
    v_mfma_f32_16x16x32_bf16 v[152:155], v[84:87], v[120:123], v[152:155]
    ds_read_b64_tr_b16 v[74:75], v20 offset:2048
    v_mfma_f32_16x16x32_bf16 v[156:159], v[84:87], v[124:127], v[156:159]
    ds_read_b64_tr_b16 v[76:77], v21 offset:0
    v_mfma_f32_16x16x32_bf16 v[160:163], v[88:91], v[112:115], v[160:163]
    ds_read_b64_tr_b16 v[78:79], v21 offset:2048
    v_mfma_f32_16x16x32_bf16 v[164:167], v[88:91], v[116:119], v[164:167]
    ds_read_b128 v[36:39], v16 offset:2048
    v_mfma_f32_16x16x32_bf16 v[168:171], v[88:91], v[120:123], v[168:171]
    ds_read_b128 v[40:43], v16 offset:4096
    v_mfma_f32_16x16x32_bf16 v[172:175], v[88:91], v[124:127], v[172:175]
    ds_read_b128 v[44:47], v16 offset:6144
    v_mfma_f32_16x16x32_bf16 v[176:179], v[92:95], v[112:115], v[176:179]
    ds_read_b128 v[48:51], v16 offset:16384
    v_mfma_f32_16x16x32_bf16 v[180:183], v[92:95], v[116:119], v[180:183]
    ds_read_b128 v[52:55], v16 offset:18432
    v_mfma_f32_16x16x32_bf16 v[184:187], v[92:95], v[120:123], v[184:187]
    ds_read_b128 v[56:59], v16 offset:20480
    v_mfma_f32_16x16x32_bf16 v[188:191], v[92:95], v[124:127], v[188:191]
    ds_read_b128 v[60:63], v16 offset:22528
    v_mfma_f32_16x16x32_bf16 v[192:195], v[96:99], v[112:115], v[192:195]
    s_add_u32 m0, s48, 147456
    s_add_u32 s12, s55, 1835008
    buffer_load_dwordx4 v30, s[20:23], s12 offen lds
    v_mfma_f32_16x16x32_bf16 v[196:199], v[96:99], v[116:119], v[196:199]
    v_mfma_f32_16x16x32_bf16 v[200:203], v[96:99], v[120:123], v[200:203]
    s_add_u32 m0, s48, 148480
    s_add_u32 s12, s55, 1851392
    buffer_load_dwordx4 v31, s[20:23], s12 offen lds
    v_mfma_f32_16x16x32_bf16 v[204:207], v[96:99], v[124:127], v[204:207]
    v_mfma_f32_16x16x32_bf16 v[208:211], v[100:103], v[112:115], v[208:211]
    s_add_u32 m0, s56, 32768
    s_add_u32 s12, s54, 512
    buffer_load_dwordx4 v10, s[16:19], s12 offen lds
    v_mfma_f32_16x16x32_bf16 v[212:215], v[100:103], v[116:119], v[212:215]
    v_mfma_f32_16x16x32_bf16 v[216:219], v[100:103], v[120:123], v[216:219]
    s_add_u32 m0, s56, 33792
    s_add_u32 s12, s54, 8704
    buffer_load_dwordx4 v11, s[16:19], s12 offen lds
    v_mfma_f32_16x16x32_bf16 v[220:223], v[100:103], v[124:127], v[220:223]
    v_mfma_f32_16x16x32_bf16 v[224:227], v[104:107], v[112:115], v[224:227]
    s_cmp_ge_u32 s3, 3
    s_cbranch_scc1 warm_9
    buffer_load_dword v28, v29, s[8:11], s51 offen
warm_9:
    v_mfma_f32_16x16x32_bf16 v[228:231], v[104:107], v[116:119], v[228:231]
    v_mfma_f32_16x16x32_bf16 v[232:235], v[104:107], v[120:123], v[232:235]
    v_mfma_f32_16x16x32_bf16 v[236:239], v[104:107], v[124:127], v[236:239]
    v_mfma_f32_16x16x32_bf16 v[240:243], v[108:111], v[112:115], v[240:243]
    v_mfma_f32_16x16x32_bf16 v[244:247], v[108:111], v[116:119], v[244:247]
    v_mfma_f32_16x16x32_bf16 v[248:251], v[108:111], v[120:123], v[248:251]
    v_mfma_f32_16x16x32_bf16 v[252:255], v[108:111], v[124:127], v[252:255]
    s_waitcnt vmcnt(10) lgkmcnt(0)
    s_barrier
    v_mfma_f32_16x16x32_bf16 v[128:131], v[32:35], v[64:67], v[128:131]
    ds_read_b128 v[80:83], v17 offset:0
    v_mfma_f32_16x16x32_bf16 v[132:135], v[32:35], v[68:71], v[132:135]
    ds_read_b64_tr_b16 v[112:113], v18 offset:16384
    v_mfma_f32_16x16x32_bf16 v[136:139], v[32:35], v[72:75], v[136:139]
    ds_read_b64_tr_b16 v[114:115], v18 offset:18432
    v_mfma_f32_16x16x32_bf16 v[140:143], v[32:35], v[76:79], v[140:143]
    ds_read_b64_tr_b16 v[116:117], v19 offset:16384
    v_mfma_f32_16x16x32_bf16 v[144:147], v[36:39], v[64:67], v[144:147]
    ds_read_b64_tr_b16 v[118:119], v19 offset:18432
    v_mfma_f32_16x16x32_bf16 v[148:151], v[36:39], v[68:71], v[148:151]
    ds_read_b64_tr_b16 v[120:121], v20 offset:16384
    v_mfma_f32_16x16x32_bf16 v[152:155], v[36:39], v[72:75], v[152:155]
    ds_read_b64_tr_b16 v[122:123], v20 offset:18432
    v_mfma_f32_16x16x32_bf16 v[156:159], v[36:39], v[76:79], v[156:159]
    ds_read_b64_tr_b16 v[124:125], v21 offset:16384
    v_mfma_f32_16x16x32_bf16 v[160:163], v[40:43], v[64:67], v[160:163]
    ds_read_b64_tr_b16 v[126:127], v21 offset:18432
    v_mfma_f32_16x16x32_bf16 v[164:167], v[40:43], v[68:71], v[164:167]
    ds_read_b128 v[84:87], v17 offset:2048
    v_mfma_f32_16x16x32_bf16 v[168:171], v[40:43], v[72:75], v[168:171]
    ds_read_b128 v[88:91], v17 offset:4096
    v_mfma_f32_16x16x32_bf16 v[172:175], v[40:43], v[76:79], v[172:175]
    ds_read_b128 v[92:95], v17 offset:6144
    v_mfma_f32_16x16x32_bf16 v[176:179], v[44:47], v[64:67], v[176:179]
    ds_read_b128 v[96:99], v17 offset:16384
    v_mfma_f32_16x16x32_bf16 v[180:183], v[44:47], v[68:71], v[180:183]
    ds_read_b128 v[100:103], v17 offset:18432
    v_mfma_f32_16x16x32_bf16 v[184:187], v[44:47], v[72:75], v[184:187]
    ds_read_b128 v[104:107], v17 offset:20480
    v_mfma_f32_16x16x32_bf16 v[188:191], v[44:47], v[76:79], v[188:191]
    ds_read_b128 v[108:111], v17 offset:22528
    v_mfma_f32_16x16x32_bf16 v[192:195], v[48:51], v[64:67], v[192:195]
    s_add_u32 m0, s48, 98304
    s_add_u32 s12, s55, 2097152
    buffer_load_dwordx4 v30, s[20:23], s12 offen lds
    v_mfma_f32_16x16x32_bf16 v[196:199], v[48:51], v[68:71], v[196:199]
    v_mfma_f32_16x16x32_bf16 v[200:203], v[48:51], v[72:75], v[200:203]
    s_add_u32 m0, s48, 99328
    s_add_u32 s12, s55, 2113536
    buffer_load_dwordx4 v31, s[20:23], s12 offen lds
    v_mfma_f32_16x16x32_bf16 v[204:207], v[48:51], v[76:79], v[204:207]
    v_mfma_f32_16x16x32_bf16 v[208:211], v[52:55], v[64:67], v[208:211]
    s_add_u32 m0, s56, 34816
    s_add_u32 s12, s54, 16896
    buffer_load_dwordx4 v10, s[16:19], s12 offen lds
    v_mfma_f32_16x16x32_bf16 v[212:215], v[52:55], v[68:71], v[212:215]
    v_mfma_f32_16x16x32_bf16 v[216:219], v[52:55], v[72:75], v[216:219]
    s_add_u32 m0, s56, 35840
    s_add_u32 s12, s54, 25088
    buffer_load_dwordx4 v11, s[16:19], s12 offen lds
    v_mfma_f32_16x16x32_bf16 v[220:223], v[52:55], v[76:79], v[220:223]
    v_mfma_f32_16x16x32_bf16 v[224:227], v[56:59], v[64:67], v[224:227]
    v_mov_b32_e64 v8, 0
    buffer_load_dword v26, v8, s[28:31], 0 offen sc1
    v_mfma_f32_16x16x32_bf16 v[228:231], v[56:59], v[68:71], v[228:231]
    v_mfma_f32_16x16x32_bf16 v[232:235], v[56:59], v[72:75], v[232:235]
    v_mfma_f32_16x16x32_bf16 v[236:239], v[56:59], v[76:79], v[236:239]
    v_mfma_f32_16x16x32_bf16 v[240:243], v[60:63], v[64:67], v[240:243]
    v_mfma_f32_16x16x32_bf16 v[244:247], v[60:63], v[68:71], v[244:247]
    v_mfma_f32_16x16x32_bf16 v[248:251], v[60:63], v[72:75], v[248:251]
    v_mfma_f32_16x16x32_bf16 v[252:255], v[60:63], v[76:79], v[252:255]
    s_waitcnt vmcnt(9) lgkmcnt(0)
    s_barrier
    v_mfma_f32_16x16x32_bf16 v[128:131], v[80:83], v[112:115], v[128:131]
    ds_read_b128 v[32:35], v14 offset:0
    v_mfma_f32_16x16x32_bf16 v[132:135], v[80:83], v[116:119], v[132:135]
    ds_read_b64_tr_b16 v[64:65], v18 offset:32768
    v_mfma_f32_16x16x32_bf16 v[136:139], v[80:83], v[120:123], v[136:139]
    ds_read_b64_tr_b16 v[66:67], v18 offset:34816
    v_mfma_f32_16x16x32_bf16 v[140:143], v[80:83], v[124:127], v[140:143]
    ds_read_b64_tr_b16 v[68:69], v19 offset:32768
    v_mfma_f32_16x16x32_bf16 v[144:147], v[84:87], v[112:115], v[144:147]
    ds_read_b64_tr_b16 v[70:71], v19 offset:34816
    v_mfma_f32_16x16x32_bf16 v[148:151], v[84:87], v[116:119], v[148:151]
    ds_read_b64_tr_b16 v[72:73], v20 offset:32768
    v_mfma_f32_16x16x32_bf16 v[152:155], v[84:87], v[120:123], v[152:155]
    ds_read_b64_tr_b16 v[74:75], v20 offset:34816
    v_mfma_f32_16x16x32_bf16 v[156:159], v[84:87], v[124:127], v[156:159]
    ds_read_b64_tr_b16 v[76:77], v21 offset:32768
    v_mfma_f32_16x16x32_bf16 v[160:163], v[88:91], v[112:115], v[160:163]
    ds_read_b64_tr_b16 v[78:79], v21 offset:34816
    v_mfma_f32_16x16x32_bf16 v[164:167], v[88:91], v[116:119], v[164:167]
    ds_read_b128 v[36:39], v14 offset:2048
    v_mfma_f32_16x16x32_bf16 v[168:171], v[88:91], v[120:123], v[168:171]
    ds_read_b128 v[40:43], v14 offset:4096
    v_mfma_f32_16x16x32_bf16 v[172:175], v[88:91], v[124:127], v[172:175]
    ds_read_b128 v[44:47], v14 offset:6144
    v_mfma_f32_16x16x32_bf16 v[176:179], v[92:95], v[112:115], v[176:179]
    ds_read_b128 v[48:51], v14 offset:16384
    v_mfma_f32_16x16x32_bf16 v[180:183], v[92:95], v[116:119], v[180:183]
    ds_read_b128 v[52:55], v14 offset:18432
    v_mfma_f32_16x16x32_bf16 v[184:187], v[92:95], v[120:123], v[184:187]
    ds_read_b128 v[56:59], v14 offset:20480
    v_mfma_f32_16x16x32_bf16 v[188:191], v[92:95], v[124:127], v[188:191]
    ds_read_b128 v[60:63], v14 offset:22528
    v_mfma_f32_16x16x32_bf16 v[192:195], v[96:99], v[112:115], v[192:195]
    s_add_u32 m0, s48, 114688
    s_add_u32 s12, s55, 2359296
    buffer_load_dwordx4 v30, s[20:23], s12 offen lds
    v_mfma_f32_16x16x32_bf16 v[196:199], v[96:99], v[116:119], v[196:199]
    v_mfma_f32_16x16x32_bf16 v[200:203], v[96:99], v[120:123], v[200:203]
    s_add_u32 m0, s48, 115712
    s_add_u32 s12, s55, 2375680
    buffer_load_dwordx4 v31, s[20:23], s12 offen lds
    v_mfma_f32_16x16x32_bf16 v[204:207], v[96:99], v[124:127], v[204:207]
    v_mfma_f32_16x16x32_bf16 v[208:211], v[100:103], v[112:115], v[208:211]
    s_add_u32 m0, s56, 65536
    s_add_u32 s12, s54, 640
    buffer_load_dwordx4 v10, s[16:19], s12 offen lds
    v_mfma_f32_16x16x32_bf16 v[212:215], v[100:103], v[116:119], v[212:215]
    v_mfma_f32_16x16x32_bf16 v[216:219], v[100:103], v[120:123], v[216:219]
    s_add_u32 m0, s56, 66560
    s_add_u32 s12, s54, 8832
    buffer_load_dwordx4 v11, s[16:19], s12 offen lds
    v_mfma_f32_16x16x32_bf16 v[220:223], v[100:103], v[124:127], v[220:223]
    v_mfma_f32_16x16x32_bf16 v[224:227], v[104:107], v[112:115], v[224:227]
    v_mfma_f32_16x16x32_bf16 v[228:231], v[104:107], v[116:119], v[228:231]
    v_mfma_f32_16x16x32_bf16 v[232:235], v[104:107], v[120:123], v[232:235]
    v_mfma_f32_16x16x32_bf16 v[236:239], v[104:107], v[124:127], v[236:239]
    v_mfma_f32_16x16x32_bf16 v[240:243], v[108:111], v[112:115], v[240:243]
    v_mfma_f32_16x16x32_bf16 v[244:247], v[108:111], v[116:119], v[244:247]
    v_mfma_f32_16x16x32_bf16 v[248:251], v[108:111], v[120:123], v[248:251]
    v_mfma_f32_16x16x32_bf16 v[252:255], v[108:111], v[124:127], v[252:255]
    s_waitcnt vmcnt(11) lgkmcnt(0)
    s_barrier
    v_mfma_f32_16x16x32_bf16 v[128:131], v[32:35], v[64:67], v[128:131]
    ds_read_b128 v[80:83], v15 offset:0
    v_mfma_f32_16x16x32_bf16 v[132:135], v[32:35], v[68:71], v[132:135]
    ds_read_b64_tr_b16 v[112:113], v18 offset:49152
    v_mfma_f32_16x16x32_bf16 v[136:139], v[32:35], v[72:75], v[136:139]
    ds_read_b64_tr_b16 v[114:115], v18 offset:51200
    v_mfma_f32_16x16x32_bf16 v[140:143], v[32:35], v[76:79], v[140:143]
    ds_read_b64_tr_b16 v[116:117], v19 offset:49152
    v_mfma_f32_16x16x32_bf16 v[144:147], v[36:39], v[64:67], v[144:147]
    ds_read_b64_tr_b16 v[118:119], v19 offset:51200
    v_mfma_f32_16x16x32_bf16 v[148:151], v[36:39], v[68:71], v[148:151]
    ds_read_b64_tr_b16 v[120:121], v20 offset:49152
    v_mfma_f32_16x16x32_bf16 v[152:155], v[36:39], v[72:75], v[152:155]
    ds_read_b64_tr_b16 v[122:123], v20 offset:51200
    v_mfma_f32_16x16x32_bf16 v[156:159], v[36:39], v[76:79], v[156:159]
    ds_read_b64_tr_b16 v[124:125], v21 offset:49152
    v_mfma_f32_16x16x32_bf16 v[160:163], v[40:43], v[64:67], v[160:163]
    ds_read_b64_tr_b16 v[126:127], v21 offset:51200
    v_mfma_f32_16x16x32_bf16 v[164:167], v[40:43], v[68:71], v[164:167]
    ds_read_b128 v[84:87], v15 offset:2048
    v_mfma_f32_16x16x32_bf16 v[168:171], v[40:43], v[72:75], v[168:171]
    ds_read_b128 v[88:91], v15 offset:4096
    v_mfma_f32_16x16x32_bf16 v[172:175], v[40:43], v[76:79], v[172:175]
    ds_read_b128 v[92:95], v15 offset:6144
    v_mfma_f32_16x16x32_bf16 v[176:179], v[44:47], v[64:67], v[176:179]
    ds_read_b128 v[96:99], v15 offset:16384
    v_mfma_f32_16x16x32_bf16 v[180:183], v[44:47], v[68:71], v[180:183]
    ds_read_b128 v[100:103], v15 offset:18432
    v_mfma_f32_16x16x32_bf16 v[184:187], v[44:47], v[72:75], v[184:187]
    ds_read_b128 v[104:107], v15 offset:20480
    v_mfma_f32_16x16x32_bf16 v[188:191], v[44:47], v[76:79], v[188:191]
    ds_read_b128 v[108:111], v15 offset:22528
    v_mfma_f32_16x16x32_bf16 v[192:195], v[48:51], v[64:67], v[192:195]
    s_add_u32 m0, s48, 131072
    s_add_u32 s12, s55, 2621440
    buffer_load_dwordx4 v30, s[20:23], s12 offen lds
    v_mfma_f32_16x16x32_bf16 v[196:199], v[48:51], v[68:71], v[196:199]
    v_mfma_f32_16x16x32_bf16 v[200:203], v[48:51], v[72:75], v[200:203]
    s_add_u32 m0, s48, 132096
    s_add_u32 s12, s55, 2637824
    buffer_load_dwordx4 v31, s[20:23], s12 offen lds
    v_mfma_f32_16x16x32_bf16 v[204:207], v[48:51], v[76:79], v[204:207]
    v_mfma_f32_16x16x32_bf16 v[208:211], v[52:55], v[64:67], v[208:211]
    s_add_u32 m0, s56, 67584
    s_add_u32 s12, s54, 17024
    buffer_load_dwordx4 v10, s[16:19], s12 offen lds
    v_mfma_f32_16x16x32_bf16 v[212:215], v[52:55], v[68:71], v[212:215]
    v_mfma_f32_16x16x32_bf16 v[216:219], v[52:55], v[72:75], v[216:219]
    s_add_u32 m0, s56, 68608
    s_add_u32 s12, s54, 25216
    buffer_load_dwordx4 v11, s[16:19], s12 offen lds
    v_mfma_f32_16x16x32_bf16 v[220:223], v[52:55], v[76:79], v[220:223]
    v_mfma_f32_16x16x32_bf16 v[224:227], v[56:59], v[64:67], v[224:227]
    v_mfma_f32_16x16x32_bf16 v[228:231], v[56:59], v[68:71], v[228:231]
    v_mfma_f32_16x16x32_bf16 v[232:235], v[56:59], v[72:75], v[232:235]
    v_mfma_f32_16x16x32_bf16 v[236:239], v[56:59], v[76:79], v[236:239]
    v_mfma_f32_16x16x32_bf16 v[240:243], v[60:63], v[64:67], v[240:243]
    v_mfma_f32_16x16x32_bf16 v[244:247], v[60:63], v[68:71], v[244:247]
    v_mfma_f32_16x16x32_bf16 v[248:251], v[60:63], v[72:75], v[248:251]
    v_mfma_f32_16x16x32_bf16 v[252:255], v[60:63], v[76:79], v[252:255]
    s_waitcnt vmcnt(9) lgkmcnt(0)
    s_barrier
    v_mfma_f32_16x16x32_bf16 v[128:131], v[80:83], v[112:115], v[128:131]
    ds_read_b128 v[32:35], v14 offset:32768
    v_mfma_f32_16x16x32_bf16 v[132:135], v[80:83], v[116:119], v[132:135]
    ds_read_b64_tr_b16 v[64:65], v18 offset:0
    v_mfma_f32_16x16x32_bf16 v[136:139], v[80:83], v[120:123], v[136:139]
    ds_read_b64_tr_b16 v[66:67], v18 offset:2048
    v_mfma_f32_16x16x32_bf16 v[140:143], v[80:83], v[124:127], v[140:143]
    ds_read_b64_tr_b16 v[68:69], v19 offset:0
    v_mfma_f32_16x16x32_bf16 v[144:147], v[84:87], v[112:115], v[144:147]
    ds_read_b64_tr_b16 v[70:71], v19 offset:2048
    v_mfma_f32_16x16x32_bf16 v[148:151], v[84:87], v[116:119], v[148:151]
    ds_read_b64_tr_b16 v[72:73], v20 offset:0
    v_mfma_f32_16x16x32_bf16 v[152:155], v[84:87], v[120:123], v[152:155]
    ds_read_b64_tr_b16 v[74:75], v20 offset:2048
    v_mfma_f32_16x16x32_bf16 v[156:159], v[84:87], v[124:127], v[156:159]
    ds_read_b64_tr_b16 v[76:77], v21 offset:0
    v_mfma_f32_16x16x32_bf16 v[160:163], v[88:91], v[112:115], v[160:163]
    ds_read_b64_tr_b16 v[78:79], v21 offset:2048
    v_mfma_f32_16x16x32_bf16 v[164:167], v[88:91], v[116:119], v[164:167]
    ds_read_b128 v[36:39], v14 offset:34816
    v_mfma_f32_16x16x32_bf16 v[168:171], v[88:91], v[120:123], v[168:171]
    ds_read_b128 v[40:43], v14 offset:36864
    v_mfma_f32_16x16x32_bf16 v[172:175], v[88:91], v[124:127], v[172:175]
    ds_read_b128 v[44:47], v14 offset:38912
    v_mfma_f32_16x16x32_bf16 v[176:179], v[92:95], v[112:115], v[176:179]
    ds_read_b128 v[48:51], v14 offset:49152
    v_mfma_f32_16x16x32_bf16 v[180:183], v[92:95], v[116:119], v[180:183]
    ds_read_b128 v[52:55], v14 offset:51200
    v_mfma_f32_16x16x32_bf16 v[184:187], v[92:95], v[120:123], v[184:187]
    ds_read_b128 v[56:59], v14 offset:53248
    v_mfma_f32_16x16x32_bf16 v[188:191], v[92:95], v[124:127], v[188:191]
    ds_read_b128 v[60:63], v14 offset:55296
    v_mfma_f32_16x16x32_bf16 v[192:195], v[96:99], v[112:115], v[192:195]
    s_add_u32 m0, s48, 147456
    s_add_u32 s12, s55, 2883584
    buffer_load_dwordx4 v30, s[20:23], s12 offen lds
    v_mfma_f32_16x16x32_bf16 v[196:199], v[96:99], v[116:119], v[196:199]
    v_mfma_f32_16x16x32_bf16 v[200:203], v[96:99], v[120:123], v[200:203]
    s_add_u32 m0, s48, 148480
    s_add_u32 s12, s55, 2899968
    buffer_load_dwordx4 v31, s[20:23], s12 offen lds
    v_mfma_f32_16x16x32_bf16 v[204:207], v[96:99], v[124:127], v[204:207]
    v_mfma_f32_16x16x32_bf16 v[208:211], v[100:103], v[112:115], v[208:211]
    s_add_u32 m0, s56, 0
    s_add_u32 s12, s54, 768
    buffer_load_dwordx4 v10, s[16:19], s12 offen lds
    v_mfma_f32_16x16x32_bf16 v[212:215], v[100:103], v[116:119], v[212:215]
    v_mfma_f32_16x16x32_bf16 v[216:219], v[100:103], v[120:123], v[216:219]
    s_add_u32 m0, s56, 1024
    s_add_u32 s12, s54, 8960
    buffer_load_dwordx4 v11, s[16:19], s12 offen lds
    v_mfma_f32_16x16x32_bf16 v[220:223], v[100:103], v[124:127], v[220:223]
    v_mfma_f32_16x16x32_bf16 v[224:227], v[104:107], v[112:115], v[224:227]
    v_mfma_f32_16x16x32_bf16 v[228:231], v[104:107], v[116:119], v[228:231]
    v_mfma_f32_16x16x32_bf16 v[232:235], v[104:107], v[120:123], v[232:235]
    v_mfma_f32_16x16x32_bf16 v[236:239], v[104:107], v[124:127], v[236:239]
    v_mfma_f32_16x16x32_bf16 v[240:243], v[108:111], v[112:115], v[240:243]
    v_mfma_f32_16x16x32_bf16 v[244:247], v[108:111], v[116:119], v[244:247]
    v_mfma_f32_16x16x32_bf16 v[248:251], v[108:111], v[120:123], v[248:251]
    v_mfma_f32_16x16x32_bf16 v[252:255], v[108:111], v[124:127], v[252:255]
    s_waitcnt vmcnt(10) lgkmcnt(0)
    s_barrier
    s_cmp_lg_u32 s3, 0
    s_cbranch_scc1 initd_11
    s_mov_b32 s15, 0x20000
initw_10:
    v_cmp_eq_u32 vcc, 0, v26
    s_cbranch_vccz initd_11
    s_sleep 8
    v_mov_b32_e64 v8, 0
    buffer_load_dword v26, v8, s[28:31], 0 offen sc1
    s_waitcnt vmcnt(0)
    s_sub_u32 s15, s15, 1
    s_cmp_lg_u32 s15, 0
    s_cbranch_scc1 initw_10
initd_11:
    s_lshr_b32 s13, s2, 4
    s_cmp_lg_u32 s3, 0
    s_cbranch_scc1 sig_12
    s_lshl_b32 s14, s13, 8
    s_add_u32 s14, s14, 117440512
    v_mov_b32_e64 v8, 0
    v_mov_b32 v9, 1
    s_mov_b64 exec, 1
    buffer_atomic_add v9, v8, s[4:7], s14 offen sc1
    s_mov_b64 exec, -1
sig_12:
    v_mfma_f32_16x16x32_bf16 v[128:131], v[32:35], v[64:67], v[128:131]
    ds_read_b128 v[80:83], v15 offset:32768
    v_mfma_f32_16x16x32_bf16 v[132:135], v[32:35], v[68:71], v[132:135]
    ds_read_b64_tr_b16 v[112:113], v18 offset:16384
    v_mfma_f32_16x16x32_bf16 v[136:139], v[32:35], v[72:75], v[136:139]
    ds_read_b64_tr_b16 v[114:115], v18 offset:18432
    v_mfma_f32_16x16x32_bf16 v[140:143], v[32:35], v[76:79], v[140:143]
    ds_read_b64_tr_b16 v[116:117], v19 offset:16384
    v_mfma_f32_16x16x32_bf16 v[144:147], v[36:39], v[64:67], v[144:147]
    ds_read_b64_tr_b16 v[118:119], v19 offset:18432
    v_mfma_f32_16x16x32_bf16 v[148:151], v[36:39], v[68:71], v[148:151]
    ds_read_b64_tr_b16 v[120:121], v20 offset:16384
    v_mfma_f32_16x16x32_bf16 v[152:155], v[36:39], v[72:75], v[152:155]
    ds_read_b64_tr_b16 v[122:123], v20 offset:18432
    v_mfma_f32_16x16x32_bf16 v[156:159], v[36:39], v[76:79], v[156:159]
    ds_read_b64_tr_b16 v[124:125], v21 offset:16384
    v_mfma_f32_16x16x32_bf16 v[160:163], v[40:43], v[64:67], v[160:163]
    ds_read_b64_tr_b16 v[126:127], v21 offset:18432
    v_mfma_f32_16x16x32_bf16 v[164:167], v[40:43], v[68:71], v[164:167]
    ds_read_b128 v[84:87], v15 offset:34816
    v_mfma_f32_16x16x32_bf16 v[168:171], v[40:43], v[72:75], v[168:171]
    ds_read_b128 v[88:91], v15 offset:36864
    v_mfma_f32_16x16x32_bf16 v[172:175], v[40:43], v[76:79], v[172:175]
    ds_read_b128 v[92:95], v15 offset:38912
    v_mfma_f32_16x16x32_bf16 v[176:179], v[44:47], v[64:67], v[176:179]
    ds_read_b128 v[96:99], v15 offset:49152
    v_mfma_f32_16x16x32_bf16 v[180:183], v[44:47], v[68:71], v[180:183]
    ds_read_b128 v[100:103], v15 offset:51200
    v_mfma_f32_16x16x32_bf16 v[184:187], v[44:47], v[72:75], v[184:187]
    ds_read_b128 v[104:107], v15 offset:53248
    v_mfma_f32_16x16x32_bf16 v[188:191], v[44:47], v[76:79], v[188:191]
    ds_read_b128 v[108:111], v15 offset:55296
    v_mfma_f32_16x16x32_bf16 v[192:195], v[48:51], v[64:67], v[192:195]
    s_add_u32 m0, s48, 98304
    s_add_u32 s12, s55, 3145728
    buffer_load_dwordx4 v30, s[20:23], s12 offen lds
    v_mfma_f32_16x16x32_bf16 v[196:199], v[48:51], v[68:71], v[196:199]
    v_mfma_f32_16x16x32_bf16 v[200:203], v[48:51], v[72:75], v[200:203]
    s_add_u32 m0, s48, 99328
    s_add_u32 s12, s55, 3162112
    buffer_load_dwordx4 v31, s[20:23], s12 offen lds
    v_mfma_f32_16x16x32_bf16 v[204:207], v[48:51], v[76:79], v[204:207]
    v_mfma_f32_16x16x32_bf16 v[208:211], v[52:55], v[64:67], v[208:211]
    s_add_u32 m0, s56, 2048
    s_add_u32 s12, s54, 17152
    buffer_load_dwordx4 v10, s[16:19], s12 offen lds
    v_mfma_f32_16x16x32_bf16 v[212:215], v[52:55], v[68:71], v[212:215]
    v_mfma_f32_16x16x32_bf16 v[216:219], v[52:55], v[72:75], v[216:219]
    s_add_u32 m0, s56, 3072
    s_add_u32 s12, s54, 25344
    buffer_load_dwordx4 v11, s[16:19], s12 offen lds
    v_mfma_f32_16x16x32_bf16 v[220:223], v[52:55], v[76:79], v[220:223]
    v_mfma_f32_16x16x32_bf16 v[224:227], v[56:59], v[64:67], v[224:227]
    v_mfma_f32_16x16x32_bf16 v[228:231], v[56:59], v[68:71], v[228:231]
    v_mfma_f32_16x16x32_bf16 v[232:235], v[56:59], v[72:75], v[232:235]
    v_mfma_f32_16x16x32_bf16 v[236:239], v[56:59], v[76:79], v[236:239]
    v_mfma_f32_16x16x32_bf16 v[240:243], v[60:63], v[64:67], v[240:243]
    v_mfma_f32_16x16x32_bf16 v[244:247], v[60:63], v[68:71], v[244:247]
    v_mfma_f32_16x16x32_bf16 v[248:251], v[60:63], v[72:75], v[248:251]
    v_mfma_f32_16x16x32_bf16 v[252:255], v[60:63], v[76:79], v[252:255]
    s_waitcnt vmcnt(8) lgkmcnt(0)
    s_barrier
    v_mfma_f32_16x16x32_bf16 v[128:131], v[80:83], v[112:115], v[128:131]
    ds_read_b128 v[32:35], v16 offset:0
    v_mfma_f32_16x16x32_bf16 v[132:135], v[80:83], v[116:119], v[132:135]
    ds_read_b64_tr_b16 v[64:65], v18 offset:32768
    v_mfma_f32_16x16x32_bf16 v[136:139], v[80:83], v[120:123], v[136:139]
    ds_read_b64_tr_b16 v[66:67], v18 offset:34816
    v_mfma_f32_16x16x32_bf16 v[140:143], v[80:83], v[124:127], v[140:143]
    ds_read_b64_tr_b16 v[68:69], v19 offset:32768
    v_mfma_f32_16x16x32_bf16 v[144:147], v[84:87], v[112:115], v[144:147]
    ds_read_b64_tr_b16 v[70:71], v19 offset:34816
    v_mfma_f32_16x16x32_bf16 v[148:151], v[84:87], v[116:119], v[148:151]
    ds_read_b64_tr_b16 v[72:73], v20 offset:32768
    v_mfma_f32_16x16x32_bf16 v[152:155], v[84:87], v[120:123], v[152:155]
    ds_read_b64_tr_b16 v[74:75], v20 offset:34816
    v_mfma_f32_16x16x32_bf16 v[156:159], v[84:87], v[124:127], v[156:159]
    ds_read_b64_tr_b16 v[76:77], v21 offset:32768
    v_mfma_f32_16x16x32_bf16 v[160:163], v[88:91], v[112:115], v[160:163]
    ds_read_b64_tr_b16 v[78:79], v21 offset:34816
    v_mfma_f32_16x16x32_bf16 v[164:167], v[88:91], v[116:119], v[164:167]
    ds_read_b128 v[36:39], v16 offset:2048
    v_mfma_f32_16x16x32_bf16 v[168:171], v[88:91], v[120:123], v[168:171]
    ds_read_b128 v[40:43], v16 offset:4096
    v_mfma_f32_16x16x32_bf16 v[172:175], v[88:91], v[124:127], v[172:175]
    ds_read_b128 v[44:47], v16 offset:6144
    v_mfma_f32_16x16x32_bf16 v[176:179], v[92:95], v[112:115], v[176:179]
    ds_read_b128 v[48:51], v16 offset:16384
    v_mfma_f32_16x16x32_bf16 v[180:183], v[92:95], v[116:119], v[180:183]
    ds_read_b128 v[52:55], v16 offset:18432
    v_mfma_f32_16x16x32_bf16 v[184:187], v[92:95], v[120:123], v[184:187]
    ds_read_b128 v[56:59], v16 offset:20480
    v_mfma_f32_16x16x32_bf16 v[188:191], v[92:95], v[124:127], v[188:191]
    ds_read_b128 v[60:63], v16 offset:22528
    v_mfma_f32_16x16x32_bf16 v[192:195], v[96:99], v[112:115], v[192:195]
    s_add_u32 m0, s48, 114688
    s_add_u32 s12, s55, 3407872
    buffer_load_dwordx4 v30, s[20:23], s12 offen lds
    v_mfma_f32_16x16x32_bf16 v[196:199], v[96:99], v[116:119], v[196:199]
    v_mfma_f32_16x16x32_bf16 v[200:203], v[96:99], v[120:123], v[200:203]
    s_add_u32 m0, s48, 115712
    s_add_u32 s12, s55, 3424256
    buffer_load_dwordx4 v31, s[20:23], s12 offen lds
    v_mfma_f32_16x16x32_bf16 v[204:207], v[96:99], v[124:127], v[204:207]
    v_mfma_f32_16x16x32_bf16 v[208:211], v[100:103], v[112:115], v[208:211]
    s_add_u32 m0, s56, 32768
    s_add_u32 s12, s54, 896
    buffer_load_dwordx4 v10, s[16:19], s12 offen lds
    v_mfma_f32_16x16x32_bf16 v[212:215], v[100:103], v[116:119], v[212:215]
    v_mfma_f32_16x16x32_bf16 v[216:219], v[100:103], v[120:123], v[216:219]
    s_add_u32 m0, s56, 33792
    s_add_u32 s12, s54, 9088
    buffer_load_dwordx4 v11, s[16:19], s12 offen lds
    v_mfma_f32_16x16x32_bf16 v[220:223], v[100:103], v[124:127], v[220:223]
    v_mfma_f32_16x16x32_bf16 v[224:227], v[104:107], v[112:115], v[224:227]
    v_mfma_f32_16x16x32_bf16 v[228:231], v[104:107], v[116:119], v[228:231]
    v_mfma_f32_16x16x32_bf16 v[232:235], v[104:107], v[120:123], v[232:235]
    v_mfma_f32_16x16x32_bf16 v[236:239], v[104:107], v[124:127], v[236:239]
    v_mfma_f32_16x16x32_bf16 v[240:243], v[108:111], v[112:115], v[240:243]
    v_mfma_f32_16x16x32_bf16 v[244:247], v[108:111], v[116:119], v[244:247]
    v_mfma_f32_16x16x32_bf16 v[248:251], v[108:111], v[120:123], v[248:251]
    v_mfma_f32_16x16x32_bf16 v[252:255], v[108:111], v[124:127], v[252:255]
    s_waitcnt vmcnt(10) lgkmcnt(0)
    s_barrier
    v_mfma_f32_16x16x32_bf16 v[128:131], v[32:35], v[64:67], v[128:131]
    ds_read_b128 v[80:83], v17 offset:0
    v_mfma_f32_16x16x32_bf16 v[132:135], v[32:35], v[68:71], v[132:135]
    ds_read_b64_tr_b16 v[112:113], v18 offset:49152
    v_mfma_f32_16x16x32_bf16 v[136:139], v[32:35], v[72:75], v[136:139]
    ds_read_b64_tr_b16 v[114:115], v18 offset:51200
    v_mfma_f32_16x16x32_bf16 v[140:143], v[32:35], v[76:79], v[140:143]
    ds_read_b64_tr_b16 v[116:117], v19 offset:49152
    v_mfma_f32_16x16x32_bf16 v[144:147], v[36:39], v[64:67], v[144:147]
    ds_read_b64_tr_b16 v[118:119], v19 offset:51200
    v_mfma_f32_16x16x32_bf16 v[148:151], v[36:39], v[68:71], v[148:151]
    ds_read_b64_tr_b16 v[120:121], v20 offset:49152
    v_mfma_f32_16x16x32_bf16 v[152:155], v[36:39], v[72:75], v[152:155]
    ds_read_b64_tr_b16 v[122:123], v20 offset:51200
    v_mfma_f32_16x16x32_bf16 v[156:159], v[36:39], v[76:79], v[156:159]
    ds_read_b64_tr_b16 v[124:125], v21 offset:49152
    v_mfma_f32_16x16x32_bf16 v[160:163], v[40:43], v[64:67], v[160:163]
    ds_read_b64_tr_b16 v[126:127], v21 offset:51200
    v_mfma_f32_16x16x32_bf16 v[164:167], v[40:43], v[68:71], v[164:167]
    ds_read_b128 v[84:87], v17 offset:2048
    v_mfma_f32_16x16x32_bf16 v[168:171], v[40:43], v[72:75], v[168:171]
    ds_read_b128 v[88:91], v17 offset:4096
    v_mfma_f32_16x16x32_bf16 v[172:175], v[40:43], v[76:79], v[172:175]
    ds_read_b128 v[92:95], v17 offset:6144
    v_mfma_f32_16x16x32_bf16 v[176:179], v[44:47], v[64:67], v[176:179]
    ds_read_b128 v[96:99], v17 offset:16384
    v_mfma_f32_16x16x32_bf16 v[180:183], v[44:47], v[68:71], v[180:183]
    ds_read_b128 v[100:103], v17 offset:18432
    v_mfma_f32_16x16x32_bf16 v[184:187], v[44:47], v[72:75], v[184:187]
    ds_read_b128 v[104:107], v17 offset:20480
    v_mfma_f32_16x16x32_bf16 v[188:191], v[44:47], v[76:79], v[188:191]
    ds_read_b128 v[108:111], v17 offset:22528
    v_mfma_f32_16x16x32_bf16 v[192:195], v[48:51], v[64:67], v[192:195]
    s_add_u32 m0, s48, 131072
    s_add_u32 s12, s55, 3670016
    buffer_load_dwordx4 v30, s[20:23], s12 offen lds
    v_mfma_f32_16x16x32_bf16 v[196:199], v[48:51], v[68:71], v[196:199]
    v_mfma_f32_16x16x32_bf16 v[200:203], v[48:51], v[72:75], v[200:203]
    s_add_u32 m0, s48, 132096
    s_add_u32 s12, s55, 3686400
    buffer_load_dwordx4 v31, s[20:23], s12 offen lds
    v_mfma_f32_16x16x32_bf16 v[204:207], v[48:51], v[76:79], v[204:207]
    v_mfma_f32_16x16x32_bf16 v[208:211], v[52:55], v[64:67], v[208:211]
    s_add_u32 m0, s56, 34816
    s_add_u32 s12, s54, 17280
    buffer_load_dwordx4 v10, s[16:19], s12 offen lds
    v_mfma_f32_16x16x32_bf16 v[212:215], v[52:55], v[68:71], v[212:215]
    v_mfma_f32_16x16x32_bf16 v[216:219], v[52:55], v[72:75], v[216:219]
    s_add_u32 m0, s56, 35840
    s_add_u32 s12, s54, 25472
    buffer_load_dwordx4 v11, s[16:19], s12 offen lds
    v_mfma_f32_16x16x32_bf16 v[220:223], v[52:55], v[76:79], v[220:223]
    v_mfma_f32_16x16x32_bf16 v[224:227], v[56:59], v[64:67], v[224:227]
    v_mfma_f32_16x16x32_bf16 v[228:231], v[56:59], v[68:71], v[228:231]
    v_mfma_f32_16x16x32_bf16 v[232:235], v[56:59], v[72:75], v[232:235]
    v_mfma_f32_16x16x32_bf16 v[236:239], v[56:59], v[76:79], v[236:239]
    v_mfma_f32_16x16x32_bf16 v[240:243], v[60:63], v[64:67], v[240:243]
    v_mfma_f32_16x16x32_bf16 v[244:247], v[60:63], v[68:71], v[244:247]
    v_mfma_f32_16x16x32_bf16 v[248:251], v[60:63], v[72:75], v[248:251]
    v_mfma_f32_16x16x32_bf16 v[252:255], v[60:63], v[76:79], v[252:255]
    s_waitcnt vmcnt(8) lgkmcnt(0)
    s_barrier
    v_mfma_f32_16x16x32_bf16 v[128:131], v[80:83], v[112:115], v[128:131]
    ds_read_b128 v[32:35], v14 offset:0
    v_mfma_f32_16x16x32_bf16 v[132:135], v[80:83], v[116:119], v[132:135]
    ds_read_b64_tr_b16 v[64:65], v18 offset:0
    v_mfma_f32_16x16x32_bf16 v[136:139], v[80:83], v[120:123], v[136:139]
    ds_read_b64_tr_b16 v[66:67], v18 offset:2048
    v_mfma_f32_16x16x32_bf16 v[140:143], v[80:83], v[124:127], v[140:143]
    ds_read_b64_tr_b16 v[68:69], v19 offset:0
    v_mfma_f32_16x16x32_bf16 v[144:147], v[84:87], v[112:115], v[144:147]
    ds_read_b64_tr_b16 v[70:71], v19 offset:2048
    v_mfma_f32_16x16x32_bf16 v[148:151], v[84:87], v[116:119], v[148:151]
    ds_read_b64_tr_b16 v[72:73], v20 offset:0
    v_mfma_f32_16x16x32_bf16 v[152:155], v[84:87], v[120:123], v[152:155]
    ds_read_b64_tr_b16 v[74:75], v20 offset:2048
    v_mfma_f32_16x16x32_bf16 v[156:159], v[84:87], v[124:127], v[156:159]
    ds_read_b64_tr_b16 v[76:77], v21 offset:0
    v_mfma_f32_16x16x32_bf16 v[160:163], v[88:91], v[112:115], v[160:163]
    ds_read_b64_tr_b16 v[78:79], v21 offset:2048
    v_mfma_f32_16x16x32_bf16 v[164:167], v[88:91], v[116:119], v[164:167]
    ds_read_b128 v[36:39], v14 offset:2048
    v_mfma_f32_16x16x32_bf16 v[168:171], v[88:91], v[120:123], v[168:171]
    ds_read_b128 v[40:43], v14 offset:4096
    v_mfma_f32_16x16x32_bf16 v[172:175], v[88:91], v[124:127], v[172:175]
    ds_read_b128 v[44:47], v14 offset:6144
    v_mfma_f32_16x16x32_bf16 v[176:179], v[92:95], v[112:115], v[176:179]
    ds_read_b128 v[48:51], v14 offset:16384
    v_mfma_f32_16x16x32_bf16 v[180:183], v[92:95], v[116:119], v[180:183]
    ds_read_b128 v[52:55], v14 offset:18432
    v_mfma_f32_16x16x32_bf16 v[184:187], v[92:95], v[120:123], v[184:187]
    ds_read_b128 v[56:59], v14 offset:20480
    v_mfma_f32_16x16x32_bf16 v[188:191], v[92:95], v[124:127], v[188:191]
    ds_read_b128 v[60:63], v14 offset:22528
    v_mfma_f32_16x16x32_bf16 v[192:195], v[96:99], v[112:115], v[192:195]
    s_add_u32 m0, s48, 147456
    s_add_u32 s12, s55, 3932160
    buffer_load_dwordx4 v30, s[20:23], s12 offen lds
    v_mfma_f32_16x16x32_bf16 v[196:199], v[96:99], v[116:119], v[196:199]
    v_mfma_f32_16x16x32_bf16 v[200:203], v[96:99], v[120:123], v[200:203]
    s_add_u32 m0, s48, 148480
    s_add_u32 s12, s55, 3948544
    buffer_load_dwordx4 v31, s[20:23], s12 offen lds
    v_mfma_f32_16x16x32_bf16 v[204:207], v[96:99], v[124:127], v[204:207]
    v_mfma_f32_16x16x32_bf16 v[208:211], v[100:103], v[112:115], v[208:211]
    v_mfma_f32_16x16x32_bf16 v[212:215], v[100:103], v[116:119], v[212:215]
    v_mfma_f32_16x16x32_bf16 v[216:219], v[100:103], v[120:123], v[216:219]
    v_mfma_f32_16x16x32_bf16 v[220:223], v[100:103], v[124:127], v[220:223]
    v_mfma_f32_16x16x32_bf16 v[224:227], v[104:107], v[112:115], v[224:227]
    v_mfma_f32_16x16x32_bf16 v[228:231], v[104:107], v[116:119], v[228:231]
    v_mfma_f32_16x16x32_bf16 v[232:235], v[104:107], v[120:123], v[232:235]
    v_mfma_f32_16x16x32_bf16 v[236:239], v[104:107], v[124:127], v[236:239]
    v_mfma_f32_16x16x32_bf16 v[240:243], v[108:111], v[112:115], v[240:243]
    v_mfma_f32_16x16x32_bf16 v[244:247], v[108:111], v[116:119], v[244:247]
    v_mfma_f32_16x16x32_bf16 v[248:251], v[108:111], v[120:123], v[248:251]
    v_mfma_f32_16x16x32_bf16 v[252:255], v[108:111], v[124:127], v[252:255]
    s_waitcnt vmcnt(8) lgkmcnt(0)
    s_barrier
    s_mov_b32 s16, s64
    s_and_b32 s17, s65, 0xffff
    s_mov_b32 s18, 0x400000
    s_mov_b32 s19, 0x00020000
    s_mov_b32 s20, s66
    s_and_b32 s21, s67, 0xffff
    s_mov_b32 s22, 0x158000
    s_mov_b32 s23, 0x00020000
    s_add_u32 s13, s34, 0
    s_lshl_b32 s14, s13, 8
    s_add_u32 s14, s14, 117440512
    v_and_b32 v8, 0, v1
    v_lshlrev_b32_e64 v8, 8, v8
    buffer_load_dword v26, v8, s[4:7], s14 offen sc1
    v_mfma_f32_16x16x32_bf16 v[128:131], v[32:35], v[64:67], v[128:131]
    ds_read_b128 v[80:83], v15 offset:0
    v_mfma_f32_16x16x32_bf16 v[132:135], v[32:35], v[68:71], v[132:135]
    ds_read_b64_tr_b16 v[112:113], v18 offset:16384
    v_mfma_f32_16x16x32_bf16 v[136:139], v[32:35], v[72:75], v[136:139]
    ds_read_b64_tr_b16 v[114:115], v18 offset:18432
    v_mfma_f32_16x16x32_bf16 v[140:143], v[32:35], v[76:79], v[140:143]
    ds_read_b64_tr_b16 v[116:117], v19 offset:16384
    v_mfma_f32_16x16x32_bf16 v[144:147], v[36:39], v[64:67], v[144:147]
    ds_read_b64_tr_b16 v[118:119], v19 offset:18432
    v_mfma_f32_16x16x32_bf16 v[148:151], v[36:39], v[68:71], v[148:151]
    ds_read_b64_tr_b16 v[120:121], v20 offset:16384
    v_mfma_f32_16x16x32_bf16 v[152:155], v[36:39], v[72:75], v[152:155]
    ds_read_b64_tr_b16 v[122:123], v20 offset:18432
    v_mfma_f32_16x16x32_bf16 v[156:159], v[36:39], v[76:79], v[156:159]
    ds_read_b64_tr_b16 v[124:125], v21 offset:16384
    v_mfma_f32_16x16x32_bf16 v[160:163], v[40:43], v[64:67], v[160:163]
    ds_read_b64_tr_b16 v[126:127], v21 offset:18432
    v_mfma_f32_16x16x32_bf16 v[164:167], v[40:43], v[68:71], v[164:167]
    ds_read_b128 v[84:87], v15 offset:2048
    v_mfma_f32_16x16x32_bf16 v[168:171], v[40:43], v[72:75], v[168:171]
    ds_read_b128 v[88:91], v15 offset:4096
    v_mfma_f32_16x16x32_bf16 v[172:175], v[40:43], v[76:79], v[172:175]
    ds_read_b128 v[92:95], v15 offset:6144
    v_mfma_f32_16x16x32_bf16 v[176:179], v[44:47], v[64:67], v[176:179]
    ds_read_b128 v[96:99], v15 offset:16384
    v_mfma_f32_16x16x32_bf16 v[180:183], v[44:47], v[68:71], v[180:183]
    ds_read_b128 v[100:103], v15 offset:18432
    v_mfma_f32_16x16x32_bf16 v[184:187], v[44:47], v[72:75], v[184:187]
    ds_read_b128 v[104:107], v15 offset:20480
    v_mfma_f32_16x16x32_bf16 v[188:191], v[44:47], v[76:79], v[188:191]
    ds_read_b128 v[108:111], v15 offset:22528
    v_mfma_f32_16x16x32_bf16 v[192:195], v[48:51], v[64:67], v[192:195]
    s_add_u32 m0, s48, 65536
    s_add_u32 s12, s46, 0
    buffer_load_dwordx4 v12, s[16:19], s12 offen lds
    v_mfma_f32_16x16x32_bf16 v[196:199], v[48:51], v[68:71], v[196:199]
    v_mfma_f32_16x16x32_bf16 v[200:203], v[48:51], v[72:75], v[200:203]
    s_add_u32 m0, s48, 66560
    s_add_u32 s12, s46, 32768
    buffer_load_dwordx4 v12, s[16:19], s12 offen lds
    v_mfma_f32_16x16x32_bf16 v[204:207], v[48:51], v[76:79], v[204:207]
    v_mfma_f32_16x16x32_bf16 v[208:211], v[52:55], v[64:67], v[208:211]
    s_add_u32 m0, s49, 81920
    s_add_u32 s12, s47, 0
    buffer_load_dwordx4 v13, s[20:23], s12 offen lds
    v_mfma_f32_16x16x32_bf16 v[212:215], v[52:55], v[68:71], v[212:215]
    v_mfma_f32_16x16x32_bf16 v[216:219], v[52:55], v[72:75], v[216:219]
    s_add_u32 m0, s48, 90112
    s_add_u32 s12, s46, 524288
    buffer_load_dwordx4 v12, s[16:19], s12 offen lds
    v_mfma_f32_16x16x32_bf16 v[220:223], v[52:55], v[76:79], v[220:223]
    v_mfma_f32_16x16x32_bf16 v[224:227], v[56:59], v[64:67], v[224:227]
    s_add_u32 m0, s48, 91136
    s_add_u32 s12, s46, 557056
    buffer_load_dwordx4 v12, s[16:19], s12 offen lds
    v_mfma_f32_16x16x32_bf16 v[228:231], v[56:59], v[68:71], v[228:231]
    v_mfma_f32_16x16x32_bf16 v[232:235], v[56:59], v[72:75], v[232:235]
    s_add_u32 m0, s49, 106496
    s_add_u32 s12, s47, 176128
    buffer_load_dwordx4 v13, s[20:23], s12 offen lds
    v_mfma_f32_16x16x32_bf16 v[236:239], v[56:59], v[76:79], v[236:239]
    v_mfma_f32_16x16x32_bf16 v[240:243], v[60:63], v[64:67], v[240:243]
    v_mfma_f32_16x16x32_bf16 v[244:247], v[60:63], v[68:71], v[244:247]
    v_mfma_f32_16x16x32_bf16 v[248:251], v[60:63], v[72:75], v[248:251]
    v_mfma_f32_16x16x32_bf16 v[252:255], v[60:63], v[76:79], v[252:255]
    s_waitcnt vmcnt(9) lgkmcnt(0)
    s_barrier
    v_mfma_f32_16x16x32_bf16 v[128:131], v[80:83], v[112:115], v[128:131]
    ds_read_b128 v[32:35], v14 offset:32768
    v_mfma_f32_16x16x32_bf16 v[132:135], v[80:83], v[116:119], v[132:135]
    ds_read_b64_tr_b16 v[64:65], v18 offset:32768
    v_mfma_f32_16x16x32_bf16 v[136:139], v[80:83], v[120:123], v[136:139]
    ds_read_b64_tr_b16 v[66:67], v18 offset:34816
    v_mfma_f32_16x16x32_bf16 v[140:143], v[80:83], v[124:127], v[140:143]
    ds_read_b64_tr_b16 v[68:69], v19 offset:32768
    v_mfma_f32_16x16x32_bf16 v[144:147], v[84:87], v[112:115], v[144:147]
    ds_read_b64_tr_b16 v[70:71], v19 offset:34816
    v_mfma_f32_16x16x32_bf16 v[148:151], v[84:87], v[116:119], v[148:151]
    ds_read_b64_tr_b16 v[72:73], v20 offset:32768
    v_mfma_f32_16x16x32_bf16 v[152:155], v[84:87], v[120:123], v[152:155]
    ds_read_b64_tr_b16 v[74:75], v20 offset:34816
    v_mfma_f32_16x16x32_bf16 v[156:159], v[84:87], v[124:127], v[156:159]
    ds_read_b64_tr_b16 v[76:77], v21 offset:32768
    v_mfma_f32_16x16x32_bf16 v[160:163], v[88:91], v[112:115], v[160:163]
    ds_read_b64_tr_b16 v[78:79], v21 offset:34816
    v_mfma_f32_16x16x32_bf16 v[164:167], v[88:91], v[116:119], v[164:167]
    ds_read_b128 v[36:39], v14 offset:34816
    v_mfma_f32_16x16x32_bf16 v[168:171], v[88:91], v[120:123], v[168:171]
    ds_read_b128 v[40:43], v14 offset:36864
    v_mfma_f32_16x16x32_bf16 v[172:175], v[88:91], v[124:127], v[172:175]
    ds_read_b128 v[44:47], v14 offset:38912
    v_mfma_f32_16x16x32_bf16 v[176:179], v[92:95], v[112:115], v[176:179]
    ds_read_b128 v[48:51], v14 offset:49152
    v_mfma_f32_16x16x32_bf16 v[180:183], v[92:95], v[116:119], v[180:183]
    ds_read_b128 v[52:55], v14 offset:51200
    v_mfma_f32_16x16x32_bf16 v[184:187], v[92:95], v[120:123], v[184:187]
    ds_read_b128 v[56:59], v14 offset:53248
    v_mfma_f32_16x16x32_bf16 v[188:191], v[92:95], v[124:127], v[188:191]
    ds_read_b128 v[60:63], v14 offset:55296
    v_mfma_f32_16x16x32_bf16 v[192:195], v[96:99], v[112:115], v[192:195]
    v_mfma_f32_16x16x32_bf16 v[196:199], v[96:99], v[116:119], v[196:199]
    v_mfma_f32_16x16x32_bf16 v[200:203], v[96:99], v[120:123], v[200:203]
    v_mfma_f32_16x16x32_bf16 v[204:207], v[96:99], v[124:127], v[204:207]
    v_mfma_f32_16x16x32_bf16 v[208:211], v[100:103], v[112:115], v[208:211]
    v_mfma_f32_16x16x32_bf16 v[212:215], v[100:103], v[116:119], v[212:215]
    v_mfma_f32_16x16x32_bf16 v[216:219], v[100:103], v[120:123], v[216:219]
    v_mfma_f32_16x16x32_bf16 v[220:223], v[100:103], v[124:127], v[220:223]
    v_mfma_f32_16x16x32_bf16 v[224:227], v[104:107], v[112:115], v[224:227]
    v_mfma_f32_16x16x32_bf16 v[228:231], v[104:107], v[116:119], v[228:231]
    v_mfma_f32_16x16x32_bf16 v[232:235], v[104:107], v[120:123], v[232:235]
    v_mfma_f32_16x16x32_bf16 v[236:239], v[104:107], v[124:127], v[236:239]
    v_mfma_f32_16x16x32_bf16 v[240:243], v[108:111], v[112:115], v[240:243]
    v_mfma_f32_16x16x32_bf16 v[244:247], v[108:111], v[116:119], v[244:247]
    v_mfma_f32_16x16x32_bf16 v[248:251], v[108:111], v[120:123], v[248:251]
    v_mfma_f32_16x16x32_bf16 v[252:255], v[108:111], v[124:127], v[252:255]
    s_waitcnt vmcnt(7) lgkmcnt(0)
    s_barrier
    v_mfma_f32_16x16x32_bf16 v[128:131], v[32:35], v[64:67], v[128:131]
    ds_read_b128 v[80:83], v15 offset:32768
    v_mfma_f32_16x16x32_bf16 v[132:135], v[32:35], v[68:71], v[132:135]
    ds_read_b64_tr_b16 v[112:113], v18 offset:49152
    v_mfma_f32_16x16x32_bf16 v[136:139], v[32:35], v[72:75], v[136:139]
    ds_read_b64_tr_b16 v[114:115], v18 offset:51200
    v_mfma_f32_16x16x32_bf16 v[140:143], v[32:35], v[76:79], v[140:143]
    ds_read_b64_tr_b16 v[116:117], v19 offset:49152
    v_mfma_f32_16x16x32_bf16 v[144:147], v[36:39], v[64:67], v[144:147]
    ds_read_b64_tr_b16 v[118:119], v19 offset:51200
    v_mfma_f32_16x16x32_bf16 v[148:151], v[36:39], v[68:71], v[148:151]
    ds_read_b64_tr_b16 v[120:121], v20 offset:49152
    v_mfma_f32_16x16x32_bf16 v[152:155], v[36:39], v[72:75], v[152:155]
    ds_read_b64_tr_b16 v[122:123], v20 offset:51200
    v_mfma_f32_16x16x32_bf16 v[156:159], v[36:39], v[76:79], v[156:159]
    ds_read_b64_tr_b16 v[124:125], v21 offset:49152
    v_mfma_f32_16x16x32_bf16 v[160:163], v[40:43], v[64:67], v[160:163]
    ds_read_b64_tr_b16 v[126:127], v21 offset:51200
    v_mfma_f32_16x16x32_bf16 v[164:167], v[40:43], v[68:71], v[164:167]
    ds_read_b128 v[84:87], v15 offset:34816
    v_mfma_f32_16x16x32_bf16 v[168:171], v[40:43], v[72:75], v[168:171]
    ds_read_b128 v[88:91], v15 offset:36864
    v_mfma_f32_16x16x32_bf16 v[172:175], v[40:43], v[76:79], v[172:175]
    ds_read_b128 v[92:95], v15 offset:38912
    v_mfma_f32_16x16x32_bf16 v[176:179], v[44:47], v[64:67], v[176:179]
    ds_read_b128 v[96:99], v15 offset:49152
    v_mfma_f32_16x16x32_bf16 v[180:183], v[44:47], v[68:71], v[180:183]
    ds_read_b128 v[100:103], v15 offset:51200
    v_mfma_f32_16x16x32_bf16 v[184:187], v[44:47], v[72:75], v[184:187]
    ds_read_b128 v[104:107], v15 offset:53248
    v_mfma_f32_16x16x32_bf16 v[188:191], v[44:47], v[76:79], v[188:191]
    ds_read_b128 v[108:111], v15 offset:55296
    v_mfma_f32_16x16x32_bf16 v[192:195], v[48:51], v[64:67], v[192:195]
    s_add_u32 m0, s48, 114688
    s_add_u32 s12, s46, 1048576
    buffer_load_dwordx4 v12, s[16:19], s12 offen lds
    v_mfma_f32_16x16x32_bf16 v[196:199], v[48:51], v[68:71], v[196:199]
    v_mfma_f32_16x16x32_bf16 v[200:203], v[48:51], v[72:75], v[200:203]
    s_add_u32 m0, s48, 115712
    s_add_u32 s12, s46, 1081344
    buffer_load_dwordx4 v12, s[16:19], s12 offen lds
    v_mfma_f32_16x16x32_bf16 v[204:207], v[48:51], v[76:79], v[204:207]
    v_mfma_f32_16x16x32_bf16 v[208:211], v[52:55], v[64:67], v[208:211]
    s_add_u32 m0, s49, 131072
    s_add_u32 s12, s47, 352256
    buffer_load_dwordx4 v13, s[20:23], s12 offen lds
    v_mfma_f32_16x16x32_bf16 v[212:215], v[52:55], v[68:71], v[212:215]
    v_mfma_f32_16x16x32_bf16 v[216:219], v[52:55], v[72:75], v[216:219]
    v_mfma_f32_16x16x32_bf16 v[220:223], v[52:55], v[76:79], v[220:223]
    v_mfma_f32_16x16x32_bf16 v[224:227], v[56:59], v[64:67], v[224:227]
    v_mfma_f32_16x16x32_bf16 v[228:231], v[56:59], v[68:71], v[228:231]
    v_mfma_f32_16x16x32_bf16 v[232:235], v[56:59], v[72:75], v[232:235]
    v_mfma_f32_16x16x32_bf16 v[236:239], v[56:59], v[76:79], v[236:239]
    v_mfma_f32_16x16x32_bf16 v[240:243], v[60:63], v[64:67], v[240:243]
    v_mfma_f32_16x16x32_bf16 v[244:247], v[60:63], v[68:71], v[244:247]
    v_mfma_f32_16x16x32_bf16 v[248:251], v[60:63], v[72:75], v[248:251]
    v_mfma_f32_16x16x32_bf16 v[252:255], v[60:63], v[76:79], v[252:255]
    s_waitcnt vmcnt(6) lgkmcnt(0)
    s_barrier
    s_waitcnt vmcnt(9)
    s_add_u32 s13, s34, 0
    s_mov_b32 s15, 0x20000
poll_13:
    v_cmp_gt_u32 vcc, 16, v26
    s_cbranch_vccz polld_14
    s_sleep 2
    s_lshl_b32 s14, s13, 8
    s_add_u32 s14, s14, 117440512
    v_and_b32 v8, 0, v1
    v_lshlrev_b32 v8, 8, v8
    buffer_load_dword v26, v8, s[4:7], s14 offen sc1
    s_waitcnt vmcnt(0)
    s_sub_u32 s15, s15, 1
    s_cmp_lg_u32 s15, 0
    s_cbranch_scc1 poll_13
polld_14:
    v_mfma_f32_16x16x32_bf16 v[128:131], v[80:83], v[112:115], v[128:131]
    s_add_u32 s12, s50, 0
    buffer_load_dwordx4 v[64:67], v2, s[4:7], s12 offen offset:0 sc1
    v_mfma_f32_16x16x32_bf16 v[132:135], v[80:83], v[116:119], v[132:135]
    v_mfma_f32_16x16x32_bf16 v[136:139], v[80:83], v[120:123], v[136:139]
    s_add_u32 s12, s50, 16384
    buffer_load_dwordx4 v[68:71], v2, s[4:7], s12 offen offset:0 sc1
    v_mfma_f32_16x16x32_bf16 v[140:143], v[80:83], v[124:127], v[140:143]
    v_mfma_f32_16x16x32_bf16 v[144:147], v[84:87], v[112:115], v[144:147]
    s_add_u32 s12, s50, 0
    buffer_load_dwordx4 v[72:75], v2, s[4:7], s12 offen offset:1024 sc1
    v_mfma_f32_16x16x32_bf16 v[148:151], v[84:87], v[116:119], v[148:151]
    v_mfma_f32_16x16x32_bf16 v[152:155], v[84:87], v[120:123], v[152:155]
    s_add_u32 s12, s50, 16384
    buffer_load_dwordx4 v[76:79], v2, s[4:7], s12 offen offset:1024 sc1
    v_mfma_f32_16x16x32_bf16 v[156:159], v[84:87], v[124:127], v[156:159]
    v_mfma_f32_16x16x32_bf16 v[160:163], v[88:91], v[112:115], v[160:163]
    v_mfma_f32_16x16x32_bf16 v[164:167], v[88:91], v[116:119], v[164:167]
    v_mfma_f32_16x16x32_bf16 v[168:171], v[88:91], v[120:123], v[168:171]
    v_mfma_f32_16x16x32_bf16 v[172:175], v[88:91], v[124:127], v[172:175]
    v_mfma_f32_16x16x32_bf16 v[176:179], v[92:95], v[112:115], v[176:179]
    v_mfma_f32_16x16x32_bf16 v[180:183], v[92:95], v[116:119], v[180:183]
    v_mfma_f32_16x16x32_bf16 v[184:187], v[92:95], v[120:123], v[184:187]
    v_mfma_f32_16x16x32_bf16 v[188:191], v[92:95], v[124:127], v[188:191]
    v_mfma_f32_16x16x32_bf16 v[192:195], v[96:99], v[112:115], v[192:195]
    v_mfma_f32_16x16x32_bf16 v[196:199], v[96:99], v[116:119], v[196:199]
    v_mfma_f32_16x16x32_bf16 v[200:203], v[96:99], v[120:123], v[200:203]
    v_mfma_f32_16x16x32_bf16 v[204:207], v[96:99], v[124:127], v[204:207]
    v_mfma_f32_16x16x32_bf16 v[208:211], v[100:103], v[112:115], v[208:211]
    v_mfma_f32_16x16x32_bf16 v[212:215], v[100:103], v[116:119], v[212:215]
    v_mfma_f32_16x16x32_bf16 v[216:219], v[100:103], v[120:123], v[216:219]
    v_mfma_f32_16x16x32_bf16 v[220:223], v[100:103], v[124:127], v[220:223]
    v_mfma_f32_16x16x32_bf16 v[224:227], v[104:107], v[112:115], v[224:227]
    v_mfma_f32_16x16x32_bf16 v[228:231], v[104:107], v[116:119], v[228:231]
    v_mfma_f32_16x16x32_bf16 v[232:235], v[104:107], v[120:123], v[232:235]
    v_mfma_f32_16x16x32_bf16 v[236:239], v[104:107], v[124:127], v[236:239]
    v_mfma_f32_16x16x32_bf16 v[240:243], v[108:111], v[112:115], v[240:243]
    v_mfma_f32_16x16x32_bf16 v[244:247], v[108:111], v[116:119], v[244:247]
    v_mfma_f32_16x16x32_bf16 v[248:251], v[108:111], v[120:123], v[248:251]
    v_mfma_f32_16x16x32_bf16 v[252:255], v[108:111], v[124:127], v[252:255]
    s_add_u32 s12, s50, 0
    buffer_load_dwordx4 v[80:83], v2, s[4:7], s12 offen offset:2048 sc1
    s_add_u32 s12, s50, 16384
    buffer_load_dwordx4 v[84:87], v2, s[4:7], s12 offen offset:2048 sc1
    v_mov_b32 v10, v27
    v_cvt_pk_bf16_f32 v88, v128, v129
    v_cvt_pk_bf16_f32 v89, v130, v131
    v_cvt_pk_bf16_f32 v90, v144, v145
    v_cvt_pk_bf16_f32 v91, v146, v147
    v_cvt_pk_bf16_f32 v92, v132, v133
    v_cvt_pk_bf16_f32 v93, v134, v135
    v_cvt_pk_bf16_f32 v94, v148, v149
    v_cvt_pk_bf16_f32 v95, v150, v151
    v_cvt_pk_bf16_f32 v96, v136, v137
    v_cvt_pk_bf16_f32 v97, v138, v139
    v_cvt_pk_bf16_f32 v98, v152, v153
    v_cvt_pk_bf16_f32 v99, v154, v155
    v_cvt_pk_bf16_f32 v100, v140, v141
    v_cvt_pk_bf16_f32 v101, v142, v143
    v_cvt_pk_bf16_f32 v102, v156, v157
    v_cvt_pk_bf16_f32 v103, v158, v159
    v_cvt_pk_bf16_f32 v104, v160, v161
    v_cvt_pk_bf16_f32 v105, v162, v163
    v_cvt_pk_bf16_f32 v106, v176, v177
    v_cvt_pk_bf16_f32 v107, v178, v179
    v_cvt_pk_bf16_f32 v108, v164, v165
    v_cvt_pk_bf16_f32 v109, v166, v167
    v_cvt_pk_bf16_f32 v110, v180, v181
    v_cvt_pk_bf16_f32 v111, v182, v183
    v_cvt_pk_bf16_f32 v112, v168, v169
    v_cvt_pk_bf16_f32 v113, v170, v171
    v_cvt_pk_bf16_f32 v114, v184, v185
    v_cvt_pk_bf16_f32 v115, v186, v187
    v_cvt_pk_bf16_f32 v116, v172, v173
    v_cvt_pk_bf16_f32 v117, v174, v175
    v_cvt_pk_bf16_f32 v118, v188, v189
    v_cvt_pk_bf16_f32 v119, v190, v191
    v_cvt_pk_bf16_f32 v20, v192, v193
    v_cvt_pk_bf16_f32 v21, v194, v195
    v_cvt_pk_bf16_f32 v22, v208, v209
    v_cvt_pk_bf16_f32 v23, v210, v211
    v_cvt_pk_bf16_f32 v24, v196, v197
    v_cvt_pk_bf16_f32 v25, v198, v199
    v_cvt_pk_bf16_f32 v26, v212, v213
    v_cvt_pk_bf16_f32 v27, v214, v215
    v_cvt_pk_bf16_f32 v28, v200, v201
    v_cvt_pk_bf16_f32 v29, v202, v203
    v_cvt_pk_bf16_f32 v30, v216, v217
    v_cvt_pk_bf16_f32 v31, v218, v219
    v_cvt_pk_bf16_f32 v32, v204, v205
    v_cvt_pk_bf16_f32 v33, v206, v207
    v_cvt_pk_bf16_f32 v34, v220, v221
    v_cvt_pk_bf16_f32 v35, v222, v223
    v_cvt_pk_bf16_f32 v36, v224, v225
    v_cvt_pk_bf16_f32 v37, v226, v227
    v_cvt_pk_bf16_f32 v38, v240, v241
    v_cvt_pk_bf16_f32 v39, v242, v243
    v_cvt_pk_bf16_f32 v40, v228, v229
    v_cvt_pk_bf16_f32 v41, v230, v231
    v_cvt_pk_bf16_f32 v42, v244, v245
    v_cvt_pk_bf16_f32 v43, v246, v247
    v_cvt_pk_bf16_f32 v44, v232, v233
    v_cvt_pk_bf16_f32 v45, v234, v235
    v_cvt_pk_bf16_f32 v46, v248, v249
    v_cvt_pk_bf16_f32 v47, v250, v251
    v_cvt_pk_bf16_f32 v48, v236, v237
    v_cvt_pk_bf16_f32 v49, v238, v239
    v_cvt_pk_bf16_f32 v50, v252, v253
    v_cvt_pk_bf16_f32 v51, v254, v255
parallel_sum__compressed_kv_cla__mixer_gmlp__prompt_kernel_kv_done:
    v_and_b32 v4, 15, v1
    v_lshrrev_b32 v5, 4, v1
    v_lshrrev_b32 v6, 2, v4
    v_and_b32 v7, 1, v5
    v_lshl_or_b32 v8, v7, 2, v6
    v_lshl_add_u32 v9, v5, 3, v6
    v_and_b32 v4, 3, v1
    v_lshlrev_b32 v4, 3, v4
    v_lshl_add_u32 v3, v9, 8, v4
    v_add_u32 v3, 65536, v3
    v_xor_b32_e64 v63, 0, v8
    v_lshl_add_u32 v52, v63, 5, v3
    v_xor_b32_e64 v63, 1, v8
    v_lshl_add_u32 v53, v63, 5, v3
    v_xor_b32_e64 v63, 2, v8
    v_lshl_add_u32 v54, v63, 5, v3
    v_xor_b32_e64 v63, 3, v8
    v_lshl_add_u32 v55, v63, 5, v3
    v_xor_b32_e64 v63, 4, v8
    v_lshl_add_u32 v56, v63, 5, v3
    v_xor_b32_e64 v63, 5, v8
    v_lshl_add_u32 v57, v63, 5, v3
    v_xor_b32_e64 v63, 6, v8
    v_lshl_add_u32 v58, v63, 5, v3
    v_xor_b32_e64 v63, 7, v8
    v_lshl_add_u32 v59, v63, 5, v3
    v_lshrrev_b32_e64 v6, 1, v6
    v_lshl_or_b32 v8, v7, 1, v6
    v_lshl_add_u32 v3, v9, 7, v4
    v_add_u32 v3, 81920, v3
    v_xor_b32_e64 v63, 0, v8
    v_lshl_add_u32 v60, v63, 5, v3
    v_xor_b32_e64 v63, 1, v8
    v_lshl_add_u32 v61, v63, 5, v3
    v_xor_b32_e64 v63, 2, v8
    v_lshl_add_u32 v62, v63, 5, v3
    ds_read_b64_tr_b16 v[120:121], v52 offset:0
    ds_read_b64_tr_b16 v[122:123], v52 offset:1024
    ds_read_b64_tr_b16 v[124:125], v53 offset:0
    ds_read_b64_tr_b16 v[126:127], v53 offset:1024
    ds_read_b64_tr_b16 v[128:129], v54 offset:0
    ds_read_b64_tr_b16 v[130:131], v54 offset:1024
    ds_read_b64_tr_b16 v[132:133], v55 offset:0
    ds_read_b64_tr_b16 v[134:135], v55 offset:1024
    ds_read_b64_tr_b16 v[136:137], v56 offset:0
    ds_read_b64_tr_b16 v[138:139], v56 offset:1024
    ds_read_b64_tr_b16 v[140:141], v57 offset:0
    ds_read_b64_tr_b16 v[142:143], v57 offset:1024
    ds_read_b64_tr_b16 v[144:145], v58 offset:0
    ds_read_b64_tr_b16 v[146:147], v58 offset:1024
    ds_read_b64_tr_b16 v[148:149], v59 offset:0
    ds_read_b64_tr_b16 v[150:151], v59 offset:1024
    ds_read_b64_tr_b16 v[152:153], v60 offset:0
    ds_read_b64_tr_b16 v[154:155], v60 offset:512
    ds_read_b64_tr_b16 v[156:157], v61 offset:0
    ds_read_b64_tr_b16 v[158:159], v61 offset:512
    ds_read_b64_tr_b16 v[160:161], v62 offset:0
    ds_read_b64_tr_b16 v[162:163], v62 offset:512
    s_waitcnt vmcnt(4)
    s_waitcnt lgkmcnt(15)
    v_mfma_f32_16x16x32_bf16 v[192:195], v[120:123], v[64:67], 0
    v_mfma_f32_16x16x32_bf16 v[196:199], v[120:123], v[68:71], 0
    v_mfma_f32_16x16x32_bf16 v[200:203], v[124:127], v[64:67], 0
    ds_read_b64_tr_b16 v[120:121], v52 offset:8192
    v_mfma_f32_16x16x32_bf16 v[204:207], v[124:127], v[68:71], 0
    ds_read_b64_tr_b16 v[122:123], v52 offset:9216
    s_add_u32 s12, s58, 0
    buffer_store_dwordx4 v[88:91], v10, s[4:7], s12 offen offset:0 sc1
    s_waitcnt lgkmcnt(15)
    v_mfma_f32_16x16x32_bf16 v[208:211], v[128:131], v[64:67], 0
    ds_read_b64_tr_b16 v[124:125], v53 offset:8192
    v_mfma_f32_16x16x32_bf16 v[212:215], v[128:131], v[68:71], 0
    ds_read_b64_tr_b16 v[126:127], v53 offset:9216
    s_add_u32 s12, s58, 0
    buffer_store_dwordx4 v[92:95], v10, s[4:7], s12 offen offset:256 sc1
    v_mfma_f32_16x16x32_bf16 v[216:219], v[132:135], v[64:67], 0
    ds_read_b64_tr_b16 v[128:129], v54 offset:8192
    v_mfma_f32_16x16x32_bf16 v[220:223], v[132:135], v[68:71], 0
    ds_read_b64_tr_b16 v[130:131], v54 offset:9216
    s_waitcnt lgkmcnt(15)
    v_mfma_f32_16x16x32_bf16 v[224:227], v[136:139], v[64:67], 0
    ds_read_b64_tr_b16 v[132:133], v55 offset:8192
    v_mfma_f32_16x16x32_bf16 v[228:231], v[136:139], v[68:71], 0
    ds_read_b64_tr_b16 v[134:135], v55 offset:9216
    v_mfma_f32_16x16x32_bf16 v[232:235], v[140:143], v[64:67], 0
    ds_read_b64_tr_b16 v[136:137], v56 offset:8192
    v_mfma_f32_16x16x32_bf16 v[236:239], v[140:143], v[68:71], 0
    ds_read_b64_tr_b16 v[138:139], v56 offset:9216
    s_waitcnt lgkmcnt(15)
    v_mfma_f32_16x16x32_bf16 v[240:243], v[144:147], v[64:67], 0
    ds_read_b64_tr_b16 v[140:141], v57 offset:8192
    v_mfma_f32_16x16x32_bf16 v[244:247], v[144:147], v[68:71], 0
    ds_read_b64_tr_b16 v[142:143], v57 offset:9216
    v_mfma_f32_16x16x32_bf16 v[248:251], v[148:151], v[64:67], 0
    ds_read_b64_tr_b16 v[144:145], v58 offset:8192
    v_mfma_f32_16x16x32_bf16 v[252:255], v[148:151], v[68:71], 0
    ds_read_b64_tr_b16 v[146:147], v58 offset:9216
    s_cmp_eq_u32 s36, 0
    s_waitcnt lgkmcnt(14)
    s_cbranch_scc0 z2_15
    v_mfma_f32_16x16x32_bf16 v[168:171], v[152:155], v[64:67], 0
    ds_read_b64_tr_b16 v[148:149], v59 offset:8192
    v_mfma_f32_16x16x32_bf16 v[172:175], v[152:155], v[68:71], 0
    ds_read_b64_tr_b16 v[150:151], v59 offset:9216
    v_mfma_f32_16x16x32_bf16 v[176:179], v[156:159], v[64:67], 0
    ds_read_b64_tr_b16 v[152:153], v60 offset:4096
    v_mfma_f32_16x16x32_bf16 v[180:183], v[156:159], v[68:71], 0
    ds_read_b64_tr_b16 v[154:155], v60 offset:4608
    v_mfma_f32_16x16x32_bf16 v[184:187], v[160:163], v[64:67], 0
    ds_read_b64_tr_b16 v[156:157], v61 offset:4096
    v_mfma_f32_16x16x32_bf16 v[188:191], v[160:163], v[68:71], 0
    ds_read_b64_tr_b16 v[158:159], v61 offset:4608
    ds_read_b64_tr_b16 v[160:161], v62 offset:4096
    ds_read_b64_tr_b16 v[162:163], v62 offset:4608
    s_branch zd_16
z2_15:
    v_mfma_f32_16x16x32_bf16 v[168:171], v[64:67], v[152:155], 0
    ds_read_b64_tr_b16 v[148:149], v59 offset:8192
    v_mfma_f32_16x16x32_bf16 v[172:175], v[68:71], v[152:155], 0
    ds_read_b64_tr_b16 v[150:151], v59 offset:9216
    v_mfma_f32_16x16x32_bf16 v[176:179], v[64:67], v[156:159], 0
    ds_read_b64_tr_b16 v[152:153], v60 offset:4096
    v_mfma_f32_16x16x32_bf16 v[180:183], v[68:71], v[156:159], 0
    ds_read_b64_tr_b16 v[154:155], v60 offset:4608
    v_mfma_f32_16x16x32_bf16 v[184:187], v[64:67], v[160:163], 0
    ds_read_b64_tr_b16 v[156:157], v61 offset:4096
    v_mfma_f32_16x16x32_bf16 v[188:191], v[68:71], v[160:163], 0
    ds_read_b64_tr_b16 v[158:159], v61 offset:4608
    ds_read_b64_tr_b16 v[160:161], v62 offset:4096
    ds_read_b64_tr_b16 v[162:163], v62 offset:4608
zd_16:
    s_add_u32 s12, s50, 0
    buffer_load_dwordx4 v[64:67], v2, s[4:7], s12 offen offset:3072 sc1
    s_add_u32 s12, s50, 16384
    buffer_load_dwordx4 v[68:71], v2, s[4:7], s12 offen offset:3072 sc1
    s_waitcnt vmcnt(6)
    s_barrier
    v_add_u32 v52, 24576, v52
    v_add_u32 v53, 24576, v53
    v_add_u32 v54, 24576, v54
    v_add_u32 v55, 24576, v55
    v_add_u32 v56, 24576, v56
    v_add_u32 v57, 24576, v57
    v_add_u32 v58, 24576, v58
    v_add_u32 v59, 24576, v59
    v_add_u32 v60, 24576, v60
    v_add_u32 v61, 24576, v61
    v_add_u32 v62, 24576, v62
    s_waitcnt lgkmcnt(15)
    v_mfma_f32_16x16x32_bf16 v[192:195], v[120:123], v[72:75], v[192:195]
    v_mfma_f32_16x16x32_bf16 v[196:199], v[120:123], v[76:79], v[196:199]
    v_mfma_f32_16x16x32_bf16 v[200:203], v[124:127], v[72:75], v[200:203]
    ds_read_b64_tr_b16 v[120:121], v52 offset:0
    v_mfma_f32_16x16x32_bf16 v[204:207], v[124:127], v[76:79], v[204:207]
    ds_read_b64_tr_b16 v[122:123], v52 offset:1024
    s_add_u32 s12, s58, 0
    s_add_u32 s12, s12, s59
    buffer_store_dwordx4 v[96:99], v10, s[4:7], s12 offen offset:0 sc1
    s_waitcnt lgkmcnt(15)
    v_mfma_f32_16x16x32_bf16 v[208:211], v[128:131], v[72:75], v[208:211]
    ds_read_b64_tr_b16 v[124:125], v53 offset:0
    v_mfma_f32_16x16x32_bf16 v[212:215], v[128:131], v[76:79], v[212:215]
    ds_read_b64_tr_b16 v[126:127], v53 offset:1024
    s_add_u32 s12, s58, 0
    s_add_u32 s12, s12, s59
    buffer_store_dwordx4 v[100:103], v10, s[4:7], s12 offen offset:256 sc1
    v_mfma_f32_16x16x32_bf16 v[216:219], v[132:135], v[72:75], v[216:219]
    ds_read_b64_tr_b16 v[128:129], v54 offset:0
    v_mfma_f32_16x16x32_bf16 v[220:223], v[132:135], v[76:79], v[220:223]
    ds_read_b64_tr_b16 v[130:131], v54 offset:1024
    s_add_u32 m0, s48, 139264
    s_add_u32 s12, s46, 1572864
    buffer_load_dwordx4 v12, s[16:19], s12 offen lds
    s_waitcnt lgkmcnt(15)
    v_mfma_f32_16x16x32_bf16 v[224:227], v[136:139], v[72:75], v[224:227]
    ds_read_b64_tr_b16 v[132:133], v55 offset:0
    v_mfma_f32_16x16x32_bf16 v[228:231], v[136:139], v[76:79], v[228:231]
    ds_read_b64_tr_b16 v[134:135], v55 offset:1024
    s_add_u32 m0, s48, 140288
    s_add_u32 s12, s46, 1605632
    buffer_load_dwordx4 v12, s[16:19], s12 offen lds
    v_mfma_f32_16x16x32_bf16 v[232:235], v[140:143], v[72:75], v[232:235]
    ds_read_b64_tr_b16 v[136:137], v56 offset:0
    v_mfma_f32_16x16x32_bf16 v[236:239], v[140:143], v[76:79], v[236:239]
    ds_read_b64_tr_b16 v[138:139], v56 offset:1024
    s_add_u32 m0, s49, 155648
    s_add_u32 s12, s47, 528384
    buffer_load_dwordx4 v13, s[20:23], s12 offen lds
    s_waitcnt lgkmcnt(15)
    v_mfma_f32_16x16x32_bf16 v[240:243], v[144:147], v[72:75], v[240:243]
    ds_read_b64_tr_b16 v[140:141], v57 offset:0
    v_mfma_f32_16x16x32_bf16 v[244:247], v[144:147], v[76:79], v[244:247]
    ds_read_b64_tr_b16 v[142:143], v57 offset:1024
    v_mfma_f32_16x16x32_bf16 v[248:251], v[148:151], v[72:75], v[248:251]
    ds_read_b64_tr_b16 v[144:145], v58 offset:0
    v_mfma_f32_16x16x32_bf16 v[252:255], v[148:151], v[76:79], v[252:255]
    ds_read_b64_tr_b16 v[146:147], v58 offset:1024
    s_cmp_eq_u32 s36, 0
    s_waitcnt lgkmcnt(14)
    s_cbranch_scc0 z2_17
    v_mfma_f32_16x16x32_bf16 v[168:171], v[152:155], v[72:75], v[168:171]
    ds_read_b64_tr_b16 v[148:149], v59 offset:0
    v_mfma_f32_16x16x32_bf16 v[172:175], v[152:155], v[76:79], v[172:175]
    ds_read_b64_tr_b16 v[150:151], v59 offset:1024
    v_mfma_f32_16x16x32_bf16 v[176:179], v[156:159], v[72:75], v[176:179]
    ds_read_b64_tr_b16 v[152:153], v60 offset:0
    v_mfma_f32_16x16x32_bf16 v[180:183], v[156:159], v[76:79], v[180:183]
    ds_read_b64_tr_b16 v[154:155], v60 offset:512
    v_mfma_f32_16x16x32_bf16 v[184:187], v[160:163], v[72:75], v[184:187]
    ds_read_b64_tr_b16 v[156:157], v61 offset:0
    v_mfma_f32_16x16x32_bf16 v[188:191], v[160:163], v[76:79], v[188:191]
    ds_read_b64_tr_b16 v[158:159], v61 offset:512
    ds_read_b64_tr_b16 v[160:161], v62 offset:0
    ds_read_b64_tr_b16 v[162:163], v62 offset:512
    s_branch zd_18
z2_17:
    v_mfma_f32_16x16x32_bf16 v[168:171], v[72:75], v[152:155], v[168:171]
    ds_read_b64_tr_b16 v[148:149], v59 offset:0
    v_mfma_f32_16x16x32_bf16 v[172:175], v[76:79], v[152:155], v[172:175]
    ds_read_b64_tr_b16 v[150:151], v59 offset:1024
    v_mfma_f32_16x16x32_bf16 v[176:179], v[72:75], v[156:159], v[176:179]
    ds_read_b64_tr_b16 v[152:153], v60 offset:0
    v_mfma_f32_16x16x32_bf16 v[180:183], v[76:79], v[156:159], v[180:183]
    ds_read_b64_tr_b16 v[154:155], v60 offset:512
    v_mfma_f32_16x16x32_bf16 v[184:187], v[72:75], v[160:163], v[184:187]
    ds_read_b64_tr_b16 v[156:157], v61 offset:0
    v_mfma_f32_16x16x32_bf16 v[188:191], v[76:79], v[160:163], v[188:191]
    ds_read_b64_tr_b16 v[158:159], v61 offset:512
    ds_read_b64_tr_b16 v[160:161], v62 offset:0
    ds_read_b64_tr_b16 v[162:163], v62 offset:512
zd_18:
    s_add_u32 s12, s50, 4096
    buffer_load_dwordx4 v[72:75], v2, s[4:7], s12 offen offset:0 sc1
    s_add_u32 s12, s50, 20480
    buffer_load_dwordx4 v[76:79], v2, s[4:7], s12 offen offset:0 sc1
    s_waitcnt vmcnt(11)
    s_waitcnt lgkmcnt(15)
    v_mfma_f32_16x16x32_bf16 v[192:195], v[120:123], v[80:83], v[192:195]
    v_mfma_f32_16x16x32_bf16 v[196:199], v[120:123], v[84:87], v[196:199]
    v_mfma_f32_16x16x32_bf16 v[200:203], v[124:127], v[80:83], v[200:203]
    ds_read_b64_tr_b16 v[120:121], v52 offset:8192
    v_mfma_f32_16x16x32_bf16 v[204:207], v[124:127], v[84:87], v[204:207]
    ds_read_b64_tr_b16 v[122:123], v52 offset:9216
    s_add_u32 s12, s58, 8192
    buffer_store_dwordx4 v[104:107], v10, s[4:7], s12 offen offset:0 sc1
    s_waitcnt lgkmcnt(15)
    v_mfma_f32_16x16x32_bf16 v[208:211], v[128:131], v[80:83], v[208:211]
    ds_read_b64_tr_b16 v[124:125], v53 offset:8192
    v_mfma_f32_16x16x32_bf16 v[212:215], v[128:131], v[84:87], v[212:215]
    ds_read_b64_tr_b16 v[126:127], v53 offset:9216
    s_add_u32 s12, s58, 8192
    buffer_store_dwordx4 v[108:111], v10, s[4:7], s12 offen offset:256 sc1
    v_mfma_f32_16x16x32_bf16 v[216:219], v[132:135], v[80:83], v[216:219]
    ds_read_b64_tr_b16 v[128:129], v54 offset:8192
    v_mfma_f32_16x16x32_bf16 v[220:223], v[132:135], v[84:87], v[220:223]
    ds_read_b64_tr_b16 v[130:131], v54 offset:9216
    s_waitcnt lgkmcnt(15)
    v_mfma_f32_16x16x32_bf16 v[224:227], v[136:139], v[80:83], v[224:227]
    ds_read_b64_tr_b16 v[132:133], v55 offset:8192
    v_mfma_f32_16x16x32_bf16 v[228:231], v[136:139], v[84:87], v[228:231]
    ds_read_b64_tr_b16 v[134:135], v55 offset:9216
    v_mfma_f32_16x16x32_bf16 v[232:235], v[140:143], v[80:83], v[232:235]
    ds_read_b64_tr_b16 v[136:137], v56 offset:8192
    v_mfma_f32_16x16x32_bf16 v[236:239], v[140:143], v[84:87], v[236:239]
    ds_read_b64_tr_b16 v[138:139], v56 offset:9216
    s_waitcnt lgkmcnt(15)
    v_mfma_f32_16x16x32_bf16 v[240:243], v[144:147], v[80:83], v[240:243]
    ds_read_b64_tr_b16 v[140:141], v57 offset:8192
    v_mfma_f32_16x16x32_bf16 v[244:247], v[144:147], v[84:87], v[244:247]
    ds_read_b64_tr_b16 v[142:143], v57 offset:9216
    v_mfma_f32_16x16x32_bf16 v[248:251], v[148:151], v[80:83], v[248:251]
    ds_read_b64_tr_b16 v[144:145], v58 offset:8192
    v_mfma_f32_16x16x32_bf16 v[252:255], v[148:151], v[84:87], v[252:255]
    ds_read_b64_tr_b16 v[146:147], v58 offset:9216
    s_cmp_eq_u32 s36, 0
    s_waitcnt lgkmcnt(14)
    s_cbranch_scc0 z2_19
    v_mfma_f32_16x16x32_bf16 v[168:171], v[152:155], v[80:83], v[168:171]
    ds_read_b64_tr_b16 v[148:149], v59 offset:8192
    v_mfma_f32_16x16x32_bf16 v[172:175], v[152:155], v[84:87], v[172:175]
    ds_read_b64_tr_b16 v[150:151], v59 offset:9216
    v_mfma_f32_16x16x32_bf16 v[176:179], v[156:159], v[80:83], v[176:179]
    ds_read_b64_tr_b16 v[152:153], v60 offset:4096
    v_mfma_f32_16x16x32_bf16 v[180:183], v[156:159], v[84:87], v[180:183]
    ds_read_b64_tr_b16 v[154:155], v60 offset:4608
    v_mfma_f32_16x16x32_bf16 v[184:187], v[160:163], v[80:83], v[184:187]
    ds_read_b64_tr_b16 v[156:157], v61 offset:4096
    v_mfma_f32_16x16x32_bf16 v[188:191], v[160:163], v[84:87], v[188:191]
    ds_read_b64_tr_b16 v[158:159], v61 offset:4608
    ds_read_b64_tr_b16 v[160:161], v62 offset:4096
    ds_read_b64_tr_b16 v[162:163], v62 offset:4608
    s_branch zd_20
z2_19:
    v_mfma_f32_16x16x32_bf16 v[168:171], v[80:83], v[152:155], v[168:171]
    ds_read_b64_tr_b16 v[148:149], v59 offset:8192
    v_mfma_f32_16x16x32_bf16 v[172:175], v[84:87], v[152:155], v[172:175]
    ds_read_b64_tr_b16 v[150:151], v59 offset:9216
    v_mfma_f32_16x16x32_bf16 v[176:179], v[80:83], v[156:159], v[176:179]
    ds_read_b64_tr_b16 v[152:153], v60 offset:4096
    v_mfma_f32_16x16x32_bf16 v[180:183], v[84:87], v[156:159], v[180:183]
    ds_read_b64_tr_b16 v[154:155], v60 offset:4608
    v_mfma_f32_16x16x32_bf16 v[184:187], v[80:83], v[160:163], v[184:187]
    ds_read_b64_tr_b16 v[156:157], v61 offset:4096
    v_mfma_f32_16x16x32_bf16 v[188:191], v[84:87], v[160:163], v[188:191]
    ds_read_b64_tr_b16 v[158:159], v61 offset:4608
    ds_read_b64_tr_b16 v[160:161], v62 offset:4096
    ds_read_b64_tr_b16 v[162:163], v62 offset:4608
zd_20:
    s_add_u32 s12, s50, 4096
    buffer_load_dwordx4 v[80:83], v2, s[4:7], s12 offen offset:1024 sc1
    s_add_u32 s12, s50, 20480
    buffer_load_dwordx4 v[84:87], v2, s[4:7], s12 offen offset:1024 sc1
    s_waitcnt vmcnt(11)
    s_barrier
    v_add_u32 v52, 24576, v52
    v_add_u32 v53, 24576, v53
    v_add_u32 v54, 24576, v54
    v_add_u32 v55, 24576, v55
    v_add_u32 v56, 24576, v56
    v_add_u32 v57, 24576, v57
    v_add_u32 v58, 24576, v58
    v_add_u32 v59, 24576, v59
    v_add_u32 v60, 24576, v60
    v_add_u32 v61, 24576, v61
    v_add_u32 v62, 24576, v62
    s_waitcnt lgkmcnt(15)
    v_mfma_f32_16x16x32_bf16 v[192:195], v[120:123], v[64:67], v[192:195]
    v_mfma_f32_16x16x32_bf16 v[196:199], v[120:123], v[68:71], v[196:199]
    v_mfma_f32_16x16x32_bf16 v[200:203], v[124:127], v[64:67], v[200:203]
    ds_read_b64_tr_b16 v[120:121], v52 offset:0
    v_mfma_f32_16x16x32_bf16 v[204:207], v[124:127], v[68:71], v[204:207]
    ds_read_b64_tr_b16 v[122:123], v52 offset:1024
    s_add_u32 s12, s58, 8192
    s_add_u32 s12, s12, s59
    buffer_store_dwordx4 v[112:115], v10, s[4:7], s12 offen offset:0 sc1
    s_waitcnt lgkmcnt(15)
    v_mfma_f32_16x16x32_bf16 v[208:211], v[128:131], v[64:67], v[208:211]
    ds_read_b64_tr_b16 v[124:125], v53 offset:0
    v_mfma_f32_16x16x32_bf16 v[212:215], v[128:131], v[68:71], v[212:215]
    ds_read_b64_tr_b16 v[126:127], v53 offset:1024
    s_add_u32 s12, s58, 8192
    s_add_u32 s12, s12, s59
    buffer_store_dwordx4 v[116:119], v10, s[4:7], s12 offen offset:256 sc1
    v_mfma_f32_16x16x32_bf16 v[216:219], v[132:135], v[64:67], v[216:219]
    ds_read_b64_tr_b16 v[128:129], v54 offset:0
    v_mfma_f32_16x16x32_bf16 v[220:223], v[132:135], v[68:71], v[220:223]
    ds_read_b64_tr_b16 v[130:131], v54 offset:1024
    s_add_u32 m0, s48, 65536
    s_add_u32 s12, s46, 2097152
    buffer_load_dwordx4 v12, s[16:19], s12 offen lds
    s_waitcnt lgkmcnt(15)
    v_mfma_f32_16x16x32_bf16 v[224:227], v[136:139], v[64:67], v[224:227]
    ds_read_b64_tr_b16 v[132:133], v55 offset:0
    v_mfma_f32_16x16x32_bf16 v[228:231], v[136:139], v[68:71], v[228:231]
    ds_read_b64_tr_b16 v[134:135], v55 offset:1024
    s_add_u32 m0, s48, 66560
    s_add_u32 s12, s46, 2129920
    buffer_load_dwordx4 v12, s[16:19], s12 offen lds
    v_mfma_f32_16x16x32_bf16 v[232:235], v[140:143], v[64:67], v[232:235]
    ds_read_b64_tr_b16 v[136:137], v56 offset:0
    v_mfma_f32_16x16x32_bf16 v[236:239], v[140:143], v[68:71], v[236:239]
    ds_read_b64_tr_b16 v[138:139], v56 offset:1024
    s_add_u32 m0, s49, 81920
    s_add_u32 s12, s47, 704512
    buffer_load_dwordx4 v13, s[20:23], s12 offen lds
    s_waitcnt lgkmcnt(15)
    v_mfma_f32_16x16x32_bf16 v[240:243], v[144:147], v[64:67], v[240:243]
    ds_read_b64_tr_b16 v[140:141], v57 offset:0
    v_mfma_f32_16x16x32_bf16 v[244:247], v[144:147], v[68:71], v[244:247]
    ds_read_b64_tr_b16 v[142:143], v57 offset:1024
    v_mfma_f32_16x16x32_bf16 v[248:251], v[148:151], v[64:67], v[248:251]
    ds_read_b64_tr_b16 v[144:145], v58 offset:0
    v_mfma_f32_16x16x32_bf16 v[252:255], v[148:151], v[68:71], v[252:255]
    ds_read_b64_tr_b16 v[146:147], v58 offset:1024
    s_cmp_eq_u32 s36, 0
    s_waitcnt lgkmcnt(14)
    s_cbranch_scc0 z2_21
    v_mfma_f32_16x16x32_bf16 v[168:171], v[152:155], v[64:67], v[168:171]
    ds_read_b64_tr_b16 v[148:149], v59 offset:0
    v_mfma_f32_16x16x32_bf16 v[172:175], v[152:155], v[68:71], v[172:175]
    ds_read_b64_tr_b16 v[150:151], v59 offset:1024
    v_mfma_f32_16x16x32_bf16 v[176:179], v[156:159], v[64:67], v[176:179]
    ds_read_b64_tr_b16 v[152:153], v60 offset:0
    v_mfma_f32_16x16x32_bf16 v[180:183], v[156:159], v[68:71], v[180:183]
    ds_read_b64_tr_b16 v[154:155], v60 offset:512
    v_mfma_f32_16x16x32_bf16 v[184:187], v[160:163], v[64:67], v[184:187]
    ds_read_b64_tr_b16 v[156:157], v61 offset:0
    v_mfma_f32_16x16x32_bf16 v[188:191], v[160:163], v[68:71], v[188:191]
    ds_read_b64_tr_b16 v[158:159], v61 offset:512
    ds_read_b64_tr_b16 v[160:161], v62 offset:0
    ds_read_b64_tr_b16 v[162:163], v62 offset:512
    s_branch zd_22
z2_21:
    v_mfma_f32_16x16x32_bf16 v[168:171], v[64:67], v[152:155], v[168:171]
    ds_read_b64_tr_b16 v[148:149], v59 offset:0
    v_mfma_f32_16x16x32_bf16 v[172:175], v[68:71], v[152:155], v[172:175]
    ds_read_b64_tr_b16 v[150:151], v59 offset:1024
    v_mfma_f32_16x16x32_bf16 v[176:179], v[64:67], v[156:159], v[176:179]
    ds_read_b64_tr_b16 v[152:153], v60 offset:0
    v_mfma_f32_16x16x32_bf16 v[180:183], v[68:71], v[156:159], v[180:183]
    ds_read_b64_tr_b16 v[154:155], v60 offset:512
    v_mfma_f32_16x16x32_bf16 v[184:187], v[64:67], v[160:163], v[184:187]
    ds_read_b64_tr_b16 v[156:157], v61 offset:0
    v_mfma_f32_16x16x32_bf16 v[188:191], v[68:71], v[160:163], v[188:191]
    ds_read_b64_tr_b16 v[158:159], v61 offset:512
    ds_read_b64_tr_b16 v[160:161], v62 offset:0
    ds_read_b64_tr_b16 v[162:163], v62 offset:512
zd_22:
    s_add_u32 s12, s50, 4096
    buffer_load_dwordx4 v[64:67], v2, s[4:7], s12 offen offset:2048 sc1
    s_add_u32 s12, s50, 20480
    buffer_load_dwordx4 v[68:71], v2, s[4:7], s12 offen offset:2048 sc1
    s_waitcnt vmcnt(11)
    s_waitcnt lgkmcnt(15)
    v_mfma_f32_16x16x32_bf16 v[192:195], v[120:123], v[72:75], v[192:195]
    v_mfma_f32_16x16x32_bf16 v[196:199], v[120:123], v[76:79], v[196:199]
    v_mfma_f32_16x16x32_bf16 v[200:203], v[124:127], v[72:75], v[200:203]
    ds_read_b64_tr_b16 v[120:121], v52 offset:8192
    v_mfma_f32_16x16x32_bf16 v[204:207], v[124:127], v[76:79], v[204:207]
    ds_read_b64_tr_b16 v[122:123], v52 offset:9216
    s_waitcnt lgkmcnt(15)
    v_mfma_f32_16x16x32_bf16 v[208:211], v[128:131], v[72:75], v[208:211]
    ds_read_b64_tr_b16 v[124:125], v53 offset:8192
    v_mfma_f32_16x16x32_bf16 v[212:215], v[128:131], v[76:79], v[212:215]
    ds_read_b64_tr_b16 v[126:127], v53 offset:9216
    v_mfma_f32_16x16x32_bf16 v[216:219], v[132:135], v[72:75], v[216:219]
    ds_read_b64_tr_b16 v[128:129], v54 offset:8192
    v_mfma_f32_16x16x32_bf16 v[220:223], v[132:135], v[76:79], v[220:223]
    ds_read_b64_tr_b16 v[130:131], v54 offset:9216
    s_waitcnt lgkmcnt(15)
    v_mfma_f32_16x16x32_bf16 v[224:227], v[136:139], v[72:75], v[224:227]
    ds_read_b64_tr_b16 v[132:133], v55 offset:8192
    v_mfma_f32_16x16x32_bf16 v[228:231], v[136:139], v[76:79], v[228:231]
    ds_read_b64_tr_b16 v[134:135], v55 offset:9216
    v_mfma_f32_16x16x32_bf16 v[232:235], v[140:143], v[72:75], v[232:235]
    ds_read_b64_tr_b16 v[136:137], v56 offset:8192
    v_mfma_f32_16x16x32_bf16 v[236:239], v[140:143], v[76:79], v[236:239]
    ds_read_b64_tr_b16 v[138:139], v56 offset:9216
    s_waitcnt lgkmcnt(15)
    v_mfma_f32_16x16x32_bf16 v[240:243], v[144:147], v[72:75], v[240:243]
    ds_read_b64_tr_b16 v[140:141], v57 offset:8192
    v_mfma_f32_16x16x32_bf16 v[244:247], v[144:147], v[76:79], v[244:247]
    ds_read_b64_tr_b16 v[142:143], v57 offset:9216
    v_mfma_f32_16x16x32_bf16 v[248:251], v[148:151], v[72:75], v[248:251]
    ds_read_b64_tr_b16 v[144:145], v58 offset:8192
    v_mfma_f32_16x16x32_bf16 v[252:255], v[148:151], v[76:79], v[252:255]
    ds_read_b64_tr_b16 v[146:147], v58 offset:9216
    s_cmp_eq_u32 s36, 0
    s_waitcnt lgkmcnt(14)
    s_cbranch_scc0 z2_23
    v_mfma_f32_16x16x32_bf16 v[168:171], v[152:155], v[72:75], v[168:171]
    ds_read_b64_tr_b16 v[148:149], v59 offset:8192
    v_mfma_f32_16x16x32_bf16 v[172:175], v[152:155], v[76:79], v[172:175]
    ds_read_b64_tr_b16 v[150:151], v59 offset:9216
    v_mfma_f32_16x16x32_bf16 v[176:179], v[156:159], v[72:75], v[176:179]
    ds_read_b64_tr_b16 v[152:153], v60 offset:4096
    v_mfma_f32_16x16x32_bf16 v[180:183], v[156:159], v[76:79], v[180:183]
    ds_read_b64_tr_b16 v[154:155], v60 offset:4608
    v_mfma_f32_16x16x32_bf16 v[184:187], v[160:163], v[72:75], v[184:187]
    ds_read_b64_tr_b16 v[156:157], v61 offset:4096
    v_mfma_f32_16x16x32_bf16 v[188:191], v[160:163], v[76:79], v[188:191]
    ds_read_b64_tr_b16 v[158:159], v61 offset:4608
    ds_read_b64_tr_b16 v[160:161], v62 offset:4096
    ds_read_b64_tr_b16 v[162:163], v62 offset:4608
    s_branch zd_24
z2_23:
    v_mfma_f32_16x16x32_bf16 v[168:171], v[72:75], v[152:155], v[168:171]
    ds_read_b64_tr_b16 v[148:149], v59 offset:8192
    v_mfma_f32_16x16x32_bf16 v[172:175], v[76:79], v[152:155], v[172:175]
    ds_read_b64_tr_b16 v[150:151], v59 offset:9216
    v_mfma_f32_16x16x32_bf16 v[176:179], v[72:75], v[156:159], v[176:179]
    ds_read_b64_tr_b16 v[152:153], v60 offset:4096
    v_mfma_f32_16x16x32_bf16 v[180:183], v[76:79], v[156:159], v[180:183]
    ds_read_b64_tr_b16 v[154:155], v60 offset:4608
    v_mfma_f32_16x16x32_bf16 v[184:187], v[72:75], v[160:163], v[184:187]
    ds_read_b64_tr_b16 v[156:157], v61 offset:4096
    v_mfma_f32_16x16x32_bf16 v[188:191], v[76:79], v[160:163], v[188:191]
    ds_read_b64_tr_b16 v[158:159], v61 offset:4608
    ds_read_b64_tr_b16 v[160:161], v62 offset:4096
    ds_read_b64_tr_b16 v[162:163], v62 offset:4608
zd_24:
    s_add_u32 s12, s50, 4096
    buffer_load_dwordx4 v[72:75], v2, s[4:7], s12 offen offset:3072 sc1
    s_add_u32 s12, s50, 20480
    buffer_load_dwordx4 v[76:79], v2, s[4:7], s12 offen offset:3072 sc1
    s_waitcnt vmcnt(9)
    s_barrier
    v_add_u32 v52, 24576, v52
    v_add_u32 v53, 24576, v53
    v_add_u32 v54, 24576, v54
    v_add_u32 v55, 24576, v55
    v_add_u32 v56, 24576, v56
    v_add_u32 v57, 24576, v57
    v_add_u32 v58, 24576, v58
    v_add_u32 v59, 24576, v59
    v_add_u32 v60, 24576, v60
    v_add_u32 v61, 24576, v61
    v_add_u32 v62, 24576, v62
    s_waitcnt lgkmcnt(15)
    v_mfma_f32_16x16x32_bf16 v[192:195], v[120:123], v[80:83], v[192:195]
    v_mfma_f32_16x16x32_bf16 v[196:199], v[120:123], v[84:87], v[196:199]
    v_mfma_f32_16x16x32_bf16 v[200:203], v[124:127], v[80:83], v[200:203]
    ds_read_b64_tr_b16 v[120:121], v52 offset:0
    v_mfma_f32_16x16x32_bf16 v[204:207], v[124:127], v[84:87], v[204:207]
    ds_read_b64_tr_b16 v[122:123], v52 offset:1024
    s_add_u32 m0, s48, 90112
    s_add_u32 s12, s46, 2621440
    buffer_load_dwordx4 v12, s[16:19], s12 offen lds
    s_waitcnt lgkmcnt(15)
    v_mfma_f32_16x16x32_bf16 v[208:211], v[128:131], v[80:83], v[208:211]
    ds_read_b64_tr_b16 v[124:125], v53 offset:0
    v_mfma_f32_16x16x32_bf16 v[212:215], v[128:131], v[84:87], v[212:215]
    ds_read_b64_tr_b16 v[126:127], v53 offset:1024
    s_add_u32 m0, s48, 91136
    s_add_u32 s12, s46, 2654208
    buffer_load_dwordx4 v12, s[16:19], s12 offen lds
    v_mfma_f32_16x16x32_bf16 v[216:219], v[132:135], v[80:83], v[216:219]
    ds_read_b64_tr_b16 v[128:129], v54 offset:0
    v_mfma_f32_16x16x32_bf16 v[220:223], v[132:135], v[84:87], v[220:223]
    ds_read_b64_tr_b16 v[130:131], v54 offset:1024
    s_add_u32 m0, s49, 106496
    s_add_u32 s12, s47, 880640
    buffer_load_dwordx4 v13, s[20:23], s12 offen lds
    s_waitcnt lgkmcnt(15)
    v_mfma_f32_16x16x32_bf16 v[224:227], v[136:139], v[80:83], v[224:227]
    ds_read_b64_tr_b16 v[132:133], v55 offset:0
    v_mfma_f32_16x16x32_bf16 v[228:231], v[136:139], v[84:87], v[228:231]
    ds_read_b64_tr_b16 v[134:135], v55 offset:1024
    v_mfma_f32_16x16x32_bf16 v[232:235], v[140:143], v[80:83], v[232:235]
    ds_read_b64_tr_b16 v[136:137], v56 offset:0
    v_mfma_f32_16x16x32_bf16 v[236:239], v[140:143], v[84:87], v[236:239]
    ds_read_b64_tr_b16 v[138:139], v56 offset:1024
    s_waitcnt lgkmcnt(15)
    v_mfma_f32_16x16x32_bf16 v[240:243], v[144:147], v[80:83], v[240:243]
    ds_read_b64_tr_b16 v[140:141], v57 offset:0
    v_mfma_f32_16x16x32_bf16 v[244:247], v[144:147], v[84:87], v[244:247]
    ds_read_b64_tr_b16 v[142:143], v57 offset:1024
    v_mfma_f32_16x16x32_bf16 v[248:251], v[148:151], v[80:83], v[248:251]
    ds_read_b64_tr_b16 v[144:145], v58 offset:0
    v_mfma_f32_16x16x32_bf16 v[252:255], v[148:151], v[84:87], v[252:255]
    ds_read_b64_tr_b16 v[146:147], v58 offset:1024
    s_cmp_eq_u32 s36, 0
    s_waitcnt lgkmcnt(14)
    s_cbranch_scc0 z2_25
    v_mfma_f32_16x16x32_bf16 v[168:171], v[152:155], v[80:83], v[168:171]
    ds_read_b64_tr_b16 v[148:149], v59 offset:0
    v_mfma_f32_16x16x32_bf16 v[172:175], v[152:155], v[84:87], v[172:175]
    ds_read_b64_tr_b16 v[150:151], v59 offset:1024
    v_mfma_f32_16x16x32_bf16 v[176:179], v[156:159], v[80:83], v[176:179]
    ds_read_b64_tr_b16 v[152:153], v60 offset:0
    v_mfma_f32_16x16x32_bf16 v[180:183], v[156:159], v[84:87], v[180:183]
    ds_read_b64_tr_b16 v[154:155], v60 offset:512
    v_mfma_f32_16x16x32_bf16 v[184:187], v[160:163], v[80:83], v[184:187]
    ds_read_b64_tr_b16 v[156:157], v61 offset:0
    v_mfma_f32_16x16x32_bf16 v[188:191], v[160:163], v[84:87], v[188:191]
    ds_read_b64_tr_b16 v[158:159], v61 offset:512
    ds_read_b64_tr_b16 v[160:161], v62 offset:0
    ds_read_b64_tr_b16 v[162:163], v62 offset:512
    s_branch zd_26
z2_25:
    v_mfma_f32_16x16x32_bf16 v[168:171], v[80:83], v[152:155], v[168:171]
    ds_read_b64_tr_b16 v[148:149], v59 offset:0
    v_mfma_f32_16x16x32_bf16 v[172:175], v[84:87], v[152:155], v[172:175]
    ds_read_b64_tr_b16 v[150:151], v59 offset:1024
    v_mfma_f32_16x16x32_bf16 v[176:179], v[80:83], v[156:159], v[176:179]
    ds_read_b64_tr_b16 v[152:153], v60 offset:0
    v_mfma_f32_16x16x32_bf16 v[180:183], v[84:87], v[156:159], v[180:183]
    ds_read_b64_tr_b16 v[154:155], v60 offset:512
    v_mfma_f32_16x16x32_bf16 v[184:187], v[80:83], v[160:163], v[184:187]
    ds_read_b64_tr_b16 v[156:157], v61 offset:0
    v_mfma_f32_16x16x32_bf16 v[188:191], v[84:87], v[160:163], v[188:191]
    ds_read_b64_tr_b16 v[158:159], v61 offset:512
    ds_read_b64_tr_b16 v[160:161], v62 offset:0
    ds_read_b64_tr_b16 v[162:163], v62 offset:512
zd_26:
    s_add_u32 s12, s50, 8192
    buffer_load_dwordx4 v[80:83], v2, s[4:7], s12 offen offset:0 sc1
    s_add_u32 s12, s50, 24576
    buffer_load_dwordx4 v[84:87], v2, s[4:7], s12 offen offset:0 sc1
    s_waitcnt vmcnt(7)
    s_waitcnt lgkmcnt(15)
    v_mfma_f32_16x16x32_bf16 v[192:195], v[120:123], v[64:67], v[192:195]
    v_mfma_f32_16x16x32_bf16 v[196:199], v[120:123], v[68:71], v[196:199]
    v_mfma_f32_16x16x32_bf16 v[200:203], v[124:127], v[64:67], v[200:203]
    ds_read_b64_tr_b16 v[120:121], v52 offset:8192
    v_mfma_f32_16x16x32_bf16 v[204:207], v[124:127], v[68:71], v[204:207]
    ds_read_b64_tr_b16 v[122:123], v52 offset:9216
    s_waitcnt lgkmcnt(15)
    v_mfma_f32_16x16x32_bf16 v[208:211], v[128:131], v[64:67], v[208:211]
    ds_read_b64_tr_b16 v[124:125], v53 offset:8192
    v_mfma_f32_16x16x32_bf16 v[212:215], v[128:131], v[68:71], v[212:215]
    ds_read_b64_tr_b16 v[126:127], v53 offset:9216
    v_mfma_f32_16x16x32_bf16 v[216:219], v[132:135], v[64:67], v[216:219]
    ds_read_b64_tr_b16 v[128:129], v54 offset:8192
    v_mfma_f32_16x16x32_bf16 v[220:223], v[132:135], v[68:71], v[220:223]
    ds_read_b64_tr_b16 v[130:131], v54 offset:9216
    s_waitcnt lgkmcnt(15)
    v_mfma_f32_16x16x32_bf16 v[224:227], v[136:139], v[64:67], v[224:227]
    ds_read_b64_tr_b16 v[132:133], v55 offset:8192
    v_mfma_f32_16x16x32_bf16 v[228:231], v[136:139], v[68:71], v[228:231]
    ds_read_b64_tr_b16 v[134:135], v55 offset:9216
    v_mfma_f32_16x16x32_bf16 v[232:235], v[140:143], v[64:67], v[232:235]
    ds_read_b64_tr_b16 v[136:137], v56 offset:8192
    v_mfma_f32_16x16x32_bf16 v[236:239], v[140:143], v[68:71], v[236:239]
    ds_read_b64_tr_b16 v[138:139], v56 offset:9216
    s_waitcnt lgkmcnt(15)
    v_mfma_f32_16x16x32_bf16 v[240:243], v[144:147], v[64:67], v[240:243]
    ds_read_b64_tr_b16 v[140:141], v57 offset:8192
    v_mfma_f32_16x16x32_bf16 v[244:247], v[144:147], v[68:71], v[244:247]
    ds_read_b64_tr_b16 v[142:143], v57 offset:9216
    v_mfma_f32_16x16x32_bf16 v[248:251], v[148:151], v[64:67], v[248:251]
    ds_read_b64_tr_b16 v[144:145], v58 offset:8192
    v_mfma_f32_16x16x32_bf16 v[252:255], v[148:151], v[68:71], v[252:255]
    ds_read_b64_tr_b16 v[146:147], v58 offset:9216
    s_cmp_eq_u32 s36, 0
    s_waitcnt lgkmcnt(14)
    s_cbranch_scc0 z2_27
    v_mfma_f32_16x16x32_bf16 v[168:171], v[152:155], v[64:67], v[168:171]
    ds_read_b64_tr_b16 v[148:149], v59 offset:8192
    v_mfma_f32_16x16x32_bf16 v[172:175], v[152:155], v[68:71], v[172:175]
    ds_read_b64_tr_b16 v[150:151], v59 offset:9216
    v_mfma_f32_16x16x32_bf16 v[176:179], v[156:159], v[64:67], v[176:179]
    ds_read_b64_tr_b16 v[152:153], v60 offset:4096
    v_mfma_f32_16x16x32_bf16 v[180:183], v[156:159], v[68:71], v[180:183]
    ds_read_b64_tr_b16 v[154:155], v60 offset:4608
    v_mfma_f32_16x16x32_bf16 v[184:187], v[160:163], v[64:67], v[184:187]
    ds_read_b64_tr_b16 v[156:157], v61 offset:4096
    v_mfma_f32_16x16x32_bf16 v[188:191], v[160:163], v[68:71], v[188:191]
    ds_read_b64_tr_b16 v[158:159], v61 offset:4608
    ds_read_b64_tr_b16 v[160:161], v62 offset:4096
    ds_read_b64_tr_b16 v[162:163], v62 offset:4608
    s_branch zd_28
z2_27:
    v_mfma_f32_16x16x32_bf16 v[168:171], v[64:67], v[152:155], v[168:171]
    ds_read_b64_tr_b16 v[148:149], v59 offset:8192
    v_mfma_f32_16x16x32_bf16 v[172:175], v[68:71], v[152:155], v[172:175]
    ds_read_b64_tr_b16 v[150:151], v59 offset:9216
    v_mfma_f32_16x16x32_bf16 v[176:179], v[64:67], v[156:159], v[176:179]
    ds_read_b64_tr_b16 v[152:153], v60 offset:4096
    v_mfma_f32_16x16x32_bf16 v[180:183], v[68:71], v[156:159], v[180:183]
    ds_read_b64_tr_b16 v[154:155], v60 offset:4608
    v_mfma_f32_16x16x32_bf16 v[184:187], v[64:67], v[160:163], v[184:187]
    ds_read_b64_tr_b16 v[156:157], v61 offset:4096
    v_mfma_f32_16x16x32_bf16 v[188:191], v[68:71], v[160:163], v[188:191]
    ds_read_b64_tr_b16 v[158:159], v61 offset:4608
    ds_read_b64_tr_b16 v[160:161], v62 offset:4096
    ds_read_b64_tr_b16 v[162:163], v62 offset:4608
zd_28:
    s_add_u32 s12, s50, 8192
    buffer_load_dwordx4 v[64:67], v2, s[4:7], s12 offen offset:1024 sc1
    s_add_u32 s12, s50, 24576
    buffer_load_dwordx4 v[68:71], v2, s[4:7], s12 offen offset:1024 sc1
    s_waitcnt vmcnt(7)
    s_barrier
    v_subrev_u32 v52, 73728, v52
    v_subrev_u32 v53, 73728, v53
    v_subrev_u32 v54, 73728, v54
    v_subrev_u32 v55, 73728, v55
    v_subrev_u32 v56, 73728, v56
    v_subrev_u32 v57, 73728, v57
    v_subrev_u32 v58, 73728, v58
    v_subrev_u32 v59, 73728, v59
    v_subrev_u32 v60, 73728, v60
    v_subrev_u32 v61, 73728, v61
    v_subrev_u32 v62, 73728, v62
    s_cmp_lg_u32 s3, 0
    s_cbranch_scc1 sig_29
    s_lshl_b32 s14, s60, 8
    s_add_u32 s14, s14, 117440512
    v_mov_b32_e64 v8, 0
    v_mov_b32 v9, 1
    s_mov_b64 exec, 1
    buffer_atomic_add v9, v8, s[4:7], s14 offen sc1
    s_mov_b64 exec, -1
sig_29:
    s_waitcnt lgkmcnt(15)
    v_mfma_f32_16x16x32_bf16 v[192:195], v[120:123], v[72:75], v[192:195]
    v_mfma_f32_16x16x32_bf16 v[196:199], v[120:123], v[76:79], v[196:199]
    v_mfma_f32_16x16x32_bf16 v[200:203], v[124:127], v[72:75], v[200:203]
    ds_read_b64_tr_b16 v[120:121], v52 offset:0
    v_mfma_f32_16x16x32_bf16 v[204:207], v[124:127], v[76:79], v[204:207]
    ds_read_b64_tr_b16 v[122:123], v52 offset:1024
    s_add_u32 m0, s48, 114688
    s_add_u32 s12, s46, 3145728
    buffer_load_dwordx4 v12, s[16:19], s12 offen lds
    s_waitcnt lgkmcnt(15)
    v_mfma_f32_16x16x32_bf16 v[208:211], v[128:131], v[72:75], v[208:211]
    ds_read_b64_tr_b16 v[124:125], v53 offset:0
    v_mfma_f32_16x16x32_bf16 v[212:215], v[128:131], v[76:79], v[212:215]
    ds_read_b64_tr_b16 v[126:127], v53 offset:1024
    s_add_u32 m0, s48, 115712
    s_add_u32 s12, s46, 3178496
    buffer_load_dwordx4 v12, s[16:19], s12 offen lds
    v_mfma_f32_16x16x32_bf16 v[216:219], v[132:135], v[72:75], v[216:219]
    ds_read_b64_tr_b16 v[128:129], v54 offset:0
    v_mfma_f32_16x16x32_bf16 v[220:223], v[132:135], v[76:79], v[220:223]
    ds_read_b64_tr_b16 v[130:131], v54 offset:1024
    s_add_u32 m0, s49, 131072
    s_add_u32 s12, s47, 1056768
    buffer_load_dwordx4 v13, s[20:23], s12 offen lds
    s_waitcnt lgkmcnt(15)
    v_mfma_f32_16x16x32_bf16 v[224:227], v[136:139], v[72:75], v[224:227]
    ds_read_b64_tr_b16 v[132:133], v55 offset:0
    v_mfma_f32_16x16x32_bf16 v[228:231], v[136:139], v[76:79], v[228:231]
    ds_read_b64_tr_b16 v[134:135], v55 offset:1024
    v_mfma_f32_16x16x32_bf16 v[232:235], v[140:143], v[72:75], v[232:235]
    ds_read_b64_tr_b16 v[136:137], v56 offset:0
    v_mfma_f32_16x16x32_bf16 v[236:239], v[140:143], v[76:79], v[236:239]
    ds_read_b64_tr_b16 v[138:139], v56 offset:1024
    s_waitcnt lgkmcnt(15)
    v_mfma_f32_16x16x32_bf16 v[240:243], v[144:147], v[72:75], v[240:243]
    ds_read_b64_tr_b16 v[140:141], v57 offset:0
    v_mfma_f32_16x16x32_bf16 v[244:247], v[144:147], v[76:79], v[244:247]
    ds_read_b64_tr_b16 v[142:143], v57 offset:1024
    v_mfma_f32_16x16x32_bf16 v[248:251], v[148:151], v[72:75], v[248:251]
    ds_read_b64_tr_b16 v[144:145], v58 offset:0
    v_mfma_f32_16x16x32_bf16 v[252:255], v[148:151], v[76:79], v[252:255]
    ds_read_b64_tr_b16 v[146:147], v58 offset:1024
    s_cmp_eq_u32 s36, 0
    s_waitcnt lgkmcnt(14)
    s_cbranch_scc0 z2_30
    v_mfma_f32_16x16x32_bf16 v[168:171], v[152:155], v[72:75], v[168:171]
    ds_read_b64_tr_b16 v[148:149], v59 offset:0
    v_mfma_f32_16x16x32_bf16 v[172:175], v[152:155], v[76:79], v[172:175]
    ds_read_b64_tr_b16 v[150:151], v59 offset:1024
    v_mfma_f32_16x16x32_bf16 v[176:179], v[156:159], v[72:75], v[176:179]
    ds_read_b64_tr_b16 v[152:153], v60 offset:0
    v_mfma_f32_16x16x32_bf16 v[180:183], v[156:159], v[76:79], v[180:183]
    ds_read_b64_tr_b16 v[154:155], v60 offset:512
    v_mfma_f32_16x16x32_bf16 v[184:187], v[160:163], v[72:75], v[184:187]
    ds_read_b64_tr_b16 v[156:157], v61 offset:0
    v_mfma_f32_16x16x32_bf16 v[188:191], v[160:163], v[76:79], v[188:191]
    ds_read_b64_tr_b16 v[158:159], v61 offset:512
    ds_read_b64_tr_b16 v[160:161], v62 offset:0
    ds_read_b64_tr_b16 v[162:163], v62 offset:512
    s_branch zd_31
z2_30:
    v_mfma_f32_16x16x32_bf16 v[168:171], v[72:75], v[152:155], v[168:171]
    ds_read_b64_tr_b16 v[148:149], v59 offset:0
    v_mfma_f32_16x16x32_bf16 v[172:175], v[76:79], v[152:155], v[172:175]
    ds_read_b64_tr_b16 v[150:151], v59 offset:1024
    v_mfma_f32_16x16x32_bf16 v[176:179], v[72:75], v[156:159], v[176:179]
    ds_read_b64_tr_b16 v[152:153], v60 offset:0
    v_mfma_f32_16x16x32_bf16 v[180:183], v[76:79], v[156:159], v[180:183]
    ds_read_b64_tr_b16 v[154:155], v60 offset:512
    v_mfma_f32_16x16x32_bf16 v[184:187], v[72:75], v[160:163], v[184:187]
    ds_read_b64_tr_b16 v[156:157], v61 offset:0
    v_mfma_f32_16x16x32_bf16 v[188:191], v[76:79], v[160:163], v[188:191]
    ds_read_b64_tr_b16 v[158:159], v61 offset:512
    ds_read_b64_tr_b16 v[160:161], v62 offset:0
    ds_read_b64_tr_b16 v[162:163], v62 offset:512
zd_31:
    s_add_u32 s12, s50, 8192
    buffer_load_dwordx4 v[72:75], v2, s[4:7], s12 offen offset:2048 sc1
    s_add_u32 s12, s50, 24576
    buffer_load_dwordx4 v[76:79], v2, s[4:7], s12 offen offset:2048 sc1
    s_waitcnt vmcnt(7)
    s_waitcnt lgkmcnt(15)
    v_mfma_f32_16x16x32_bf16 v[192:195], v[120:123], v[80:83], v[192:195]
    v_mfma_f32_16x16x32_bf16 v[196:199], v[120:123], v[84:87], v[196:199]
    v_mfma_f32_16x16x32_bf16 v[200:203], v[124:127], v[80:83], v[200:203]
    ds_read_b64_tr_b16 v[120:121], v52 offset:8192
    v_mfma_f32_16x16x32_bf16 v[204:207], v[124:127], v[84:87], v[204:207]
    ds_read_b64_tr_b16 v[122:123], v52 offset:9216
    s_waitcnt lgkmcnt(15)
    v_mfma_f32_16x16x32_bf16 v[208:211], v[128:131], v[80:83], v[208:211]
    ds_read_b64_tr_b16 v[124:125], v53 offset:8192
    v_mfma_f32_16x16x32_bf16 v[212:215], v[128:131], v[84:87], v[212:215]
    ds_read_b64_tr_b16 v[126:127], v53 offset:9216
    v_mfma_f32_16x16x32_bf16 v[216:219], v[132:135], v[80:83], v[216:219]
    ds_read_b64_tr_b16 v[128:129], v54 offset:8192
    v_mfma_f32_16x16x32_bf16 v[220:223], v[132:135], v[84:87], v[220:223]
    ds_read_b64_tr_b16 v[130:131], v54 offset:9216
    s_waitcnt lgkmcnt(15)
    v_mfma_f32_16x16x32_bf16 v[224:227], v[136:139], v[80:83], v[224:227]
    ds_read_b64_tr_b16 v[132:133], v55 offset:8192
    v_mfma_f32_16x16x32_bf16 v[228:231], v[136:139], v[84:87], v[228:231]
    ds_read_b64_tr_b16 v[134:135], v55 offset:9216
    v_mfma_f32_16x16x32_bf16 v[232:235], v[140:143], v[80:83], v[232:235]
    ds_read_b64_tr_b16 v[136:137], v56 offset:8192
    v_mfma_f32_16x16x32_bf16 v[236:239], v[140:143], v[84:87], v[236:239]
    ds_read_b64_tr_b16 v[138:139], v56 offset:9216
    s_waitcnt lgkmcnt(15)
    v_mfma_f32_16x16x32_bf16 v[240:243], v[144:147], v[80:83], v[240:243]
    ds_read_b64_tr_b16 v[140:141], v57 offset:8192
    v_mfma_f32_16x16x32_bf16 v[244:247], v[144:147], v[84:87], v[244:247]
    ds_read_b64_tr_b16 v[142:143], v57 offset:9216
    v_mfma_f32_16x16x32_bf16 v[248:251], v[148:151], v[80:83], v[248:251]
    ds_read_b64_tr_b16 v[144:145], v58 offset:8192
    v_mfma_f32_16x16x32_bf16 v[252:255], v[148:151], v[84:87], v[252:255]
    ds_read_b64_tr_b16 v[146:147], v58 offset:9216
    s_cmp_eq_u32 s36, 0
    s_waitcnt lgkmcnt(14)
    s_cbranch_scc0 z2_32
    v_mfma_f32_16x16x32_bf16 v[168:171], v[152:155], v[80:83], v[168:171]
    ds_read_b64_tr_b16 v[148:149], v59 offset:8192
    v_mfma_f32_16x16x32_bf16 v[172:175], v[152:155], v[84:87], v[172:175]
    ds_read_b64_tr_b16 v[150:151], v59 offset:9216
    v_mfma_f32_16x16x32_bf16 v[176:179], v[156:159], v[80:83], v[176:179]
    ds_read_b64_tr_b16 v[152:153], v60 offset:4096
    v_mfma_f32_16x16x32_bf16 v[180:183], v[156:159], v[84:87], v[180:183]
    ds_read_b64_tr_b16 v[154:155], v60 offset:4608
    v_mfma_f32_16x16x32_bf16 v[184:187], v[160:163], v[80:83], v[184:187]
    ds_read_b64_tr_b16 v[156:157], v61 offset:4096
    v_mfma_f32_16x16x32_bf16 v[188:191], v[160:163], v[84:87], v[188:191]
    ds_read_b64_tr_b16 v[158:159], v61 offset:4608
    ds_read_b64_tr_b16 v[160:161], v62 offset:4096
    ds_read_b64_tr_b16 v[162:163], v62 offset:4608
    s_branch zd_33
z2_32:
    v_mfma_f32_16x16x32_bf16 v[168:171], v[80:83], v[152:155], v[168:171]
    ds_read_b64_tr_b16 v[148:149], v59 offset:8192
    v_mfma_f32_16x16x32_bf16 v[172:175], v[84:87], v[152:155], v[172:175]
    ds_read_b64_tr_b16 v[150:151], v59 offset:9216
    v_mfma_f32_16x16x32_bf16 v[176:179], v[80:83], v[156:159], v[176:179]
    ds_read_b64_tr_b16 v[152:153], v60 offset:4096
    v_mfma_f32_16x16x32_bf16 v[180:183], v[84:87], v[156:159], v[180:183]
    ds_read_b64_tr_b16 v[154:155], v60 offset:4608
    v_mfma_f32_16x16x32_bf16 v[184:187], v[80:83], v[160:163], v[184:187]
    ds_read_b64_tr_b16 v[156:157], v61 offset:4096
    v_mfma_f32_16x16x32_bf16 v[188:191], v[84:87], v[160:163], v[188:191]
    ds_read_b64_tr_b16 v[158:159], v61 offset:4608
    ds_read_b64_tr_b16 v[160:161], v62 offset:4096
    ds_read_b64_tr_b16 v[162:163], v62 offset:4608
zd_33:
    s_add_u32 s12, s50, 8192
    buffer_load_dwordx4 v[80:83], v2, s[4:7], s12 offen offset:3072 sc1
    s_add_u32 s12, s50, 24576
    buffer_load_dwordx4 v[84:87], v2, s[4:7], s12 offen offset:3072 sc1
    s_waitcnt vmcnt(7)
    s_barrier
    v_add_u32 v52, 24576, v52
    v_add_u32 v53, 24576, v53
    v_add_u32 v54, 24576, v54
    v_add_u32 v55, 24576, v55
    v_add_u32 v56, 24576, v56
    v_add_u32 v57, 24576, v57
    v_add_u32 v58, 24576, v58
    v_add_u32 v59, 24576, v59
    v_add_u32 v60, 24576, v60
    v_add_u32 v61, 24576, v61
    v_add_u32 v62, 24576, v62
    s_waitcnt lgkmcnt(15)
    v_mfma_f32_16x16x32_bf16 v[192:195], v[120:123], v[64:67], v[192:195]
    v_mfma_f32_16x16x32_bf16 v[196:199], v[120:123], v[68:71], v[196:199]
    v_mfma_f32_16x16x32_bf16 v[200:203], v[124:127], v[64:67], v[200:203]
    ds_read_b64_tr_b16 v[120:121], v52 offset:0
    v_mfma_f32_16x16x32_bf16 v[204:207], v[124:127], v[68:71], v[204:207]
    ds_read_b64_tr_b16 v[122:123], v52 offset:1024
    s_add_u32 m0, s48, 139264
    s_add_u32 s12, s46, 3670016
    buffer_load_dwordx4 v12, s[16:19], s12 offen lds
    s_waitcnt lgkmcnt(15)
    v_mfma_f32_16x16x32_bf16 v[208:211], v[128:131], v[64:67], v[208:211]
    ds_read_b64_tr_b16 v[124:125], v53 offset:0
    v_mfma_f32_16x16x32_bf16 v[212:215], v[128:131], v[68:71], v[212:215]
    ds_read_b64_tr_b16 v[126:127], v53 offset:1024
    s_add_u32 m0, s48, 140288
    s_add_u32 s12, s46, 3702784
    buffer_load_dwordx4 v12, s[16:19], s12 offen lds
    v_mfma_f32_16x16x32_bf16 v[216:219], v[132:135], v[64:67], v[216:219]
    ds_read_b64_tr_b16 v[128:129], v54 offset:0
    v_mfma_f32_16x16x32_bf16 v[220:223], v[132:135], v[68:71], v[220:223]
    ds_read_b64_tr_b16 v[130:131], v54 offset:1024
    s_add_u32 m0, s49, 155648
    s_add_u32 s12, s47, 1232896
    buffer_load_dwordx4 v13, s[20:23], s12 offen lds
    s_waitcnt lgkmcnt(15)
    v_mfma_f32_16x16x32_bf16 v[224:227], v[136:139], v[64:67], v[224:227]
    ds_read_b64_tr_b16 v[132:133], v55 offset:0
    v_mfma_f32_16x16x32_bf16 v[228:231], v[136:139], v[68:71], v[228:231]
    ds_read_b64_tr_b16 v[134:135], v55 offset:1024
    v_mfma_f32_16x16x32_bf16 v[232:235], v[140:143], v[64:67], v[232:235]
    ds_read_b64_tr_b16 v[136:137], v56 offset:0
    v_mfma_f32_16x16x32_bf16 v[236:239], v[140:143], v[68:71], v[236:239]
    ds_read_b64_tr_b16 v[138:139], v56 offset:1024
    s_waitcnt lgkmcnt(15)
    v_mfma_f32_16x16x32_bf16 v[240:243], v[144:147], v[64:67], v[240:243]
    ds_read_b64_tr_b16 v[140:141], v57 offset:0
    v_mfma_f32_16x16x32_bf16 v[244:247], v[144:147], v[68:71], v[244:247]
    ds_read_b64_tr_b16 v[142:143], v57 offset:1024
    v_mfma_f32_16x16x32_bf16 v[248:251], v[148:151], v[64:67], v[248:251]
    ds_read_b64_tr_b16 v[144:145], v58 offset:0
    v_mfma_f32_16x16x32_bf16 v[252:255], v[148:151], v[68:71], v[252:255]
    ds_read_b64_tr_b16 v[146:147], v58 offset:1024
    s_cmp_eq_u32 s36, 0
    s_waitcnt lgkmcnt(14)
    s_cbranch_scc0 z2_34
    v_mfma_f32_16x16x32_bf16 v[168:171], v[152:155], v[64:67], v[168:171]
    ds_read_b64_tr_b16 v[148:149], v59 offset:0
    v_mfma_f32_16x16x32_bf16 v[172:175], v[152:155], v[68:71], v[172:175]
    ds_read_b64_tr_b16 v[150:151], v59 offset:1024
    v_mfma_f32_16x16x32_bf16 v[176:179], v[156:159], v[64:67], v[176:179]
    ds_read_b64_tr_b16 v[152:153], v60 offset:0
    v_mfma_f32_16x16x32_bf16 v[180:183], v[156:159], v[68:71], v[180:183]
    ds_read_b64_tr_b16 v[154:155], v60 offset:512
    v_mfma_f32_16x16x32_bf16 v[184:187], v[160:163], v[64:67], v[184:187]
    ds_read_b64_tr_b16 v[156:157], v61 offset:0
    v_mfma_f32_16x16x32_bf16 v[188:191], v[160:163], v[68:71], v[188:191]
    ds_read_b64_tr_b16 v[158:159], v61 offset:512
    ds_read_b64_tr_b16 v[160:161], v62 offset:0
    ds_read_b64_tr_b16 v[162:163], v62 offset:512
    s_branch zd_35
z2_34:
    v_mfma_f32_16x16x32_bf16 v[168:171], v[64:67], v[152:155], v[168:171]
    ds_read_b64_tr_b16 v[148:149], v59 offset:0
    v_mfma_f32_16x16x32_bf16 v[172:175], v[68:71], v[152:155], v[172:175]
    ds_read_b64_tr_b16 v[150:151], v59 offset:1024
    v_mfma_f32_16x16x32_bf16 v[176:179], v[64:67], v[156:159], v[176:179]
    ds_read_b64_tr_b16 v[152:153], v60 offset:0
    v_mfma_f32_16x16x32_bf16 v[180:183], v[68:71], v[156:159], v[180:183]
    ds_read_b64_tr_b16 v[154:155], v60 offset:512
    v_mfma_f32_16x16x32_bf16 v[184:187], v[64:67], v[160:163], v[184:187]
    ds_read_b64_tr_b16 v[156:157], v61 offset:0
    v_mfma_f32_16x16x32_bf16 v[188:191], v[68:71], v[160:163], v[188:191]
    ds_read_b64_tr_b16 v[158:159], v61 offset:512
    ds_read_b64_tr_b16 v[160:161], v62 offset:0
    ds_read_b64_tr_b16 v[162:163], v62 offset:512
zd_35:
    s_add_u32 s12, s50, 12288
    buffer_load_dwordx4 v[64:67], v2, s[4:7], s12 offen offset:0 sc1
    s_add_u32 s12, s50, 28672
    buffer_load_dwordx4 v[68:71], v2, s[4:7], s12 offen offset:0 sc1
    s_waitcnt vmcnt(7)
    s_waitcnt lgkmcnt(15)
    v_mfma_f32_16x16x32_bf16 v[192:195], v[120:123], v[72:75], v[192:195]
    v_mfma_f32_16x16x32_bf16 v[196:199], v[120:123], v[76:79], v[196:199]
    v_mfma_f32_16x16x32_bf16 v[200:203], v[124:127], v[72:75], v[200:203]
    ds_read_b64_tr_b16 v[120:121], v52 offset:8192
    v_mfma_f32_16x16x32_bf16 v[204:207], v[124:127], v[76:79], v[204:207]
    ds_read_b64_tr_b16 v[122:123], v52 offset:9216
    s_waitcnt lgkmcnt(15)
    v_mfma_f32_16x16x32_bf16 v[208:211], v[128:131], v[72:75], v[208:211]
    ds_read_b64_tr_b16 v[124:125], v53 offset:8192
    v_mfma_f32_16x16x32_bf16 v[212:215], v[128:131], v[76:79], v[212:215]
    ds_read_b64_tr_b16 v[126:127], v53 offset:9216
    v_mfma_f32_16x16x32_bf16 v[216:219], v[132:135], v[72:75], v[216:219]
    ds_read_b64_tr_b16 v[128:129], v54 offset:8192
    v_mfma_f32_16x16x32_bf16 v[220:223], v[132:135], v[76:79], v[220:223]
    ds_read_b64_tr_b16 v[130:131], v54 offset:9216
    s_waitcnt lgkmcnt(15)
    v_mfma_f32_16x16x32_bf16 v[224:227], v[136:139], v[72:75], v[224:227]
    ds_read_b64_tr_b16 v[132:133], v55 offset:8192
    v_mfma_f32_16x16x32_bf16 v[228:231], v[136:139], v[76:79], v[228:231]
    ds_read_b64_tr_b16 v[134:135], v55 offset:9216
    v_mfma_f32_16x16x32_bf16 v[232:235], v[140:143], v[72:75], v[232:235]
    ds_read_b64_tr_b16 v[136:137], v56 offset:8192
    v_mfma_f32_16x16x32_bf16 v[236:239], v[140:143], v[76:79], v[236:239]
    ds_read_b64_tr_b16 v[138:139], v56 offset:9216
    s_waitcnt lgkmcnt(15)
    v_mfma_f32_16x16x32_bf16 v[240:243], v[144:147], v[72:75], v[240:243]
    ds_read_b64_tr_b16 v[140:141], v57 offset:8192
    v_mfma_f32_16x16x32_bf16 v[244:247], v[144:147], v[76:79], v[244:247]
    ds_read_b64_tr_b16 v[142:143], v57 offset:9216
    v_mfma_f32_16x16x32_bf16 v[248:251], v[148:151], v[72:75], v[248:251]
    ds_read_b64_tr_b16 v[144:145], v58 offset:8192
    v_mfma_f32_16x16x32_bf16 v[252:255], v[148:151], v[76:79], v[252:255]
    ds_read_b64_tr_b16 v[146:147], v58 offset:9216
    s_cmp_eq_u32 s36, 0
    s_waitcnt lgkmcnt(14)
    s_cbranch_scc0 z2_36
    v_mfma_f32_16x16x32_bf16 v[168:171], v[152:155], v[72:75], v[168:171]
    ds_read_b64_tr_b16 v[148:149], v59 offset:8192
    v_mfma_f32_16x16x32_bf16 v[172:175], v[152:155], v[76:79], v[172:175]
    ds_read_b64_tr_b16 v[150:151], v59 offset:9216
    v_mfma_f32_16x16x32_bf16 v[176:179], v[156:159], v[72:75], v[176:179]
    ds_read_b64_tr_b16 v[152:153], v60 offset:4096
    v_mfma_f32_16x16x32_bf16 v[180:183], v[156:159], v[76:79], v[180:183]
    ds_read_b64_tr_b16 v[154:155], v60 offset:4608
    v_mfma_f32_16x16x32_bf16 v[184:187], v[160:163], v[72:75], v[184:187]
    ds_read_b64_tr_b16 v[156:157], v61 offset:4096
    v_mfma_f32_16x16x32_bf16 v[188:191], v[160:163], v[76:79], v[188:191]
    ds_read_b64_tr_b16 v[158:159], v61 offset:4608
    ds_read_b64_tr_b16 v[160:161], v62 offset:4096
    ds_read_b64_tr_b16 v[162:163], v62 offset:4608
    s_branch zd_37
z2_36:
    v_mfma_f32_16x16x32_bf16 v[168:171], v[72:75], v[152:155], v[168:171]
    ds_read_b64_tr_b16 v[148:149], v59 offset:8192
    v_mfma_f32_16x16x32_bf16 v[172:175], v[76:79], v[152:155], v[172:175]
    ds_read_b64_tr_b16 v[150:151], v59 offset:9216
    v_mfma_f32_16x16x32_bf16 v[176:179], v[72:75], v[156:159], v[176:179]
    ds_read_b64_tr_b16 v[152:153], v60 offset:4096
    v_mfma_f32_16x16x32_bf16 v[180:183], v[76:79], v[156:159], v[180:183]
    ds_read_b64_tr_b16 v[154:155], v60 offset:4608
    v_mfma_f32_16x16x32_bf16 v[184:187], v[72:75], v[160:163], v[184:187]
    ds_read_b64_tr_b16 v[156:157], v61 offset:4096
    v_mfma_f32_16x16x32_bf16 v[188:191], v[76:79], v[160:163], v[188:191]
    ds_read_b64_tr_b16 v[158:159], v61 offset:4608
    ds_read_b64_tr_b16 v[160:161], v62 offset:4096
    ds_read_b64_tr_b16 v[162:163], v62 offset:4608
zd_37:
    s_add_u32 s12, s50, 12288
    buffer_load_dwordx4 v[72:75], v2, s[4:7], s12 offen offset:1024 sc1
    s_add_u32 s12, s50, 28672
    buffer_load_dwordx4 v[76:79], v2, s[4:7], s12 offen offset:1024 sc1
    s_waitcnt vmcnt(7)
    s_barrier
    v_add_u32 v52, 24576, v52
    v_add_u32 v53, 24576, v53
    v_add_u32 v54, 24576, v54
    v_add_u32 v55, 24576, v55
    v_add_u32 v56, 24576, v56
    v_add_u32 v57, 24576, v57
    v_add_u32 v58, 24576, v58
    v_add_u32 v59, 24576, v59
    v_add_u32 v60, 24576, v60
    v_add_u32 v61, 24576, v61
    v_add_u32 v62, 24576, v62
    s_waitcnt lgkmcnt(15)
    v_mfma_f32_16x16x32_bf16 v[192:195], v[120:123], v[80:83], v[192:195]
    v_mfma_f32_16x16x32_bf16 v[196:199], v[120:123], v[84:87], v[196:199]
    v_mfma_f32_16x16x32_bf16 v[200:203], v[124:127], v[80:83], v[200:203]
    ds_read_b64_tr_b16 v[120:121], v52 offset:0
    v_mfma_f32_16x16x32_bf16 v[204:207], v[124:127], v[84:87], v[204:207]
    ds_read_b64_tr_b16 v[122:123], v52 offset:1024
    s_waitcnt lgkmcnt(15)
    v_mfma_f32_16x16x32_bf16 v[208:211], v[128:131], v[80:83], v[208:211]
    ds_read_b64_tr_b16 v[124:125], v53 offset:0
    v_mfma_f32_16x16x32_bf16 v[212:215], v[128:131], v[84:87], v[212:215]
    ds_read_b64_tr_b16 v[126:127], v53 offset:1024
    v_mfma_f32_16x16x32_bf16 v[216:219], v[132:135], v[80:83], v[216:219]
    ds_read_b64_tr_b16 v[128:129], v54 offset:0
    v_mfma_f32_16x16x32_bf16 v[220:223], v[132:135], v[84:87], v[220:223]
    ds_read_b64_tr_b16 v[130:131], v54 offset:1024
    s_waitcnt lgkmcnt(15)
    v_mfma_f32_16x16x32_bf16 v[224:227], v[136:139], v[80:83], v[224:227]
    ds_read_b64_tr_b16 v[132:133], v55 offset:0
    v_mfma_f32_16x16x32_bf16 v[228:231], v[136:139], v[84:87], v[228:231]
    ds_read_b64_tr_b16 v[134:135], v55 offset:1024
    v_mfma_f32_16x16x32_bf16 v[232:235], v[140:143], v[80:83], v[232:235]
    ds_read_b64_tr_b16 v[136:137], v56 offset:0
    v_mfma_f32_16x16x32_bf16 v[236:239], v[140:143], v[84:87], v[236:239]
    ds_read_b64_tr_b16 v[138:139], v56 offset:1024
    s_waitcnt lgkmcnt(15)
    v_mfma_f32_16x16x32_bf16 v[240:243], v[144:147], v[80:83], v[240:243]
    ds_read_b64_tr_b16 v[140:141], v57 offset:0
    v_mfma_f32_16x16x32_bf16 v[244:247], v[144:147], v[84:87], v[244:247]
    ds_read_b64_tr_b16 v[142:143], v57 offset:1024
    v_mfma_f32_16x16x32_bf16 v[248:251], v[148:151], v[80:83], v[248:251]
    ds_read_b64_tr_b16 v[144:145], v58 offset:0
    v_mfma_f32_16x16x32_bf16 v[252:255], v[148:151], v[84:87], v[252:255]
    ds_read_b64_tr_b16 v[146:147], v58 offset:1024
    s_cmp_eq_u32 s36, 0
    s_waitcnt lgkmcnt(14)
    s_cbranch_scc0 z2_38
    v_mfma_f32_16x16x32_bf16 v[168:171], v[152:155], v[80:83], v[168:171]
    ds_read_b64_tr_b16 v[148:149], v59 offset:0
    v_mfma_f32_16x16x32_bf16 v[172:175], v[152:155], v[84:87], v[172:175]
    ds_read_b64_tr_b16 v[150:151], v59 offset:1024
    v_mfma_f32_16x16x32_bf16 v[176:179], v[156:159], v[80:83], v[176:179]
    ds_read_b64_tr_b16 v[152:153], v60 offset:0
    v_mfma_f32_16x16x32_bf16 v[180:183], v[156:159], v[84:87], v[180:183]
    ds_read_b64_tr_b16 v[154:155], v60 offset:512
    v_mfma_f32_16x16x32_bf16 v[184:187], v[160:163], v[80:83], v[184:187]
    ds_read_b64_tr_b16 v[156:157], v61 offset:0
    v_mfma_f32_16x16x32_bf16 v[188:191], v[160:163], v[84:87], v[188:191]
    ds_read_b64_tr_b16 v[158:159], v61 offset:512
    ds_read_b64_tr_b16 v[160:161], v62 offset:0
    ds_read_b64_tr_b16 v[162:163], v62 offset:512
    s_branch zd_39
z2_38:
    v_mfma_f32_16x16x32_bf16 v[168:171], v[80:83], v[152:155], v[168:171]
    ds_read_b64_tr_b16 v[148:149], v59 offset:0
    v_mfma_f32_16x16x32_bf16 v[172:175], v[84:87], v[152:155], v[172:175]
    ds_read_b64_tr_b16 v[150:151], v59 offset:1024
    v_mfma_f32_16x16x32_bf16 v[176:179], v[80:83], v[156:159], v[176:179]
    ds_read_b64_tr_b16 v[152:153], v60 offset:0
    v_mfma_f32_16x16x32_bf16 v[180:183], v[84:87], v[156:159], v[180:183]
    ds_read_b64_tr_b16 v[154:155], v60 offset:512
    v_mfma_f32_16x16x32_bf16 v[184:187], v[80:83], v[160:163], v[184:187]
    ds_read_b64_tr_b16 v[156:157], v61 offset:0
    v_mfma_f32_16x16x32_bf16 v[188:191], v[84:87], v[160:163], v[188:191]
    ds_read_b64_tr_b16 v[158:159], v61 offset:512
    ds_read_b64_tr_b16 v[160:161], v62 offset:0
    ds_read_b64_tr_b16 v[162:163], v62 offset:512
zd_39:
    s_add_u32 s12, s50, 12288
    buffer_load_dwordx4 v[80:83], v2, s[4:7], s12 offen offset:2048 sc1
    s_add_u32 s12, s50, 28672
    buffer_load_dwordx4 v[84:87], v2, s[4:7], s12 offen offset:2048 sc1
    s_lshr_b32 s13, s32, 1
    s_add_u32 s13, s13, 16
    s_lshl_b32 s14, s13, 8
    s_add_u32 s14, s14, 117440512
    v_and_b32 v8, 0, v1
    v_lshlrev_b32 v8, 8, v8
    buffer_load_dword v11, v8, s[4:7], s14 offen sc1
    s_waitcnt vmcnt(5)
    s_waitcnt lgkmcnt(15)
    v_mfma_f32_16x16x32_bf16 v[192:195], v[120:123], v[64:67], v[192:195]
    v_mfma_f32_16x16x32_bf16 v[196:199], v[120:123], v[68:71], v[196:199]
    v_mfma_f32_16x16x32_bf16 v[200:203], v[124:127], v[64:67], v[200:203]
    ds_read_b64_tr_b16 v[120:121], v52 offset:8192
    v_mfma_f32_16x16x32_bf16 v[204:207], v[124:127], v[68:71], v[204:207]
    ds_read_b64_tr_b16 v[122:123], v52 offset:9216
    s_waitcnt lgkmcnt(15)
    v_mfma_f32_16x16x32_bf16 v[208:211], v[128:131], v[64:67], v[208:211]
    ds_read_b64_tr_b16 v[124:125], v53 offset:8192
    v_mfma_f32_16x16x32_bf16 v[212:215], v[128:131], v[68:71], v[212:215]
    ds_read_b64_tr_b16 v[126:127], v53 offset:9216
    v_mfma_f32_16x16x32_bf16 v[216:219], v[132:135], v[64:67], v[216:219]
    ds_read_b64_tr_b16 v[128:129], v54 offset:8192
    v_mfma_f32_16x16x32_bf16 v[220:223], v[132:135], v[68:71], v[220:223]
    ds_read_b64_tr_b16 v[130:131], v54 offset:9216
    s_waitcnt lgkmcnt(15)
    v_mfma_f32_16x16x32_bf16 v[224:227], v[136:139], v[64:67], v[224:227]
    ds_read_b64_tr_b16 v[132:133], v55 offset:8192
    v_mfma_f32_16x16x32_bf16 v[228:231], v[136:139], v[68:71], v[228:231]
    ds_read_b64_tr_b16 v[134:135], v55 offset:9216
    v_mfma_f32_16x16x32_bf16 v[232:235], v[140:143], v[64:67], v[232:235]
    ds_read_b64_tr_b16 v[136:137], v56 offset:8192
    v_mfma_f32_16x16x32_bf16 v[236:239], v[140:143], v[68:71], v[236:239]
    ds_read_b64_tr_b16 v[138:139], v56 offset:9216
    s_waitcnt lgkmcnt(15)
    v_mfma_f32_16x16x32_bf16 v[240:243], v[144:147], v[64:67], v[240:243]
    ds_read_b64_tr_b16 v[140:141], v57 offset:8192
    v_mfma_f32_16x16x32_bf16 v[244:247], v[144:147], v[68:71], v[244:247]
    ds_read_b64_tr_b16 v[142:143], v57 offset:9216
    v_mfma_f32_16x16x32_bf16 v[248:251], v[148:151], v[64:67], v[248:251]
    ds_read_b64_tr_b16 v[144:145], v58 offset:8192
    v_mfma_f32_16x16x32_bf16 v[252:255], v[148:151], v[68:71], v[252:255]
    ds_read_b64_tr_b16 v[146:147], v58 offset:9216
    s_cmp_eq_u32 s36, 0
    s_waitcnt lgkmcnt(14)
    s_cbranch_scc0 z2_40
    v_mfma_f32_16x16x32_bf16 v[168:171], v[152:155], v[64:67], v[168:171]
    ds_read_b64_tr_b16 v[148:149], v59 offset:8192
    v_mfma_f32_16x16x32_bf16 v[172:175], v[152:155], v[68:71], v[172:175]
    ds_read_b64_tr_b16 v[150:151], v59 offset:9216
    v_mfma_f32_16x16x32_bf16 v[176:179], v[156:159], v[64:67], v[176:179]
    ds_read_b64_tr_b16 v[152:153], v60 offset:4096
    v_mfma_f32_16x16x32_bf16 v[180:183], v[156:159], v[68:71], v[180:183]
    ds_read_b64_tr_b16 v[154:155], v60 offset:4608
    v_mfma_f32_16x16x32_bf16 v[184:187], v[160:163], v[64:67], v[184:187]
    ds_read_b64_tr_b16 v[156:157], v61 offset:4096
    v_mfma_f32_16x16x32_bf16 v[188:191], v[160:163], v[68:71], v[188:191]
    ds_read_b64_tr_b16 v[158:159], v61 offset:4608
    ds_read_b64_tr_b16 v[160:161], v62 offset:4096
    ds_read_b64_tr_b16 v[162:163], v62 offset:4608
    s_branch zd_41
z2_40:
    v_mfma_f32_16x16x32_bf16 v[168:171], v[64:67], v[152:155], v[168:171]
    ds_read_b64_tr_b16 v[148:149], v59 offset:8192
    v_mfma_f32_16x16x32_bf16 v[172:175], v[68:71], v[152:155], v[172:175]
    ds_read_b64_tr_b16 v[150:151], v59 offset:9216
    v_mfma_f32_16x16x32_bf16 v[176:179], v[64:67], v[156:159], v[176:179]
    ds_read_b64_tr_b16 v[152:153], v60 offset:4096
    v_mfma_f32_16x16x32_bf16 v[180:183], v[68:71], v[156:159], v[180:183]
    ds_read_b64_tr_b16 v[154:155], v60 offset:4608
    v_mfma_f32_16x16x32_bf16 v[184:187], v[64:67], v[160:163], v[184:187]
    ds_read_b64_tr_b16 v[156:157], v61 offset:4096
    v_mfma_f32_16x16x32_bf16 v[188:191], v[68:71], v[160:163], v[188:191]
    ds_read_b64_tr_b16 v[158:159], v61 offset:4608
    ds_read_b64_tr_b16 v[160:161], v62 offset:4096
    ds_read_b64_tr_b16 v[162:163], v62 offset:4608
zd_41:
    s_add_u32 s12, s50, 12288
    buffer_load_dwordx4 v[64:67], v2, s[4:7], s12 offen offset:3072 sc1
    s_add_u32 s12, s50, 28672
    buffer_load_dwordx4 v[68:71], v2, s[4:7], s12 offen offset:3072 sc1
    s_waitcnt vmcnt(2)
    s_barrier
    v_add_u32 v52, 24576, v52
    v_add_u32 v53, 24576, v53
    v_add_u32 v54, 24576, v54
    v_add_u32 v55, 24576, v55
    v_add_u32 v56, 24576, v56
    v_add_u32 v57, 24576, v57
    v_add_u32 v58, 24576, v58
    v_add_u32 v59, 24576, v59
    v_add_u32 v60, 24576, v60
    v_add_u32 v61, 24576, v61
    v_add_u32 v62, 24576, v62
    s_lshr_b32 s13, s32, 1
    s_add_u32 s13, s13, 16
    s_mov_b32 s15, 0x20000
poll_42:
    v_cmp_gt_u32 vcc, 16, v11
    s_cbranch_vccz polld_43
    s_sleep 2
    s_lshl_b32 s14, s13, 8
    s_add_u32 s14, s14, 117440512
    v_and_b32 v8, 0, v1
    v_lshlrev_b32_e64 v8, 8, v8
    buffer_load_dword v11, v8, s[4:7], s14 offen sc1
    s_waitcnt vmcnt(0)
    s_sub_u32 s15, s15, 1
    s_cmp_lg_u32 s15, 0
    s_cbranch_scc1 poll_42
polld_43:
    s_waitcnt lgkmcnt(15)
    v_mfma_f32_16x16x32_bf16 v[192:195], v[120:123], v[72:75], v[192:195]
    v_mfma_f32_16x16x32_bf16 v[196:199], v[120:123], v[76:79], v[196:199]
    v_mfma_f32_16x16x32_bf16 v[200:203], v[124:127], v[72:75], v[200:203]
    ds_read_b64_tr_b16 v[120:121], v52 offset:0
    v_mfma_f32_16x16x32_bf16 v[204:207], v[124:127], v[76:79], v[204:207]
    ds_read_b64_tr_b16 v[122:123], v52 offset:1024
    s_add_u32 m0, s48, 0
    s_add_u32 s12, s42, s48
    s_add_u32 s12, s12, 0
    buffer_load_dwordx4 v2, s[4:7], s12 offen sc1 lds
    buffer_load_dwordx4 v2, s[4:7], s12 offen offset:1024 sc1 lds
    s_waitcnt lgkmcnt(15)
    v_mfma_f32_16x16x32_bf16 v[208:211], v[128:131], v[72:75], v[208:211]
    ds_read_b64_tr_b16 v[124:125], v53 offset:0
    v_mfma_f32_16x16x32_bf16 v[212:215], v[128:131], v[76:79], v[212:215]
    ds_read_b64_tr_b16 v[126:127], v53 offset:1024
    s_add_u32 m0, s48, 16384
    s_add_u32 s12, s42, s48
    s_add_u32 s12, s12, 16384
    buffer_load_dwordx4 v2, s[4:7], s12 offen sc1 lds
    buffer_load_dwordx4 v2, s[4:7], s12 offen offset:1024 sc1 lds
    v_mfma_f32_16x16x32_bf16 v[216:219], v[132:135], v[72:75], v[216:219]
    ds_read_b64_tr_b16 v[128:129], v54 offset:0
    v_mfma_f32_16x16x32_bf16 v[220:223], v[132:135], v[76:79], v[220:223]
    ds_read_b64_tr_b16 v[130:131], v54 offset:1024
    s_add_u32 m0, s48, 65536
    s_add_u32 s12, s43, s48
    s_add_u32 s12, s12, 0
    s_cmp_lt_u32 s3, 4
    s_cselect_b32 s12, 536870912, s12
    buffer_load_dwordx4 v2, s[4:7], s12 offen sc1 lds
    buffer_load_dwordx4 v2, s[4:7], s12 offen offset:1024 sc1 lds
    s_waitcnt lgkmcnt(15)
    v_mfma_f32_16x16x32_bf16 v[224:227], v[136:139], v[72:75], v[224:227]
    ds_read_b64_tr_b16 v[132:133], v55 offset:0
    v_mfma_f32_16x16x32_bf16 v[228:231], v[136:139], v[76:79], v[228:231]
    ds_read_b64_tr_b16 v[134:135], v55 offset:1024
    s_add_u32 m0, s48, 32768
    s_add_u32 s12, s42, s48
    s_add_u32 s12, s12, 32768
    buffer_load_dwordx4 v2, s[4:7], s12 offen sc1 lds
    buffer_load_dwordx4 v2, s[4:7], s12 offen offset:1024 sc1 lds
    v_mfma_f32_16x16x32_bf16 v[232:235], v[140:143], v[72:75], v[232:235]
    ds_read_b64_tr_b16 v[136:137], v56 offset:0
    v_mfma_f32_16x16x32_bf16 v[236:239], v[140:143], v[76:79], v[236:239]
    ds_read_b64_tr_b16 v[138:139], v56 offset:1024
    s_add_u32 m0, s48, 81920
    s_add_u32 s12, s43, s48
    s_add_u32 s12, s12, 16384
    buffer_load_dwordx4 v2, s[4:7], s12 offen sc1 lds
    buffer_load_dwordx4 v2, s[4:7], s12 offen offset:1024 sc1 lds
    s_waitcnt lgkmcnt(15)
    v_mfma_f32_16x16x32_bf16 v[240:243], v[144:147], v[72:75], v[240:243]
    ds_read_b64_tr_b16 v[140:141], v57 offset:0
    v_mfma_f32_16x16x32_bf16 v[244:247], v[144:147], v[76:79], v[244:247]
    ds_read_b64_tr_b16 v[142:143], v57 offset:1024
    v_mfma_f32_16x16x32_bf16 v[248:251], v[148:151], v[72:75], v[248:251]
    ds_read_b64_tr_b16 v[144:145], v58 offset:0
    v_mfma_f32_16x16x32_bf16 v[252:255], v[148:151], v[76:79], v[252:255]
    ds_read_b64_tr_b16 v[146:147], v58 offset:1024
    s_cmp_eq_u32 s36, 0
    s_waitcnt lgkmcnt(14)
    s_cbranch_scc0 z2_44
    v_mfma_f32_16x16x32_bf16 v[168:171], v[152:155], v[72:75], v[168:171]
    ds_read_b64_tr_b16 v[148:149], v59 offset:0
    v_mfma_f32_16x16x32_bf16 v[172:175], v[152:155], v[76:79], v[172:175]
    ds_read_b64_tr_b16 v[150:151], v59 offset:1024
    v_mfma_f32_16x16x32_bf16 v[176:179], v[156:159], v[72:75], v[176:179]
    ds_read_b64_tr_b16 v[152:153], v60 offset:0
    v_mfma_f32_16x16x32_bf16 v[180:183], v[156:159], v[76:79], v[180:183]
    ds_read_b64_tr_b16 v[154:155], v60 offset:512
    v_mfma_f32_16x16x32_bf16 v[184:187], v[160:163], v[72:75], v[184:187]
    ds_read_b64_tr_b16 v[156:157], v61 offset:0
    v_mfma_f32_16x16x32_bf16 v[188:191], v[160:163], v[76:79], v[188:191]
    ds_read_b64_tr_b16 v[158:159], v61 offset:512
    ds_read_b64_tr_b16 v[160:161], v62 offset:0
    ds_read_b64_tr_b16 v[162:163], v62 offset:512
    s_branch zd_45
z2_44:
    v_mfma_f32_16x16x32_bf16 v[168:171], v[72:75], v[152:155], v[168:171]
    ds_read_b64_tr_b16 v[148:149], v59 offset:0
    v_mfma_f32_16x16x32_bf16 v[172:175], v[76:79], v[152:155], v[172:175]
    ds_read_b64_tr_b16 v[150:151], v59 offset:1024
    v_mfma_f32_16x16x32_bf16 v[176:179], v[72:75], v[156:159], v[176:179]
    ds_read_b64_tr_b16 v[152:153], v60 offset:0
    v_mfma_f32_16x16x32_bf16 v[180:183], v[76:79], v[156:159], v[180:183]
    ds_read_b64_tr_b16 v[154:155], v60 offset:512
    v_mfma_f32_16x16x32_bf16 v[184:187], v[72:75], v[160:163], v[184:187]
    ds_read_b64_tr_b16 v[156:157], v61 offset:0
    v_mfma_f32_16x16x32_bf16 v[188:191], v[76:79], v[160:163], v[188:191]
    ds_read_b64_tr_b16 v[158:159], v61 offset:512
    ds_read_b64_tr_b16 v[160:161], v62 offset:0
    ds_read_b64_tr_b16 v[162:163], v62 offset:512
zd_45:
    s_waitcnt vmcnt(13)
    s_waitcnt lgkmcnt(15)
    v_mfma_f32_16x16x32_bf16 v[192:195], v[120:123], v[80:83], v[192:195]
    v_mfma_f32_16x16x32_bf16 v[196:199], v[120:123], v[84:87], v[196:199]
    v_mfma_f32_16x16x32_bf16 v[200:203], v[124:127], v[80:83], v[200:203]
    ds_read_b64_tr_b16 v[120:121], v52 offset:8192
    v_mfma_f32_16x16x32_bf16 v[204:207], v[124:127], v[84:87], v[204:207]
    ds_read_b64_tr_b16 v[122:123], v52 offset:9216
    s_waitcnt lgkmcnt(15)
    v_mfma_f32_16x16x32_bf16 v[208:211], v[128:131], v[80:83], v[208:211]
    ds_read_b64_tr_b16 v[124:125], v53 offset:8192
    v_mfma_f32_16x16x32_bf16 v[212:215], v[128:131], v[84:87], v[212:215]
    ds_read_b64_tr_b16 v[126:127], v53 offset:9216
    v_mfma_f32_16x16x32_bf16 v[216:219], v[132:135], v[80:83], v[216:219]
    ds_read_b64_tr_b16 v[128:129], v54 offset:8192
    v_mfma_f32_16x16x32_bf16 v[220:223], v[132:135], v[84:87], v[220:223]
    ds_read_b64_tr_b16 v[130:131], v54 offset:9216
    s_waitcnt lgkmcnt(15)
    v_mfma_f32_16x16x32_bf16 v[224:227], v[136:139], v[80:83], v[224:227]
    ds_read_b64_tr_b16 v[132:133], v55 offset:8192
    v_mfma_f32_16x16x32_bf16 v[228:231], v[136:139], v[84:87], v[228:231]
    ds_read_b64_tr_b16 v[134:135], v55 offset:9216
    v_mfma_f32_16x16x32_bf16 v[232:235], v[140:143], v[80:83], v[232:235]
    ds_read_b64_tr_b16 v[136:137], v56 offset:8192
    v_mfma_f32_16x16x32_bf16 v[236:239], v[140:143], v[84:87], v[236:239]
    ds_read_b64_tr_b16 v[138:139], v56 offset:9216
    s_waitcnt lgkmcnt(15)
    v_mfma_f32_16x16x32_bf16 v[240:243], v[144:147], v[80:83], v[240:243]
    ds_read_b64_tr_b16 v[140:141], v57 offset:8192
    v_mfma_f32_16x16x32_bf16 v[244:247], v[144:147], v[84:87], v[244:247]
    ds_read_b64_tr_b16 v[142:143], v57 offset:9216
    v_mfma_f32_16x16x32_bf16 v[248:251], v[148:151], v[80:83], v[248:251]
    ds_read_b64_tr_b16 v[144:145], v58 offset:8192
    v_mfma_f32_16x16x32_bf16 v[252:255], v[148:151], v[84:87], v[252:255]
    ds_read_b64_tr_b16 v[146:147], v58 offset:9216
    s_cmp_eq_u32 s36, 0
    s_waitcnt lgkmcnt(14)
    s_cbranch_scc0 z2_46
    v_mfma_f32_16x16x32_bf16 v[168:171], v[152:155], v[80:83], v[168:171]
    ds_read_b64_tr_b16 v[148:149], v59 offset:8192
    v_mfma_f32_16x16x32_bf16 v[172:175], v[152:155], v[84:87], v[172:175]
    ds_read_b64_tr_b16 v[150:151], v59 offset:9216
    v_mfma_f32_16x16x32_bf16 v[176:179], v[156:159], v[80:83], v[176:179]
    ds_read_b64_tr_b16 v[152:153], v60 offset:4096
    v_mfma_f32_16x16x32_bf16 v[180:183], v[156:159], v[84:87], v[180:183]
    ds_read_b64_tr_b16 v[154:155], v60 offset:4608
    v_mfma_f32_16x16x32_bf16 v[184:187], v[160:163], v[80:83], v[184:187]
    ds_read_b64_tr_b16 v[156:157], v61 offset:4096
    v_mfma_f32_16x16x32_bf16 v[188:191], v[160:163], v[84:87], v[188:191]
    ds_read_b64_tr_b16 v[158:159], v61 offset:4608
    ds_read_b64_tr_b16 v[160:161], v62 offset:4096
    ds_read_b64_tr_b16 v[162:163], v62 offset:4608
    s_branch zd_47
z2_46:
    v_mfma_f32_16x16x32_bf16 v[168:171], v[80:83], v[152:155], v[168:171]
    ds_read_b64_tr_b16 v[148:149], v59 offset:8192
    v_mfma_f32_16x16x32_bf16 v[172:175], v[84:87], v[152:155], v[172:175]
    ds_read_b64_tr_b16 v[150:151], v59 offset:9216
    v_mfma_f32_16x16x32_bf16 v[176:179], v[80:83], v[156:159], v[176:179]
    ds_read_b64_tr_b16 v[152:153], v60 offset:4096
    v_mfma_f32_16x16x32_bf16 v[180:183], v[84:87], v[156:159], v[180:183]
    ds_read_b64_tr_b16 v[154:155], v60 offset:4608
    v_mfma_f32_16x16x32_bf16 v[184:187], v[80:83], v[160:163], v[184:187]
    ds_read_b64_tr_b16 v[156:157], v61 offset:4096
    v_mfma_f32_16x16x32_bf16 v[188:191], v[84:87], v[160:163], v[188:191]
    ds_read_b64_tr_b16 v[158:159], v61 offset:4608
    ds_read_b64_tr_b16 v[160:161], v62 offset:4096
    ds_read_b64_tr_b16 v[162:163], v62 offset:4608
zd_47:
    s_waitcnt vmcnt(0)
    s_barrier
    s_waitcnt lgkmcnt(15)
    v_mfma_f32_16x16x32_bf16 v[192:195], v[120:123], v[64:67], v[192:195]
    v_mfma_f32_16x16x32_bf16 v[196:199], v[120:123], v[68:71], v[196:199]
    v_mfma_f32_16x16x32_bf16 v[200:203], v[124:127], v[64:67], v[200:203]
    v_mfma_f32_16x16x32_bf16 v[204:207], v[124:127], v[68:71], v[204:207]
    s_waitcnt lgkmcnt(14)
    v_mfma_f32_16x16x32_bf16 v[208:211], v[128:131], v[64:67], v[208:211]
    v_mfma_f32_16x16x32_bf16 v[212:215], v[128:131], v[68:71], v[212:215]
    v_mfma_f32_16x16x32_bf16 v[216:219], v[132:135], v[64:67], v[216:219]
    v_mfma_f32_16x16x32_bf16 v[220:223], v[132:135], v[68:71], v[220:223]
    s_waitcnt lgkmcnt(10)
    v_mfma_f32_16x16x32_bf16 v[224:227], v[136:139], v[64:67], v[224:227]
    v_mfma_f32_16x16x32_bf16 v[228:231], v[136:139], v[68:71], v[228:231]
    v_mfma_f32_16x16x32_bf16 v[232:235], v[140:143], v[64:67], v[232:235]
    v_mfma_f32_16x16x32_bf16 v[236:239], v[140:143], v[68:71], v[236:239]
    s_waitcnt lgkmcnt(6)
    v_mfma_f32_16x16x32_bf16 v[240:243], v[144:147], v[64:67], v[240:243]
    v_mfma_f32_16x16x32_bf16 v[244:247], v[144:147], v[68:71], v[244:247]
    v_mfma_f32_16x16x32_bf16 v[248:251], v[148:151], v[64:67], v[248:251]
    v_mfma_f32_16x16x32_bf16 v[252:255], v[148:151], v[68:71], v[252:255]
    s_cmp_eq_u32 s36, 0
    s_waitcnt lgkmcnt(0)
    s_cbranch_scc0 z2_48
    v_mfma_f32_16x16x32_bf16 v[168:171], v[152:155], v[64:67], v[168:171]
    v_mfma_f32_16x16x32_bf16 v[172:175], v[152:155], v[68:71], v[172:175]
    v_mfma_f32_16x16x32_bf16 v[176:179], v[156:159], v[64:67], v[176:179]
    v_mfma_f32_16x16x32_bf16 v[180:183], v[156:159], v[68:71], v[180:183]
    v_mfma_f32_16x16x32_bf16 v[184:187], v[160:163], v[64:67], v[184:187]
    v_mfma_f32_16x16x32_bf16 v[188:191], v[160:163], v[68:71], v[188:191]
    s_branch zd_49
z2_48:
    v_mfma_f32_16x16x32_bf16 v[168:171], v[64:67], v[152:155], v[168:171]
    v_mfma_f32_16x16x32_bf16 v[172:175], v[68:71], v[152:155], v[172:175]
    v_mfma_f32_16x16x32_bf16 v[176:179], v[64:67], v[156:159], v[176:179]
    v_mfma_f32_16x16x32_bf16 v[180:183], v[68:71], v[156:159], v[180:183]
    v_mfma_f32_16x16x32_bf16 v[184:187], v[64:67], v[160:163], v[184:187]
    v_mfma_f32_16x16x32_bf16 v[188:191], v[68:71], v[160:163], v[188:191]
zd_49:
    s_nop 7
    v_mov_b32 v4, 0xc0135761
    v_mov_b32 v5, 0xc0135761
    v_mov_b32 v6, 0xbdd2d3e8
    v_mov_b32 v7, 0xbdd2d3e8
    v_mov_b32 v8, 0x3f800000
    v_mov_b32_e64 v9, 0x3f800000
    v_pk_mul_f32 v[64:65], v[168:169], v[168:169]
    v_pk_mul_f32 v[66:67], v[170:171], v[170:171]
    v_pk_mul_f32 v[68:69], v[172:173], v[172:173]
    v_pk_mul_f32 v[70:71], v[174:175], v[174:175]
    v_pk_fma_f32 v[64:65], v[64:65], v[6:7], v[4:5]
    v_pk_fma_f32 v[66:67], v[66:67], v[6:7], v[4:5]
    v_pk_fma_f32 v[68:69], v[68:69], v[6:7], v[4:5]
    v_pk_fma_f32 v[70:71], v[70:71], v[6:7], v[4:5]
    v_pk_mul_f32 v[64:65], v[64:65], v[168:169]
    v_pk_mul_f32 v[66:67], v[66:67], v[170:171]
    v_pk_mul_f32 v[68:69], v[68:69], v[172:173]
    v_pk_mul_f32 v[70:71], v[70:71], v[174:175]
    v_exp_f32 v64, v64
    v_exp_f32 v65, v65
    v_exp_f32 v66, v66
    v_exp_f32 v67, v67
    v_exp_f32 v68, v68
    v_exp_f32 v69, v69
    v_exp_f32 v70, v70
    v_exp_f32 v71, v71
    v_pk_add_f32 v[64:65], v[64:65], v[8:9]
    v_pk_add_f32 v[66:67], v[66:67], v[8:9]
    v_pk_add_f32 v[68:69], v[68:69], v[8:9]
    v_pk_add_f32 v[70:71], v[70:71], v[8:9]
    v_rcp_f32 v64, v64
    v_rcp_f32 v65, v65
    v_rcp_f32 v66, v66
    v_rcp_f32 v67, v67
    v_rcp_f32 v68, v68
    v_rcp_f32 v69, v69
    v_rcp_f32 v70, v70
    v_rcp_f32 v71, v71
    v_pk_mul_f32 v[168:169], v[64:65], v[168:169]
    v_pk_mul_f32 v[170:171], v[66:67], v[170:171]
    v_pk_mul_f32 v[172:173], v[68:69], v[172:173]
    v_pk_mul_f32 v[174:175], v[70:71], v[174:175]
    v_cvt_pk_bf16_f32 v72, v168, v169
    v_cvt_pk_bf16_f32 v73, v170, v171
    v_cvt_pk_bf16_f32 v74, v172, v173
    v_cvt_pk_bf16_f32 v75, v174, v175
    v_pk_mul_f32 v[64:65], v[176:177], v[176:177]
    v_pk_mul_f32 v[66:67], v[178:179], v[178:179]
    v_pk_mul_f32 v[68:69], v[180:181], v[180:181]
    v_pk_mul_f32 v[70:71], v[182:183], v[182:183]
    v_pk_fma_f32 v[64:65], v[64:65], v[6:7], v[4:5]
    v_pk_fma_f32 v[66:67], v[66:67], v[6:7], v[4:5]
    v_pk_fma_f32 v[68:69], v[68:69], v[6:7], v[4:5]
    v_pk_fma_f32 v[70:71], v[70:71], v[6:7], v[4:5]
    v_pk_mul_f32 v[64:65], v[64:65], v[176:177]
    v_pk_mul_f32 v[66:67], v[66:67], v[178:179]
    v_pk_mul_f32 v[68:69], v[68:69], v[180:181]
    v_pk_mul_f32 v[70:71], v[70:71], v[182:183]
    v_exp_f32 v64, v64
    v_exp_f32 v65, v65
    v_exp_f32 v66, v66
    v_exp_f32 v67, v67
    v_exp_f32 v68, v68
    v_exp_f32 v69, v69
    v_exp_f32 v70, v70
    v_exp_f32 v71, v71
    v_pk_add_f32 v[64:65], v[64:65], v[8:9]
    v_pk_add_f32 v[66:67], v[66:67], v[8:9]
    v_pk_add_f32 v[68:69], v[68:69], v[8:9]
    v_pk_add_f32 v[70:71], v[70:71], v[8:9]
    v_rcp_f32 v64, v64
    v_rcp_f32 v65, v65
    v_rcp_f32 v66, v66
    v_rcp_f32 v67, v67
    v_rcp_f32 v68, v68
    v_rcp_f32 v69, v69
    v_rcp_f32 v70, v70
    v_rcp_f32 v71, v71
    v_pk_mul_f32 v[176:177], v[64:65], v[176:177]
    v_pk_mul_f32 v[178:179], v[66:67], v[178:179]
    v_pk_mul_f32 v[180:181], v[68:69], v[180:181]
    v_pk_mul_f32 v[182:183], v[70:71], v[182:183]
    v_cvt_pk_bf16_f32 v76, v176, v177
    v_cvt_pk_bf16_f32 v77, v178, v179
    v_cvt_pk_bf16_f32 v78, v180, v181
    v_cvt_pk_bf16_f32 v79, v182, v183
    v_pk_mul_f32 v[64:65], v[184:185], v[184:185]
    v_pk_mul_f32 v[66:67], v[186:187], v[186:187]
    v_pk_mul_f32 v[68:69], v[188:189], v[188:189]
    v_pk_mul_f32 v[70:71], v[190:191], v[190:191]
    v_pk_fma_f32 v[64:65], v[64:65], v[6:7], v[4:5]
    v_pk_fma_f32 v[66:67], v[66:67], v[6:7], v[4:5]
    v_pk_fma_f32 v[68:69], v[68:69], v[6:7], v[4:5]
    v_pk_fma_f32 v[70:71], v[70:71], v[6:7], v[4:5]
    v_pk_mul_f32 v[64:65], v[64:65], v[184:185]
    v_pk_mul_f32 v[66:67], v[66:67], v[186:187]
    v_pk_mul_f32 v[68:69], v[68:69], v[188:189]
    v_pk_mul_f32 v[70:71], v[70:71], v[190:191]
    v_exp_f32 v64, v64
    v_exp_f32 v65, v65
    v_exp_f32 v66, v66
    v_exp_f32 v67, v67
    v_exp_f32 v68, v68
    v_exp_f32 v69, v69
    v_exp_f32 v70, v70
    v_exp_f32 v71, v71
    v_pk_add_f32 v[64:65], v[64:65], v[8:9]
    v_pk_add_f32 v[66:67], v[66:67], v[8:9]
    v_pk_add_f32 v[68:69], v[68:69], v[8:9]
    v_pk_add_f32 v[70:71], v[70:71], v[8:9]
    v_rcp_f32 v64, v64
    v_rcp_f32 v65, v65
    v_rcp_f32 v66, v66
    v_rcp_f32 v67, v67
    v_rcp_f32 v68, v68
    v_rcp_f32 v69, v69
    v_rcp_f32 v70, v70
    v_rcp_f32 v71, v71
    v_pk_mul_f32 v[184:185], v[64:65], v[184:185]
    v_pk_mul_f32 v[186:187], v[66:67], v[186:187]
    v_pk_mul_f32 v[188:189], v[68:69], v[188:189]
    v_pk_mul_f32 v[190:191], v[70:71], v[190:191]
    v_cvt_pk_bf16_f32 v80, v184, v185
    v_cvt_pk_bf16_f32 v81, v186, v187
    v_cvt_pk_bf16_f32 v82, v188, v189
    v_cvt_pk_bf16_f32 v83, v190, v191
    v_and_b32 v4, 15, v1
    v_lshrrev_b32 v5, 5, v1
    v_lshl_add_u32 v4, v5, 4, v4
    v_lshlrev_b32_e64 v4, 4, v4
    v_bfe_u32 v5, v1, 4, 1
    v_lshl_add_u32 v4, v5, 3, v4
    s_movk_i32 s11, 512
    s_cmp_eq_u32 s36, 0
    s_cselect_b64 vcc, -1, 0
    v_lshlrev_b32 v5, 3, v1
    v_cndmask_b32 v4, v4, v5, vcc
    s_cselect_b32 s10, 43, 86
    s_cselect_b32 s11, 22528, s11
    s_add_u32 s12, s37, 0
    s_mul_i32 s13, s35, 44
    s_add_u32 s13, s13, s12
    s_lshl_b32 s13, s13, 9
    s_add_u32 s13, s13, 56623104
    s_sub_u32 s14, s12, 43
    s_lshl_b32 s14, s14, 6
    s_lshr_b32 s15, s35, 1
    s_add_u32 s14, s14, s15
    s_lshl_b32 s14, s14, 10
    s_add_u32 s14, s14, 60817408
    s_cmp_eq_u32 s36, 0
    s_cselect_b32 s13, s13, s14
    s_cmp_lt_u32 s12, s10
    s_cselect_b32 s13, s13, 536870912
    buffer_store_dwordx2 v[72:73], v4, s[4:7], s13 offen sc1
    s_add_u32 s13, s13, s11
    buffer_store_dwordx2 v[74:75], v4, s[4:7], s13 offen sc1
    s_add_u32 s12, s37, 1
    s_mul_i32 s13, s35, 44
    s_add_u32 s13, s13, s12
    s_lshl_b32 s13, s13, 9
    s_add_u32 s13, s13, 56623104
    s_sub_u32 s14, s12, 43
    s_lshl_b32 s14, s14, 6
    s_lshr_b32 s15, s35, 1
    s_add_u32 s14, s14, s15
    s_lshl_b32 s14, s14, 10
    s_add_u32 s14, s14, 60817408
    s_cmp_eq_u32 s36, 0
    s_cselect_b32 s13, s13, s14
    s_cmp_lt_u32 s12, s10
    s_cselect_b32 s13, s13, 536870912
    buffer_store_dwordx2 v[76:77], v4, s[4:7], s13 offen sc1
    s_add_u32 s13, s13, s11
    buffer_store_dwordx2 v[78:79], v4, s[4:7], s13 offen sc1
    s_add_u32 s12, s37, 2
    s_mul_i32 s13, s35, 44
    s_add_u32 s13, s13, s12
    s_lshl_b32 s13, s13, 9
    s_add_u32 s13, s13, 56623104
    s_sub_u32 s14, s12, 43
    s_lshl_b32 s14, s14, 6
    s_lshr_b32 s15, s35, 1
    s_add_u32 s14, s14, s15
    s_lshl_b32 s14, s14, 10
    s_add_u32 s14, s14, 60817408
    s_cmp_eq_u32 s36, 0
    s_cselect_b32 s13, s13, s14
    s_cmp_lt_u32 s12, s10
    s_cselect_b32 s13, s13, 536870912
    buffer_store_dwordx2 v[80:81], v4, s[4:7], s13 offen sc1
    s_add_u32 s13, s13, s11
    buffer_store_dwordx2 v[82:83], v4, s[4:7], s13 offen sc1
    v_mov_b32 v6, 0x3e0293ee
    v_mov_b32_e64 v7, v6
    v_pk_mul_f32 v[192:193], v[192:193], v[6:7]
    v_pk_mul_f32 v[194:195], v[194:195], v[6:7]
    v_cvt_pk_bf16_f32 v112, v192, v193
    v_cvt_pk_bf16_f32 v113, v194, v195
    v_pk_mul_f32 v[196:197], v[196:197], v[6:7]
    v_pk_mul_f32 v[198:199], v[198:199], v[6:7]
    v_cvt_pk_bf16_f32 v116, v196, v197
    v_cvt_pk_bf16_f32 v117, v198, v199
    v_pk_mul_f32 v[200:201], v[200:201], v[6:7]
    v_pk_mul_f32 v[202:203], v[202:203], v[6:7]
    v_cvt_pk_bf16_f32 v114, v200, v201
    v_cvt_pk_bf16_f32 v115, v202, v203
    v_pk_mul_f32 v[204:205], v[204:205], v[6:7]
    v_pk_mul_f32 v[206:207], v[206:207], v[6:7]
    v_cvt_pk_bf16_f32 v118, v204, v205
    v_cvt_pk_bf16_f32 v119, v206, v207
    v_pk_mul_f32 v[208:209], v[208:209], v[6:7]
    v_pk_mul_f32 v[210:211], v[210:211], v[6:7]
    v_cvt_pk_bf16_f32 v120, v208, v209
    v_cvt_pk_bf16_f32 v121, v210, v211
    v_pk_mul_f32 v[212:213], v[212:213], v[6:7]
    v_pk_mul_f32 v[214:215], v[214:215], v[6:7]
    v_cvt_pk_bf16_f32 v124, v212, v213
    v_cvt_pk_bf16_f32 v125, v214, v215
    v_pk_mul_f32 v[216:217], v[216:217], v[6:7]
    v_pk_mul_f32 v[218:219], v[218:219], v[6:7]
    v_cvt_pk_bf16_f32 v122, v216, v217
    v_cvt_pk_bf16_f32 v123, v218, v219
    v_pk_mul_f32 v[220:221], v[220:221], v[6:7]
    v_pk_mul_f32 v[222:223], v[222:223], v[6:7]
    v_cvt_pk_bf16_f32 v126, v220, v221
    v_cvt_pk_bf16_f32 v127, v222, v223
    v_pk_mul_f32 v[224:225], v[224:225], v[6:7]
    v_pk_mul_f32 v[226:227], v[226:227], v[6:7]
    v_cvt_pk_bf16_f32 v128, v224, v225
    v_cvt_pk_bf16_f32 v129, v226, v227
    v_pk_mul_f32 v[228:229], v[228:229], v[6:7]
    v_pk_mul_f32 v[230:231], v[230:231], v[6:7]
    v_cvt_pk_bf16_f32 v132, v228, v229
    v_cvt_pk_bf16_f32 v133, v230, v231
    v_pk_mul_f32 v[232:233], v[232:233], v[6:7]
    v_pk_mul_f32 v[234:235], v[234:235], v[6:7]
    v_cvt_pk_bf16_f32 v130, v232, v233
    v_cvt_pk_bf16_f32 v131, v234, v235
    v_pk_mul_f32 v[236:237], v[236:237], v[6:7]
    v_pk_mul_f32 v[238:239], v[238:239], v[6:7]
    v_cvt_pk_bf16_f32 v134, v236, v237
    v_cvt_pk_bf16_f32 v135, v238, v239
    v_pk_mul_f32 v[240:241], v[240:241], v[6:7]
    v_pk_mul_f32 v[242:243], v[242:243], v[6:7]
    v_cvt_pk_bf16_f32 v136, v240, v241
    v_cvt_pk_bf16_f32 v137, v242, v243
    v_pk_mul_f32 v[244:245], v[244:245], v[6:7]
    v_pk_mul_f32 v[246:247], v[246:247], v[6:7]
    v_cvt_pk_bf16_f32 v140, v244, v245
    v_cvt_pk_bf16_f32 v141, v246, v247
    v_pk_mul_f32 v[248:249], v[248:249], v[6:7]
    v_pk_mul_f32 v[250:251], v[250:251], v[6:7]
    v_cvt_pk_bf16_f32 v138, v248, v249
    v_cvt_pk_bf16_f32 v139, v250, v251
    v_pk_mul_f32 v[252:253], v[252:253], v[6:7]
    v_pk_mul_f32 v[254:255], v[254:255], v[6:7]
    v_cvt_pk_bf16_f32 v142, v252, v253
    v_cvt_pk_bf16_f32 v143, v254, v255
    v_permlane16_swap_b32 v112, v116
    v_permlane16_swap_b32 v113, v117
    v_permlane16_swap_b32 v114, v118
    v_permlane16_swap_b32 v115, v119
    v_permlane16_swap_b32 v120, v124
    v_permlane16_swap_b32 v121, v125
    v_permlane16_swap_b32 v122, v126
    v_permlane16_swap_b32 v123, v127
    v_permlane16_swap_b32 v128, v132
    v_permlane16_swap_b32 v129, v133
    v_permlane16_swap_b32 v130, v134
    v_permlane16_swap_b32 v131, v135
    v_permlane16_swap_b32 v136, v140
    v_permlane16_swap_b32 v137, v141
    v_permlane16_swap_b32 v138, v142
    v_permlane16_swap_b32 v139, v143
    s_load_dwordx2 s[16:17], s[0:1], 64
    s_load_dwordx2 s[20:21], s[0:1], 40
    s_load_dwordx2 s[24:25], s[0:1], 80
    s_mov_b32 s44, 0x4e800000
    s_mov_b32 s54, 5167
    s_cmp_ge_u32 s3, 4
    s_lshl_b32 s8, 0x220, s3
    s_and_b32 s8, s8, 0xfe0
    s_or_b32 s8, s8, 31
    s_cmp_ge_u32 s3, 4
    s_cselect_b32 s54, s54, s8
    s_lshr_b32 s8, s2, 3
    s_lshl_b32 s8, s8, 2
    s_and_b32 s9, s2, 7
    s_lshl_b32 s9, s9, 7
    s_add_u32 s8, s8, s9
    s_add_u32 s8, s8, s3
    s_lshl_b32 s50, s8, 13
    s_and_b32 s8, s3, 1
    s_lshl_b32 s8, s8, 8
    s_add_u32 s8, s8, s2
    s_lshl_b32 s51, s8, 13
    s_mov_b32 s55, 166026
    v_mov_b32 v3, 0xff800000
    v_and_b32 v4, 31, v1
    v_lshrrev_b32 v5, 5, v1
    v_lshlrev_b32 v5, 2, v5
    v_sub_u32 v16, v4, v5
    v_mov_b32 v4, 0
    v_mov_b32_e64 v5, 0
    v_pk_mov_b32 v[192:193], v[4:5], v[4:5]
    v_pk_mov_b32 v[194:195], v[4:5], v[4:5]
    v_pk_mov_b32 v[196:197], v[4:5], v[4:5]
    v_pk_mov_b32 v[198:199], v[4:5], v[4:5]
    v_pk_mov_b32 v[200:201], v[4:5], v[4:5]
    v_pk_mov_b32 v[202:203], v[4:5], v[4:5]
    v_pk_mov_b32 v[204:205], v[4:5], v[4:5]
    v_pk_mov_b32 v[206:207], v[4:5], v[4:5]
    v_pk_mov_b32 v[208:209], v[4:5], v[4:5]
    v_pk_mov_b32 v[210:211], v[4:5], v[4:5]
    v_pk_mov_b32 v[212:213], v[4:5], v[4:5]
    v_pk_mov_b32 v[214:215], v[4:5], v[4:5]
    v_pk_mov_b32 v[216:217], v[4:5], v[4:5]
    v_pk_mov_b32 v[218:219], v[4:5], v[4:5]
    v_pk_mov_b32 v[220:221], v[4:5], v[4:5]
    v_pk_mov_b32 v[222:223], v[4:5], v[4:5]
    v_pk_mov_b32 v[224:225], v[4:5], v[4:5]
    v_pk_mov_b32 v[226:227], v[4:5], v[4:5]
    v_pk_mov_b32 v[228:229], v[4:5], v[4:5]
    v_pk_mov_b32 v[230:231], v[4:5], v[4:5]
    v_pk_mov_b32 v[232:233], v[4:5], v[4:5]
    v_pk_mov_b32 v[234:235], v[4:5], v[4:5]
    v_pk_mov_b32 v[236:237], v[4:5], v[4:5]
    v_pk_mov_b32 v[238:239], v[4:5], v[4:5]
    v_pk_mov_b32 v[240:241], v[4:5], v[4:5]
    v_pk_mov_b32 v[242:243], v[4:5], v[4:5]
    v_pk_mov_b32 v[244:245], v[4:5], v[4:5]
    v_pk_mov_b32 v[246:247], v[4:5], v[4:5]
    v_pk_mov_b32 v[248:249], v[4:5], v[4:5]
    v_pk_mov_b32 v[250:251], v[4:5], v[4:5]
    v_pk_mov_b32 v[252:253], v[4:5], v[4:5]
    v_pk_mov_b32 v[254:255], v[4:5], v[4:5]
    v_mov_b32_e64 v53, 0
    s_and_b32 s46, s3, 3
    s_lshl_b32 s46, s46, 12
    s_add_u32 s47, s46, 0x10000
    s_add_u32 s56, s42, 520192
    s_add_u32 s57, s43, 528384
    v_lshlrev_b32 v19, 7, v1
    s_add_u32 s42, s42, s46
    s_add_u32 s43, s43, s46
    s_mov_b32 s41, -1
    v_mov_b32_e64 v14, v2
    s_waitcnt lgkmcnt(0)
    s_mov_b32 s16, s16
    s_and_b32 s17, s17, 0xffff
    s_mov_b32 s18, 0x800000
    s_mov_b32 s19, 0x00020000
    s_mov_b32 s20, s20
    s_and_b32 s21, s21, 0xffff
    s_mov_b32 s22, 0x400000
    s_mov_b32 s23, 0x00020000
    s_mov_b32 s24, s24
    s_and_b32 s25, s25, 0xffff
    s_mov_b32 s26, 0xac000
    s_mov_b32 s27, 0x00020000
    s_cmp_lt_u32 s3, 2
    s_cselect_b64 s[28:29], s[20:21], s[24:25]
    s_cselect_b32 s30, s22, s26
    s_mov_b32 s31, 0x00020000
    ds_read_b128 v[80:83], v14 offset:0
    ds_read_b128 v[84:87], v14 offset:1024
    ds_read_b128 v[88:91], v14 offset:2048
    ds_read_b128 v[92:95], v14 offset:3072
    ds_read_b128 v[96:99], v14 offset:4096
    ds_read_b128 v[100:103], v14 offset:5120
    ds_read_b128 v[104:107], v14 offset:6144
    ds_read_b128 v[108:111], v14 offset:7168
    s_waitcnt lgkmcnt(7)
    v_mfma_f32_32x32x16_bf16 v[160:175], v[80:83], v[112:115], 0
    ds_read_b128 v[80:83], v14 offset:8192
    s_waitcnt lgkmcnt(7)
    v_mfma_f32_32x32x16_bf16 v[160:175], v[84:87], v[116:119], v[160:175]
    ds_read_b128 v[84:87], v14 offset:9216
    s_waitcnt lgkmcnt(7)
    v_mfma_f32_32x32x16_bf16 v[160:175], v[88:91], v[120:123], v[160:175]
    ds_read_b128 v[88:91], v14 offset:10240
    s_waitcnt lgkmcnt(7)
    v_mfma_f32_32x32x16_bf16 v[160:175], v[92:95], v[124:127], v[160:175]
    ds_read_b128 v[92:95], v14 offset:11264
    s_waitcnt lgkmcnt(7)
    v_mfma_f32_32x32x16_bf16 v[160:175], v[96:99], v[128:131], v[160:175]
    ds_read_b128 v[96:99], v14 offset:12288
    s_waitcnt lgkmcnt(7)
    v_mfma_f32_32x32x16_bf16 v[160:175], v[100:103], v[132:135], v[160:175]
    ds_read_b128 v[100:103], v14 offset:13312
    s_waitcnt lgkmcnt(7)
    v_mfma_f32_32x32x16_bf16 v[160:175], v[104:107], v[136:139], v[160:175]
    ds_read_b128 v[104:107], v14 offset:14336
    s_waitcnt lgkmcnt(7)
    v_mfma_f32_32x32x16_bf16 v[160:175], v[108:111], v[140:143], v[160:175]
    ds_read_b128 v[108:111], v14 offset:15360
    s_cmp_eq_u32 s39, 0
    s_cbranch_scc0 nomask_50
    s_nop 11
    v_cmp_le_i32 s[8:9], 0, v16
    v_cmp_le_i32 s[10:11], 1, v16
    v_cmp_le_i32 s[12:13], 2, v16
    v_cmp_le_i32 s[14:15], 3, v16
    v_cndmask_b32 v160, v3, v160, s[8:9]
    v_cndmask_b32 v161, v3, v161, s[10:11]
    v_cndmask_b32 v162, v3, v162, s[12:13]
    v_cndmask_b32 v163, v3, v163, s[14:15]
    v_cmp_le_i32 s[8:9], 8, v16
    v_cmp_le_i32 s[10:11], 9, v16
    v_cmp_le_i32 s[12:13], 10, v16
    v_cmp_le_i32 s[14:15], 11, v16
    v_cndmask_b32 v164, v3, v164, s[8:9]
    v_cndmask_b32 v165, v3, v165, s[10:11]
    v_cndmask_b32 v166, v3, v166, s[12:13]
    v_cndmask_b32 v167, v3, v167, s[14:15]
    v_cmp_le_i32 s[8:9], 16, v16
    v_cmp_le_i32 s[10:11], 17, v16
    v_cmp_le_i32 s[12:13], 18, v16
    v_cmp_le_i32 s[14:15], 19, v16
    v_cndmask_b32 v168, v3, v168, s[8:9]
    v_cndmask_b32 v169, v3, v169, s[10:11]
    v_cndmask_b32 v170, v3, v170, s[12:13]
    v_cndmask_b32 v171, v3, v171, s[14:15]
    v_cmp_le_i32 s[8:9], 24, v16
    v_cmp_le_i32 s[10:11], 25, v16
    v_cmp_le_i32 s[12:13], 26, v16
    v_cmp_le_i32 s[14:15], 27, v16
    v_cndmask_b32 v172, v3, v172, s[8:9]
    v_cndmask_b32 v173, v3, v173, s[10:11]
    v_cndmask_b32 v174, v3, v174, s[12:13]
    v_cndmask_b32 v175, v3, v175, s[14:15]
nomask_50:
    s_nop 11
    v_max3_f32 v4, v160, v161, v162
    v_max3_f32 v4, v4, v163, v164
    v_max3_f32 v4, v4, v165, v166
    v_max3_f32 v4, v4, v167, v168
    v_max3_f32 v4, v4, v169, v170
    v_max3_f32 v4, v4, v171, v172
    v_max3_f32 v4, v4, v173, v174
    v_max_f32 v4, v4, v175
    v_mov_b32 v5, v4
    s_nop 1
    v_permlane32_swap_b32 v4, v5
    v_max_f32 v4, v4, v5
    v_sub_f32 v144, 0, v4
    v_sub_f32 v145, 0, v4
    v_sub_f32 v146, 0, v4
    v_sub_f32 v147, 0, v4
    v_sub_f32 v148, 0, v4
    v_sub_f32 v149, 0, v4
    v_sub_f32 v150, 0, v4
    v_sub_f32 v151, 0, v4
    v_sub_f32 v152, 0, v4
    v_sub_f32 v153, 0, v4
    v_sub_f32 v154, 0, v4
    v_sub_f32 v155, 0, v4
    v_sub_f32 v156, 0, v4
    v_sub_f32 v157, 0, v4
    v_sub_f32 v158, 0, v4
    v_sub_f32 v159, 0, v4
    v_sub_f32 v160, v160, v4
    v_sub_f32 v161, v161, v4
    v_sub_f32 v162, v162, v4
    v_sub_f32 v163, v163, v4
    v_sub_f32 v164, v164, v4
    v_sub_f32 v165, v165, v4
    v_sub_f32 v166, v166, v4
    v_sub_f32 v167, v167, v4
    v_sub_f32 v168, v168, v4
    v_sub_f32 v169, v169, v4
    v_sub_f32 v170, v170, v4
    v_sub_f32 v171, v171, v4
    v_sub_f32 v172, v172, v4
    v_sub_f32 v173, v173, v4
    v_sub_f32 v174, v174, v4
    v_sub_f32 v175, v175, v4
    v_exp_f32 v56, v160
    v_exp_f32 v57, v161
    s_nop 0
    v_add_f32 v54, v56, v57
    v_exp_f32_e64 v58, v162
    v_cvt_pk_bf16_f32 v64, v56, v57
    v_add_f32 v54, v54, v58
    v_exp_f32 v59, v163
    s_nop 0
    v_add_f32 v54, v54, v59
    v_exp_f32_e64 v56, v168
    v_cvt_pk_bf16_f32 v65, v58, v59
    v_add_f32_e64 v54, v54, v56
    v_exp_f32 v57, v169
    s_cmp_ge_u32 s3, 4
    s_cbranch_scc1 parallel_sum__compressed_kv_cla__mixer_gmlp__prompt_kernel_at_A
    s_add_u32 s53, s41, 1
    s_and_b32 s53, s53, 3
    s_lshl_b32 s53, s53, 14
    s_add_u32 s52, s53, 0x4000
    s_and_b32 s52, s52, 0xc000
    s_add_u32 s53, s53, 0x10000
    s_add_u32 s41, s41, 1
    v_add_u32 v15, s53, v2
    v_add_u32_e64 v14, s52, v2
    s_bitcmp1_b32 s54, s41
    s_cbranch_scc1 hk_51
hb_52:
    s_sub_u32 s40, s39, 2
    s_waitcnt lgkmcnt(6)
    v_mfma_f32_32x32x16_bf16 v[176:191], v[80:83], v[112:115], v[144:159]
    ds_read_b128 v[80:83], v14 offset:0
    v_add_f32 v54, v54, v57
    v_exp_f32 v58, v170
    v_cvt_pk_bf16_f32 v66, v56, v57
    v_mfma_f32_32x32x16_bf16 v[176:191], v[84:87], v[116:119], v[176:191]
    ds_read_b128 v[84:87], v14 offset:1024
    v_add_f32_e64 v54, v54, v58
    v_exp_f32 v59, v171
    s_waitcnt lgkmcnt(6)
    v_mfma_f32_32x32x16_bf16 v[176:191], v[88:91], v[120:123], v[176:191]
    ds_read_b128 v[88:91], v14 offset:2048
    v_add_f32 v54, v54, v59
    v_exp_f32 v56, v164
    v_cvt_pk_bf16_f32 v67, v58, v59
    v_mfma_f32_32x32x16_bf16 v[176:191], v[92:95], v[124:127], v[176:191]
    ds_read_b128 v[92:95], v14 offset:3072
    v_add_f32_e64 v54, v54, v56
    v_exp_f32 v57, v165
    s_waitcnt lgkmcnt(6)
    v_mfma_f32_32x32x16_bf16 v[176:191], v[96:99], v[128:131], v[176:191]
    ds_read_b128 v[96:99], v14 offset:4096
    v_add_f32 v54, v54, v57
    v_exp_f32 v58, v166
    v_cvt_pk_bf16_f32 v68, v56, v57
    v_mfma_f32_32x32x16_bf16 v[176:191], v[100:103], v[132:135], v[176:191]
    ds_read_b128 v[100:103], v14 offset:5120
    v_add_f32_e64 v54, v54, v58
    v_exp_f32 v59, v167
    s_waitcnt lgkmcnt(6)
    v_mfma_f32_32x32x16_bf16 v[176:191], v[104:107], v[136:139], v[176:191]
    ds_read_b128 v[104:107], v14 offset:6144
    v_add_f32 v54, v54, v59
    v_exp_f32 v56, v172
    v_cvt_pk_bf16_f32 v69, v58, v59
    v_mfma_f32_32x32x16_bf16 v[176:191], v[108:111], v[140:143], v[176:191]
    ds_read_b128 v[108:111], v14 offset:7168
    v_add_f32 v54, v54, v56
    v_exp_f32 v57, v173
    s_nop 0
    v_add_f32 v54, v54, v57
    v_exp_f32_e64 v58, v174
    v_cvt_pk_bf16_f32 v70, v56, v57
    v_add_f32 v54, v54, v58
    v_exp_f32 v59, v175
    s_nop 0
    v_add_f32 v54, v54, v59
    v_cvt_pk_bf16_f32 v71, v58, v59
    v_exp_f32 v56, v176
    v_cmp_nge_f32 vcc, s44, v54
    v_exp_f32 v57, v177
    s_nop 0
    v_add_f32 v55, v56, v57
    v_exp_f32 v58, v178
    v_cvt_pk_bf16_f32 v72, v56, v57
    v_add_f32 v55, v55, v58
    v_exp_f32 v59, v179
    s_nop 0
    v_add_f32 v55, v55, v59
    v_exp_f32_e64 v56, v184
    v_cvt_pk_bf16_f32 v73, v58, v59
    s_cbranch_vccnz rs_53
rb_54:
    s_cmp_eq_u32 s40, 0
    v_add_f32_e64 v55, v55, v56
    v_exp_f32 v57, v185
    s_waitcnt lgkmcnt(6)
    v_mfma_f32_32x32x16_bf16 v[160:175], v[80:83], v[112:115], v[144:159]
    s_cbranch_scc1 parallel_sum__compressed_kv_cla__mixer_gmlp__prompt_kernel_at_toddB
parallel_sum__compressed_kv_cla__mixer_gmlp__prompt_kernel_at_loopB1:
    ds_read_b128 v[80:83], v15 offset:8192
    v_add_f32 v55, v55, v57
    v_exp_f32_e64 v58, v186
    v_cvt_pk_bf16_f32 v74, v56, v57
    v_mfma_f32_32x32x16_bf16 v[160:175], v[84:87], v[116:119], v[160:175]
    ds_read_b128 v[84:87], v15 offset:9216
    v_add_f32 v55, v55, v58
    v_exp_f32 v59, v187
    v_add_f32 v53, v53, v54
    s_waitcnt lgkmcnt(6)
    v_mfma_f32_32x32x16_bf16 v[160:175], v[88:91], v[120:123], v[160:175]
    ds_read_b128 v[88:91], v15 offset:10240
    v_add_f32 v55, v55, v59
    v_exp_f32 v56, v180
    v_cvt_pk_bf16_f32 v75, v58, v59
    v_mfma_f32_32x32x16_bf16 v[160:175], v[92:95], v[124:127], v[160:175]
    ds_read_b128 v[92:95], v15 offset:11264
    s_add_u32 s53, s41, 1
    s_and_b32 s53, s53, 3
    v_add_f32_e64 v55, v55, v56
    v_exp_f32 v57, v181
    s_waitcnt lgkmcnt(6)
    v_mfma_f32_32x32x16_bf16 v[160:175], v[96:99], v[128:131], v[160:175]
    ds_read_b128 v[96:99], v15 offset:12288
    v_add_f32 v55, v55, v57
    v_exp_f32 v58, v182
    v_cvt_pk_bf16_f32 v76, v56, v57
    v_mfma_f32_32x32x16_bf16 v[160:175], v[100:103], v[132:135], v[160:175]
    ds_read_b128 v[100:103], v15 offset:13312
    s_lshl_b32 s53, s53, 14
    s_add_u32 s52, s53, 0x4000
    v_add_f32 v55, v55, v58
    v_exp_f32 v59, v183
    s_waitcnt lgkmcnt(6)
    v_mfma_f32_32x32x16_bf16 v[160:175], v[104:107], v[136:139], v[160:175]
    ds_read_b128 v[104:107], v15 offset:14336
    v_add_f32 v55, v55, v59
    v_exp_f32 v56, v188
    v_cvt_pk_bf16_f32 v77, v58, v59
    v_mfma_f32_32x32x16_bf16 v[160:175], v[108:111], v[140:143], v[160:175]
    ds_read_b128 v[108:111], v15 offset:15360
    s_and_b32 s52, s52, 0xc000
    s_add_u32 s53, s53, 0x10000
    v_add_f32_e64 v55, v55, v56
    v_exp_f32 v57, v189
    s_waitcnt lgkmcnt(6)
    v_mfma_f32_32x32x16_bf16 v[192:207], v[80:83], v[64:67], v[192:207]
    ds_read_b128 v[80:83], v14 offset:8192
    v_add_f32 v55, v55, v57
    v_exp_f32 v58, v190
    v_cvt_pk_bf16_f32 v78, v56, v57
    v_mfma_f32_32x32x16_bf16 v[208:223], v[84:87], v[64:67], v[208:223]
    ds_read_b128 v[84:87], v14 offset:9216
    v_add_f32 v55, v55, v58
    v_exp_f32 v59, v191
    v_add_u32 v15, s53, v2
    s_waitcnt lgkmcnt(6)
    v_mfma_f32_32x32x16_bf16 v[224:239], v[88:91], v[64:67], v[224:239]
    ds_read_b128 v[88:91], v14 offset:10240
    v_add_f32_e64 v55, v55, v59
    v_cvt_pk_bf16_f32 v79, v58, v59
    v_exp_f32_e64 v56, v160
    v_mfma_f32_32x32x16_bf16 v[240:255], v[92:95], v[64:67], v[240:255]
    ds_read_b128 v[92:95], v14 offset:11264
    v_cmp_nge_f32_e64 vcc, s44, v55
    v_exp_f32 v57, v161
    s_waitcnt lgkmcnt(6)
    v_mfma_f32_32x32x16_bf16 v[192:207], v[96:99], v[68:71], v[192:207]
    ds_read_b128 v[96:99], v14 offset:12288
    v_add_f32 v54, v56, v57
    v_exp_f32 v58, v162
    v_cvt_pk_bf16_f32 v64, v56, v57
    v_mfma_f32_32x32x16_bf16 v[208:223], v[100:103], v[68:71], v[208:223]
    ds_read_b128 v[100:103], v14 offset:13312
    v_add_f32_e64 v54, v54, v58
    v_exp_f32 v59, v163
    s_waitcnt lgkmcnt(6)
    v_mfma_f32_32x32x16_bf16 v[224:239], v[104:107], v[68:71], v[224:239]
    ds_read_b128 v[104:107], v14 offset:14336
    v_add_f32 v54, v54, v59
    v_exp_f32 v56, v168
    v_cvt_pk_bf16_f32 v65, v58, v59
    v_mfma_f32_32x32x16_bf16 v[240:255], v[108:111], v[68:71], v[240:255]
    s_cbranch_vccnz rs_55
rb_56:
    ds_read_b128 v[108:111], v14 offset:15360
    v_add_f32 v54, v54, v56
    v_exp_f32 v57, v169
    s_waitcnt lgkmcnt(6)
    v_mfma_f32_32x32x16_bf16 v[176:191], v[80:83], v[112:115], v[144:159]
    s_barrier
    s_add_u32 s41, s41, 1
    ds_read_b128 v[80:83], v15 offset:0
    s_bitcmp1_b32 s54, s41
    s_cbranch_scc1 hk_57
hb_58:
    v_add_f32 v54, v54, v57
    v_exp_f32 v58, v170
    v_cvt_pk_bf16_f32 v66, v56, v57
    v_mfma_f32_32x32x16_bf16 v[176:191], v[84:87], v[116:119], v[176:191]
    ds_read_b128 v[84:87], v15 offset:1024
    v_add_f32 v54, v54, v58
    v_exp_f32 v59, v171
    v_add_f32 v53, v53, v55
    s_waitcnt lgkmcnt(6)
    v_mfma_f32_32x32x16_bf16 v[176:191], v[88:91], v[120:123], v[176:191]
    ds_read_b128 v[88:91], v15 offset:2048
    v_add_f32 v54, v54, v59
    v_exp_f32 v56, v164
    v_cvt_pk_bf16_f32 v67, v58, v59
    v_mfma_f32_32x32x16_bf16 v[176:191], v[92:95], v[124:127], v[176:191]
    ds_read_b128 v[92:95], v15 offset:3072
    v_add_f32 v54, v54, v56
    v_exp_f32 v57, v165
    v_add_u32 v14, s52, v2
    s_waitcnt lgkmcnt(6)
    v_mfma_f32_32x32x16_bf16 v[176:191], v[96:99], v[128:131], v[176:191]
    ds_read_b128 v[96:99], v15 offset:4096
    s_nop 0
    v_add_f32 v54, v54, v57
    v_exp_f32_e64 v58, v166
    v_cvt_pk_bf16_f32 v68, v56, v57
    v_mfma_f32_32x32x16_bf16 v[176:191], v[100:103], v[132:135], v[176:191]
    s_sub_u32 s40, s40, 2
    ds_read_b128 v[100:103], v15 offset:5120
    v_add_f32 v54, v54, v58
    v_exp_f32 v59, v167
    s_waitcnt lgkmcnt(6)
    v_mfma_f32_32x32x16_bf16 v[176:191], v[104:107], v[136:139], v[176:191]
    ds_read_b128 v[104:107], v15 offset:6144
    v_add_f32 v54, v54, v59
    v_exp_f32 v56, v172
    v_cvt_pk_bf16_f32 v69, v58, v59
    v_mfma_f32_32x32x16_bf16 v[176:191], v[108:111], v[140:143], v[176:191]
    ds_read_b128 v[108:111], v15 offset:7168
    v_add_f32_e64 v54, v54, v56
    v_exp_f32 v57, v173
    s_waitcnt lgkmcnt(6)
    v_mfma_f32_32x32x16_bf16 v[192:207], v[80:83], v[72:75], v[192:207]
    ds_read_b128 v[80:83], v14 offset:0
    v_add_f32 v54, v54, v57
    v_exp_f32 v58, v174
    v_cvt_pk_bf16_f32 v70, v56, v57
    v_mfma_f32_32x32x16_bf16 v[208:223], v[84:87], v[72:75], v[208:223]
    ds_read_b128 v[84:87], v14 offset:1024
    v_add_f32_e64 v54, v54, v58
    v_exp_f32 v59, v175
    s_waitcnt lgkmcnt(6)
    v_mfma_f32_32x32x16_bf16 v[224:239], v[88:91], v[72:75], v[224:239]
    ds_read_b128 v[88:91], v14 offset:2048
    v_add_f32_e64 v54, v54, v59
    v_cvt_pk_bf16_f32 v71, v58, v59
    v_exp_f32_e64 v56, v176
    v_mfma_f32_32x32x16_bf16 v[240:255], v[92:95], v[72:75], v[240:255]
    ds_read_b128 v[92:95], v14 offset:3072
    v_cmp_nge_f32_e64 vcc, s44, v54
    v_exp_f32 v57, v177
    s_waitcnt lgkmcnt(6)
    v_mfma_f32_32x32x16_bf16 v[192:207], v[96:99], v[76:79], v[192:207]
    ds_read_b128 v[96:99], v14 offset:4096
    v_add_f32 v55, v56, v57
    v_exp_f32 v58, v178
    v_cvt_pk_bf16_f32 v72, v56, v57
    v_mfma_f32_32x32x16_bf16 v[208:223], v[100:103], v[76:79], v[208:223]
    ds_read_b128 v[100:103], v14 offset:5120
    v_add_f32_e64 v55, v55, v58
    v_exp_f32 v59, v179
    s_waitcnt lgkmcnt(6)
    v_mfma_f32_32x32x16_bf16 v[224:239], v[104:107], v[76:79], v[224:239]
    ds_read_b128 v[104:107], v14 offset:6144
    v_add_f32 v55, v55, v59
    v_exp_f32 v56, v184
    v_cvt_pk_bf16_f32 v73, v58, v59
    v_mfma_f32_32x32x16_bf16 v[240:255], v[108:111], v[76:79], v[240:255]
    s_cbranch_vccnz rs_59
rb_60:
    ds_read_b128 v[108:111], v14 offset:7168
    s_cmp_lt_u32 s41, 11
    v_add_f32_e64 v55, v55, v56
    v_exp_f32 v57, v185
    s_waitcnt lgkmcnt(6)
    v_mfma_f32_32x32x16_bf16 v[160:175], v[80:83], v[112:115], v[144:159]
    s_cbranch_scc1 parallel_sum__compressed_kv_cla__mixer_gmlp__prompt_kernel_at_loopB1
parallel_sum__compressed_kv_cla__mixer_gmlp__prompt_kernel_at_loopB:
    ds_read_b128 v[80:83], v15 offset:8192
    v_add_f32 v55, v55, v57
    v_exp_f32_e64 v58, v186
    v_cvt_pk_bf16_f32 v74, v56, v57
    v_mfma_f32_32x32x16_bf16 v[160:175], v[84:87], v[116:119], v[160:175]
    ds_read_b128 v[84:87], v15 offset:9216
    v_add_f32 v55, v55, v58
    v_exp_f32 v59, v187
    v_add_f32 v53, v53, v54
    s_waitcnt lgkmcnt(6)
    v_mfma_f32_32x32x16_bf16 v[160:175], v[88:91], v[120:123], v[160:175]
    ds_read_b128 v[88:91], v15 offset:10240
    v_add_f32 v55, v55, v59
    v_exp_f32 v56, v180
    v_cvt_pk_bf16_f32 v75, v58, v59
    v_mfma_f32_32x32x16_bf16 v[160:175], v[92:95], v[124:127], v[160:175]
    ds_read_b128 v[92:95], v15 offset:11264
    s_add_u32 s53, s41, 1
    s_and_b32 s53, s53, 3
    v_add_f32_e64 v55, v55, v56
    v_exp_f32 v57, v181
    s_waitcnt lgkmcnt(6)
    v_mfma_f32_32x32x16_bf16 v[160:175], v[96:99], v[128:131], v[160:175]
    ds_read_b128 v[96:99], v15 offset:12288
    v_add_f32 v55, v55, v57
    v_exp_f32 v58, v182
    v_cvt_pk_bf16_f32 v76, v56, v57
    v_mfma_f32_32x32x16_bf16 v[160:175], v[100:103], v[132:135], v[160:175]
    ds_read_b128 v[100:103], v15 offset:13312
    s_lshl_b32 s53, s53, 14
    s_add_u32 s52, s53, 0x4000
    v_add_f32 v55, v55, v58
    v_exp_f32 v59, v183
    s_waitcnt lgkmcnt(6)
    v_mfma_f32_32x32x16_bf16 v[160:175], v[104:107], v[136:139], v[160:175]
    ds_read_b128 v[104:107], v15 offset:14336
    v_add_f32 v55, v55, v59
    v_exp_f32 v56, v188
    v_cvt_pk_bf16_f32 v77, v58, v59
    v_mfma_f32_32x32x16_bf16 v[160:175], v[108:111], v[140:143], v[160:175]
    ds_read_b128 v[108:111], v15 offset:15360
    s_and_b32 s52, s52, 0xc000
    s_add_u32 s53, s53, 0x10000
    v_add_f32_e64 v55, v55, v56
    v_exp_f32 v57, v189
    s_waitcnt lgkmcnt(6)
    v_mfma_f32_32x32x16_bf16 v[192:207], v[80:83], v[64:67], v[192:207]
    ds_read_b128 v[80:83], v14 offset:8192
    v_add_f32 v55, v55, v57
    v_exp_f32 v58, v190
    v_cvt_pk_bf16_f32 v78, v56, v57
    v_mfma_f32_32x32x16_bf16 v[208:223], v[84:87], v[64:67], v[208:223]
    ds_read_b128 v[84:87], v14 offset:9216
    v_add_f32 v55, v55, v58
    v_exp_f32 v59, v191
    v_add_u32 v15, s53, v2
    s_waitcnt lgkmcnt(6)
    v_mfma_f32_32x32x16_bf16 v[224:239], v[88:91], v[64:67], v[224:239]
    ds_read_b128 v[88:91], v14 offset:10240
    v_add_f32_e64 v55, v55, v59
    v_cvt_pk_bf16_f32 v79, v58, v59
    v_exp_f32_e64 v56, v160
    v_mfma_f32_32x32x16_bf16 v[240:255], v[92:95], v[64:67], v[240:255]
    ds_read_b128 v[92:95], v14 offset:11264
    v_cmp_nge_f32_e64 vcc, s44, v55
    v_exp_f32 v57, v161
    s_waitcnt lgkmcnt(6)
    v_mfma_f32_32x32x16_bf16 v[192:207], v[96:99], v[68:71], v[192:207]
    ds_read_b128 v[96:99], v14 offset:12288
    v_add_f32 v54, v56, v57
    v_exp_f32 v58, v162
    v_cvt_pk_bf16_f32 v64, v56, v57
    v_mfma_f32_32x32x16_bf16 v[208:223], v[100:103], v[68:71], v[208:223]
    ds_read_b128 v[100:103], v14 offset:13312
    v_add_f32_e64 v54, v54, v58
    v_exp_f32 v59, v163
    s_waitcnt lgkmcnt(6)
    v_mfma_f32_32x32x16_bf16 v[224:239], v[104:107], v[68:71], v[224:239]
    ds_read_b128 v[104:107], v14 offset:14336
    v_add_f32 v54, v54, v59
    v_exp_f32 v56, v168
    v_cvt_pk_bf16_f32 v65, v58, v59
    v_mfma_f32_32x32x16_bf16 v[240:255], v[108:111], v[68:71], v[240:255]
    s_cbranch_vccnz rs_61
rb_62:
    ds_read_b128 v[108:111], v14 offset:15360
    v_add_f32 v54, v54, v56
    v_exp_f32 v57, v169
    s_waitcnt lgkmcnt(6)
    v_mfma_f32_32x32x16_bf16 v[176:191], v[80:83], v[112:115], v[144:159]
    s_barrier
    s_add_u32 s41, s41, 1
    ds_read_b128 v[80:83], v15 offset:0
    v_add_f32 v54, v54, v57
    v_exp_f32 v58, v170
    v_cvt_pk_bf16_f32 v66, v56, v57
    v_mfma_f32_32x32x16_bf16 v[176:191], v[84:87], v[116:119], v[176:191]
    ds_read_b128 v[84:87], v15 offset:1024
    v_add_f32 v54, v54, v58
    v_exp_f32 v59, v171
    v_add_f32 v53, v53, v55
    s_waitcnt lgkmcnt(6)
    v_mfma_f32_32x32x16_bf16 v[176:191], v[88:91], v[120:123], v[176:191]
    ds_read_b128 v[88:91], v15 offset:2048
    v_add_f32 v54, v54, v59
    v_exp_f32 v56, v164
    v_cvt_pk_bf16_f32 v67, v58, v59
    v_mfma_f32_32x32x16_bf16 v[176:191], v[92:95], v[124:127], v[176:191]
    ds_read_b128 v[92:95], v15 offset:3072
    v_add_f32 v54, v54, v56
    v_exp_f32 v57, v165
    v_add_u32 v14, s52, v2
    s_waitcnt lgkmcnt(6)
    v_mfma_f32_32x32x16_bf16 v[176:191], v[96:99], v[128:131], v[176:191]
    ds_read_b128 v[96:99], v15 offset:4096
    s_cmp_eq_u32 s40, 1
    v_add_f32 v54, v54, v57
    v_exp_f32_e64 v58, v166
    v_cvt_pk_bf16_f32 v68, v56, v57
    v_mfma_f32_32x32x16_bf16 v[176:191], v[100:103], v[132:135], v[176:191]
    s_cbranch_scc1 parallel_sum__compressed_kv_cla__mixer_gmlp__prompt_kernel_at_tevenB
    s_sub_u32 s40, s40, 2
    ds_read_b128 v[100:103], v15 offset:5120
    v_add_f32_e64 v54, v54, v58
    v_exp_f32 v59, v167
    s_waitcnt lgkmcnt(6)
    v_mfma_f32_32x32x16_bf16 v[176:191], v[104:107], v[136:139], v[176:191]
    ds_read_b128 v[104:107], v15 offset:6144
    v_add_f32 v54, v54, v59
    v_exp_f32 v56, v172
    v_cvt_pk_bf16_f32 v69, v58, v59
    v_mfma_f32_32x32x16_bf16 v[176:191], v[108:111], v[140:143], v[176:191]
    ds_read_b128 v[108:111], v15 offset:7168
    v_add_f32_e64 v54, v54, v56
    v_exp_f32 v57, v173
    s_waitcnt lgkmcnt(6)
    v_mfma_f32_32x32x16_bf16 v[192:207], v[80:83], v[72:75], v[192:207]
    ds_read_b128 v[80:83], v14 offset:0
    v_add_f32 v54, v54, v57
    v_exp_f32 v58, v174
    v_cvt_pk_bf16_f32 v70, v56, v57
    v_mfma_f32_32x32x16_bf16 v[208:223], v[84:87], v[72:75], v[208:223]
    ds_read_b128 v[84:87], v14 offset:1024
    v_add_f32_e64 v54, v54, v58
    v_exp_f32 v59, v175
    s_waitcnt lgkmcnt(6)
    v_mfma_f32_32x32x16_bf16 v[224:239], v[88:91], v[72:75], v[224:239]
    ds_read_b128 v[88:91], v14 offset:2048
    v_add_f32_e64 v54, v54, v59
    v_cvt_pk_bf16_f32 v71, v58, v59
    v_exp_f32_e64 v56, v176
    v_mfma_f32_32x32x16_bf16 v[240:255], v[92:95], v[72:75], v[240:255]
    ds_read_b128 v[92:95], v14 offset:3072
    v_cmp_nge_f32_e64 vcc, s44, v54
    v_exp_f32 v57, v177
    s_waitcnt lgkmcnt(6)
    v_mfma_f32_32x32x16_bf16 v[192:207], v[96:99], v[76:79], v[192:207]
    ds_read_b128 v[96:99], v14 offset:4096
    v_add_f32 v55, v56, v57
    v_exp_f32 v58, v178
    v_cvt_pk_bf16_f32 v72, v56, v57
    v_mfma_f32_32x32x16_bf16 v[208:223], v[100:103], v[76:79], v[208:223]
    ds_read_b128 v[100:103], v14 offset:5120
    v_add_f32_e64 v55, v55, v58
    v_exp_f32 v59, v179
    s_waitcnt lgkmcnt(6)
    v_mfma_f32_32x32x16_bf16 v[224:239], v[104:107], v[76:79], v[224:239]
    ds_read_b128 v[104:107], v14 offset:6144
    v_add_f32 v55, v55, v59
    v_exp_f32 v56, v184
    v_cvt_pk_bf16_f32 v73, v58, v59
    v_mfma_f32_32x32x16_bf16 v[240:255], v[108:111], v[76:79], v[240:255]
    s_cbranch_vccnz rs_63
rb_64:
    ds_read_b128 v[108:111], v14 offset:7168
    s_cmp_lg_u32 s40, 0
    v_add_f32_e64 v55, v55, v56
    v_exp_f32 v57, v185
    s_waitcnt lgkmcnt(6)
    v_mfma_f32_32x32x16_bf16 v[160:175], v[80:83], v[112:115], v[144:159]
    s_cbranch_scc1 parallel_sum__compressed_kv_cla__mixer_gmlp__prompt_kernel_at_loopB
parallel_sum__compressed_kv_cla__mixer_gmlp__prompt_kernel_at_toddB:
    ds_read_b128 v[80:83], v15 offset:8192
    v_add_f32 v55, v55, v57
    v_exp_f32_e64 v58, v186
    v_cvt_pk_bf16_f32 v74, v56, v57
    v_mfma_f32_32x32x16_bf16 v[160:175], v[84:87], v[116:119], v[160:175]
    ds_read_b128 v[84:87], v15 offset:9216
    v_add_f32 v55, v55, v58
    v_exp_f32 v59, v187
    v_add_f32 v53, v53, v54
    s_waitcnt lgkmcnt(6)
    v_mfma_f32_32x32x16_bf16 v[160:175], v[88:91], v[120:123], v[160:175]
    ds_read_b128 v[88:91], v15 offset:10240
    v_add_f32 v55, v55, v59
    v_exp_f32 v56, v180
    v_cvt_pk_bf16_f32 v75, v58, v59
    v_mfma_f32_32x32x16_bf16 v[160:175], v[92:95], v[124:127], v[160:175]
    ds_read_b128 v[92:95], v15 offset:11264
    v_add_f32_e64 v55, v55, v56
    v_exp_f32 v57, v181
    s_waitcnt lgkmcnt(6)
    v_mfma_f32_32x32x16_bf16 v[160:175], v[96:99], v[128:131], v[160:175]
    ds_read_b128 v[96:99], v15 offset:12288
    v_add_f32 v55, v55, v57
    v_exp_f32 v58, v182
    v_cvt_pk_bf16_f32 v76, v56, v57
    v_mfma_f32_32x32x16_bf16 v[160:175], v[100:103], v[132:135], v[160:175]
    ds_read_b128 v[100:103], v15 offset:13312
    v_add_f32_e64 v55, v55, v58
    v_exp_f32 v59, v183
    s_waitcnt lgkmcnt(6)
    v_mfma_f32_32x32x16_bf16 v[160:175], v[104:107], v[136:139], v[160:175]
    ds_read_b128 v[104:107], v15 offset:14336
    v_add_f32 v55, v55, v59
    v_exp_f32 v56, v188
    v_cvt_pk_bf16_f32 v77, v58, v59
    v_mfma_f32_32x32x16_bf16 v[160:175], v[108:111], v[140:143], v[160:175]
    ds_read_b128 v[108:111], v15 offset:15360
    v_add_f32_e64 v55, v55, v56
    v_exp_f32 v57, v189
    s_waitcnt lgkmcnt(6)
    v_mfma_f32_32x32x16_bf16 v[192:207], v[80:83], v[64:67], v[192:207]
    v_add_f32 v55, v55, v57
    v_exp_f32 v58, v190
    v_cvt_pk_bf16_f32 v78, v56, v57
    v_mfma_f32_32x32x16_bf16 v[208:223], v[84:87], v[64:67], v[208:223]
    s_waitcnt lgkmcnt(4)
    v_add_f32 v55, v55, v58
    v_exp_f32 v59, v191
    s_waitcnt lgkmcnt(6)
    v_mfma_f32_32x32x16_bf16 v[224:239], v[88:91], v[64:67], v[224:239]
    v_add_f32_e64 v55, v55, v59
    v_cvt_pk_bf16_f32 v79, v58, v59
    v_mfma_f32_32x32x16_bf16 v[240:255], v[92:95], v[64:67], v[240:255]
    s_waitcnt lgkmcnt(2)
    v_cmp_nge_f32 vcc, s44, v55
    s_waitcnt lgkmcnt(6)
    v_mfma_f32_32x32x16_bf16 v[192:207], v[96:99], v[68:71], v[192:207]
    v_mfma_f32_32x32x16_bf16 v[208:223], v[100:103], v[68:71], v[208:223]
    s_waitcnt lgkmcnt(0)
    s_waitcnt lgkmcnt(6)
    v_mfma_f32_32x32x16_bf16 v[224:239], v[104:107], v[68:71], v[224:239]
    v_mfma_f32_32x32x16_bf16 v[240:255], v[108:111], v[68:71], v[240:255]
    s_cbranch_vccnz rs_65
rb_66:
    s_add_u32 s53, s41, 1
    s_and_b32 s53, s53, 3
    s_lshl_b32 s53, s53, 14
    s_add_u32 s52, s53, 0x4000
    s_and_b32 s52, s52, 0xc000
    s_add_u32 s53, s53, 0x10000
    s_barrier
    s_add_u32 s41, s41, 1
    v_add_u32 v15, s53, v2
    v_add_u32_e64 v14, s52, v2
    ds_read_b128 v[80:83], v15 offset:0
    ds_read_b128 v[84:87], v15 offset:1024
    ds_read_b128 v[88:91], v15 offset:2048
    ds_read_b128 v[92:95], v15 offset:3072
    ds_read_b128 v[96:99], v15 offset:4096
    ds_read_b128 v[100:103], v15 offset:5120
    ds_read_b128 v[104:107], v15 offset:6144
    ds_read_b128 v[108:111], v15 offset:7168
    v_add_f32_e64 v53, v53, v55
    v_cmp_le_i32 s[8:9], 0, v16
    v_cmp_le_i32 s[10:11], 1, v16
    v_cmp_le_i32 s[12:13], 2, v16
    v_cmp_le_i32 s[14:15], 3, v16
    v_cndmask_b32 v160, v3, v160, s[8:9]
    v_cndmask_b32 v161, v3, v161, s[10:11]
    v_cndmask_b32 v162, v3, v162, s[12:13]
    v_cndmask_b32 v163, v3, v163, s[14:15]
    v_cmp_le_i32 s[8:9], 8, v16
    v_cmp_le_i32 s[10:11], 9, v16
    v_cmp_le_i32 s[12:13], 10, v16
    v_cmp_le_i32 s[14:15], 11, v16
    v_cndmask_b32 v164, v3, v164, s[8:9]
    v_cndmask_b32 v165, v3, v165, s[10:11]
    v_cndmask_b32 v166, v3, v166, s[12:13]
    v_cndmask_b32 v167, v3, v167, s[14:15]
    v_cmp_le_i32 s[8:9], 16, v16
    v_cmp_le_i32 s[10:11], 17, v16
    v_cmp_le_i32 s[12:13], 18, v16
    v_cmp_le_i32 s[14:15], 19, v16
    v_cndmask_b32 v168, v3, v168, s[8:9]
    v_cndmask_b32 v169, v3, v169, s[10:11]
    v_cndmask_b32 v170, v3, v170, s[12:13]
    v_cndmask_b32 v171, v3, v171, s[14:15]
    v_cmp_le_i32 s[8:9], 24, v16
    v_cmp_le_i32 s[10:11], 25, v16
    v_cmp_le_i32 s[12:13], 26, v16
    v_cmp_le_i32 s[14:15], 27, v16
    v_cndmask_b32 v172, v3, v172, s[8:9]
    v_cndmask_b32 v173, v3, v173, s[10:11]
    v_cndmask_b32 v174, v3, v174, s[12:13]
    v_cndmask_b32 v175, v3, v175, s[14:15]
    v_exp_f32 v56, v160
    v_exp_f32 v57, v161
    s_nop 0
    v_add_f32 v54, v56, v57
    v_exp_f32_e64 v58, v162
    v_cvt_pk_bf16_f32 v64, v56, v57
    v_add_f32 v54, v54, v58
    v_exp_f32 v59, v163
    s_nop 0
    v_add_f32 v54, v54, v59
    v_exp_f32_e64 v56, v168
    v_cvt_pk_bf16_f32 v65, v58, v59
    v_add_f32 v54, v54, v56
    v_exp_f32 v57, v169
    s_nop 0
    v_add_f32 v54, v54, v57
    v_exp_f32_e64 v58, v170
    v_cvt_pk_bf16_f32 v66, v56, v57
    v_add_f32_e64 v54, v54, v58
    v_exp_f32 v59, v171
    s_waitcnt lgkmcnt(7)
    v_mfma_f32_32x32x16_bf16 v[192:207], v[80:83], v[72:75], v[192:207]
    v_add_f32 v54, v54, v59
    v_exp_f32 v56, v164
    v_cvt_pk_bf16_f32 v67, v58, v59
    s_waitcnt lgkmcnt(6)
    v_mfma_f32_32x32x16_bf16 v[208:223], v[84:87], v[72:75], v[208:223]
    v_add_f32 v54, v54, v56
    v_exp_f32 v57, v165
    s_waitcnt lgkmcnt(5)
    v_mfma_f32_32x32x16_bf16 v[224:239], v[88:91], v[72:75], v[224:239]
    v_add_f32 v54, v54, v57
    v_exp_f32 v58, v166
    v_cvt_pk_bf16_f32 v68, v56, v57
    s_waitcnt lgkmcnt(4)
    v_mfma_f32_32x32x16_bf16 v[240:255], v[92:95], v[72:75], v[240:255]
    v_add_f32 v54, v54, v58
    v_exp_f32 v59, v167
    s_waitcnt lgkmcnt(3)
    v_mfma_f32_32x32x16_bf16 v[192:207], v[96:99], v[76:79], v[192:207]
    v_add_f32 v54, v54, v59
    v_exp_f32 v56, v172
    v_cvt_pk_bf16_f32 v69, v58, v59
    s_waitcnt lgkmcnt(2)
    v_mfma_f32_32x32x16_bf16 v[208:223], v[100:103], v[76:79], v[208:223]
    v_add_f32 v54, v54, v56
    v_exp_f32 v57, v173
    s_waitcnt lgkmcnt(1)
    v_mfma_f32_32x32x16_bf16 v[224:239], v[104:107], v[76:79], v[224:239]
    v_add_f32 v54, v54, v57
    v_exp_f32 v58, v174
    v_cvt_pk_bf16_f32 v70, v56, v57
    s_waitcnt lgkmcnt(0)
    v_mfma_f32_32x32x16_bf16 v[240:255], v[108:111], v[76:79], v[240:255]
    v_add_f32 v54, v54, v58
    v_exp_f32 v59, v175
    s_nop 0
    v_add_f32_e64 v54, v54, v59
    v_cvt_pk_bf16_f32 v71, v58, v59
    v_cmp_nge_f32 vcc, s44, v54
    s_cbranch_vccnz rs_67
rb_68:
    v_add_f32_e64 v53, v53, v54
    ds_read_b128 v[80:83], v15 offset:8192
    ds_read_b128 v[84:87], v15 offset:9216
    ds_read_b128 v[88:91], v15 offset:10240
    ds_read_b128 v[92:95], v15 offset:11264
    ds_read_b128 v[96:99], v15 offset:12288
    ds_read_b128 v[100:103], v15 offset:13312
    ds_read_b128 v[104:107], v15 offset:14336
    ds_read_b128 v[108:111], v15 offset:15360
    s_waitcnt lgkmcnt(7)
    v_mfma_f32_32x32x16_bf16 v[192:207], v[80:83], v[64:67], v[192:207]
    s_waitcnt lgkmcnt(6)
    v_mfma_f32_32x32x16_bf16 v[208:223], v[84:87], v[64:67], v[208:223]
    s_waitcnt lgkmcnt(5)
    v_mfma_f32_32x32x16_bf16 v[224:239], v[88:91], v[64:67], v[224:239]
    s_waitcnt lgkmcnt(4)
    v_mfma_f32_32x32x16_bf16 v[240:255], v[92:95], v[64:67], v[240:255]
    s_waitcnt lgkmcnt(3)
    v_mfma_f32_32x32x16_bf16 v[192:207], v[96:99], v[68:71], v[192:207]
    s_waitcnt lgkmcnt(2)
    v_mfma_f32_32x32x16_bf16 v[208:223], v[100:103], v[68:71], v[208:223]
    s_waitcnt lgkmcnt(1)
    v_mfma_f32_32x32x16_bf16 v[224:239], v[104:107], v[68:71], v[224:239]
    s_waitcnt lgkmcnt(0)
    v_mfma_f32_32x32x16_bf16 v[240:255], v[108:111], v[68:71], v[240:255]
    s_branch parallel_sum__compressed_kv_cla__mixer_gmlp__prompt_kernel_at_epiB
parallel_sum__compressed_kv_cla__mixer_gmlp__prompt_kernel_at_tevenB:
    ds_read_b128 v[100:103], v15 offset:5120
    v_add_f32 v54, v54, v58
    v_exp_f32 v59, v167
    s_waitcnt lgkmcnt(6)
    v_mfma_f32_32x32x16_bf16 v[176:191], v[104:107], v[136:139], v[176:191]
    ds_read_b128 v[104:107], v15 offset:6144
    v_add_f32 v54, v54, v59
    v_exp_f32 v56, v172
    v_cvt_pk_bf16_f32 v69, v58, v59
    v_mfma_f32_32x32x16_bf16 v[176:191], v[108:111], v[140:143], v[176:191]
    ds_read_b128 v[108:111], v15 offset:7168
    v_add_f32_e64 v54, v54, v56
    v_exp_f32 v57, v173
    s_waitcnt lgkmcnt(6)
    v_mfma_f32_32x32x16_bf16 v[192:207], v[80:83], v[72:75], v[192:207]
    v_add_f32 v54, v54, v57
    v_exp_f32 v58, v174
    v_cvt_pk_bf16_f32 v70, v56, v57
    v_mfma_f32_32x32x16_bf16 v[208:223], v[84:87], v[72:75], v[208:223]
    s_waitcnt lgkmcnt(4)
    v_add_f32 v54, v54, v58
    v_exp_f32 v59, v175
    s_waitcnt lgkmcnt(6)
    v_mfma_f32_32x32x16_bf16 v[224:239], v[88:91], v[72:75], v[224:239]
    v_add_f32_e64 v54, v54, v59
    v_cvt_pk_bf16_f32 v71, v58, v59
    v_mfma_f32_32x32x16_bf16 v[240:255], v[92:95], v[72:75], v[240:255]
    s_waitcnt lgkmcnt(2)
    v_cmp_nge_f32 vcc, s44, v54
    s_waitcnt lgkmcnt(6)
    v_mfma_f32_32x32x16_bf16 v[192:207], v[96:99], v[76:79], v[192:207]
    v_mfma_f32_32x32x16_bf16 v[208:223], v[100:103], v[76:79], v[208:223]
    s_waitcnt lgkmcnt(0)
    s_waitcnt lgkmcnt(6)
    v_mfma_f32_32x32x16_bf16 v[224:239], v[104:107], v[76:79], v[224:239]
    v_mfma_f32_32x32x16_bf16 v[240:255], v[108:111], v[76:79], v[240:255]
    s_cbranch_vccnz rs_69
rb_70:
    ds_read_b128 v[80:83], v15 offset:8192
    ds_read_b128 v[84:87], v15 offset:9216
    ds_read_b128 v[88:91], v15 offset:10240
    ds_read_b128 v[92:95], v15 offset:11264
    ds_read_b128 v[96:99], v15 offset:12288
    ds_read_b128 v[100:103], v15 offset:13312
    ds_read_b128 v[104:107], v15 offset:14336
    ds_read_b128 v[108:111], v15 offset:15360
    v_add_f32_e64 v53, v53, v54
    v_cmp_le_i32 s[8:9], 0, v16
    v_cmp_le_i32 s[10:11], 1, v16
    v_cmp_le_i32 s[12:13], 2, v16
    v_cmp_le_i32 s[14:15], 3, v16
    v_cndmask_b32 v176, v3, v176, s[8:9]
    v_cndmask_b32 v177, v3, v177, s[10:11]
    v_cndmask_b32 v178, v3, v178, s[12:13]
    v_cndmask_b32 v179, v3, v179, s[14:15]
    v_cmp_le_i32 s[8:9], 8, v16
    v_cmp_le_i32 s[10:11], 9, v16
    v_cmp_le_i32 s[12:13], 10, v16
    v_cmp_le_i32 s[14:15], 11, v16
    v_cndmask_b32 v180, v3, v180, s[8:9]
    v_cndmask_b32 v181, v3, v181, s[10:11]
    v_cndmask_b32 v182, v3, v182, s[12:13]
    v_cndmask_b32 v183, v3, v183, s[14:15]
    v_cmp_le_i32 s[8:9], 16, v16
    v_cmp_le_i32 s[10:11], 17, v16
    v_cmp_le_i32 s[12:13], 18, v16
    v_cmp_le_i32 s[14:15], 19, v16
    v_cndmask_b32 v184, v3, v184, s[8:9]
    v_cndmask_b32 v185, v3, v185, s[10:11]
    v_cndmask_b32 v186, v3, v186, s[12:13]
    v_cndmask_b32 v187, v3, v187, s[14:15]
    v_cmp_le_i32 s[8:9], 24, v16
    v_cmp_le_i32 s[10:11], 25, v16
    v_cmp_le_i32 s[12:13], 26, v16
    v_cmp_le_i32 s[14:15], 27, v16
    v_cndmask_b32 v188, v3, v188, s[8:9]
    v_cndmask_b32 v189, v3, v189, s[10:11]
    v_cndmask_b32 v190, v3, v190, s[12:13]
    v_cndmask_b32 v191, v3, v191, s[14:15]
    v_exp_f32 v56, v176
    v_exp_f32 v57, v177
    s_nop 0
    v_add_f32 v55, v56, v57
    v_exp_f32_e64 v58, v178
    v_cvt_pk_bf16_f32 v72, v56, v57
    v_add_f32 v55, v55, v58
    v_exp_f32 v59, v179
    s_nop 0
    v_add_f32 v55, v55, v59
    v_exp_f32_e64 v56, v184
    v_cvt_pk_bf16_f32 v73, v58, v59
    v_add_f32 v55, v55, v56
    v_exp_f32 v57, v185
    s_nop 0
    v_add_f32 v55, v55, v57
    v_exp_f32_e64 v58, v186
    v_cvt_pk_bf16_f32 v74, v56, v57
    v_add_f32_e64 v55, v55, v58
    v_exp_f32 v59, v187
    s_waitcnt lgkmcnt(7)
    v_mfma_f32_32x32x16_bf16 v[192:207], v[80:83], v[64:67], v[192:207]
    v_add_f32 v55, v55, v59
    v_exp_f32 v56, v180
    v_cvt_pk_bf16_f32 v75, v58, v59
    s_waitcnt lgkmcnt(6)
    v_mfma_f32_32x32x16_bf16 v[208:223], v[84:87], v[64:67], v[208:223]
    v_add_f32 v55, v55, v56
    v_exp_f32 v57, v181
    s_waitcnt lgkmcnt(5)
    v_mfma_f32_32x32x16_bf16 v[224:239], v[88:91], v[64:67], v[224:239]
    v_add_f32 v55, v55, v57
    v_exp_f32 v58, v182
    v_cvt_pk_bf16_f32 v76, v56, v57
    s_waitcnt lgkmcnt(4)
    v_mfma_f32_32x32x16_bf16 v[240:255], v[92:95], v[64:67], v[240:255]
    v_add_f32 v55, v55, v58
    v_exp_f32 v59, v183
    s_waitcnt lgkmcnt(3)
    v_mfma_f32_32x32x16_bf16 v[192:207], v[96:99], v[68:71], v[192:207]
    v_add_f32 v55, v55, v59
    v_exp_f32 v56, v188
    v_cvt_pk_bf16_f32 v77, v58, v59
    s_waitcnt lgkmcnt(2)
    v_mfma_f32_32x32x16_bf16 v[208:223], v[100:103], v[68:71], v[208:223]
    v_add_f32 v55, v55, v56
    v_exp_f32 v57, v189
    s_waitcnt lgkmcnt(1)
    v_mfma_f32_32x32x16_bf16 v[224:239], v[104:107], v[68:71], v[224:239]
    v_add_f32 v55, v55, v57
    v_exp_f32 v58, v190
    v_cvt_pk_bf16_f32 v78, v56, v57
    s_waitcnt lgkmcnt(0)
    v_mfma_f32_32x32x16_bf16 v[240:255], v[108:111], v[68:71], v[240:255]
    v_add_f32 v55, v55, v58
    v_exp_f32 v59, v191
    s_nop 0
    v_add_f32_e64 v55, v55, v59
    v_cvt_pk_bf16_f32 v79, v58, v59
    v_cmp_nge_f32 vcc, s44, v55
    s_cbranch_vccnz rs_71
rb_72:
    v_add_f32 v53, v53, v55
    s_add_u32 s53, s41, 1
    s_and_b32 s53, s53, 3
    s_lshl_b32 s53, s53, 14
    s_add_u32 s52, s53, 0x4000
    s_and_b32 s52, s52, 0xc000
    s_add_u32 s53, s53, 0x10000
    s_barrier
    s_add_u32 s41, s41, 1
    v_add_u32 v15, s53, v2
    v_add_u32 v14, s52, v2
    ds_read_b128 v[80:83], v15 offset:0
    ds_read_b128 v[84:87], v15 offset:1024
    ds_read_b128 v[88:91], v15 offset:2048
    ds_read_b128 v[92:95], v15 offset:3072
    ds_read_b128 v[96:99], v15 offset:4096
    ds_read_b128 v[100:103], v15 offset:5120
    ds_read_b128 v[104:107], v15 offset:6144
    ds_read_b128 v[108:111], v15 offset:7168
    s_waitcnt lgkmcnt(7)
    v_mfma_f32_32x32x16_bf16 v[192:207], v[80:83], v[72:75], v[192:207]
    s_waitcnt lgkmcnt(6)
    v_mfma_f32_32x32x16_bf16 v[208:223], v[84:87], v[72:75], v[208:223]
    s_waitcnt lgkmcnt(5)
    v_mfma_f32_32x32x16_bf16 v[224:239], v[88:91], v[72:75], v[224:239]
    s_waitcnt lgkmcnt(4)
    v_mfma_f32_32x32x16_bf16 v[240:255], v[92:95], v[72:75], v[240:255]
    s_waitcnt lgkmcnt(3)
    v_mfma_f32_32x32x16_bf16 v[192:207], v[96:99], v[76:79], v[192:207]
    s_waitcnt lgkmcnt(2)
    v_mfma_f32_32x32x16_bf16 v[208:223], v[100:103], v[76:79], v[208:223]
    s_waitcnt lgkmcnt(1)
    v_mfma_f32_32x32x16_bf16 v[224:239], v[104:107], v[76:79], v[224:239]
    s_waitcnt lgkmcnt(0)
    v_mfma_f32_32x32x16_bf16 v[240:255], v[108:111], v[76:79], v[240:255]
parallel_sum__compressed_kv_cla__mixer_gmlp__prompt_kernel_at_epiB:
    s_nop 11
    v_mov_b32 v4, v53
    s_nop 1
    v_permlane32_swap_b32 v53, v4
    v_add_f32 v53, v53, v4
    v_rcp_f32 v53, v53
    s_nop 0
    v_mov_b32 v52, v53
    v_bfe_u32 v4, v1, 4, 1
    v_mul_u32_u24 v4, 153600, v4
    v_and_b32 v5, 15, v1
    v_lshrrev_b32 v6, 5, v1
    v_lshl_add_u32 v5, v6, 4, v5
    v_lshl_add_u32 v4, v5, 4, v4
    s_mul_i32 s8, s35, 150
    s_lshl_b32 s9, s32, 2
    s_add_u32 s8, s8, s9
    s_lshl_b32 s8, s8, 10
    s_add_u32 s8, s8, 35651584
    v_pk_mul_f32 v[192:193], v[192:193], v[52:53]
    v_pk_mul_f32 v[194:195], v[194:195], v[52:53]
    v_pk_mul_f32 v[196:197], v[196:197], v[52:53]
    v_pk_mul_f32 v[198:199], v[198:199], v[52:53]
    v_pk_mul_f32 v[200:201], v[200:201], v[52:53]
    v_pk_mul_f32 v[202:203], v[202:203], v[52:53]
    v_pk_mul_f32 v[204:205], v[204:205], v[52:53]
    v_pk_mul_f32 v[206:207], v[206:207], v[52:53]
    v_cvt_pk_bf16_f32 v80, v192, v193
    v_cvt_pk_bf16_f32 v81, v194, v195
    v_cvt_pk_bf16_f32 v82, v200, v201
    v_cvt_pk_bf16_f32 v83, v202, v203
    buffer_store_dwordx4 v[80:83], v4, s[4:7], s8 offen offset:0 sc1
    v_cvt_pk_bf16_f32 v84, v196, v197
    v_cvt_pk_bf16_f32 v85, v198, v199
    v_cvt_pk_bf16_f32 v86, v204, v205
    v_cvt_pk_bf16_f32 v87, v206, v207
    buffer_store_dwordx4 v[84:87], v4, s[4:7], s8 offen offset:512 sc1
    v_pk_mul_f32 v[208:209], v[208:209], v[52:53]
    v_pk_mul_f32 v[210:211], v[210:211], v[52:53]
    v_pk_mul_f32 v[212:213], v[212:213], v[52:53]
    v_pk_mul_f32 v[214:215], v[214:215], v[52:53]
    v_pk_mul_f32 v[216:217], v[216:217], v[52:53]
    v_pk_mul_f32 v[218:219], v[218:219], v[52:53]
    v_pk_mul_f32 v[220:221], v[220:221], v[52:53]
    v_pk_mul_f32 v[222:223], v[222:223], v[52:53]
    v_cvt_pk_bf16_f32 v88, v208, v209
    v_cvt_pk_bf16_f32 v89, v210, v211
    v_cvt_pk_bf16_f32 v90, v216, v217
    v_cvt_pk_bf16_f32 v91, v218, v219
    buffer_store_dwordx4 v[88:91], v4, s[4:7], s8 offen offset:1024 sc1
    v_cvt_pk_bf16_f32 v92, v212, v213
    v_cvt_pk_bf16_f32 v93, v214, v215
    v_cvt_pk_bf16_f32 v94, v220, v221
    v_cvt_pk_bf16_f32 v95, v222, v223
    buffer_store_dwordx4 v[92:95], v4, s[4:7], s8 offen offset:1536 sc1
    v_pk_mul_f32 v[224:225], v[224:225], v[52:53]
    v_pk_mul_f32 v[226:227], v[226:227], v[52:53]
    v_pk_mul_f32 v[228:229], v[228:229], v[52:53]
    v_pk_mul_f32 v[230:231], v[230:231], v[52:53]
    v_pk_mul_f32 v[232:233], v[232:233], v[52:53]
    v_pk_mul_f32 v[234:235], v[234:235], v[52:53]
    v_pk_mul_f32 v[236:237], v[236:237], v[52:53]
    v_pk_mul_f32 v[238:239], v[238:239], v[52:53]
    v_cvt_pk_bf16_f32 v96, v224, v225
    v_cvt_pk_bf16_f32 v97, v226, v227
    v_cvt_pk_bf16_f32 v98, v232, v233
    v_cvt_pk_bf16_f32 v99, v234, v235
    buffer_store_dwordx4 v[96:99], v4, s[4:7], s8 offen offset:2048 sc1
    v_cvt_pk_bf16_f32 v100, v228, v229
    v_cvt_pk_bf16_f32 v101, v230, v231
    v_cvt_pk_bf16_f32 v102, v236, v237
    v_cvt_pk_bf16_f32 v103, v238, v239
    buffer_store_dwordx4 v[100:103], v4, s[4:7], s8 offen offset:2560 sc1
    v_pk_mul_f32 v[240:241], v[240:241], v[52:53]
    v_pk_mul_f32 v[242:243], v[242:243], v[52:53]
    v_pk_mul_f32 v[244:245], v[244:245], v[52:53]
    v_pk_mul_f32 v[246:247], v[246:247], v[52:53]
    v_pk_mul_f32 v[248:249], v[248:249], v[52:53]
    v_pk_mul_f32 v[250:251], v[250:251], v[52:53]
    v_pk_mul_f32 v[252:253], v[252:253], v[52:53]
    v_pk_mul_f32 v[254:255], v[254:255], v[52:53]
    v_cvt_pk_bf16_f32 v104, v240, v241
    v_cvt_pk_bf16_f32 v105, v242, v243
    v_cvt_pk_bf16_f32 v106, v248, v249
    v_cvt_pk_bf16_f32 v107, v250, v251
    buffer_store_dwordx4 v[104:107], v4, s[4:7], s8 offen offset:3072 sc1
    v_cvt_pk_bf16_f32 v108, v244, v245
    v_cvt_pk_bf16_f32 v109, v246, v247
    v_cvt_pk_bf16_f32 v110, v252, v253
    v_cvt_pk_bf16_f32 v111, v254, v255
    buffer_store_dwordx4 v[108:111], v4, s[4:7], s8 offen offset:3584 sc1
parallel_sum__compressed_kv_cla__mixer_gmlp__prompt_kernel_at_restB:
    s_cmp_ge_u32 s41, s38
    s_cbranch_scc1 parallel_sum__compressed_kv_cla__mixer_gmlp__prompt_kernel_at_done
    s_barrier
    s_add_u32 s41, s41, 1
    s_branch parallel_sum__compressed_kv_cla__mixer_gmlp__prompt_kernel_at_restB
parallel_sum__compressed_kv_cla__mixer_gmlp__prompt_kernel_at_A:
    s_add_u32 s53, s41, 1
    s_and_b32 s53, s53, 3
    s_lshl_b32 s53, s53, 14
    s_add_u32 s52, s53, 0x4000
    s_and_b32 s52, s52, 0xc000
    s_add_u32 s53, s53, 0x10000
    s_add_u32 s41, s41, 1
    v_add_u32 v15, s53, v2
    v_add_u32 v14, s52, v2
    s_bitcmp1_b32 s54, s41
    s_cbranch_scc1 hk_73
hb_74:
    s_add_u32 s10, s41, 3
    s_lshl_b32 s11, s10, 14
    s_and_b32 s10, s11, 0xc000
    s_add_u32 m0, s10, s46
    s_add_u32 s11, s11, s42
    s_min_u32 s11, s11, s56
    buffer_load_dwordx4 v2, s[4:7], s11 offen offset:0 sc1 lds
    buffer_load_dwordx4 v2, s[4:7], s11 offen offset:1024 sc1 lds
    buffer_load_dwordx4 v2, s[4:7], s11 offen offset:2048 sc1 lds
    buffer_load_dwordx4 v2, s[4:7], s11 offen offset:3072 sc1 lds
    s_add_u32 s10, s41, 2
    s_lshl_b32 s11, s10, 14
    s_and_b32 s10, s11, 0xc000
    s_add_u32 m0, s10, s47
    s_add_u32 s11, s11, s43
    s_min_u32 s11, s11, s57
    buffer_load_dwordx4 v2, s[4:7], s11 offen offset:0 sc1 lds
    buffer_load_dwordx4 v2, s[4:7], s11 offen offset:1024 sc1 lds
    buffer_load_dwordx4 v2, s[4:7], s11 offen offset:2048 sc1 lds
    buffer_load_dwordx4 v2, s[4:7], s11 offen offset:3072 sc1 lds
    s_cmp_lt_u32 s39, 2
    s_cbranch_scc1 parallel_sum__compressed_kv_cla__mixer_gmlp__prompt_kernel_at_small
    s_sub_u32 s40, s39, 2
    s_waitcnt lgkmcnt(6)
    v_mfma_f32_32x32x16_bf16 v[176:191], v[80:83], v[112:115], v[144:159]
    ds_read_b128 v[80:83], v14 offset:0
    v_add_f32 v54, v54, v57
    v_exp_f32 v58, v170
    v_cvt_pk_bf16_f32 v66, v56, v57
    v_mfma_f32_32x32x16_bf16 v[176:191], v[84:87], v[116:119], v[176:191]
    ds_read_b128 v[84:87], v14 offset:1024
    v_add_f32_e64 v54, v54, v58
    v_exp_f32 v59, v171
    s_waitcnt lgkmcnt(6)
    v_mfma_f32_32x32x16_bf16 v[176:191], v[88:91], v[120:123], v[176:191]
    ds_read_b128 v[88:91], v14 offset:2048
    v_add_f32 v54, v54, v59
    v_exp_f32 v56, v164
    v_cvt_pk_bf16_f32 v67, v58, v59
    v_mfma_f32_32x32x16_bf16 v[176:191], v[92:95], v[124:127], v[176:191]
    ds_read_b128 v[92:95], v14 offset:3072
    v_add_f32_e64 v54, v54, v56
    v_exp_f32 v57, v165
    s_waitcnt lgkmcnt(6)
    v_mfma_f32_32x32x16_bf16 v[176:191], v[96:99], v[128:131], v[176:191]
    ds_read_b128 v[96:99], v14 offset:4096
    v_add_f32 v54, v54, v57
    v_exp_f32 v58, v166
    v_cvt_pk_bf16_f32 v68, v56, v57
    v_mfma_f32_32x32x16_bf16 v[176:191], v[100:103], v[132:135], v[176:191]
    ds_read_b128 v[100:103], v14 offset:5120
    v_add_f32_e64 v54, v54, v58
    v_exp_f32 v59, v167
    s_waitcnt lgkmcnt(6)
    v_mfma_f32_32x32x16_bf16 v[176:191], v[104:107], v[136:139], v[176:191]
    ds_read_b128 v[104:107], v14 offset:6144
    v_add_f32 v54, v54, v59
    v_exp_f32 v56, v172
    v_cvt_pk_bf16_f32 v69, v58, v59
    v_mfma_f32_32x32x16_bf16 v[176:191], v[108:111], v[140:143], v[176:191]
    ds_read_b128 v[108:111], v14 offset:7168
    v_add_f32 v54, v54, v56
    v_exp_f32 v57, v173
    s_nop 0
    v_add_f32 v54, v54, v57
    v_exp_f32_e64 v58, v174
    v_cvt_pk_bf16_f32 v70, v56, v57
    v_add_f32 v54, v54, v58
    v_exp_f32 v59, v175
    s_nop 0
    v_add_f32 v54, v54, v59
    v_cvt_pk_bf16_f32 v71, v58, v59
    v_exp_f32 v56, v176
    v_cmp_nge_f32 vcc, s44, v54
    v_exp_f32 v57, v177
    s_nop 0
    v_add_f32 v55, v56, v57
    v_exp_f32 v58, v178
    v_cvt_pk_bf16_f32 v72, v56, v57
    v_add_f32 v55, v55, v58
    v_exp_f32 v59, v179
    s_nop 0
    v_add_f32 v55, v55, v59
    v_exp_f32_e64 v56, v184
    v_cvt_pk_bf16_f32 v73, v58, v59
    s_cbranch_vccnz rs_75
rb_76:
    s_cmp_eq_u32 s40, 0
    v_add_f32_e64 v55, v55, v56
    v_exp_f32 v57, v185
    s_waitcnt lgkmcnt(6)
    v_mfma_f32_32x32x16_bf16 v[160:175], v[80:83], v[112:115], v[144:159]
    s_cbranch_scc1 parallel_sum__compressed_kv_cla__mixer_gmlp__prompt_kernel_at_toddA
parallel_sum__compressed_kv_cla__mixer_gmlp__prompt_kernel_at_loopA:
    ds_read_b128 v[80:83], v15 offset:8192
    v_add_f32 v55, v55, v57
    v_exp_f32_e64 v58, v186
    v_cvt_pk_bf16_f32 v74, v56, v57
    v_mfma_f32_32x32x16_bf16 v[160:175], v[84:87], v[116:119], v[160:175]
    ds_read_b128 v[84:87], v15 offset:9216
    v_add_f32 v55, v55, v58
    v_exp_f32 v59, v187
    v_add_f32 v53, v53, v54
    s_waitcnt lgkmcnt(6)
    v_mfma_f32_32x32x16_bf16 v[160:175], v[88:91], v[120:123], v[160:175]
    ds_read_b128 v[88:91], v15 offset:10240
    v_add_f32 v55, v55, v59
    v_exp_f32 v56, v180
    v_cvt_pk_bf16_f32 v75, v58, v59
    v_mfma_f32_32x32x16_bf16 v[160:175], v[92:95], v[124:127], v[160:175]
    ds_read_b128 v[92:95], v15 offset:11264
    s_add_u32 s53, s41, 1
    s_and_b32 s53, s53, 3
    v_add_f32_e64 v55, v55, v56
    v_exp_f32 v57, v181
    s_waitcnt lgkmcnt(6)
    v_mfma_f32_32x32x16_bf16 v[160:175], v[96:99], v[128:131], v[160:175]
    ds_read_b128 v[96:99], v15 offset:12288
    v_add_f32 v55, v55, v57
    v_exp_f32 v58, v182
    v_cvt_pk_bf16_f32 v76, v56, v57
    v_mfma_f32_32x32x16_bf16 v[160:175], v[100:103], v[132:135], v[160:175]
    ds_read_b128 v[100:103], v15 offset:13312
    s_lshl_b32 s53, s53, 14
    s_add_u32 s52, s53, 0x4000
    v_add_f32 v55, v55, v58
    v_exp_f32 v59, v183
    s_waitcnt lgkmcnt(6)
    v_mfma_f32_32x32x16_bf16 v[160:175], v[104:107], v[136:139], v[160:175]
    ds_read_b128 v[104:107], v15 offset:14336
    v_add_f32 v55, v55, v59
    v_exp_f32 v56, v188
    v_cvt_pk_bf16_f32 v77, v58, v59
    v_mfma_f32_32x32x16_bf16 v[160:175], v[108:111], v[140:143], v[160:175]
    ds_read_b128 v[108:111], v15 offset:15360
    s_and_b32 s52, s52, 0xc000
    s_add_u32 s53, s53, 0x10000
    v_add_f32_e64 v55, v55, v56
    v_exp_f32 v57, v189
    s_waitcnt lgkmcnt(6)
    v_mfma_f32_32x32x16_bf16 v[192:207], v[80:83], v[64:67], v[192:207]
    ds_read_b128 v[80:83], v14 offset:8192
    v_add_f32 v55, v55, v57
    v_exp_f32 v58, v190
    v_cvt_pk_bf16_f32 v78, v56, v57
    v_mfma_f32_32x32x16_bf16 v[208:223], v[84:87], v[64:67], v[208:223]
    ds_read_b128 v[84:87], v14 offset:9216
    v_add_f32 v55, v55, v58
    v_exp_f32 v59, v191
    v_add_u32 v15, s53, v2
    s_waitcnt lgkmcnt(6)
    v_mfma_f32_32x32x16_bf16 v[224:239], v[88:91], v[64:67], v[224:239]
    ds_read_b128 v[88:91], v14 offset:10240
    v_add_f32_e64 v55, v55, v59
    v_cvt_pk_bf16_f32 v79, v58, v59
    v_exp_f32_e64 v56, v160
    v_mfma_f32_32x32x16_bf16 v[240:255], v[92:95], v[64:67], v[240:255]
    ds_read_b128 v[92:95], v14 offset:11264
    v_cmp_nge_f32_e64 vcc, s44, v55
    v_exp_f32 v57, v161
    s_waitcnt lgkmcnt(6)
    v_mfma_f32_32x32x16_bf16 v[192:207], v[96:99], v[68:71], v[192:207]
    ds_read_b128 v[96:99], v14 offset:12288
    v_add_f32 v54, v56, v57
    v_exp_f32 v58, v162
    v_cvt_pk_bf16_f32 v64, v56, v57
    v_mfma_f32_32x32x16_bf16 v[208:223], v[100:103], v[68:71], v[208:223]
    ds_read_b128 v[100:103], v14 offset:13312
    v_add_f32_e64 v54, v54, v58
    v_exp_f32 v59, v163
    s_waitcnt lgkmcnt(6)
    v_mfma_f32_32x32x16_bf16 v[224:239], v[104:107], v[68:71], v[224:239]
    ds_read_b128 v[104:107], v14 offset:14336
    v_add_f32 v54, v54, v59
    v_exp_f32 v56, v168
    v_cvt_pk_bf16_f32 v65, v58, v59
    v_mfma_f32_32x32x16_bf16 v[240:255], v[108:111], v[68:71], v[240:255]
    s_cbranch_vccnz rs_77
rb_78:
    ds_read_b128 v[108:111], v14 offset:15360
    v_add_f32 v54, v54, v56
    v_exp_f32 v57, v169
    s_waitcnt lgkmcnt(6)
    v_mfma_f32_32x32x16_bf16 v[176:191], v[80:83], v[112:115], v[144:159]
    s_waitcnt vmcnt(8)
    s_barrier
    s_add_u32 s41, s41, 1
    ds_read_b128 v[80:83], v15 offset:0
    s_bitcmp1_b32 s54, s41
    s_cbranch_scc1 hk_79
hb_80:
    v_add_f32 v54, v54, v57
    v_exp_f32_e64 v58, v170
    v_cvt_pk_bf16_f32 v66, v56, v57
    v_mfma_f32_32x32x16_bf16 v[176:191], v[84:87], v[116:119], v[176:191]
    ds_read_b128 v[84:87], v15 offset:1024
    s_add_u32 s10, s41, 3
    s_lshl_b32 s11, s10, 14
    s_and_b32 s10, s11, 0xc000
    s_add_u32 m0, s10, s46
    s_add_u32 s11, s11, s42
    s_min_u32 s11, s11, s56
    buffer_load_dwordx4 v2, s[4:7], s11 offen offset:0 sc1 lds
    v_add_f32 v54, v54, v58
    v_exp_f32_e64 v59, v171
    v_add_f32 v53, v53, v55
    s_waitcnt lgkmcnt(6)
    v_mfma_f32_32x32x16_bf16 v[176:191], v[88:91], v[120:123], v[176:191]
    ds_read_b128 v[88:91], v15 offset:2048
    v_add_f32 v54, v54, v59
    v_exp_f32 v56, v164
    v_cvt_pk_bf16_f32 v67, v58, v59
    v_mfma_f32_32x32x16_bf16 v[176:191], v[92:95], v[124:127], v[176:191]
    ds_read_b128 v[92:95], v15 offset:3072
    buffer_load_dwordx4 v2, s[4:7], s11 offen offset:1024 sc1 lds
    v_add_f32 v54, v54, v56
    v_exp_f32 v57, v165
    v_add_u32 v14, s52, v2
    s_waitcnt lgkmcnt(6)
    v_mfma_f32_32x32x16_bf16 v[176:191], v[96:99], v[128:131], v[176:191]
    ds_read_b128 v[96:99], v15 offset:4096
    s_cmp_eq_u32 s40, 1
    v_add_f32 v54, v54, v57
    v_exp_f32_e64 v58, v166
    v_cvt_pk_bf16_f32 v68, v56, v57
    v_mfma_f32_32x32x16_bf16 v[176:191], v[100:103], v[132:135], v[176:191]
    s_cbranch_scc1 parallel_sum__compressed_kv_cla__mixer_gmlp__prompt_kernel_at_tevenA
    s_sub_u32 s40, s40, 2
    ds_read_b128 v[100:103], v15 offset:5120
    buffer_load_dwordx4 v2, s[4:7], s11 offen offset:2048 sc1 lds
    v_add_f32_e64 v54, v54, v58
    v_exp_f32 v59, v167
    s_waitcnt lgkmcnt(6)
    v_mfma_f32_32x32x16_bf16 v[176:191], v[104:107], v[136:139], v[176:191]
    ds_read_b128 v[104:107], v15 offset:6144
    v_add_f32 v54, v54, v59
    v_exp_f32 v56, v172
    v_cvt_pk_bf16_f32 v69, v58, v59
    v_mfma_f32_32x32x16_bf16 v[176:191], v[108:111], v[140:143], v[176:191]
    ds_read_b128 v[108:111], v15 offset:7168
    buffer_load_dwordx4 v2, s[4:7], s11 offen offset:3072 sc1 lds
    v_add_f32_e64 v54, v54, v56
    v_exp_f32 v57, v173
    s_waitcnt lgkmcnt(6)
    v_mfma_f32_32x32x16_bf16 v[192:207], v[80:83], v[72:75], v[192:207]
    ds_read_b128 v[80:83], v14 offset:0
    v_add_f32 v54, v54, v57
    v_exp_f32 v58, v174
    v_cvt_pk_bf16_f32 v70, v56, v57
    v_mfma_f32_32x32x16_bf16 v[208:223], v[84:87], v[72:75], v[208:223]
    ds_read_b128 v[84:87], v14 offset:1024
    s_add_u32 s10, s41, 2
    s_lshl_b32 s11, s10, 14
    s_and_b32 s10, s11, 0xc000
    s_add_u32 m0, s10, s47
    s_add_u32 s11, s11, s43
    s_min_u32 s11, s11, s57
    buffer_load_dwordx4 v2, s[4:7], s11 offen offset:0 sc1 lds
    v_add_f32 v54, v54, v58
    v_exp_f32 v59, v175
    s_waitcnt lgkmcnt(6)
    v_mfma_f32_32x32x16_bf16 v[224:239], v[88:91], v[72:75], v[224:239]
    ds_read_b128 v[88:91], v14 offset:2048
    v_add_f32_e64 v54, v54, v59
    v_cvt_pk_bf16_f32 v71, v58, v59
    v_exp_f32_e64 v56, v176
    v_mfma_f32_32x32x16_bf16 v[240:255], v[92:95], v[72:75], v[240:255]
    ds_read_b128 v[92:95], v14 offset:3072
    buffer_load_dwordx4 v2, s[4:7], s11 offen offset:1024 sc1 lds
    v_cmp_nge_f32_e64 vcc, s44, v54
    v_exp_f32 v57, v177
    s_waitcnt lgkmcnt(6)
    v_mfma_f32_32x32x16_bf16 v[192:207], v[96:99], v[76:79], v[192:207]
    ds_read_b128 v[96:99], v14 offset:4096
    v_add_f32 v55, v56, v57
    v_exp_f32 v58, v178
    v_cvt_pk_bf16_f32 v72, v56, v57
    v_mfma_f32_32x32x16_bf16 v[208:223], v[100:103], v[76:79], v[208:223]
    ds_read_b128 v[100:103], v14 offset:5120
    buffer_load_dwordx4 v2, s[4:7], s11 offen offset:2048 sc1 lds
    v_add_f32_e64 v55, v55, v58
    v_exp_f32 v59, v179
    s_waitcnt lgkmcnt(6)
    v_mfma_f32_32x32x16_bf16 v[224:239], v[104:107], v[76:79], v[224:239]
    ds_read_b128 v[104:107], v14 offset:6144
    v_add_f32 v55, v55, v59
    v_exp_f32 v56, v184
    v_cvt_pk_bf16_f32 v73, v58, v59
    v_mfma_f32_32x32x16_bf16 v[240:255], v[108:111], v[76:79], v[240:255]
    s_cbranch_vccnz rs_81
rb_82:
    ds_read_b128 v[108:111], v14 offset:7168
    buffer_load_dwordx4 v2, s[4:7], s11 offen offset:3072 sc1 lds
    s_cmp_lg_u32 s40, 0
    v_add_f32_e64 v55, v55, v56
    v_exp_f32 v57, v185
    s_waitcnt lgkmcnt(6)
    v_mfma_f32_32x32x16_bf16 v[160:175], v[80:83], v[112:115], v[144:159]
    s_cbranch_scc1 parallel_sum__compressed_kv_cla__mixer_gmlp__prompt_kernel_at_loopA
parallel_sum__compressed_kv_cla__mixer_gmlp__prompt_kernel_at_toddA:
    ds_read_b128 v[80:83], v15 offset:8192
    v_add_f32 v55, v55, v57
    v_exp_f32_e64 v58, v186
    v_cvt_pk_bf16_f32 v74, v56, v57
    v_mfma_f32_32x32x16_bf16 v[160:175], v[84:87], v[116:119], v[160:175]
    ds_read_b128 v[84:87], v15 offset:9216
    v_add_f32 v55, v55, v58
    v_exp_f32 v59, v187
    v_add_f32 v53, v53, v54
    s_waitcnt lgkmcnt(6)
    v_mfma_f32_32x32x16_bf16 v[160:175], v[88:91], v[120:123], v[160:175]
    ds_read_b128 v[88:91], v15 offset:10240
    v_add_f32 v55, v55, v59
    v_exp_f32 v56, v180
    v_cvt_pk_bf16_f32 v75, v58, v59
    v_mfma_f32_32x32x16_bf16 v[160:175], v[92:95], v[124:127], v[160:175]
    ds_read_b128 v[92:95], v15 offset:11264
    v_add_f32_e64 v55, v55, v56
    v_exp_f32 v57, v181
    s_waitcnt lgkmcnt(6)
    v_mfma_f32_32x32x16_bf16 v[160:175], v[96:99], v[128:131], v[160:175]
    ds_read_b128 v[96:99], v15 offset:12288
    v_add_f32 v55, v55, v57
    v_exp_f32 v58, v182
    v_cvt_pk_bf16_f32 v76, v56, v57
    v_mfma_f32_32x32x16_bf16 v[160:175], v[100:103], v[132:135], v[160:175]
    ds_read_b128 v[100:103], v15 offset:13312
    v_add_f32_e64 v55, v55, v58
    v_exp_f32 v59, v183
    s_waitcnt lgkmcnt(6)
    v_mfma_f32_32x32x16_bf16 v[160:175], v[104:107], v[136:139], v[160:175]
    ds_read_b128 v[104:107], v15 offset:14336
    v_add_f32 v55, v55, v59
    v_exp_f32 v56, v188
    v_cvt_pk_bf16_f32 v77, v58, v59
    v_mfma_f32_32x32x16_bf16 v[160:175], v[108:111], v[140:143], v[160:175]
    ds_read_b128 v[108:111], v15 offset:15360
    v_add_f32_e64 v55, v55, v56
    v_exp_f32 v57, v189
    s_waitcnt lgkmcnt(6)
    v_mfma_f32_32x32x16_bf16 v[192:207], v[80:83], v[64:67], v[192:207]
    v_add_f32 v55, v55, v57
    v_exp_f32 v58, v190
    v_cvt_pk_bf16_f32 v78, v56, v57
    v_mfma_f32_32x32x16_bf16 v[208:223], v[84:87], v[64:67], v[208:223]
    s_waitcnt lgkmcnt(4)
    v_add_f32 v55, v55, v58
    v_exp_f32 v59, v191
    s_waitcnt lgkmcnt(6)
    v_mfma_f32_32x32x16_bf16 v[224:239], v[88:91], v[64:67], v[224:239]
    v_add_f32_e64 v55, v55, v59
    v_cvt_pk_bf16_f32 v79, v58, v59
    v_mfma_f32_32x32x16_bf16 v[240:255], v[92:95], v[64:67], v[240:255]
    s_waitcnt lgkmcnt(2)
    v_cmp_nge_f32 vcc, s44, v55
    s_waitcnt lgkmcnt(6)
    v_mfma_f32_32x32x16_bf16 v[192:207], v[96:99], v[68:71], v[192:207]
    v_mfma_f32_32x32x16_bf16 v[208:223], v[100:103], v[68:71], v[208:223]
    s_waitcnt lgkmcnt(0)
    s_waitcnt lgkmcnt(6)
    v_mfma_f32_32x32x16_bf16 v[224:239], v[104:107], v[68:71], v[224:239]
    v_mfma_f32_32x32x16_bf16 v[240:255], v[108:111], v[68:71], v[240:255]
    s_cbranch_vccnz rs_83
rb_84:
    s_add_u32 s53, s41, 1
    s_and_b32 s53, s53, 3
    s_lshl_b32 s53, s53, 14
    s_add_u32 s52, s53, 0x4000
    s_and_b32 s52, s52, 0xc000
    s_add_u32 s53, s53, 0x10000
    s_waitcnt vmcnt(8)
    s_barrier
    s_add_u32 s41, s41, 1
    v_add_u32 v15, s53, v2
    v_add_u32 v14, s52, v2
    s_bitcmp1_b32 s54, s41
    s_cbranch_scc1 hk_85
hb_86:
    s_add_u32 s10, s41, 3
    s_lshl_b32 s11, s10, 14
    s_and_b32 s10, s11, 0xc000
    s_add_u32 m0, s10, s46
    s_add_u32 s11, s11, s42
    s_min_u32 s11, s11, s56
    buffer_load_dwordx4 v2, s[4:7], s11 offen offset:0 sc1 lds
    buffer_load_dwordx4 v2, s[4:7], s11 offen offset:1024 sc1 lds
    buffer_load_dwordx4 v2, s[4:7], s11 offen offset:2048 sc1 lds
    buffer_load_dwordx4 v2, s[4:7], s11 offen offset:3072 sc1 lds
    s_add_u32 s10, s41, 2
    s_lshl_b32 s11, s10, 14
    s_and_b32 s10, s11, 0xc000
    s_add_u32 m0, s10, s47
    s_add_u32 s11, s11, s43
    s_min_u32 s11, s11, s57
    buffer_load_dwordx4 v2, s[4:7], s11 offen offset:0 sc1 lds
    buffer_load_dwordx4 v2, s[4:7], s11 offen offset:1024 sc1 lds
    buffer_load_dwordx4 v2, s[4:7], s11 offen offset:2048 sc1 lds
    buffer_load_dwordx4 v2, s[4:7], s11 offen offset:3072 sc1 lds
    ds_read_b128 v[80:83], v15 offset:0
    ds_read_b128 v[84:87], v15 offset:1024
    ds_read_b128 v[88:91], v15 offset:2048
    ds_read_b128 v[92:95], v15 offset:3072
    ds_read_b128 v[96:99], v15 offset:4096
    ds_read_b128 v[100:103], v15 offset:5120
    ds_read_b128 v[104:107], v15 offset:6144
    ds_read_b128 v[108:111], v15 offset:7168
    v_add_f32_e64 v53, v53, v55
    v_cmp_le_i32 s[8:9], 0, v16
    v_cmp_le_i32 s[10:11], 1, v16
    v_cmp_le_i32 s[12:13], 2, v16
    v_cmp_le_i32 s[14:15], 3, v16
    v_cndmask_b32 v160, v3, v160, s[8:9]
    v_cndmask_b32 v161, v3, v161, s[10:11]
    v_cndmask_b32 v162, v3, v162, s[12:13]
    v_cndmask_b32 v163, v3, v163, s[14:15]
    v_cmp_le_i32 s[8:9], 8, v16
    v_cmp_le_i32 s[10:11], 9, v16
    v_cmp_le_i32 s[12:13], 10, v16
    v_cmp_le_i32 s[14:15], 11, v16
    v_cndmask_b32 v164, v3, v164, s[8:9]
    v_cndmask_b32 v165, v3, v165, s[10:11]
    v_cndmask_b32 v166, v3, v166, s[12:13]
    v_cndmask_b32 v167, v3, v167, s[14:15]
    v_cmp_le_i32 s[8:9], 16, v16
    v_cmp_le_i32 s[10:11], 17, v16
    v_cmp_le_i32 s[12:13], 18, v16
    v_cmp_le_i32 s[14:15], 19, v16
    v_cndmask_b32 v168, v3, v168, s[8:9]
    v_cndmask_b32 v169, v3, v169, s[10:11]
    v_cndmask_b32 v170, v3, v170, s[12:13]
    v_cndmask_b32 v171, v3, v171, s[14:15]
    v_cmp_le_i32 s[8:9], 24, v16
    v_cmp_le_i32 s[10:11], 25, v16
    v_cmp_le_i32 s[12:13], 26, v16
    v_cmp_le_i32 s[14:15], 27, v16
    v_cndmask_b32 v172, v3, v172, s[8:9]
    v_cndmask_b32 v173, v3, v173, s[10:11]
    v_cndmask_b32 v174, v3, v174, s[12:13]
    v_cndmask_b32 v175, v3, v175, s[14:15]
    v_exp_f32 v56, v160
    v_exp_f32 v57, v161
    s_nop 0
    v_add_f32 v54, v56, v57
    v_exp_f32_e64 v58, v162
    v_cvt_pk_bf16_f32 v64, v56, v57
    v_add_f32 v54, v54, v58
    v_exp_f32 v59, v163
    s_nop 0
    v_add_f32 v54, v54, v59
    v_exp_f32_e64 v56, v168
    v_cvt_pk_bf16_f32 v65, v58, v59
    v_add_f32 v54, v54, v56
    v_exp_f32 v57, v169
    s_nop 0
    v_add_f32 v54, v54, v57
    v_exp_f32_e64 v58, v170
    v_cvt_pk_bf16_f32 v66, v56, v57
    v_add_f32_e64 v54, v54, v58
    v_exp_f32 v59, v171
    s_waitcnt lgkmcnt(7)
    v_mfma_f32_32x32x16_bf16 v[192:207], v[80:83], v[72:75], v[192:207]
    v_add_f32 v54, v54, v59
    v_exp_f32 v56, v164
    v_cvt_pk_bf16_f32 v67, v58, v59
    s_waitcnt lgkmcnt(6)
    v_mfma_f32_32x32x16_bf16 v[208:223], v[84:87], v[72:75], v[208:223]
    v_add_f32 v54, v54, v56
    v_exp_f32 v57, v165
    s_waitcnt lgkmcnt(5)
    v_mfma_f32_32x32x16_bf16 v[224:239], v[88:91], v[72:75], v[224:239]
    v_add_f32 v54, v54, v57
    v_exp_f32 v58, v166
    v_cvt_pk_bf16_f32 v68, v56, v57
    s_waitcnt lgkmcnt(4)
    v_mfma_f32_32x32x16_bf16 v[240:255], v[92:95], v[72:75], v[240:255]
    v_add_f32 v54, v54, v58
    v_exp_f32 v59, v167
    s_waitcnt lgkmcnt(3)
    v_mfma_f32_32x32x16_bf16 v[192:207], v[96:99], v[76:79], v[192:207]
    v_add_f32 v54, v54, v59
    v_exp_f32 v56, v172
    v_cvt_pk_bf16_f32 v69, v58, v59
    s_waitcnt lgkmcnt(2)
    v_mfma_f32_32x32x16_bf16 v[208:223], v[100:103], v[76:79], v[208:223]
    v_add_f32 v54, v54, v56
    v_exp_f32 v57, v173
    s_waitcnt lgkmcnt(1)
    v_mfma_f32_32x32x16_bf16 v[224:239], v[104:107], v[76:79], v[224:239]
    v_add_f32 v54, v54, v57
    v_exp_f32 v58, v174
    v_cvt_pk_bf16_f32 v70, v56, v57
    s_waitcnt lgkmcnt(0)
    v_mfma_f32_32x32x16_bf16 v[240:255], v[108:111], v[76:79], v[240:255]
    v_add_f32 v54, v54, v58
    v_exp_f32 v59, v175
    s_nop 0
    v_add_f32_e64 v54, v54, v59
    v_cvt_pk_bf16_f32 v71, v58, v59
    v_cmp_nge_f32 vcc, s44, v54
    s_cbranch_vccnz rs_87
rb_88:
    v_add_f32_e64 v53, v53, v54
    ds_read_b128 v[80:83], v15 offset:8192
    ds_read_b128 v[84:87], v15 offset:9216
    ds_read_b128 v[88:91], v15 offset:10240
    ds_read_b128 v[92:95], v15 offset:11264
    ds_read_b128 v[96:99], v15 offset:12288
    ds_read_b128 v[100:103], v15 offset:13312
    ds_read_b128 v[104:107], v15 offset:14336
    ds_read_b128 v[108:111], v15 offset:15360
    s_waitcnt lgkmcnt(7)
    v_mfma_f32_32x32x16_bf16 v[192:207], v[80:83], v[64:67], v[192:207]
    s_waitcnt lgkmcnt(6)
    v_mfma_f32_32x32x16_bf16 v[208:223], v[84:87], v[64:67], v[208:223]
    s_waitcnt lgkmcnt(5)
    v_mfma_f32_32x32x16_bf16 v[224:239], v[88:91], v[64:67], v[224:239]
    s_waitcnt lgkmcnt(4)
    v_mfma_f32_32x32x16_bf16 v[240:255], v[92:95], v[64:67], v[240:255]
    s_waitcnt lgkmcnt(3)
    v_mfma_f32_32x32x16_bf16 v[192:207], v[96:99], v[68:71], v[192:207]
    s_waitcnt lgkmcnt(2)
    v_mfma_f32_32x32x16_bf16 v[208:223], v[100:103], v[68:71], v[208:223]
    s_waitcnt lgkmcnt(1)
    v_mfma_f32_32x32x16_bf16 v[224:239], v[104:107], v[68:71], v[224:239]
    s_waitcnt lgkmcnt(0)
    v_mfma_f32_32x32x16_bf16 v[240:255], v[108:111], v[68:71], v[240:255]
    s_branch parallel_sum__compressed_kv_cla__mixer_gmlp__prompt_kernel_at_epiA
parallel_sum__compressed_kv_cla__mixer_gmlp__prompt_kernel_at_tevenA:
    ds_read_b128 v[100:103], v15 offset:5120
    buffer_load_dwordx4 v2, s[4:7], s11 offen offset:2048 sc1 lds
    v_add_f32 v54, v54, v58
    v_exp_f32 v59, v167
    s_waitcnt lgkmcnt(6)
    v_mfma_f32_32x32x16_bf16 v[176:191], v[104:107], v[136:139], v[176:191]
    ds_read_b128 v[104:107], v15 offset:6144
    v_add_f32 v54, v54, v59
    v_exp_f32 v56, v172
    v_cvt_pk_bf16_f32 v69, v58, v59
    v_mfma_f32_32x32x16_bf16 v[176:191], v[108:111], v[140:143], v[176:191]
    ds_read_b128 v[108:111], v15 offset:7168
    buffer_load_dwordx4 v2, s[4:7], s11 offen offset:3072 sc1 lds
    v_add_f32_e64 v54, v54, v56
    v_exp_f32 v57, v173
    s_waitcnt lgkmcnt(6)
    v_mfma_f32_32x32x16_bf16 v[192:207], v[80:83], v[72:75], v[192:207]
    v_add_f32 v54, v54, v57
    v_exp_f32 v58, v174
    v_cvt_pk_bf16_f32 v70, v56, v57
    v_mfma_f32_32x32x16_bf16 v[208:223], v[84:87], v[72:75], v[208:223]
    s_waitcnt lgkmcnt(4)
    s_add_u32 s10, s41, 2
    s_lshl_b32 s11, s10, 14
    s_and_b32 s10, s11, 0xc000
    s_add_u32 m0, s10, s47
    s_add_u32 s11, s11, s43
    s_min_u32 s11, s11, s57
    buffer_load_dwordx4 v2, s[4:7], s11 offen offset:0 sc1 lds
    v_add_f32_e64 v54, v54, v58
    v_exp_f32 v59, v175
    s_waitcnt lgkmcnt(6)
    v_mfma_f32_32x32x16_bf16 v[224:239], v[88:91], v[72:75], v[224:239]
    v_add_f32_e64 v54, v54, v59
    v_cvt_pk_bf16_f32 v71, v58, v59
    v_mfma_f32_32x32x16_bf16 v[240:255], v[92:95], v[72:75], v[240:255]
    s_waitcnt lgkmcnt(2)
    buffer_load_dwordx4 v2, s[4:7], s11 offen offset:1024 sc1 lds
    v_cmp_nge_f32 vcc, s44, v54
    s_waitcnt lgkmcnt(6)
    v_mfma_f32_32x32x16_bf16 v[192:207], v[96:99], v[76:79], v[192:207]
    v_mfma_f32_32x32x16_bf16 v[208:223], v[100:103], v[76:79], v[208:223]
    s_waitcnt lgkmcnt(0)
    buffer_load_dwordx4 v2, s[4:7], s11 offen offset:2048 sc1 lds
    s_waitcnt lgkmcnt(6)
    v_mfma_f32_32x32x16_bf16 v[224:239], v[104:107], v[76:79], v[224:239]
    v_mfma_f32_32x32x16_bf16 v[240:255], v[108:111], v[76:79], v[240:255]
    s_cbranch_vccnz rs_89
rb_90:
    buffer_load_dwordx4 v2, s[4:7], s11 offen offset:3072 sc1 lds
parallel_sum__compressed_kv_cla__mixer_gmlp__prompt_kernel_at_u1b:
    ds_read_b128 v[80:83], v15 offset:8192
    ds_read_b128 v[84:87], v15 offset:9216
    ds_read_b128 v[88:91], v15 offset:10240
    ds_read_b128 v[92:95], v15 offset:11264
    ds_read_b128 v[96:99], v15 offset:12288
    ds_read_b128 v[100:103], v15 offset:13312
    ds_read_b128 v[104:107], v15 offset:14336
    ds_read_b128 v[108:111], v15 offset:15360
    v_add_f32_e64 v53, v53, v54
    v_cmp_le_i32 s[8:9], 0, v16
    v_cmp_le_i32 s[10:11], 1, v16
    v_cmp_le_i32 s[12:13], 2, v16
    v_cmp_le_i32 s[14:15], 3, v16
    v_cndmask_b32 v176, v3, v176, s[8:9]
    v_cndmask_b32 v177, v3, v177, s[10:11]
    v_cndmask_b32 v178, v3, v178, s[12:13]
    v_cndmask_b32 v179, v3, v179, s[14:15]
    v_cmp_le_i32 s[8:9], 8, v16
    v_cmp_le_i32 s[10:11], 9, v16
    v_cmp_le_i32 s[12:13], 10, v16
    v_cmp_le_i32 s[14:15], 11, v16
    v_cndmask_b32 v180, v3, v180, s[8:9]
    v_cndmask_b32 v181, v3, v181, s[10:11]
    v_cndmask_b32 v182, v3, v182, s[12:13]
    v_cndmask_b32 v183, v3, v183, s[14:15]
    v_cmp_le_i32 s[8:9], 16, v16
    v_cmp_le_i32 s[10:11], 17, v16
    v_cmp_le_i32 s[12:13], 18, v16
    v_cmp_le_i32 s[14:15], 19, v16
    v_cndmask_b32 v184, v3, v184, s[8:9]
    v_cndmask_b32 v185, v3, v185, s[10:11]
    v_cndmask_b32 v186, v3, v186, s[12:13]
    v_cndmask_b32 v187, v3, v187, s[14:15]
    v_cmp_le_i32 s[8:9], 24, v16
    v_cmp_le_i32 s[10:11], 25, v16
    v_cmp_le_i32 s[12:13], 26, v16
    v_cmp_le_i32 s[14:15], 27, v16
    v_cndmask_b32 v188, v3, v188, s[8:9]
    v_cndmask_b32 v189, v3, v189, s[10:11]
    v_cndmask_b32 v190, v3, v190, s[12:13]
    v_cndmask_b32 v191, v3, v191, s[14:15]
    v_exp_f32 v56, v176
    v_exp_f32 v57, v177
    s_nop 0
    v_add_f32 v55, v56, v57
    v_exp_f32_e64 v58, v178
    v_cvt_pk_bf16_f32 v72, v56, v57
    v_add_f32 v55, v55, v58
    v_exp_f32 v59, v179
    s_nop 0
    v_add_f32 v55, v55, v59
    v_exp_f32_e64 v56, v184
    v_cvt_pk_bf16_f32 v73, v58, v59
    v_add_f32 v55, v55, v56
    v_exp_f32 v57, v185
    s_nop 0
    v_add_f32 v55, v55, v57
    v_exp_f32_e64 v58, v186
    v_cvt_pk_bf16_f32 v74, v56, v57
    v_add_f32_e64 v55, v55, v58
    v_exp_f32 v59, v187
    s_waitcnt lgkmcnt(7)
    v_mfma_f32_32x32x16_bf16 v[192:207], v[80:83], v[64:67], v[192:207]
    v_add_f32 v55, v55, v59
    v_exp_f32 v56, v180
    v_cvt_pk_bf16_f32 v75, v58, v59
    s_waitcnt lgkmcnt(6)
    v_mfma_f32_32x32x16_bf16 v[208:223], v[84:87], v[64:67], v[208:223]
    v_add_f32 v55, v55, v56
    v_exp_f32 v57, v181
    s_waitcnt lgkmcnt(5)
    v_mfma_f32_32x32x16_bf16 v[224:239], v[88:91], v[64:67], v[224:239]
    v_add_f32 v55, v55, v57
    v_exp_f32 v58, v182
    v_cvt_pk_bf16_f32 v76, v56, v57
    s_waitcnt lgkmcnt(4)
    v_mfma_f32_32x32x16_bf16 v[240:255], v[92:95], v[64:67], v[240:255]
    v_add_f32 v55, v55, v58
    v_exp_f32 v59, v183
    s_waitcnt lgkmcnt(3)
    v_mfma_f32_32x32x16_bf16 v[192:207], v[96:99], v[68:71], v[192:207]
    v_add_f32 v55, v55, v59
    v_exp_f32 v56, v188
    v_cvt_pk_bf16_f32 v77, v58, v59
    s_waitcnt lgkmcnt(2)
    v_mfma_f32_32x32x16_bf16 v[208:223], v[100:103], v[68:71], v[208:223]
    v_add_f32 v55, v55, v56
    v_exp_f32 v57, v189
    s_waitcnt lgkmcnt(1)
    v_mfma_f32_32x32x16_bf16 v[224:239], v[104:107], v[68:71], v[224:239]
    v_add_f32 v55, v55, v57
    v_exp_f32 v58, v190
    v_cvt_pk_bf16_f32 v78, v56, v57
    s_waitcnt lgkmcnt(0)
    v_mfma_f32_32x32x16_bf16 v[240:255], v[108:111], v[68:71], v[240:255]
    v_add_f32 v55, v55, v58
    v_exp_f32 v59, v191
    s_nop 0
    v_add_f32_e64 v55, v55, v59
    v_cvt_pk_bf16_f32 v79, v58, v59
    v_cmp_nge_f32 vcc, s44, v55
    s_cbranch_vccnz rs_91
rb_92:
    v_add_f32 v53, v53, v55
    s_add_u32 s53, s41, 1
    s_and_b32 s53, s53, 3
    s_lshl_b32 s53, s53, 14
    s_add_u32 s52, s53, 0x4000
    s_and_b32 s52, s52, 0xc000
    s_add_u32 s53, s53, 0x10000
    s_waitcnt vmcnt(8)
    s_barrier
    s_add_u32 s41, s41, 1
    v_add_u32 v15, s53, v2
    v_add_u32_e64 v14, s52, v2
    s_bitcmp1_b32 s54, s41
    s_cbranch_scc1 hk_93
hb_94:
    s_add_u32 s10, s41, 3
    s_lshl_b32 s11, s10, 14
    s_and_b32 s10, s11, 0xc000
    s_add_u32 m0, s10, s46
    s_add_u32 s11, s11, s42
    s_min_u32 s11, s11, s56
    buffer_load_dwordx4 v2, s[4:7], s11 offen offset:0 sc1 lds
    buffer_load_dwordx4 v2, s[4:7], s11 offen offset:1024 sc1 lds
    buffer_load_dwordx4 v2, s[4:7], s11 offen offset:2048 sc1 lds
    buffer_load_dwordx4 v2, s[4:7], s11 offen offset:3072 sc1 lds
    s_add_u32 s10, s41, 2
    s_lshl_b32 s11, s10, 14
    s_and_b32 s10, s11, 0xc000
    s_add_u32 m0, s10, s47
    s_add_u32 s11, s11, s43
    s_min_u32 s11, s11, s57
    buffer_load_dwordx4 v2, s[4:7], s11 offen offset:0 sc1 lds
    buffer_load_dwordx4 v2, s[4:7], s11 offen offset:1024 sc1 lds
    buffer_load_dwordx4 v2, s[4:7], s11 offen offset:2048 sc1 lds
    buffer_load_dwordx4 v2, s[4:7], s11 offen offset:3072 sc1 lds
    ds_read_b128 v[80:83], v15 offset:0
    ds_read_b128 v[84:87], v15 offset:1024
    ds_read_b128 v[88:91], v15 offset:2048
    ds_read_b128 v[92:95], v15 offset:3072
    ds_read_b128 v[96:99], v15 offset:4096
    ds_read_b128 v[100:103], v15 offset:5120
    ds_read_b128 v[104:107], v15 offset:6144
    ds_read_b128 v[108:111], v15 offset:7168
    s_waitcnt lgkmcnt(7)
    v_mfma_f32_32x32x16_bf16 v[192:207], v[80:83], v[72:75], v[192:207]
    s_waitcnt lgkmcnt(6)
    v_mfma_f32_32x32x16_bf16 v[208:223], v[84:87], v[72:75], v[208:223]
    s_waitcnt lgkmcnt(5)
    v_mfma_f32_32x32x16_bf16 v[224:239], v[88:91], v[72:75], v[224:239]
    s_waitcnt lgkmcnt(4)
    v_mfma_f32_32x32x16_bf16 v[240:255], v[92:95], v[72:75], v[240:255]
    s_waitcnt lgkmcnt(3)
    v_mfma_f32_32x32x16_bf16 v[192:207], v[96:99], v[76:79], v[192:207]
    s_waitcnt lgkmcnt(2)
    v_mfma_f32_32x32x16_bf16 v[208:223], v[100:103], v[76:79], v[208:223]
    s_waitcnt lgkmcnt(1)
    v_mfma_f32_32x32x16_bf16 v[224:239], v[104:107], v[76:79], v[224:239]
    s_waitcnt lgkmcnt(0)
    v_mfma_f32_32x32x16_bf16 v[240:255], v[108:111], v[76:79], v[240:255]
parallel_sum__compressed_kv_cla__mixer_gmlp__prompt_kernel_at_epiA:
    s_nop 11
    v_mov_b32 v4, v53
    s_nop 1
    v_permlane32_swap_b32 v53, v4
    v_add_f32 v53, v53, v4
    v_rcp_f32 v53, v53
    s_nop 0
    v_mov_b32 v52, v53
    v_bfe_u32 v4, v1, 4, 1
    v_mul_u32_u24 v4, 153600, v4
    v_and_b32 v5, 15, v1
    v_lshrrev_b32 v6, 5, v1
    v_lshl_add_u32 v5, v6, 4, v5
    v_lshl_add_u32 v4, v5, 4, v4
    s_mul_i32 s8, s35, 150
    s_lshl_b32 s9, s32, 2
    s_add_u32 s8, s8, s9
    s_lshl_b32 s8, s8, 10
    s_add_u32 s8, s8, 35651584
    v_pk_mul_f32 v[192:193], v[192:193], v[52:53]
    v_pk_mul_f32 v[194:195], v[194:195], v[52:53]
    v_pk_mul_f32 v[196:197], v[196:197], v[52:53]
    v_pk_mul_f32 v[198:199], v[198:199], v[52:53]
    v_pk_mul_f32 v[200:201], v[200:201], v[52:53]
    v_pk_mul_f32 v[202:203], v[202:203], v[52:53]
    v_pk_mul_f32 v[204:205], v[204:205], v[52:53]
    v_pk_mul_f32 v[206:207], v[206:207], v[52:53]
    v_cvt_pk_bf16_f32 v80, v192, v193
    v_cvt_pk_bf16_f32 v81, v194, v195
    v_cvt_pk_bf16_f32 v82, v200, v201
    v_cvt_pk_bf16_f32 v83, v202, v203
    buffer_store_dwordx4 v[80:83], v4, s[4:7], s8 offen offset:0 sc1
    v_cvt_pk_bf16_f32 v84, v196, v197
    v_cvt_pk_bf16_f32 v85, v198, v199
    v_cvt_pk_bf16_f32 v86, v204, v205
    v_cvt_pk_bf16_f32 v87, v206, v207
    buffer_store_dwordx4 v[84:87], v4, s[4:7], s8 offen offset:512 sc1
    v_pk_mul_f32 v[208:209], v[208:209], v[52:53]
    v_pk_mul_f32 v[210:211], v[210:211], v[52:53]
    v_pk_mul_f32 v[212:213], v[212:213], v[52:53]
    v_pk_mul_f32 v[214:215], v[214:215], v[52:53]
    v_pk_mul_f32 v[216:217], v[216:217], v[52:53]
    v_pk_mul_f32 v[218:219], v[218:219], v[52:53]
    v_pk_mul_f32 v[220:221], v[220:221], v[52:53]
    v_pk_mul_f32 v[222:223], v[222:223], v[52:53]
    v_cvt_pk_bf16_f32 v88, v208, v209
    v_cvt_pk_bf16_f32 v89, v210, v211
    v_cvt_pk_bf16_f32 v90, v216, v217
    v_cvt_pk_bf16_f32 v91, v218, v219
    buffer_store_dwordx4 v[88:91], v4, s[4:7], s8 offen offset:1024 sc1
    v_cvt_pk_bf16_f32 v92, v212, v213
    v_cvt_pk_bf16_f32 v93, v214, v215
    v_cvt_pk_bf16_f32 v94, v220, v221
    v_cvt_pk_bf16_f32 v95, v222, v223
    buffer_store_dwordx4 v[92:95], v4, s[4:7], s8 offen offset:1536 sc1
    v_pk_mul_f32 v[224:225], v[224:225], v[52:53]
    v_pk_mul_f32 v[226:227], v[226:227], v[52:53]
    v_pk_mul_f32 v[228:229], v[228:229], v[52:53]
    v_pk_mul_f32 v[230:231], v[230:231], v[52:53]
    v_pk_mul_f32 v[232:233], v[232:233], v[52:53]
    v_pk_mul_f32 v[234:235], v[234:235], v[52:53]
    v_pk_mul_f32 v[236:237], v[236:237], v[52:53]
    v_pk_mul_f32 v[238:239], v[238:239], v[52:53]
    v_cvt_pk_bf16_f32 v96, v224, v225
    v_cvt_pk_bf16_f32 v97, v226, v227
    v_cvt_pk_bf16_f32 v98, v232, v233
    v_cvt_pk_bf16_f32 v99, v234, v235
    buffer_store_dwordx4 v[96:99], v4, s[4:7], s8 offen offset:2048 sc1
    v_cvt_pk_bf16_f32 v100, v228, v229
    v_cvt_pk_bf16_f32 v101, v230, v231
    v_cvt_pk_bf16_f32 v102, v236, v237
    v_cvt_pk_bf16_f32 v103, v238, v239
    buffer_store_dwordx4 v[100:103], v4, s[4:7], s8 offen offset:2560 sc1
    v_pk_mul_f32 v[240:241], v[240:241], v[52:53]
    v_pk_mul_f32 v[242:243], v[242:243], v[52:53]
    v_pk_mul_f32 v[244:245], v[244:245], v[52:53]
    v_pk_mul_f32 v[246:247], v[246:247], v[52:53]
    v_pk_mul_f32 v[248:249], v[248:249], v[52:53]
    v_pk_mul_f32 v[250:251], v[250:251], v[52:53]
    v_pk_mul_f32 v[252:253], v[252:253], v[52:53]
    v_pk_mul_f32 v[254:255], v[254:255], v[52:53]
    v_cvt_pk_bf16_f32 v104, v240, v241
    v_cvt_pk_bf16_f32 v105, v242, v243
    v_cvt_pk_bf16_f32 v106, v248, v249
    v_cvt_pk_bf16_f32 v107, v250, v251
    buffer_store_dwordx4 v[104:107], v4, s[4:7], s8 offen offset:3072 sc1
    v_cvt_pk_bf16_f32 v108, v244, v245
    v_cvt_pk_bf16_f32 v109, v246, v247
    v_cvt_pk_bf16_f32 v110, v252, v253
    v_cvt_pk_bf16_f32 v111, v254, v255
    buffer_store_dwordx4 v[108:111], v4, s[4:7], s8 offen offset:3584 sc1
    s_sub_u32 s48, s38, 2
parallel_sum__compressed_kv_cla__mixer_gmlp__prompt_kernel_at_ld:
    s_lshr_b32 s8, s33, 1
    s_cmp_eq_u32 s8, 0
    s_cselect_b32 s8, 5, -2
    s_cmp_eq_u32 s41, s8
    s_cbranch_scc1 parallel_sum__compressed_kv_cla__mixer_gmlp__prompt_kernel_at_lnz
    s_cmp_ge_u32 s41, s48
    s_cbranch_scc1 parallel_sum__compressed_kv_cla__mixer_gmlp__prompt_kernel_at_ld2
    s_waitcnt vmcnt(8)
    s_barrier
    s_add_u32 s41, s41, 1
    s_bitcmp1_b32 s54, s41
    s_cbranch_scc1 hk_95
hb_96:
    s_add_u32 s10, s41, 3
    s_lshl_b32 s11, s10, 14
    s_and_b32 s10, s11, 0xc000
    s_add_u32 m0, s10, s46
    s_add_u32 s11, s11, s42
    s_min_u32 s11, s11, s56
    buffer_load_dwordx4 v2, s[4:7], s11 offen offset:0 sc1 lds
    buffer_load_dwordx4 v2, s[4:7], s11 offen offset:1024 sc1 lds
    buffer_load_dwordx4 v2, s[4:7], s11 offen offset:2048 sc1 lds
    buffer_load_dwordx4 v2, s[4:7], s11 offen offset:3072 sc1 lds
    s_add_u32 s10, s41, 2
    s_lshl_b32 s11, s10, 14
    s_and_b32 s10, s11, 0xc000
    s_add_u32 m0, s10, s47
    s_add_u32 s11, s11, s43
    s_min_u32 s11, s11, s57
    buffer_load_dwordx4 v2, s[4:7], s11 offen offset:0 sc1 lds
    buffer_load_dwordx4 v2, s[4:7], s11 offen offset:1024 sc1 lds
    buffer_load_dwordx4 v2, s[4:7], s11 offen offset:2048 sc1 lds
    buffer_load_dwordx4 v2, s[4:7], s11 offen offset:3072 sc1 lds
    s_branch parallel_sum__compressed_kv_cla__mixer_gmlp__prompt_kernel_at_ld
parallel_sum__compressed_kv_cla__mixer_gmlp__prompt_kernel_at_ld2:
    s_waitcnt vmcnt(8)
    s_barrier
    s_waitcnt vmcnt(0)
    s_barrier
    s_branch parallel_sum__compressed_kv_cla__mixer_gmlp__prompt_kernel_at_done
parallel_sum__compressed_kv_cla__mixer_gmlp__prompt_kernel_at_pre:
    s_lshr_b32 s49, s2, 3
    s_lshl_b32 s49, s49, 2
    s_and_b32 s8, s3, 3
    s_add_u32 s49, s49, s8
    s_lshl_b32 s49, s49, 13
    s_and_b32 s50, s2, 7
    s_lshl_b32 s50, s50, 20
    s_add_u32 s50, s50, s49
    s_mov_b32 s8, 88
    s_lshl_b32 s14, s8, 8
    s_add_u32 s14, s14, 117440512
    v_and_b32 v8, 7, v1
    v_lshlrev_b32_e64 v8, 8, v8
    buffer_load_dword v11, v8, s[4:7], s14 offen sc1
    buffer_load_dword v18, v19, s[16:19], s50 offen
    s_waitcnt vmcnt(10)
    s_barrier
    s_add_u32 s41, s41, 1
    s_bitcmp1_b32 s54, s41
    s_cbranch_scc1 hk_97
hb_98:
    s_add_u32 s10, s41, 3
    s_lshl_b32 s11, s10, 14
    s_and_b32 s10, s11, 0xc000
    s_add_u32 m0, s10, s46
    s_add_u32 s11, s11, s42
    s_min_u32 s11, s11, s56
    buffer_load_dwordx4 v2, s[4:7], s11 offen offset:0 sc1 lds
    buffer_load_dwordx4 v2, s[4:7], s11 offen offset:1024 sc1 lds
    buffer_load_dwordx4 v2, s[4:7], s11 offen offset:2048 sc1 lds
    buffer_load_dwordx4 v2, s[4:7], s11 offen offset:3072 sc1 lds
    s_add_u32 s10, s41, 2
    s_lshl_b32 s11, s10, 14
    s_and_b32 s10, s11, 0xc000
    s_add_u32 m0, s10, s47
    s_add_u32 s11, s11, s43
    s_min_u32 s11, s11, s57
    buffer_load_dwordx4 v2, s[4:7], s11 offen offset:0 sc1 lds
    buffer_load_dwordx4 v2, s[4:7], s11 offen offset:1024 sc1 lds
    buffer_load_dwordx4 v2, s[4:7], s11 offen offset:2048 sc1 lds
    buffer_load_dwordx4 v2, s[4:7], s11 offen offset:3072 sc1 lds
    s_add_u32 s8, s50, 786432
    s_cmp_lt_u32 s49, 262144
    s_cselect_b32 s8, s8, 536870912
    buffer_load_dword v18, v19, s[16:19], s8 offen
    s_waitcnt vmcnt(9)
    s_barrier
    s_add_u32 s41, s41, 1
    s_bitcmp1_b32 s54, s41
    s_cbranch_scc1 hk_99
hb_100:
    s_add_u32 s10, s41, 3
    s_lshl_b32 s11, s10, 14
    s_and_b32 s10, s11, 0xc000
    s_add_u32 m0, s10, s46
    s_add_u32 s11, s11, s42
    s_min_u32 s11, s11, s56
    buffer_load_dwordx4 v2, s[4:7], s11 offen offset:0 sc1 lds
    buffer_load_dwordx4 v2, s[4:7], s11 offen offset:1024 sc1 lds
    buffer_load_dwordx4 v2, s[4:7], s11 offen offset:2048 sc1 lds
    buffer_load_dwordx4 v2, s[4:7], s11 offen offset:3072 sc1 lds
    s_add_u32 s10, s41, 2
    s_lshl_b32 s11, s10, 14
    s_and_b32 s10, s11, 0xc000
    s_add_u32 m0, s10, s47
    s_add_u32 s11, s11, s43
    s_min_u32 s11, s11, s57
    buffer_load_dwordx4 v2, s[4:7], s11 offen offset:0 sc1 lds
    buffer_load_dwordx4 v2, s[4:7], s11 offen offset:1024 sc1 lds
    buffer_load_dwordx4 v2, s[4:7], s11 offen offset:2048 sc1 lds
    buffer_load_dwordx4 v2, s[4:7], s11 offen offset:3072 sc1 lds
    s_mov_b32 s8, 88
    s_mov_b32 s15, 0x20000
poll_101:
    v_cmp_gt_u32 vcc, 32, v11
    s_cbranch_vccz polld_102
    s_sleep 2
    s_lshl_b32 s14, s8, 8
    s_add_u32 s14, s14, 117440512
    v_and_b32 v8, 7, v1
    v_lshlrev_b32 v8, 8, v8
    buffer_load_dword v11, v8, s[4:7], s14 offen sc1
    s_waitcnt vmcnt(0)
    s_sub_u32 s15, s15, 1
    s_cmp_lg_u32 s15, 0
    s_cbranch_scc1 poll_101
polld_102:
    s_add_u32 s8, s49, 65011712
    buffer_load_dword v18, v19, s[4:7], s8 offen sc1
    s_waitcnt vmcnt(9)
    s_barrier
    s_add_u32 s41, s41, 1
    s_bitcmp1_b32 s54, s41
    s_cbranch_scc1 hk_103
hb_104:
    s_add_u32 s10, s41, 3
    s_lshl_b32 s11, s10, 14
    s_and_b32 s10, s11, 0xc000
    s_add_u32 m0, s10, s46
    s_add_u32 s11, s11, s42
    s_min_u32 s11, s11, s56
    buffer_load_dwordx4 v2, s[4:7], s11 offen offset:0 sc1 lds
    buffer_load_dwordx4 v2, s[4:7], s11 offen offset:1024 sc1 lds
    buffer_load_dwordx4 v2, s[4:7], s11 offen offset:2048 sc1 lds
    buffer_load_dwordx4 v2, s[4:7], s11 offen offset:3072 sc1 lds
    s_add_u32 s10, s41, 2
    s_lshl_b32 s11, s10, 14
    s_and_b32 s10, s11, 0xc000
    s_add_u32 m0, s10, s47
    s_add_u32 s11, s11, s43
    s_min_u32 s11, s11, s57
    buffer_load_dwordx4 v2, s[4:7], s11 offen offset:0 sc1 lds
    buffer_load_dwordx4 v2, s[4:7], s11 offen offset:1024 sc1 lds
    buffer_load_dwordx4 v2, s[4:7], s11 offen offset:2048 sc1 lds
    buffer_load_dwordx4 v2, s[4:7], s11 offen offset:3072 sc1 lds
    s_add_u32 s8, s49, 65798144
    buffer_load_dword v18, v19, s[4:7], s8 offen sc1
    s_waitcnt vmcnt(9)
    s_barrier
    s_add_u32 s41, s41, 1
    s_bitcmp1_b32 s54, s41
    s_cbranch_scc1 hk_105
hb_106:
    s_add_u32 s10, s41, 3
    s_lshl_b32 s11, s10, 14
    s_and_b32 s10, s11, 0xc000
    s_add_u32 m0, s10, s46
    s_add_u32 s11, s11, s42
    s_min_u32 s11, s11, s56
    buffer_load_dwordx4 v2, s[4:7], s11 offen offset:0 sc1 lds
    buffer_load_dwordx4 v2, s[4:7], s11 offen offset:1024 sc1 lds
    buffer_load_dwordx4 v2, s[4:7], s11 offen offset:2048 sc1 lds
    buffer_load_dwordx4 v2, s[4:7], s11 offen offset:3072 sc1 lds
    s_add_u32 s10, s41, 2
    s_lshl_b32 s11, s10, 14
    s_and_b32 s10, s11, 0xc000
    s_add_u32 m0, s10, s47
    s_add_u32 s11, s11, s43
    s_min_u32 s11, s11, s57
    buffer_load_dwordx4 v2, s[4:7], s11 offen offset:0 sc1 lds
    buffer_load_dwordx4 v2, s[4:7], s11 offen offset:1024 sc1 lds
    buffer_load_dwordx4 v2, s[4:7], s11 offen offset:2048 sc1 lds
    buffer_load_dwordx4 v2, s[4:7], s11 offen offset:3072 sc1 lds
    s_add_u32 s8, s49, 66584576
    buffer_load_dword v18, v19, s[4:7], s8 offen sc1
    s_waitcnt vmcnt(9)
    s_barrier
    s_add_u32 s41, s41, 1
    s_bitcmp1_b32 s54, s41
    s_cbranch_scc1 hk_107
hb_108:
    s_add_u32 s10, s41, 3
    s_lshl_b32 s11, s10, 14
    s_and_b32 s10, s11, 0xc000
    s_add_u32 m0, s10, s46
    s_add_u32 s11, s11, s42
    s_min_u32 s11, s11, s56
    buffer_load_dwordx4 v2, s[4:7], s11 offen offset:0 sc1 lds
    buffer_load_dwordx4 v2, s[4:7], s11 offen offset:1024 sc1 lds
    buffer_load_dwordx4 v2, s[4:7], s11 offen offset:2048 sc1 lds
    buffer_load_dwordx4 v2, s[4:7], s11 offen offset:3072 sc1 lds
    s_add_u32 s10, s41, 2
    s_lshl_b32 s11, s10, 14
    s_and_b32 s10, s11, 0xc000
    s_add_u32 m0, s10, s47
    s_add_u32 s11, s11, s43
    s_min_u32 s11, s11, s57
    buffer_load_dwordx4 v2, s[4:7], s11 offen offset:0 sc1 lds
    buffer_load_dwordx4 v2, s[4:7], s11 offen offset:1024 sc1 lds
    buffer_load_dwordx4 v2, s[4:7], s11 offen offset:2048 sc1 lds
    buffer_load_dwordx4 v2, s[4:7], s11 offen offset:3072 sc1 lds
    s_add_u32 s8, s49, 67371008
    s_cmp_lt_u32 s49, 458752
    s_cselect_b32 s8, s8, 536870912
    buffer_load_dword v18, v19, s[4:7], s8 offen sc1
    s_waitcnt vmcnt(9)
    s_barrier
    s_add_u32 s41, s41, 1
    s_bitcmp1_b32 s54, s41
    s_cbranch_scc1 hk_109
hb_110:
    s_add_u32 s10, s41, 3
    s_lshl_b32 s11, s10, 14
    s_and_b32 s10, s11, 0xc000
    s_add_u32 m0, s10, s46
    s_add_u32 s11, s11, s42
    s_min_u32 s11, s11, s56
    buffer_load_dwordx4 v2, s[4:7], s11 offen offset:0 sc1 lds
    buffer_load_dwordx4 v2, s[4:7], s11 offen offset:1024 sc1 lds
    buffer_load_dwordx4 v2, s[4:7], s11 offen offset:2048 sc1 lds
    buffer_load_dwordx4 v2, s[4:7], s11 offen offset:3072 sc1 lds
    s_add_u32 s10, s41, 2
    s_lshl_b32 s11, s10, 14
    s_and_b32 s10, s11, 0xc000
    s_add_u32 m0, s10, s47
    s_add_u32 s11, s11, s43
    s_min_u32 s11, s11, s57
    buffer_load_dwordx4 v2, s[4:7], s11 offen offset:0 sc1 lds
    buffer_load_dwordx4 v2, s[4:7], s11 offen offset:1024 sc1 lds
    buffer_load_dwordx4 v2, s[4:7], s11 offen offset:2048 sc1 lds
    buffer_load_dwordx4 v2, s[4:7], s11 offen offset:3072 sc1 lds
    s_branch parallel_sum__compressed_kv_cla__mixer_gmlp__prompt_kernel_at_ld2
parallel_sum__compressed_kv_cla__mixer_gmlp__prompt_kernel_at_lnz:
    s_and_b32 s49, s33, 1
    s_lshl_b32 s49, s49, 5
    s_add_u32 s49, s49, s32
    s_lshl_b32 s49, s49, 2
    s_and_b32 s8, s3, 3
    s_add_u32 s49, s49, s8
    s_lshr_b32 s8, s49, 4
    s_sub_u32 s9, 15, s8
    s_min_u32 s8, s8, s9
    s_add_u32 s8, s8, 80
    s_lshl_b32 s14, s8, 8
    s_add_u32 s14, s14, 117440512
    v_and_b32 v8, 0, v1
    v_lshlrev_b32_e64 v8, 8, v8
    buffer_load_dword v11, v8, s[4:7], s14 offen sc1
    s_waitcnt vmcnt(9)
    s_barrier
    s_add_u32 s41, s41, 1
    s_bitcmp1_b32 s54, s41
    s_cbranch_scc1 hk_111
hb_112:
    s_add_u32 s10, s41, 3
    s_lshl_b32 s11, s10, 14
    s_and_b32 s10, s11, 0xc000
    s_add_u32 m0, s10, s46
    s_add_u32 s11, s11, s42
    s_min_u32 s11, s11, s56
    buffer_load_dwordx4 v2, s[4:7], s11 offen offset:0 sc1 lds
    buffer_load_dwordx4 v2, s[4:7], s11 offen offset:1024 sc1 lds
    buffer_load_dwordx4 v2, s[4:7], s11 offen offset:2048 sc1 lds
    buffer_load_dwordx4 v2, s[4:7], s11 offen offset:3072 sc1 lds
    s_add_u32 s10, s41, 2
    s_lshl_b32 s11, s10, 14
    s_and_b32 s10, s11, 0xc000
    s_add_u32 m0, s10, s47
    s_add_u32 s11, s11, s43
    s_min_u32 s11, s11, s57
    buffer_load_dwordx4 v2, s[4:7], s11 offen offset:0 sc1 lds
    buffer_load_dwordx4 v2, s[4:7], s11 offen offset:1024 sc1 lds
    buffer_load_dwordx4 v2, s[4:7], s11 offen offset:2048 sc1 lds
    buffer_load_dwordx4 v2, s[4:7], s11 offen offset:3072 sc1 lds
    s_waitcnt vmcnt(8)
    s_barrier
    s_add_u32 s41, s41, 1
    s_bitcmp1_b32 s54, s41
    s_cbranch_scc1 hk_113
hb_114:
    s_add_u32 s10, s41, 3
    s_lshl_b32 s11, s10, 14
    s_and_b32 s10, s11, 0xc000
    s_add_u32 m0, s10, s46
    s_add_u32 s11, s11, s42
    s_min_u32 s11, s11, s56
    buffer_load_dwordx4 v2, s[4:7], s11 offen offset:0 sc1 lds
    buffer_load_dwordx4 v2, s[4:7], s11 offen offset:1024 sc1 lds
    buffer_load_dwordx4 v2, s[4:7], s11 offen offset:2048 sc1 lds
    buffer_load_dwordx4 v2, s[4:7], s11 offen offset:3072 sc1 lds
    s_add_u32 s10, s41, 2
    s_lshl_b32 s11, s10, 14
    s_and_b32 s10, s11, 0xc000
    s_add_u32 m0, s10, s47
    s_add_u32 s11, s11, s43
    s_min_u32 s11, s11, s57
    buffer_load_dwordx4 v2, s[4:7], s11 offen offset:0 sc1 lds
    buffer_load_dwordx4 v2, s[4:7], s11 offen offset:1024 sc1 lds
    buffer_load_dwordx4 v2, s[4:7], s11 offen offset:2048 sc1 lds
    buffer_load_dwordx4 v2, s[4:7], s11 offen offset:3072 sc1 lds
    s_lshr_b32 s8, s49, 4
    s_sub_u32 s9, 15, s8
    s_min_u32 s8, s8, s9
    s_add_u32 s8, s8, 80
    s_mov_b32 s15, 0x20000
poll_115:
    v_cmp_gt_u32 vcc, 32, v11
    s_cbranch_vccz polld_116
    s_sleep 2
    s_lshl_b32 s14, s8, 8
    s_add_u32 s14, s14, 117440512
    v_and_b32 v8, 0, v1
    v_lshlrev_b32_e64 v8, 8, v8
    buffer_load_dword v11, v8, s[4:7], s14 offen sc1
    s_waitcnt vmcnt(0)
    s_sub_u32 s15, s15, 1
    s_cmp_lg_u32 s15, 0
    s_cbranch_scc1 poll_115
polld_116:
    v_lshrrev_b32 v4, 4, v1
    v_lshlrev_b32 v4, 16, v4
    v_and_b32_e64 v5, 15, v1
    v_lshl_add_u32 v6, v5, 4, v4
    v_mov_b32 v4, 0x20000000
    v_cmp_gt_u32 vcc, 48, v1
    s_nop 1
    v_cndmask_b32 v7, v4, v6, vcc
    s_lshl_b32 s50, s49, 8
    s_add_u32 s51, s50, 60817408
    buffer_load_dwordx4 v[64:67], v6, s[4:7], s51 offen sc1
    s_add_u32 s51, s50, 61079552
    buffer_load_dwordx4 v[68:71], v6, s[4:7], s51 offen sc1
    s_add_u32 s51, s50, 61341696
    buffer_load_dwordx4 v[72:75], v6, s[4:7], s51 offen sc1
    s_add_u32 s51, s50, 61603840
    buffer_load_dwordx4 v[76:79], v6, s[4:7], s51 offen sc1
    s_add_u32 s51, s50, 61865984
    buffer_load_dwordx4 v[80:83], v6, s[4:7], s51 offen sc1
    s_add_u32 s51, s50, 62128128
    buffer_load_dwordx4 v[84:87], v6, s[4:7], s51 offen sc1
    s_add_u32 s51, s50, 62390272
    buffer_load_dwordx4 v[88:91], v6, s[4:7], s51 offen sc1
    s_add_u32 s51, s50, 62652416
    buffer_load_dwordx4 v[92:95], v6, s[4:7], s51 offen sc1
    s_add_u32 s51, s50, 62914560
    buffer_load_dwordx4 v[96:99], v6, s[4:7], s51 offen sc1
    s_add_u32 s51, s50, 63176704
    buffer_load_dwordx4 v[100:103], v6, s[4:7], s51 offen sc1
    s_add_u32 s51, s50, 63438848
    buffer_load_dwordx4 v[104:107], v7, s[4:7], s51 offen sc1
    s_waitcnt vmcnt(19)
    s_barrier
    s_add_u32 s41, s41, 1
    s_bitcmp1_b32 s54, s41
    s_cbranch_scc1 hk_117
hb_118:
    s_add_u32 s10, s41, 3
    s_lshl_b32 s11, s10, 14
    s_and_b32 s10, s11, 0xc000
    s_add_u32 m0, s10, s46
    s_add_u32 s11, s11, s42
    s_min_u32 s11, s11, s56
    buffer_load_dwordx4 v2, s[4:7], s11 offen offset:0 sc1 lds
    buffer_load_dwordx4 v2, s[4:7], s11 offen offset:1024 sc1 lds
    buffer_load_dwordx4 v2, s[4:7], s11 offen offset:2048 sc1 lds
    buffer_load_dwordx4 v2, s[4:7], s11 offen offset:3072 sc1 lds
    s_add_u32 s10, s41, 2
    s_lshl_b32 s11, s10, 14
    s_and_b32 s10, s11, 0xc000
    s_add_u32 m0, s10, s47
    s_add_u32 s11, s11, s43
    s_min_u32 s11, s11, s57
    buffer_load_dwordx4 v2, s[4:7], s11 offen offset:0 sc1 lds
    buffer_load_dwordx4 v2, s[4:7], s11 offen offset:1024 sc1 lds
    buffer_load_dwordx4 v2, s[4:7], s11 offen offset:2048 sc1 lds
    buffer_load_dwordx4 v2, s[4:7], s11 offen offset:3072 sc1 lds
    s_waitcnt vmcnt(8)
    s_barrier
    s_add_u32 s41, s41, 1
    s_bitcmp1_b32 s54, s41
    s_cbranch_scc1 hk_119
hb_120:
    s_add_u32 s10, s41, 3
    s_lshl_b32 s11, s10, 14
    s_and_b32 s10, s11, 0xc000
    s_add_u32 m0, s10, s46
    s_add_u32 s11, s11, s42
    s_min_u32 s11, s11, s56
    buffer_load_dwordx4 v2, s[4:7], s11 offen offset:0 sc1 lds
    buffer_load_dwordx4 v2, s[4:7], s11 offen offset:1024 sc1 lds
    buffer_load_dwordx4 v2, s[4:7], s11 offen offset:2048 sc1 lds
    buffer_load_dwordx4 v2, s[4:7], s11 offen offset:3072 sc1 lds
    s_add_u32 s10, s41, 2
    s_lshl_b32 s11, s10, 14
    s_and_b32 s10, s11, 0xc000
    s_add_u32 m0, s10, s47
    s_add_u32 s11, s11, s43
    s_min_u32 s11, s11, s57
    buffer_load_dwordx4 v2, s[4:7], s11 offen offset:0 sc1 lds
    buffer_load_dwordx4 v2, s[4:7], s11 offen offset:1024 sc1 lds
    buffer_load_dwordx4 v2, s[4:7], s11 offen offset:2048 sc1 lds
    buffer_load_dwordx4 v2, s[4:7], s11 offen offset:3072 sc1 lds
    v_lshlrev_b32_e64 v124, 16, v64
    v_and_b32 v125, 0xffff0000, v64
    v_mov_b32 v108, v124
    v_mov_b32 v109, v125
    v_mul_f32 v116, v124, v124
    v_mul_f32 v117, v125, v125
    v_lshlrev_b32_e64 v124, 16, v65
    v_and_b32 v125, 0xffff0000, v65
    v_mov_b32 v110, v124
    v_mov_b32 v111, v125
    v_mul_f32 v118, v124, v124
    v_mul_f32 v119, v125, v125
    v_lshlrev_b32_e64 v124, 16, v66
    v_and_b32 v125, 0xffff0000, v66
    v_mov_b32 v112, v124
    v_mov_b32 v113, v125
    v_mul_f32 v120, v124, v124
    v_mul_f32 v121, v125, v125
    v_lshlrev_b32_e64 v124, 16, v67
    v_and_b32 v125, 0xffff0000, v67
    v_mov_b32 v114, v124
    v_mov_b32 v115, v125
    v_mul_f32 v122, v124, v124
    v_mul_f32 v123, v125, v125
    v_lshlrev_b32_e64 v124, 16, v68
    v_and_b32 v125, 0xffff0000, v68
    v_add_f32 v108, v108, v124
    v_add_f32 v109, v109, v125
    v_fmac_f32 v116, v124, v124
    v_fmac_f32 v117, v125, v125
    v_lshlrev_b32_e64 v124, 16, v69
    v_and_b32 v125, 0xffff0000, v69
    v_add_f32 v110, v110, v124
    v_add_f32 v111, v111, v125
    v_fmac_f32 v118, v124, v124
    v_fmac_f32 v119, v125, v125
    v_lshlrev_b32_e64 v124, 16, v70
    v_and_b32 v125, 0xffff0000, v70
    v_add_f32 v112, v112, v124
    v_add_f32 v113, v113, v125
    v_fmac_f32 v120, v124, v124
    v_fmac_f32 v121, v125, v125
    v_lshlrev_b32_e64 v124, 16, v71
    v_and_b32 v125, 0xffff0000, v71
    v_add_f32 v114, v114, v124
    v_add_f32 v115, v115, v125
    v_fmac_f32 v122, v124, v124
    v_fmac_f32 v123, v125, v125
    v_lshlrev_b32_e64 v124, 16, v72
    v_and_b32 v125, 0xffff0000, v72
    v_add_f32 v108, v108, v124
    v_add_f32 v109, v109, v125
    v_fmac_f32 v116, v124, v124
    v_fmac_f32 v117, v125, v125
    v_lshlrev_b32_e64 v124, 16, v73
    v_and_b32 v125, 0xffff0000, v73
    v_add_f32 v110, v110, v124
    v_add_f32 v111, v111, v125
    v_fmac_f32 v118, v124, v124
    v_fmac_f32 v119, v125, v125
    v_lshlrev_b32_e64 v124, 16, v74
    v_and_b32 v125, 0xffff0000, v74
    v_add_f32 v112, v112, v124
    v_add_f32 v113, v113, v125
    v_fmac_f32 v120, v124, v124
    v_fmac_f32 v121, v125, v125
    v_lshlrev_b32_e64 v124, 16, v75
    v_and_b32 v125, 0xffff0000, v75
    v_add_f32 v114, v114, v124
    v_add_f32 v115, v115, v125
    v_fmac_f32_e64 v122, v124, v124
    v_fmac_f32 v123, v125, v125
    s_waitcnt vmcnt(8)
    s_barrier
    s_add_u32 s41, s41, 1
    s_bitcmp1_b32 s54, s41
    s_cbranch_scc1 hk_121
hb_122:
    s_add_u32 s10, s41, 3
    s_lshl_b32 s11, s10, 14
    s_and_b32 s10, s11, 0xc000
    s_add_u32 m0, s10, s46
    s_add_u32 s11, s11, s42
    s_min_u32 s11, s11, s56
    buffer_load_dwordx4 v2, s[4:7], s11 offen offset:0 sc1 lds
    buffer_load_dwordx4 v2, s[4:7], s11 offen offset:1024 sc1 lds
    buffer_load_dwordx4 v2, s[4:7], s11 offen offset:2048 sc1 lds
    buffer_load_dwordx4 v2, s[4:7], s11 offen offset:3072 sc1 lds
    s_add_u32 s10, s41, 2
    s_lshl_b32 s11, s10, 14
    s_and_b32 s10, s11, 0xc000
    s_add_u32 m0, s10, s47
    s_add_u32 s11, s11, s43
    s_min_u32 s11, s11, s57
    buffer_load_dwordx4 v2, s[4:7], s11 offen offset:0 sc1 lds
    buffer_load_dwordx4 v2, s[4:7], s11 offen offset:1024 sc1 lds
    buffer_load_dwordx4 v2, s[4:7], s11 offen offset:2048 sc1 lds
    buffer_load_dwordx4 v2, s[4:7], s11 offen offset:3072 sc1 lds
    v_lshlrev_b32_e64 v124, 16, v76
    v_and_b32 v125, 0xffff0000, v76
    v_add_f32 v108, v108, v124
    v_add_f32 v109, v109, v125
    v_fmac_f32 v116, v124, v124
    v_fmac_f32 v117, v125, v125
    v_lshlrev_b32_e64 v124, 16, v77
    v_and_b32 v125, 0xffff0000, v77
    v_add_f32 v110, v110, v124
    v_add_f32 v111, v111, v125
    v_fmac_f32 v118, v124, v124
    v_fmac_f32 v119, v125, v125
    v_lshlrev_b32_e64 v124, 16, v78
    v_and_b32 v125, 0xffff0000, v78
    v_add_f32 v112, v112, v124
    v_add_f32 v113, v113, v125
    v_fmac_f32 v120, v124, v124
    v_fmac_f32 v121, v125, v125
    v_lshlrev_b32_e64 v124, 16, v79
    v_and_b32 v125, 0xffff0000, v79
    v_add_f32 v114, v114, v124
    v_add_f32 v115, v115, v125
    v_fmac_f32 v122, v124, v124
    v_fmac_f32 v123, v125, v125
    v_lshlrev_b32_e64 v124, 16, v80
    v_and_b32 v125, 0xffff0000, v80
    v_add_f32 v108, v108, v124
    v_add_f32 v109, v109, v125
    v_fmac_f32 v116, v124, v124
    v_fmac_f32 v117, v125, v125
    v_lshlrev_b32_e64 v124, 16, v81
    v_and_b32 v125, 0xffff0000, v81
    v_add_f32 v110, v110, v124
    v_add_f32 v111, v111, v125
    v_fmac_f32 v118, v124, v124
    v_fmac_f32 v119, v125, v125
    v_lshlrev_b32_e64 v124, 16, v82
    v_and_b32 v125, 0xffff0000, v82
    v_add_f32 v112, v112, v124
    v_add_f32 v113, v113, v125
    v_fmac_f32 v120, v124, v124
    v_fmac_f32 v121, v125, v125
    v_lshlrev_b32_e64 v124, 16, v83
    v_and_b32 v125, 0xffff0000, v83
    v_add_f32 v114, v114, v124
    v_add_f32 v115, v115, v125
    v_fmac_f32 v122, v124, v124
    v_fmac_f32 v123, v125, v125
    v_lshlrev_b32_e64 v124, 16, v84
    v_and_b32 v125, 0xffff0000, v84
    v_add_f32 v108, v108, v124
    v_add_f32 v109, v109, v125
    v_fmac_f32 v116, v124, v124
    v_fmac_f32 v117, v125, v125
    v_lshlrev_b32_e64 v124, 16, v85
    v_and_b32 v125, 0xffff0000, v85
    v_add_f32 v110, v110, v124
    v_add_f32 v111, v111, v125
    v_fmac_f32 v118, v124, v124
    v_fmac_f32 v119, v125, v125
    v_lshlrev_b32_e64 v124, 16, v86
    v_and_b32 v125, 0xffff0000, v86
    v_add_f32 v112, v112, v124
    v_add_f32 v113, v113, v125
    v_fmac_f32 v120, v124, v124
    v_fmac_f32 v121, v125, v125
    v_lshlrev_b32_e64 v124, 16, v87
    v_and_b32 v125, 0xffff0000, v87
    v_add_f32 v114, v114, v124
    v_add_f32 v115, v115, v125
    v_fmac_f32_e64 v122, v124, v124
    v_fmac_f32 v123, v125, v125
    s_waitcnt vmcnt(8)
    s_barrier
    s_add_u32 s41, s41, 1
    s_bitcmp1_b32 s54, s41
    s_cbranch_scc1 hk_123
hb_124:
    s_add_u32 s10, s41, 3
    s_lshl_b32 s11, s10, 14
    s_and_b32 s10, s11, 0xc000
    s_add_u32 m0, s10, s46
    s_add_u32 s11, s11, s42
    s_min_u32 s11, s11, s56
    buffer_load_dwordx4 v2, s[4:7], s11 offen offset:0 sc1 lds
    buffer_load_dwordx4 v2, s[4:7], s11 offen offset:1024 sc1 lds
    buffer_load_dwordx4 v2, s[4:7], s11 offen offset:2048 sc1 lds
    buffer_load_dwordx4 v2, s[4:7], s11 offen offset:3072 sc1 lds
    s_add_u32 s10, s41, 2
    s_lshl_b32 s11, s10, 14
    s_and_b32 s10, s11, 0xc000
    s_add_u32 m0, s10, s47
    s_add_u32 s11, s11, s43
    s_min_u32 s11, s11, s57
    buffer_load_dwordx4 v2, s[4:7], s11 offen offset:0 sc1 lds
    buffer_load_dwordx4 v2, s[4:7], s11 offen offset:1024 sc1 lds
    buffer_load_dwordx4 v2, s[4:7], s11 offen offset:2048 sc1 lds
    buffer_load_dwordx4 v2, s[4:7], s11 offen offset:3072 sc1 lds
    v_lshlrev_b32_e64 v124, 16, v88
    v_and_b32 v125, 0xffff0000, v88
    v_add_f32 v108, v108, v124
    v_add_f32 v109, v109, v125
    v_fmac_f32 v116, v124, v124
    v_fmac_f32 v117, v125, v125
    v_lshlrev_b32_e64 v124, 16, v89
    v_and_b32 v125, 0xffff0000, v89
    v_add_f32 v110, v110, v124
    v_add_f32 v111, v111, v125
    v_fmac_f32 v118, v124, v124
    v_fmac_f32 v119, v125, v125
    v_lshlrev_b32_e64 v124, 16, v90
    v_and_b32 v125, 0xffff0000, v90
    v_add_f32 v112, v112, v124
    v_add_f32 v113, v113, v125
    v_fmac_f32 v120, v124, v124
    v_fmac_f32 v121, v125, v125
    v_lshlrev_b32_e64 v124, 16, v91
    v_and_b32 v125, 0xffff0000, v91
    v_add_f32 v114, v114, v124
    v_add_f32 v115, v115, v125
    v_fmac_f32 v122, v124, v124
    v_fmac_f32 v123, v125, v125
    v_lshlrev_b32_e64 v124, 16, v92
    v_and_b32 v125, 0xffff0000, v92
    v_add_f32 v108, v108, v124
    v_add_f32 v109, v109, v125
    v_fmac_f32 v116, v124, v124
    v_fmac_f32 v117, v125, v125
    v_lshlrev_b32_e64 v124, 16, v93
    v_and_b32 v125, 0xffff0000, v93
    v_add_f32 v110, v110, v124
    v_add_f32 v111, v111, v125
    v_fmac_f32 v118, v124, v124
    v_fmac_f32 v119, v125, v125
    v_lshlrev_b32_e64 v124, 16, v94
    v_and_b32 v125, 0xffff0000, v94
    v_add_f32 v112, v112, v124
    v_add_f32 v113, v113, v125
    v_fmac_f32 v120, v124, v124
    v_fmac_f32 v121, v125, v125
    v_lshlrev_b32_e64 v124, 16, v95
    v_and_b32 v125, 0xffff0000, v95
    v_add_f32 v114, v114, v124
    v_add_f32 v115, v115, v125
    v_fmac_f32 v122, v124, v124
    v_fmac_f32 v123, v125, v125
    v_lshlrev_b32_e64 v124, 16, v96
    v_and_b32 v125, 0xffff0000, v96
    v_add_f32 v108, v108, v124
    v_add_f32 v109, v109, v125
    v_fmac_f32 v116, v124, v124
    v_fmac_f32 v117, v125, v125
    v_lshlrev_b32_e64 v124, 16, v97
    v_and_b32 v125, 0xffff0000, v97
    v_add_f32 v110, v110, v124
    v_add_f32 v111, v111, v125
    v_fmac_f32 v118, v124, v124
    v_fmac_f32 v119, v125, v125
    v_lshlrev_b32_e64 v124, 16, v98
    v_and_b32 v125, 0xffff0000, v98
    v_add_f32 v112, v112, v124
    v_add_f32 v113, v113, v125
    v_fmac_f32 v120, v124, v124
    v_fmac_f32 v121, v125, v125
    v_lshlrev_b32_e64 v124, 16, v99
    v_and_b32 v125, 0xffff0000, v99
    v_add_f32 v114, v114, v124
    v_add_f32 v115, v115, v125
    v_fmac_f32_e64 v122, v124, v124
    v_fmac_f32 v123, v125, v125
    s_waitcnt vmcnt(8)
    s_barrier
    s_add_u32 s41, s41, 1
    s_bitcmp1_b32 s54, s41
    s_cbranch_scc1 hk_125
hb_126:
    s_add_u32 s10, s41, 3
    s_lshl_b32 s11, s10, 14
    s_and_b32 s10, s11, 0xc000
    s_add_u32 m0, s10, s46
    s_add_u32 s11, s11, s42
    s_min_u32 s11, s11, s56
    buffer_load_dwordx4 v2, s[4:7], s11 offen offset:0 sc1 lds
    buffer_load_dwordx4 v2, s[4:7], s11 offen offset:1024 sc1 lds
    buffer_load_dwordx4 v2, s[4:7], s11 offen offset:2048 sc1 lds
    buffer_load_dwordx4 v2, s[4:7], s11 offen offset:3072 sc1 lds
    s_add_u32 s10, s41, 2
    s_lshl_b32 s11, s10, 14
    s_and_b32 s10, s11, 0xc000
    s_add_u32 m0, s10, s47
    s_add_u32 s11, s11, s43
    s_min_u32 s11, s11, s57
    buffer_load_dwordx4 v2, s[4:7], s11 offen offset:0 sc1 lds
    buffer_load_dwordx4 v2, s[4:7], s11 offen offset:1024 sc1 lds
    buffer_load_dwordx4 v2, s[4:7], s11 offen offset:2048 sc1 lds
    buffer_load_dwordx4 v2, s[4:7], s11 offen offset:3072 sc1 lds
    v_lshlrev_b32_e64 v124, 16, v100
    v_and_b32 v125, 0xffff0000, v100
    v_add_f32 v108, v108, v124
    v_add_f32 v109, v109, v125
    v_fmac_f32 v116, v124, v124
    v_fmac_f32 v117, v125, v125
    v_lshlrev_b32_e64 v124, 16, v101
    v_and_b32 v125, 0xffff0000, v101
    v_add_f32 v110, v110, v124
    v_add_f32 v111, v111, v125
    v_fmac_f32 v118, v124, v124
    v_fmac_f32 v119, v125, v125
    v_lshlrev_b32_e64 v124, 16, v102
    v_and_b32 v125, 0xffff0000, v102
    v_add_f32 v112, v112, v124
    v_add_f32 v113, v113, v125
    v_fmac_f32 v120, v124, v124
    v_fmac_f32 v121, v125, v125
    v_lshlrev_b32_e64 v124, 16, v103
    v_and_b32 v125, 0xffff0000, v103
    v_add_f32 v114, v114, v124
    v_add_f32 v115, v115, v125
    v_fmac_f32 v122, v124, v124
    v_fmac_f32 v123, v125, v125
    v_lshlrev_b32_e64 v124, 16, v104
    v_and_b32 v125, 0xffff0000, v104
    v_add_f32 v108, v108, v124
    v_add_f32 v109, v109, v125
    v_fmac_f32 v116, v124, v124
    v_fmac_f32 v117, v125, v125
    v_lshlrev_b32_e64 v124, 16, v105
    v_and_b32 v125, 0xffff0000, v105
    v_add_f32 v110, v110, v124
    v_add_f32 v111, v111, v125
    v_fmac_f32 v118, v124, v124
    v_fmac_f32 v119, v125, v125
    v_lshlrev_b32_e64 v124, 16, v106
    v_and_b32 v125, 0xffff0000, v106
    v_add_f32 v112, v112, v124
    v_add_f32 v113, v113, v125
    v_fmac_f32 v120, v124, v124
    v_fmac_f32 v121, v125, v125
    v_lshlrev_b32_e64 v124, 16, v107
    v_and_b32 v125, 0xffff0000, v107
    v_add_f32 v114, v114, v124
    v_add_f32 v115, v115, v125
    v_fmac_f32_e64 v122, v124, v124
    v_fmac_f32 v123, v125, v125
    s_waitcnt vmcnt(8)
    s_barrier
    s_add_u32 s41, s41, 1
    s_bitcmp1_b32 s54, s41
    s_cbranch_scc1 hk_127
hb_128:
    s_add_u32 s10, s41, 3
    s_lshl_b32 s11, s10, 14
    s_and_b32 s10, s11, 0xc000
    s_add_u32 m0, s10, s46
    s_add_u32 s11, s11, s42
    s_min_u32 s11, s11, s56
    buffer_load_dwordx4 v2, s[4:7], s11 offen offset:0 sc1 lds
    buffer_load_dwordx4 v2, s[4:7], s11 offen offset:1024 sc1 lds
    buffer_load_dwordx4 v2, s[4:7], s11 offen offset:2048 sc1 lds
    buffer_load_dwordx4 v2, s[4:7], s11 offen offset:3072 sc1 lds
    s_add_u32 s10, s41, 2
    s_lshl_b32 s11, s10, 14
    s_and_b32 s10, s11, 0xc000
    s_add_u32 m0, s10, s47
    s_add_u32 s11, s11, s43
    s_min_u32 s11, s11, s57
    buffer_load_dwordx4 v2, s[4:7], s11 offen offset:0 sc1 lds
    buffer_load_dwordx4 v2, s[4:7], s11 offen offset:1024 sc1 lds
    buffer_load_dwordx4 v2, s[4:7], s11 offen offset:2048 sc1 lds
    buffer_load_dwordx4 v2, s[4:7], s11 offen offset:3072 sc1 lds
    v_add_f32 v108, v108, v108 quad_perm:[1,0,3,2] row_mask:0xf bank_mask:0xf
    v_add_f32 v109, v109, v109 quad_perm:[1,0,3,2] row_mask:0xf bank_mask:0xf
    v_add_f32 v110, v110, v110 quad_perm:[1,0,3,2] row_mask:0xf bank_mask:0xf
    v_add_f32 v111, v111, v111 quad_perm:[1,0,3,2] row_mask:0xf bank_mask:0xf
    v_add_f32 v112, v112, v112 quad_perm:[1,0,3,2] row_mask:0xf bank_mask:0xf
    v_add_f32 v113, v113, v113 quad_perm:[1,0,3,2] row_mask:0xf bank_mask:0xf
    v_add_f32 v114, v114, v114 quad_perm:[1,0,3,2] row_mask:0xf bank_mask:0xf
    v_add_f32 v115, v115, v115 quad_perm:[1,0,3,2] row_mask:0xf bank_mask:0xf
    v_add_f32 v116, v116, v116 quad_perm:[1,0,3,2] row_mask:0xf bank_mask:0xf
    v_add_f32 v117, v117, v117 quad_perm:[1,0,3,2] row_mask:0xf bank_mask:0xf
    v_add_f32 v118, v118, v118 quad_perm:[1,0,3,2] row_mask:0xf bank_mask:0xf
    v_add_f32 v119, v119, v119 quad_perm:[1,0,3,2] row_mask:0xf bank_mask:0xf
    v_add_f32 v120, v120, v120 quad_perm:[1,0,3,2] row_mask:0xf bank_mask:0xf
    v_add_f32 v121, v121, v121 quad_perm:[1,0,3,2] row_mask:0xf bank_mask:0xf
    v_add_f32 v122, v122, v122 quad_perm:[1,0,3,2] row_mask:0xf bank_mask:0xf
    v_add_f32 v123, v123, v123 quad_perm:[1,0,3,2] row_mask:0xf bank_mask:0xf
    v_add_f32 v108, v108, v108 quad_perm:[2,3,0,1] row_mask:0xf bank_mask:0xf
    v_add_f32 v109, v109, v109 quad_perm:[2,3,0,1] row_mask:0xf bank_mask:0xf
    v_add_f32 v110, v110, v110 quad_perm:[2,3,0,1] row_mask:0xf bank_mask:0xf
    v_add_f32 v111, v111, v111 quad_perm:[2,3,0,1] row_mask:0xf bank_mask:0xf
    v_add_f32 v112, v112, v112 quad_perm:[2,3,0,1] row_mask:0xf bank_mask:0xf
    v_add_f32 v113, v113, v113 quad_perm:[2,3,0,1] row_mask:0xf bank_mask:0xf
    v_add_f32 v114, v114, v114 quad_perm:[2,3,0,1] row_mask:0xf bank_mask:0xf
    v_add_f32 v115, v115, v115 quad_perm:[2,3,0,1] row_mask:0xf bank_mask:0xf
    v_add_f32 v116, v116, v116 quad_perm:[2,3,0,1] row_mask:0xf bank_mask:0xf
    v_add_f32 v117, v117, v117 quad_perm:[2,3,0,1] row_mask:0xf bank_mask:0xf
    v_add_f32 v118, v118, v118 quad_perm:[2,3,0,1] row_mask:0xf bank_mask:0xf
    v_add_f32 v119, v119, v119 quad_perm:[2,3,0,1] row_mask:0xf bank_mask:0xf
    v_add_f32 v120, v120, v120 quad_perm:[2,3,0,1] row_mask:0xf bank_mask:0xf
    v_add_f32 v121, v121, v121 quad_perm:[2,3,0,1] row_mask:0xf bank_mask:0xf
    v_add_f32 v122, v122, v122 quad_perm:[2,3,0,1] row_mask:0xf bank_mask:0xf
    v_add_f32 v123, v123, v123 quad_perm:[2,3,0,1] row_mask:0xf bank_mask:0xf
    v_add_f32 v108, v108, v108 row_half_mirror row_mask:0xf bank_mask:0xf
    v_add_f32 v109, v109, v109 row_half_mirror row_mask:0xf bank_mask:0xf
    v_add_f32 v110, v110, v110 row_half_mirror row_mask:0xf bank_mask:0xf
    v_add_f32 v111, v111, v111 row_half_mirror row_mask:0xf bank_mask:0xf
    v_add_f32 v112, v112, v112 row_half_mirror row_mask:0xf bank_mask:0xf
    v_add_f32 v113, v113, v113 row_half_mirror row_mask:0xf bank_mask:0xf
    v_add_f32 v114, v114, v114 row_half_mirror row_mask:0xf bank_mask:0xf
    v_add_f32 v115, v115, v115 row_half_mirror row_mask:0xf bank_mask:0xf
    v_add_f32 v116, v116, v116 row_half_mirror row_mask:0xf bank_mask:0xf
    v_add_f32 v117, v117, v117 row_half_mirror row_mask:0xf bank_mask:0xf
    v_add_f32 v118, v118, v118 row_half_mirror row_mask:0xf bank_mask:0xf
    v_add_f32 v119, v119, v119 row_half_mirror row_mask:0xf bank_mask:0xf
    v_add_f32 v120, v120, v120 row_half_mirror row_mask:0xf bank_mask:0xf
    v_add_f32 v121, v121, v121 row_half_mirror row_mask:0xf bank_mask:0xf
    v_add_f32 v122, v122, v122 row_half_mirror row_mask:0xf bank_mask:0xf
    v_add_f32 v123, v123, v123 row_half_mirror row_mask:0xf bank_mask:0xf
    v_add_f32 v108, v108, v108 row_mirror row_mask:0xf bank_mask:0xf
    v_add_f32 v109, v109, v109 row_mirror row_mask:0xf bank_mask:0xf
    v_add_f32 v110, v110, v110 row_mirror row_mask:0xf bank_mask:0xf
    v_add_f32 v111, v111, v111 row_mirror row_mask:0xf bank_mask:0xf
    v_add_f32 v112, v112, v112 row_mirror row_mask:0xf bank_mask:0xf
    v_add_f32 v113, v113, v113 row_mirror row_mask:0xf bank_mask:0xf
    v_add_f32 v114, v114, v114 row_mirror row_mask:0xf bank_mask:0xf
    v_add_f32 v115, v115, v115 row_mirror row_mask:0xf bank_mask:0xf
    v_add_f32 v116, v116, v116 row_mirror row_mask:0xf bank_mask:0xf
    v_add_f32 v117, v117, v117 row_mirror row_mask:0xf bank_mask:0xf
    v_add_f32 v118, v118, v118 row_mirror row_mask:0xf bank_mask:0xf
    v_add_f32 v119, v119, v119 row_mirror row_mask:0xf bank_mask:0xf
    v_add_f32 v120, v120, v120 row_mirror row_mask:0xf bank_mask:0xf
    v_add_f32 v121, v121, v121 row_mirror row_mask:0xf bank_mask:0xf
    v_add_f32 v122, v122, v122 row_mirror row_mask:0xf bank_mask:0xf
    v_add_f32 v123, v123, v123 row_mirror row_mask:0xf bank_mask:0xf
    s_waitcnt vmcnt(8)
    s_barrier
    s_add_u32 s41, s41, 1
    s_bitcmp1_b32 s54, s41
    s_cbranch_scc1 hk_129
hb_130:
    s_add_u32 s10, s41, 3
    s_lshl_b32 s11, s10, 14
    s_and_b32 s10, s11, 0xc000
    s_add_u32 m0, s10, s46
    s_add_u32 s11, s11, s42
    s_min_u32 s11, s11, s56
    buffer_load_dwordx4 v2, s[4:7], s11 offen offset:0 sc1 lds
    buffer_load_dwordx4 v2, s[4:7], s11 offen offset:1024 sc1 lds
    buffer_load_dwordx4 v2, s[4:7], s11 offen offset:2048 sc1 lds
    buffer_load_dwordx4 v2, s[4:7], s11 offen offset:3072 sc1 lds
    s_add_u32 s10, s41, 2
    s_lshl_b32 s11, s10, 14
    s_and_b32 s10, s11, 0xc000
    s_add_u32 m0, s10, s47
    s_add_u32 s11, s11, s43
    s_min_u32 s11, s11, s57
    buffer_load_dwordx4 v2, s[4:7], s11 offen offset:0 sc1 lds
    buffer_load_dwordx4 v2, s[4:7], s11 offen offset:1024 sc1 lds
    buffer_load_dwordx4 v2, s[4:7], s11 offen offset:2048 sc1 lds
    buffer_load_dwordx4 v2, s[4:7], s11 offen offset:3072 sc1 lds
    v_mov_b32 v126, v108
    v_mov_b32 v127, v109
    v_mov_b32 v128, v110
    v_mov_b32 v129, v111
    v_permlane16_swap_b32 v108, v126
    v_permlane16_swap_b32 v109, v127
    v_permlane16_swap_b32 v110, v128
    v_permlane16_swap_b32 v111, v129
    v_add_f32 v108, v108, v126
    v_add_f32 v109, v109, v127
    v_add_f32 v110, v110, v128
    v_add_f32 v111, v111, v129
    v_mov_b32 v126, v112
    v_mov_b32 v127, v113
    v_mov_b32 v128, v114
    v_mov_b32 v129, v115
    v_permlane16_swap_b32 v112, v126
    v_permlane16_swap_b32 v113, v127
    v_permlane16_swap_b32 v114, v128
    v_permlane16_swap_b32 v115, v129
    v_add_f32 v112, v112, v126
    v_add_f32 v113, v113, v127
    v_add_f32 v114, v114, v128
    v_add_f32 v115, v115, v129
    v_mov_b32 v126, v116
    v_mov_b32 v127, v117
    v_mov_b32 v128, v118
    v_mov_b32 v129, v119
    v_permlane16_swap_b32 v116, v126
    v_permlane16_swap_b32 v117, v127
    v_permlane16_swap_b32 v118, v128
    v_permlane16_swap_b32 v119, v129
    v_add_f32 v116, v116, v126
    v_add_f32 v117, v117, v127
    v_add_f32 v118, v118, v128
    v_add_f32 v119, v119, v129
    v_mov_b32 v126, v120
    v_mov_b32 v127, v121
    v_mov_b32 v128, v122
    v_mov_b32 v129, v123
    v_permlane16_swap_b32 v120, v126
    v_permlane16_swap_b32 v121, v127
    v_permlane16_swap_b32 v122, v128
    v_permlane16_swap_b32 v123, v129
    v_add_f32 v120, v120, v126
    v_add_f32 v121, v121, v127
    v_add_f32 v122, v122, v128
    v_add_f32 v123, v123, v129
    v_mov_b32 v126, v108
    v_mov_b32 v127, v109
    v_mov_b32 v128, v110
    v_mov_b32 v129, v111
    v_permlane32_swap_b32 v108, v126
    v_permlane32_swap_b32 v109, v127
    v_permlane32_swap_b32 v110, v128
    v_permlane32_swap_b32 v111, v129
    v_add_f32 v108, v108, v126
    v_add_f32 v109, v109, v127
    v_add_f32 v110, v110, v128
    v_add_f32 v111, v111, v129
    v_mov_b32 v126, v112
    v_mov_b32 v127, v113
    v_mov_b32 v128, v114
    v_mov_b32 v129, v115
    v_permlane32_swap_b32 v112, v126
    v_permlane32_swap_b32 v113, v127
    v_permlane32_swap_b32 v114, v128
    v_permlane32_swap_b32 v115, v129
    v_add_f32 v112, v112, v126
    v_add_f32 v113, v113, v127
    v_add_f32 v114, v114, v128
    v_add_f32 v115, v115, v129
    v_mov_b32 v126, v116
    v_mov_b32 v127, v117
    v_mov_b32 v128, v118
    v_mov_b32 v129, v119
    v_permlane32_swap_b32 v116, v126
    v_permlane32_swap_b32 v117, v127
    v_permlane32_swap_b32 v118, v128
    v_permlane32_swap_b32 v119, v129
    v_add_f32 v116, v116, v126
    v_add_f32 v117, v117, v127
    v_add_f32 v118, v118, v128
    v_add_f32 v119, v119, v129
    v_mov_b32 v126, v120
    v_mov_b32 v127, v121
    v_mov_b32 v128, v122
    v_mov_b32 v129, v123
    v_permlane32_swap_b32 v120, v126
    v_permlane32_swap_b32 v121, v127
    v_permlane32_swap_b32 v122, v128
    v_permlane32_swap_b32 v123, v129
    v_add_f32 v120, v120, v126
    v_add_f32 v121, v121, v127
    v_add_f32 v122, v122, v128
    v_add_f32 v123, v123, v129
    s_waitcnt vmcnt(8)
    s_barrier
    s_add_u32 s41, s41, 1
    s_bitcmp1_b32 s54, s41
    s_cbranch_scc1 hk_131
hb_132:
    s_add_u32 s10, s41, 3
    s_lshl_b32 s11, s10, 14
    s_and_b32 s10, s11, 0xc000
    s_add_u32 m0, s10, s46
    s_add_u32 s11, s11, s42
    s_min_u32 s11, s11, s56
    buffer_load_dwordx4 v2, s[4:7], s11 offen offset:0 sc1 lds
    buffer_load_dwordx4 v2, s[4:7], s11 offen offset:1024 sc1 lds
    buffer_load_dwordx4 v2, s[4:7], s11 offen offset:2048 sc1 lds
    buffer_load_dwordx4 v2, s[4:7], s11 offen offset:3072 sc1 lds
    s_add_u32 s10, s41, 2
    s_lshl_b32 s11, s10, 14
    s_and_b32 s10, s11, 0xc000
    s_add_u32 m0, s10, s47
    s_add_u32 s11, s11, s43
    s_min_u32 s11, s11, s57
    buffer_load_dwordx4 v2, s[4:7], s11 offen offset:0 sc1 lds
    buffer_load_dwordx4 v2, s[4:7], s11 offen offset:1024 sc1 lds
    buffer_load_dwordx4 v2, s[4:7], s11 offen offset:2048 sc1 lds
    buffer_load_dwordx4 v2, s[4:7], s11 offen offset:3072 sc1 lds
    s_mov_b32 s51, 0x3abe82fa
    v_mul_f32 v108, s51, v108
    v_mul_f32 v116, s51, v116
    v_fma_f32 v116, -v108, v108, v116
    v_max_f32_e64 v116, 0, v116
    v_add_f32 v116, 0x3727c5ac, v116
    v_rsq_f32 v116, v116
    v_mul_f32 v109, s51, v109
    v_mul_f32_e64 v117, s51, v117
    v_fma_f32 v117, -v109, v109, v117
    v_max_f32_e64 v117, 0, v117
    v_add_f32 v117, 0x3727c5ac, v117
    v_rsq_f32 v117, v117
    v_mul_f32 v110, s51, v110
    v_mul_f32_e64 v118, s51, v118
    v_fma_f32 v118, -v110, v110, v118
    v_max_f32_e64 v118, 0, v118
    v_add_f32 v118, 0x3727c5ac, v118
    v_rsq_f32 v118, v118
    v_mul_f32 v111, s51, v111
    v_mul_f32_e64 v119, s51, v119
    v_fma_f32 v119, -v111, v111, v119
    v_max_f32_e64 v119, 0, v119
    v_add_f32 v119, 0x3727c5ac, v119
    v_rsq_f32 v119, v119
    v_mul_f32 v112, s51, v112
    v_mul_f32_e64 v120, s51, v120
    v_fma_f32 v120, -v112, v112, v120
    v_max_f32_e64 v120, 0, v120
    v_add_f32 v120, 0x3727c5ac, v120
    v_rsq_f32 v120, v120
    v_mul_f32 v113, s51, v113
    v_mul_f32_e64 v121, s51, v121
    v_fma_f32 v121, -v113, v113, v121
    v_max_f32_e64 v121, 0, v121
    v_add_f32 v121, 0x3727c5ac, v121
    v_rsq_f32 v121, v121
    v_mul_f32 v114, s51, v114
    v_mul_f32_e64 v122, s51, v122
    v_fma_f32 v122, -v114, v114, v122
    v_max_f32_e64 v122, 0, v122
    v_add_f32 v122, 0x3727c5ac, v122
    v_rsq_f32 v122, v122
    v_mul_f32 v115, s51, v115
    v_mul_f32_e64 v123, s51, v123
    v_fma_f32 v123, -v115, v115, v123
    v_max_f32_e64 v123, 0, v123
    v_add_f32 v123, 0x3727c5ac, v123
    v_rsq_f32 v123, v123
    v_mul_f32 v108, v108, v116
    v_mul_f32 v109, v109, v117
    v_mul_f32 v110, v110, v118
    v_mul_f32 v111, v111, v119
    v_mul_f32 v112, v112, v120
    v_mul_f32 v113, v113, v121
    v_mul_f32 v114, v114, v122
    v_mul_f32 v115, v115, v123
    s_waitcnt vmcnt(8)
    s_barrier
    s_add_u32 s41, s41, 1
    s_bitcmp1_b32 s54, s41
    s_cbranch_scc1 hk_133
hb_134:
    s_add_u32 s10, s41, 3
    s_lshl_b32 s11, s10, 14
    s_and_b32 s10, s11, 0xc000
    s_add_u32 m0, s10, s46
    s_add_u32 s11, s11, s42
    s_min_u32 s11, s11, s56
    buffer_load_dwordx4 v2, s[4:7], s11 offen offset:0 sc1 lds
    buffer_load_dwordx4 v2, s[4:7], s11 offen offset:1024 sc1 lds
    buffer_load_dwordx4 v2, s[4:7], s11 offen offset:2048 sc1 lds
    buffer_load_dwordx4 v2, s[4:7], s11 offen offset:3072 sc1 lds
    s_add_u32 s10, s41, 2
    s_lshl_b32 s11, s10, 14
    s_and_b32 s10, s11, 0xc000
    s_add_u32 m0, s10, s47
    s_add_u32 s11, s11, s43
    s_min_u32 s11, s11, s57
    buffer_load_dwordx4 v2, s[4:7], s11 offen offset:0 sc1 lds
    buffer_load_dwordx4 v2, s[4:7], s11 offen offset:1024 sc1 lds
    buffer_load_dwordx4 v2, s[4:7], s11 offen offset:2048 sc1 lds
    buffer_load_dwordx4 v2, s[4:7], s11 offen offset:3072 sc1 lds
    v_lshlrev_b32_e64 v124, 16, v64
    v_and_b32 v125, 0xffff0000, v64
    v_fma_f32 v124, v124, v116, -v108
    v_fma_f32 v125, v125, v117, -v109
    v_cvt_pk_bf16_f32 v64, v124, v125
    v_lshlrev_b32_e64 v124, 16, v65
    v_and_b32 v125, 0xffff0000, v65
    v_fma_f32 v124, v124, v118, -v110
    v_fma_f32 v125, v125, v119, -v111
    v_cvt_pk_bf16_f32 v65, v124, v125
    v_lshlrev_b32_e64 v124, 16, v66
    v_and_b32 v125, 0xffff0000, v66
    v_fma_f32 v124, v124, v120, -v112
    v_fma_f32 v125, v125, v121, -v113
    v_cvt_pk_bf16_f32 v66, v124, v125
    v_lshlrev_b32_e64 v124, 16, v67
    v_and_b32 v125, 0xffff0000, v67
    v_fma_f32 v124, v124, v122, -v114
    v_fma_f32 v125, v125, v123, -v115
    v_cvt_pk_bf16_f32 v67, v124, v125
    s_add_u32 s51, s50, 65011712
    buffer_store_dwordx4 v[64:67], v6, s[4:7], s51 offen sc1
    v_lshlrev_b32_e64 v124, 16, v68
    v_and_b32 v125, 0xffff0000, v68
    v_fma_f32 v124, v124, v116, -v108
    v_fma_f32 v125, v125, v117, -v109
    v_cvt_pk_bf16_f32 v68, v124, v125
    v_lshlrev_b32_e64 v124, 16, v69
    v_and_b32 v125, 0xffff0000, v69
    v_fma_f32 v124, v124, v118, -v110
    v_fma_f32 v125, v125, v119, -v111
    v_cvt_pk_bf16_f32 v69, v124, v125
    v_lshlrev_b32_e64 v124, 16, v70
    v_and_b32 v125, 0xffff0000, v70
    v_fma_f32 v124, v124, v120, -v112
    v_fma_f32 v125, v125, v121, -v113
    v_cvt_pk_bf16_f32 v70, v124, v125
    v_lshlrev_b32_e64 v124, 16, v71
    v_and_b32 v125, 0xffff0000, v71
    v_fma_f32 v124, v124, v122, -v114
    v_fma_f32 v125, v125, v123, -v115
    v_cvt_pk_bf16_f32 v71, v124, v125
    s_add_u32 s51, s50, 65273856
    buffer_store_dwordx4 v[68:71], v6, s[4:7], s51 offen sc1
    v_lshlrev_b32_e64 v124, 16, v72
    v_and_b32 v125, 0xffff0000, v72
    v_fma_f32 v124, v124, v116, -v108
    v_fma_f32 v125, v125, v117, -v109
    v_cvt_pk_bf16_f32 v72, v124, v125
    v_lshlrev_b32_e64 v124, 16, v73
    v_and_b32 v125, 0xffff0000, v73
    v_fma_f32 v124, v124, v118, -v110
    v_fma_f32 v125, v125, v119, -v111
    v_cvt_pk_bf16_f32 v73, v124, v125
    v_lshlrev_b32_e64 v124, 16, v74
    v_and_b32 v125, 0xffff0000, v74
    v_fma_f32 v124, v124, v120, -v112
    v_fma_f32 v125, v125, v121, -v113
    v_cvt_pk_bf16_f32 v74, v124, v125
    v_lshlrev_b32_e64 v124, 16, v75
    v_and_b32 v125, 0xffff0000, v75
    v_fma_f32 v124, v124, v122, -v114
    v_fma_f32 v125, v125, v123, -v115
    v_cvt_pk_bf16_f32 v75, v124, v125
    s_add_u32 s51, s50, 65536000
    buffer_store_dwordx4 v[72:75], v6, s[4:7], s51 offen sc1
    s_waitcnt vmcnt(11)
    s_barrier
    s_add_u32 s41, s41, 1
    s_bitcmp1_b32 s54, s41
    s_cbranch_scc1 hk_135
hb_136:
    s_add_u32 s10, s41, 3
    s_lshl_b32 s11, s10, 14
    s_and_b32 s10, s11, 0xc000
    s_add_u32 m0, s10, s46
    s_add_u32 s11, s11, s42
    s_min_u32 s11, s11, s56
    buffer_load_dwordx4 v2, s[4:7], s11 offen offset:0 sc1 lds
    buffer_load_dwordx4 v2, s[4:7], s11 offen offset:1024 sc1 lds
    buffer_load_dwordx4 v2, s[4:7], s11 offen offset:2048 sc1 lds
    buffer_load_dwordx4 v2, s[4:7], s11 offen offset:3072 sc1 lds
    s_add_u32 s10, s41, 2
    s_lshl_b32 s11, s10, 14
    s_and_b32 s10, s11, 0xc000
    s_add_u32 m0, s10, s47
    s_add_u32 s11, s11, s43
    s_min_u32 s11, s11, s57
    buffer_load_dwordx4 v2, s[4:7], s11 offen offset:0 sc1 lds
    buffer_load_dwordx4 v2, s[4:7], s11 offen offset:1024 sc1 lds
    buffer_load_dwordx4 v2, s[4:7], s11 offen offset:2048 sc1 lds
    buffer_load_dwordx4 v2, s[4:7], s11 offen offset:3072 sc1 lds
    v_lshlrev_b32 v124, 16, v76
    v_and_b32 v125, 0xffff0000, v76
    v_fma_f32 v124, v124, v116, -v108
    v_fma_f32 v125, v125, v117, -v109
    v_cvt_pk_bf16_f32 v76, v124, v125
    v_lshlrev_b32_e64 v124, 16, v77
    v_and_b32 v125, 0xffff0000, v77
    v_fma_f32 v124, v124, v118, -v110
    v_fma_f32 v125, v125, v119, -v111
    v_cvt_pk_bf16_f32 v77, v124, v125
    v_lshlrev_b32_e64 v124, 16, v78
    v_and_b32 v125, 0xffff0000, v78
    v_fma_f32 v124, v124, v120, -v112
    v_fma_f32 v125, v125, v121, -v113
    v_cvt_pk_bf16_f32 v78, v124, v125
    v_lshlrev_b32_e64 v124, 16, v79
    v_and_b32 v125, 0xffff0000, v79
    v_fma_f32 v124, v124, v122, -v114
    v_fma_f32 v125, v125, v123, -v115
    v_cvt_pk_bf16_f32 v79, v124, v125
    s_add_u32 s51, s50, 65798144
    buffer_store_dwordx4 v[76:79], v6, s[4:7], s51 offen sc1
    v_lshlrev_b32_e64 v124, 16, v80
    v_and_b32 v125, 0xffff0000, v80
    v_fma_f32 v124, v124, v116, -v108
    v_fma_f32 v125, v125, v117, -v109
    v_cvt_pk_bf16_f32 v80, v124, v125
    v_lshlrev_b32_e64 v124, 16, v81
    v_and_b32 v125, 0xffff0000, v81
    v_fma_f32 v124, v124, v118, -v110
    v_fma_f32 v125, v125, v119, -v111
    v_cvt_pk_bf16_f32 v81, v124, v125
    v_lshlrev_b32_e64 v124, 16, v82
    v_and_b32 v125, 0xffff0000, v82
    v_fma_f32 v124, v124, v120, -v112
    v_fma_f32 v125, v125, v121, -v113
    v_cvt_pk_bf16_f32 v82, v124, v125
    v_lshlrev_b32_e64 v124, 16, v83
    v_and_b32 v125, 0xffff0000, v83
    v_fma_f32 v124, v124, v122, -v114
    v_fma_f32 v125, v125, v123, -v115
    v_cvt_pk_bf16_f32 v83, v124, v125
    s_add_u32 s51, s50, 66060288
    buffer_store_dwordx4 v[80:83], v6, s[4:7], s51 offen sc1
    v_lshlrev_b32_e64 v124, 16, v84
    v_and_b32 v125, 0xffff0000, v84
    v_fma_f32 v124, v124, v116, -v108
    v_fma_f32 v125, v125, v117, -v109
    v_cvt_pk_bf16_f32 v84, v124, v125
    v_lshlrev_b32_e64 v124, 16, v85
    v_and_b32 v125, 0xffff0000, v85
    v_fma_f32 v124, v124, v118, -v110
    v_fma_f32 v125, v125, v119, -v111
    v_cvt_pk_bf16_f32 v85, v124, v125
    v_lshlrev_b32_e64 v124, 16, v86
    v_and_b32 v125, 0xffff0000, v86
    v_fma_f32 v124, v124, v120, -v112
    v_fma_f32 v125, v125, v121, -v113
    v_cvt_pk_bf16_f32 v86, v124, v125
    v_lshlrev_b32_e64 v124, 16, v87
    v_and_b32 v125, 0xffff0000, v87
    v_fma_f32 v124, v124, v122, -v114
    v_fma_f32 v125, v125, v123, -v115
    v_cvt_pk_bf16_f32 v87, v124, v125
    s_add_u32 s51, s50, 66322432
    buffer_store_dwordx4 v[84:87], v6, s[4:7], s51 offen sc1
    s_waitcnt vmcnt(11)
    s_barrier
    s_add_u32 s41, s41, 1
    s_bitcmp1_b32 s54, s41
    s_cbranch_scc1 hk_137
hb_138:
    s_add_u32 s10, s41, 3
    s_lshl_b32 s11, s10, 14
    s_and_b32 s10, s11, 0xc000
    s_add_u32 m0, s10, s46
    s_add_u32 s11, s11, s42
    s_min_u32 s11, s11, s56
    buffer_load_dwordx4 v2, s[4:7], s11 offen offset:0 sc1 lds
    buffer_load_dwordx4 v2, s[4:7], s11 offen offset:1024 sc1 lds
    buffer_load_dwordx4 v2, s[4:7], s11 offen offset:2048 sc1 lds
    buffer_load_dwordx4 v2, s[4:7], s11 offen offset:3072 sc1 lds
    s_add_u32 s10, s41, 2
    s_lshl_b32 s11, s10, 14
    s_and_b32 s10, s11, 0xc000
    s_add_u32 m0, s10, s47
    s_add_u32 s11, s11, s43
    s_min_u32 s11, s11, s57
    buffer_load_dwordx4 v2, s[4:7], s11 offen offset:0 sc1 lds
    buffer_load_dwordx4 v2, s[4:7], s11 offen offset:1024 sc1 lds
    buffer_load_dwordx4 v2, s[4:7], s11 offen offset:2048 sc1 lds
    buffer_load_dwordx4 v2, s[4:7], s11 offen offset:3072 sc1 lds
    v_lshlrev_b32 v124, 16, v88
    v_and_b32 v125, 0xffff0000, v88
    v_fma_f32 v124, v124, v116, -v108
    v_fma_f32 v125, v125, v117, -v109
    v_cvt_pk_bf16_f32 v88, v124, v125
    v_lshlrev_b32_e64 v124, 16, v89
    v_and_b32 v125, 0xffff0000, v89
    v_fma_f32 v124, v124, v118, -v110
    v_fma_f32 v125, v125, v119, -v111
    v_cvt_pk_bf16_f32 v89, v124, v125
    v_lshlrev_b32_e64 v124, 16, v90
    v_and_b32 v125, 0xffff0000, v90
    v_fma_f32 v124, v124, v120, -v112
    v_fma_f32 v125, v125, v121, -v113
    v_cvt_pk_bf16_f32 v90, v124, v125
    v_lshlrev_b32_e64 v124, 16, v91
    v_and_b32 v125, 0xffff0000, v91
    v_fma_f32 v124, v124, v122, -v114
    v_fma_f32 v125, v125, v123, -v115
    v_cvt_pk_bf16_f32 v91, v124, v125
    s_add_u32 s51, s50, 66584576
    buffer_store_dwordx4 v[88:91], v6, s[4:7], s51 offen sc1
    v_lshlrev_b32_e64 v124, 16, v92
    v_and_b32 v125, 0xffff0000, v92
    v_fma_f32 v124, v124, v116, -v108
    v_fma_f32 v125, v125, v117, -v109
    v_cvt_pk_bf16_f32 v92, v124, v125
    v_lshlrev_b32_e64 v124, 16, v93
    v_and_b32 v125, 0xffff0000, v93
    v_fma_f32 v124, v124, v118, -v110
    v_fma_f32 v125, v125, v119, -v111
    v_cvt_pk_bf16_f32 v93, v124, v125
    v_lshlrev_b32_e64 v124, 16, v94
    v_and_b32 v125, 0xffff0000, v94
    v_fma_f32 v124, v124, v120, -v112
    v_fma_f32 v125, v125, v121, -v113
    v_cvt_pk_bf16_f32 v94, v124, v125
    v_lshlrev_b32_e64 v124, 16, v95
    v_and_b32 v125, 0xffff0000, v95
    v_fma_f32 v124, v124, v122, -v114
    v_fma_f32 v125, v125, v123, -v115
    v_cvt_pk_bf16_f32 v95, v124, v125
    s_add_u32 s51, s50, 66846720
    buffer_store_dwordx4 v[92:95], v6, s[4:7], s51 offen sc1
    v_lshlrev_b32_e64 v124, 16, v96
    v_and_b32 v125, 0xffff0000, v96
    v_fma_f32 v124, v124, v116, -v108
    v_fma_f32 v125, v125, v117, -v109
    v_cvt_pk_bf16_f32 v96, v124, v125
    v_lshlrev_b32_e64 v124, 16, v97
    v_and_b32 v125, 0xffff0000, v97
    v_fma_f32 v124, v124, v118, -v110
    v_fma_f32 v125, v125, v119, -v111
    v_cvt_pk_bf16_f32 v97, v124, v125
    v_lshlrev_b32_e64 v124, 16, v98
    v_and_b32 v125, 0xffff0000, v98
    v_fma_f32 v124, v124, v120, -v112
    v_fma_f32 v125, v125, v121, -v113
    v_cvt_pk_bf16_f32 v98, v124, v125
    v_lshlrev_b32_e64 v124, 16, v99
    v_and_b32 v125, 0xffff0000, v99
    v_fma_f32 v124, v124, v122, -v114
    v_fma_f32 v125, v125, v123, -v115
    v_cvt_pk_bf16_f32 v99, v124, v125
    s_add_u32 s51, s50, 67108864
    buffer_store_dwordx4 v[96:99], v6, s[4:7], s51 offen sc1
    s_waitcnt vmcnt(11)
    s_barrier
    s_add_u32 s41, s41, 1
    s_bitcmp1_b32 s54, s41
    s_cbranch_scc1 hk_139
hb_140:
    s_add_u32 s10, s41, 3
    s_lshl_b32 s11, s10, 14
    s_and_b32 s10, s11, 0xc000
    s_add_u32 m0, s10, s46
    s_add_u32 s11, s11, s42
    s_min_u32 s11, s11, s56
    buffer_load_dwordx4 v2, s[4:7], s11 offen offset:0 sc1 lds
    buffer_load_dwordx4 v2, s[4:7], s11 offen offset:1024 sc1 lds
    buffer_load_dwordx4 v2, s[4:7], s11 offen offset:2048 sc1 lds
    buffer_load_dwordx4 v2, s[4:7], s11 offen offset:3072 sc1 lds
    s_add_u32 s10, s41, 2
    s_lshl_b32 s11, s10, 14
    s_and_b32 s10, s11, 0xc000
    s_add_u32 m0, s10, s47
    s_add_u32 s11, s11, s43
    s_min_u32 s11, s11, s57
    buffer_load_dwordx4 v2, s[4:7], s11 offen offset:0 sc1 lds
    buffer_load_dwordx4 v2, s[4:7], s11 offen offset:1024 sc1 lds
    buffer_load_dwordx4 v2, s[4:7], s11 offen offset:2048 sc1 lds
    buffer_load_dwordx4 v2, s[4:7], s11 offen offset:3072 sc1 lds
    v_lshlrev_b32 v124, 16, v100
    v_and_b32 v125, 0xffff0000, v100
    v_fma_f32 v124, v124, v116, -v108
    v_fma_f32 v125, v125, v117, -v109
    v_cvt_pk_bf16_f32 v100, v124, v125
    v_lshlrev_b32_e64 v124, 16, v101
    v_and_b32 v125, 0xffff0000, v101
    v_fma_f32 v124, v124, v118, -v110
    v_fma_f32 v125, v125, v119, -v111
    v_cvt_pk_bf16_f32 v101, v124, v125
    v_lshlrev_b32_e64 v124, 16, v102
    v_and_b32 v125, 0xffff0000, v102
    v_fma_f32 v124, v124, v120, -v112
    v_fma_f32 v125, v125, v121, -v113
    v_cvt_pk_bf16_f32 v102, v124, v125
    v_lshlrev_b32_e64 v124, 16, v103
    v_and_b32 v125, 0xffff0000, v103
    v_fma_f32 v124, v124, v122, -v114
    v_fma_f32 v125, v125, v123, -v115
    v_cvt_pk_bf16_f32 v103, v124, v125
    s_add_u32 s51, s50, 67371008
    buffer_store_dwordx4 v[100:103], v6, s[4:7], s51 offen sc1
    v_lshlrev_b32_e64 v124, 16, v104
    v_and_b32 v125, 0xffff0000, v104
    v_fma_f32 v124, v124, v116, -v108
    v_fma_f32 v125, v125, v117, -v109
    v_cvt_pk_bf16_f32 v104, v124, v125
    v_lshlrev_b32_e64 v124, 16, v105
    v_and_b32 v125, 0xffff0000, v105
    v_fma_f32 v124, v124, v118, -v110
    v_fma_f32 v125, v125, v119, -v111
    v_cvt_pk_bf16_f32 v105, v124, v125
    v_lshlrev_b32_e64 v124, 16, v106
    v_and_b32 v125, 0xffff0000, v106
    v_fma_f32 v124, v124, v120, -v112
    v_fma_f32 v125, v125, v121, -v113
    v_cvt_pk_bf16_f32 v106, v124, v125
    v_lshlrev_b32_e64 v124, 16, v107
    v_and_b32 v125, 0xffff0000, v107
    v_fma_f32 v124, v124, v122, -v114
    v_fma_f32 v125, v125, v123, -v115
    v_cvt_pk_bf16_f32 v107, v124, v125
    s_add_u32 s51, s50, 67633152
    buffer_store_dwordx4 v[104:107], v7, s[4:7], s51 offen sc1
    s_waitcnt vmcnt(10)
    s_barrier
    s_add_u32 s41, s41, 1
    s_bitcmp1_b32 s54, s41
    s_cbranch_scc1 hk_141
hb_142:
    s_add_u32 s10, s41, 3
    s_lshl_b32 s11, s10, 14
    s_and_b32 s10, s11, 0xc000
    s_add_u32 m0, s10, s46
    s_add_u32 s11, s11, s42
    s_min_u32 s11, s11, s56
    buffer_load_dwordx4 v2, s[4:7], s11 offen offset:0 sc1 lds
    buffer_load_dwordx4 v2, s[4:7], s11 offen offset:1024 sc1 lds
    buffer_load_dwordx4 v2, s[4:7], s11 offen offset:2048 sc1 lds
    buffer_load_dwordx4 v2, s[4:7], s11 offen offset:3072 sc1 lds
    s_add_u32 s10, s41, 2
    s_lshl_b32 s11, s10, 14
    s_and_b32 s10, s11, 0xc000
    s_add_u32 m0, s10, s47
    s_add_u32 s11, s11, s43
    s_min_u32 s11, s11, s57
    buffer_load_dwordx4 v2, s[4:7], s11 offen offset:0 sc1 lds
    buffer_load_dwordx4 v2, s[4:7], s11 offen offset:1024 sc1 lds
    buffer_load_dwordx4 v2, s[4:7], s11 offen offset:2048 sc1 lds
    buffer_load_dwordx4 v2, s[4:7], s11 offen offset:3072 sc1 lds
    s_waitcnt vmcnt(8)
    s_barrier
    s_add_u32 s41, s41, 1
    s_bitcmp1_b32 s54, s41
    s_cbranch_scc1 hk_143
hb_144:
    s_add_u32 s10, s41, 3
    s_lshl_b32 s11, s10, 14
    s_and_b32 s10, s11, 0xc000
    s_add_u32 m0, s10, s46
    s_add_u32 s11, s11, s42
    s_min_u32 s11, s11, s56
    buffer_load_dwordx4 v2, s[4:7], s11 offen offset:0 sc1 lds
    buffer_load_dwordx4 v2, s[4:7], s11 offen offset:1024 sc1 lds
    buffer_load_dwordx4 v2, s[4:7], s11 offen offset:2048 sc1 lds
    buffer_load_dwordx4 v2, s[4:7], s11 offen offset:3072 sc1 lds
    s_add_u32 s10, s41, 2
    s_lshl_b32 s11, s10, 14
    s_and_b32 s10, s11, 0xc000
    s_add_u32 m0, s10, s47
    s_add_u32 s11, s11, s43
    s_min_u32 s11, s11, s57
    buffer_load_dwordx4 v2, s[4:7], s11 offen offset:0 sc1 lds
    buffer_load_dwordx4 v2, s[4:7], s11 offen offset:1024 sc1 lds
    buffer_load_dwordx4 v2, s[4:7], s11 offen offset:2048 sc1 lds
    buffer_load_dwordx4 v2, s[4:7], s11 offen offset:3072 sc1 lds
    s_and_b32 s8, s49, 7
    s_add_u32 s8, s8, 88
    s_lshl_b32 s14, s8, 8
    s_add_u32 s14, s14, 117440512
    v_mov_b32_e64 v8, 0
    v_mov_b32 v9, 1
    s_mov_b64 exec, 1
    buffer_atomic_add v9, v8, s[4:7], s14 offen sc1
    s_mov_b64 exec, -1
sig_145:
    s_waitcnt vmcnt(9)
    s_barrier
    s_add_u32 s41, s41, 1
    s_bitcmp1_b32 s54, s41
    s_cbranch_scc1 hk_146
hb_147:
    s_add_u32 s10, s41, 3
    s_lshl_b32 s11, s10, 14
    s_and_b32 s10, s11, 0xc000
    s_add_u32 m0, s10, s46
    s_add_u32 s11, s11, s42
    s_min_u32 s11, s11, s56
    buffer_load_dwordx4 v2, s[4:7], s11 offen offset:0 sc1 lds
    buffer_load_dwordx4 v2, s[4:7], s11 offen offset:1024 sc1 lds
    buffer_load_dwordx4 v2, s[4:7], s11 offen offset:2048 sc1 lds
    buffer_load_dwordx4 v2, s[4:7], s11 offen offset:3072 sc1 lds
    s_add_u32 s10, s41, 2
    s_lshl_b32 s11, s10, 14
    s_and_b32 s10, s11, 0xc000
    s_add_u32 m0, s10, s47
    s_add_u32 s11, s11, s43
    s_min_u32 s11, s11, s57
    buffer_load_dwordx4 v2, s[4:7], s11 offen offset:0 sc1 lds
    buffer_load_dwordx4 v2, s[4:7], s11 offen offset:1024 sc1 lds
    buffer_load_dwordx4 v2, s[4:7], s11 offen offset:2048 sc1 lds
    buffer_load_dwordx4 v2, s[4:7], s11 offen offset:3072 sc1 lds
    s_branch parallel_sum__compressed_kv_cla__mixer_gmlp__prompt_kernel_at_ld
parallel_sum__compressed_kv_cla__mixer_gmlp__prompt_kernel_at_small:
    s_cmp_eq_u32 s39, 0
    s_cbranch_scc1 parallel_sum__compressed_kv_cla__mixer_gmlp__prompt_kernel_at_u0
    s_waitcnt lgkmcnt(6)
    v_mfma_f32_32x32x16_bf16 v[176:191], v[80:83], v[112:115], v[144:159]
    v_add_f32 v54, v54, v57
    v_exp_f32 v58, v170
    v_cvt_pk_bf16_f32 v66, v56, v57
    v_mfma_f32_32x32x16_bf16 v[176:191], v[84:87], v[116:119], v[176:191]
    s_waitcnt lgkmcnt(4)
    v_add_f32 v54, v54, v58
    v_exp_f32 v59, v171
    s_waitcnt lgkmcnt(6)
    v_mfma_f32_32x32x16_bf16 v[176:191], v[88:91], v[120:123], v[176:191]
    v_add_f32 v54, v54, v59
    v_exp_f32 v56, v164
    v_cvt_pk_bf16_f32 v67, v58, v59
    v_mfma_f32_32x32x16_bf16 v[176:191], v[92:95], v[124:127], v[176:191]
    s_waitcnt lgkmcnt(2)
    v_add_f32 v54, v54, v56
    v_exp_f32 v57, v165
    s_waitcnt lgkmcnt(6)
    v_mfma_f32_32x32x16_bf16 v[176:191], v[96:99], v[128:131], v[176:191]
    v_add_f32 v54, v54, v57
    v_exp_f32 v58, v166
    v_cvt_pk_bf16_f32 v68, v56, v57
    v_mfma_f32_32x32x16_bf16 v[176:191], v[100:103], v[132:135], v[176:191]
    s_waitcnt lgkmcnt(0)
    v_add_f32 v54, v54, v58
    v_exp_f32 v59, v167
    s_waitcnt lgkmcnt(6)
    v_mfma_f32_32x32x16_bf16 v[176:191], v[104:107], v[136:139], v[176:191]
    v_add_f32 v54, v54, v59
    v_exp_f32 v56, v172
    v_cvt_pk_bf16_f32 v69, v58, v59
    v_mfma_f32_32x32x16_bf16 v[176:191], v[108:111], v[140:143], v[176:191]
    v_add_f32 v54, v54, v56
    v_exp_f32 v57, v173
    s_nop 0
    v_add_f32 v54, v54, v57
    v_exp_f32_e64 v58, v174
    v_cvt_pk_bf16_f32 v70, v56, v57
    v_add_f32 v54, v54, v58
    v_exp_f32 v59, v175
    s_nop 0
    v_add_f32 v54, v54, v59
    v_cvt_pk_bf16_f32 v71, v58, v59
    v_cmp_nge_f32 vcc, s44, v54
    s_cbranch_vccnz rs_148
rb_149:
    s_branch parallel_sum__compressed_kv_cla__mixer_gmlp__prompt_kernel_at_u1b
parallel_sum__compressed_kv_cla__mixer_gmlp__prompt_kernel_at_u0:
    s_waitcnt lgkmcnt(0)
    v_cmp_le_i32 s[8:9], 0, v16
    v_cmp_le_i32 s[10:11], 1, v16
    v_cmp_le_i32 s[12:13], 2, v16
    v_cmp_le_i32 s[14:15], 3, v16
    v_cndmask_b32 v160, v3, v160, s[8:9]
    v_cndmask_b32 v161, v3, v161, s[10:11]
    v_cndmask_b32 v162, v3, v162, s[12:13]
    v_cndmask_b32 v163, v3, v163, s[14:15]
    v_cmp_le_i32 s[8:9], 8, v16
    v_cmp_le_i32 s[10:11], 9, v16
    v_cmp_le_i32 s[12:13], 10, v16
    v_cmp_le_i32 s[14:15], 11, v16
    v_cndmask_b32 v164, v3, v164, s[8:9]
    v_cndmask_b32 v165, v3, v165, s[10:11]
    v_cndmask_b32 v166, v3, v166, s[12:13]
    v_cndmask_b32 v167, v3, v167, s[14:15]
    v_cmp_le_i32 s[8:9], 16, v16
    v_cmp_le_i32 s[10:11], 17, v16
    v_cmp_le_i32 s[12:13], 18, v16
    v_cmp_le_i32 s[14:15], 19, v16
    v_cndmask_b32 v168, v3, v168, s[8:9]
    v_cndmask_b32 v169, v3, v169, s[10:11]
    v_cndmask_b32 v170, v3, v170, s[12:13]
    v_cndmask_b32 v171, v3, v171, s[14:15]
    v_cmp_le_i32 s[8:9], 24, v16
    v_cmp_le_i32 s[10:11], 25, v16
    v_cmp_le_i32 s[12:13], 26, v16
    v_cmp_le_i32 s[14:15], 27, v16
    v_cndmask_b32 v172, v3, v172, s[8:9]
    v_cndmask_b32 v173, v3, v173, s[10:11]
    v_cndmask_b32 v174, v3, v174, s[12:13]
    v_cndmask_b32 v175, v3, v175, s[14:15]
    v_exp_f32 v56, v160
    v_exp_f32 v57, v161
    s_nop 0
    v_add_f32 v54, v56, v57
    v_exp_f32_e64 v58, v162
    v_cvt_pk_bf16_f32 v64, v56, v57
    v_add_f32 v54, v54, v58
    v_exp_f32 v59, v163
    s_nop 0
    v_add_f32 v54, v54, v59
    v_exp_f32_e64 v56, v168
    v_cvt_pk_bf16_f32 v65, v58, v59
    v_add_f32 v54, v54, v56
    v_exp_f32 v57, v169
    s_nop 0
    v_add_f32 v54, v54, v57
    v_exp_f32_e64 v58, v170
    v_cvt_pk_bf16_f32 v66, v56, v57
    v_add_f32 v54, v54, v58
    v_exp_f32 v59, v171
    s_nop 0
    v_add_f32 v54, v54, v59
    v_exp_f32_e64 v56, v164
    v_cvt_pk_bf16_f32 v67, v58, v59
    v_add_f32 v54, v54, v56
    v_exp_f32 v57, v165
    s_nop 0
    v_add_f32 v54, v54, v57
    v_exp_f32_e64 v58, v166
    v_cvt_pk_bf16_f32 v68, v56, v57
    v_add_f32 v54, v54, v58
    v_exp_f32 v59, v167
    s_nop 0
    v_add_f32 v54, v54, v59
    v_exp_f32_e64 v56, v172
    v_cvt_pk_bf16_f32 v69, v58, v59
    v_add_f32 v54, v54, v56
    v_exp_f32 v57, v173
    s_nop 0
    v_add_f32 v54, v54, v57
    v_exp_f32_e64 v58, v174
    v_cvt_pk_bf16_f32 v70, v56, v57
    v_add_f32 v54, v54, v58
    v_exp_f32 v59, v175
    s_nop 0
    v_add_f32 v54, v54, v59
    v_cvt_pk_bf16_f32 v71, v58, v59
    v_cmp_nge_f32 vcc, s44, v54
    s_cbranch_vccnz rs_150
rb_151:
    v_add_f32_e64 v53, v53, v54
    ds_read_b128 v[80:83], v15 offset:8192
    ds_read_b128 v[84:87], v15 offset:9216
    ds_read_b128 v[88:91], v15 offset:10240
    ds_read_b128 v[92:95], v15 offset:11264
    ds_read_b128 v[96:99], v15 offset:12288
    ds_read_b128 v[100:103], v15 offset:13312
    ds_read_b128 v[104:107], v15 offset:14336
    ds_read_b128 v[108:111], v15 offset:15360
    s_waitcnt lgkmcnt(7)
    v_mfma_f32_32x32x16_bf16 v[192:207], v[80:83], v[64:67], v[192:207]
    s_waitcnt lgkmcnt(6)
    v_mfma_f32_32x32x16_bf16 v[208:223], v[84:87], v[64:67], v[208:223]
    s_waitcnt lgkmcnt(5)
    v_mfma_f32_32x32x16_bf16 v[224:239], v[88:91], v[64:67], v[224:239]
    s_waitcnt lgkmcnt(4)
    v_mfma_f32_32x32x16_bf16 v[240:255], v[92:95], v[64:67], v[240:255]
    s_waitcnt lgkmcnt(3)
    v_mfma_f32_32x32x16_bf16 v[192:207], v[96:99], v[68:71], v[192:207]
    s_waitcnt lgkmcnt(2)
    v_mfma_f32_32x32x16_bf16 v[208:223], v[100:103], v[68:71], v[208:223]
    s_waitcnt lgkmcnt(1)
    v_mfma_f32_32x32x16_bf16 v[224:239], v[104:107], v[68:71], v[224:239]
    s_waitcnt lgkmcnt(0)
    v_mfma_f32_32x32x16_bf16 v[240:255], v[108:111], v[68:71], v[240:255]
    s_branch parallel_sum__compressed_kv_cla__mixer_gmlp__prompt_kernel_at_epiA
rs_53:
    s_call_b64 s[62:63], parallel_sum__compressed_kv_cla__mixer_gmlp__prompt_kernel_rare0
    s_branch rb_54
rs_55:
    s_call_b64 s[62:63], parallel_sum__compressed_kv_cla__mixer_gmlp__prompt_kernel_rare1
    s_branch rb_56
rs_59:
    s_call_b64 s[62:63], parallel_sum__compressed_kv_cla__mixer_gmlp__prompt_kernel_rare0
    s_branch rb_60
rs_61:
    s_call_b64 s[62:63], parallel_sum__compressed_kv_cla__mixer_gmlp__prompt_kernel_rare1
    s_branch rb_62
rs_63:
    s_call_b64 s[62:63], parallel_sum__compressed_kv_cla__mixer_gmlp__prompt_kernel_rare0
    s_branch rb_64
rs_65:
    s_call_b64 s[62:63], parallel_sum__compressed_kv_cla__mixer_gmlp__prompt_kernel_rare1
    s_branch rb_66
rs_67:
    s_call_b64 s[62:63], parallel_sum__compressed_kv_cla__mixer_gmlp__prompt_kernel_rare0
    s_branch rb_68
rs_69:
    s_call_b64 s[62:63], parallel_sum__compressed_kv_cla__mixer_gmlp__prompt_kernel_rare0
    s_branch rb_70
rs_71:
    s_call_b64 s[62:63], parallel_sum__compressed_kv_cla__mixer_gmlp__prompt_kernel_rare1
    s_branch rb_72
rs_75:
    s_call_b64 s[62:63], parallel_sum__compressed_kv_cla__mixer_gmlp__prompt_kernel_rare0
    s_branch rb_76
rs_77:
    s_call_b64 s[62:63], parallel_sum__compressed_kv_cla__mixer_gmlp__prompt_kernel_rare1
    s_branch rb_78
rs_81:
    s_call_b64 s[62:63], parallel_sum__compressed_kv_cla__mixer_gmlp__prompt_kernel_rare0
    s_branch rb_82
rs_83:
    s_call_b64 s[62:63], parallel_sum__compressed_kv_cla__mixer_gmlp__prompt_kernel_rare1
    s_branch rb_84
rs_87:
    s_call_b64 s[62:63], parallel_sum__compressed_kv_cla__mixer_gmlp__prompt_kernel_rare0
    s_branch rb_88
rs_89:
    s_call_b64 s[62:63], parallel_sum__compressed_kv_cla__mixer_gmlp__prompt_kernel_rare0
    s_branch rb_90
rs_91:
    s_call_b64 s[62:63], parallel_sum__compressed_kv_cla__mixer_gmlp__prompt_kernel_rare1
    s_branch rb_92
rs_148:
    s_call_b64 s[62:63], parallel_sum__compressed_kv_cla__mixer_gmlp__prompt_kernel_rare0
    s_branch rb_149
rs_150:
    s_call_b64 s[62:63], parallel_sum__compressed_kv_cla__mixer_gmlp__prompt_kernel_rare0
    s_branch rb_151
hk_51:
    s_call_b64 s[62:63], parallel_sum__compressed_kv_cla__mixer_gmlp__prompt_kernel_hook
    s_branch hb_52
hk_57:
    s_call_b64 s[62:63], parallel_sum__compressed_kv_cla__mixer_gmlp__prompt_kernel_hook
    s_branch hb_58
hk_73:
    s_call_b64 s[62:63], parallel_sum__compressed_kv_cla__mixer_gmlp__prompt_kernel_hook
    s_branch hb_74
hk_79:
    s_call_b64 s[62:63], parallel_sum__compressed_kv_cla__mixer_gmlp__prompt_kernel_hook
    s_branch hb_80
hk_85:
    s_call_b64 s[62:63], parallel_sum__compressed_kv_cla__mixer_gmlp__prompt_kernel_hook
    s_branch hb_86
hk_93:
    s_call_b64 s[62:63], parallel_sum__compressed_kv_cla__mixer_gmlp__prompt_kernel_hook
    s_branch hb_94
hk_95:
    s_call_b64 s[62:63], parallel_sum__compressed_kv_cla__mixer_gmlp__prompt_kernel_hook
    s_branch hb_96
hk_97:
    s_call_b64 s[62:63], parallel_sum__compressed_kv_cla__mixer_gmlp__prompt_kernel_hook
    s_branch hb_98
hk_99:
    s_call_b64 s[62:63], parallel_sum__compressed_kv_cla__mixer_gmlp__prompt_kernel_hook
    s_branch hb_100
hk_103:
    s_call_b64 s[62:63], parallel_sum__compressed_kv_cla__mixer_gmlp__prompt_kernel_hook
    s_branch hb_104
hk_105:
    s_call_b64 s[62:63], parallel_sum__compressed_kv_cla__mixer_gmlp__prompt_kernel_hook
    s_branch hb_106
hk_107:
    s_call_b64 s[62:63], parallel_sum__compressed_kv_cla__mixer_gmlp__prompt_kernel_hook
    s_branch hb_108
hk_109:
    s_call_b64 s[62:63], parallel_sum__compressed_kv_cla__mixer_gmlp__prompt_kernel_hook
    s_branch hb_110
hk_111:
    s_call_b64 s[62:63], parallel_sum__compressed_kv_cla__mixer_gmlp__prompt_kernel_hook
    s_branch hb_112
hk_113:
    s_call_b64 s[62:63], parallel_sum__compressed_kv_cla__mixer_gmlp__prompt_kernel_hook
    s_branch hb_114
hk_117:
    s_call_b64 s[62:63], parallel_sum__compressed_kv_cla__mixer_gmlp__prompt_kernel_hook
    s_branch hb_118
hk_119:
    s_call_b64 s[62:63], parallel_sum__compressed_kv_cla__mixer_gmlp__prompt_kernel_hook
    s_branch hb_120
hk_121:
    s_call_b64 s[62:63], parallel_sum__compressed_kv_cla__mixer_gmlp__prompt_kernel_hook
    s_branch hb_122
hk_123:
    s_call_b64 s[62:63], parallel_sum__compressed_kv_cla__mixer_gmlp__prompt_kernel_hook
    s_branch hb_124
hk_125:
    s_call_b64 s[62:63], parallel_sum__compressed_kv_cla__mixer_gmlp__prompt_kernel_hook
    s_branch hb_126
hk_127:
    s_call_b64 s[62:63], parallel_sum__compressed_kv_cla__mixer_gmlp__prompt_kernel_hook
    s_branch hb_128
hk_129:
    s_call_b64 s[62:63], parallel_sum__compressed_kv_cla__mixer_gmlp__prompt_kernel_hook
    s_branch hb_130
hk_131:
    s_call_b64 s[62:63], parallel_sum__compressed_kv_cla__mixer_gmlp__prompt_kernel_hook
    s_branch hb_132
hk_133:
    s_call_b64 s[62:63], parallel_sum__compressed_kv_cla__mixer_gmlp__prompt_kernel_hook
    s_branch hb_134
hk_135:
    s_call_b64 s[62:63], parallel_sum__compressed_kv_cla__mixer_gmlp__prompt_kernel_hook
    s_branch hb_136
hk_137:
    s_call_b64 s[62:63], parallel_sum__compressed_kv_cla__mixer_gmlp__prompt_kernel_hook
    s_branch hb_138
hk_139:
    s_call_b64 s[62:63], parallel_sum__compressed_kv_cla__mixer_gmlp__prompt_kernel_hook
    s_branch hb_140
hk_141:
    s_call_b64 s[62:63], parallel_sum__compressed_kv_cla__mixer_gmlp__prompt_kernel_hook
    s_branch hb_142
hk_143:
    s_call_b64 s[62:63], parallel_sum__compressed_kv_cla__mixer_gmlp__prompt_kernel_hook
    s_branch hb_144
hk_146:
    s_call_b64 s[62:63], parallel_sum__compressed_kv_cla__mixer_gmlp__prompt_kernel_hook
    s_branch hb_147
parallel_sum__compressed_kv_cla__mixer_gmlp__prompt_kernel_rare0:
    s_nop 15
    v_max3_f32 v4, v160, v161, v162
    v_max3_f32 v4, v4, v163, v164
    v_max3_f32 v4, v4, v165, v166
    v_max3_f32 v4, v4, v167, v168
    v_max3_f32 v4, v4, v169, v170
    v_max3_f32 v4, v4, v171, v172
    v_max3_f32 v4, v4, v173, v174
    v_max_f32 v4, v4, v175
    v_mov_b32 v5, v4
    s_nop 1
    v_permlane32_swap_b32 v4, v5
    v_max_f32 v4, v4, v5
    v_max_f32 v4, 0, v4
    v_sub_f32 v5, 0, v4
    v_exp_f32 v5, v5
    v_sub_f32 v144, v144, v4
    v_sub_f32 v145, v145, v4
    v_sub_f32 v146, v146, v4
    v_sub_f32 v147, v147, v4
    v_sub_f32 v148, v148, v4
    v_sub_f32 v149, v149, v4
    v_sub_f32 v150, v150, v4
    v_sub_f32 v151, v151, v4
    v_sub_f32 v152, v152, v4
    v_sub_f32 v153, v153, v4
    v_sub_f32 v154, v154, v4
    v_sub_f32 v155, v155, v4
    v_sub_f32 v156, v156, v4
    v_sub_f32 v157, v157, v4
    v_sub_f32 v158, v158, v4
    v_sub_f32 v159, v159, v4
    v_sub_f32 v160, v160, v4
    v_sub_f32 v161, v161, v4
    v_sub_f32 v162, v162, v4
    v_sub_f32 v163, v163, v4
    v_sub_f32 v164, v164, v4
    v_sub_f32 v165, v165, v4
    v_sub_f32 v166, v166, v4
    v_sub_f32 v167, v167, v4
    v_sub_f32 v168, v168, v4
    v_sub_f32 v169, v169, v4
    v_sub_f32 v170, v170, v4
    v_sub_f32 v171, v171, v4
    v_sub_f32 v172, v172, v4
    v_sub_f32 v173, v173, v4
    v_sub_f32 v174, v174, v4
    v_sub_f32 v175, v175, v4
    v_sub_f32 v176, v176, v4
    v_sub_f32 v177, v177, v4
    v_sub_f32 v178, v178, v4
    v_sub_f32 v179, v179, v4
    v_sub_f32 v180, v180, v4
    v_sub_f32 v181, v181, v4
    v_sub_f32 v182, v182, v4
    v_sub_f32 v183, v183, v4
    v_sub_f32 v184, v184, v4
    v_sub_f32 v185, v185, v4
    v_sub_f32 v186, v186, v4
    v_sub_f32 v187, v187, v4
    v_sub_f32 v188, v188, v4
    v_sub_f32 v189, v189, v4
    v_sub_f32 v190, v190, v4
    v_sub_f32 v191, v191, v4
    v_mul_f32 v192, v192, v5
    v_mul_f32 v193, v193, v5
    v_mul_f32 v194, v194, v5
    v_mul_f32 v195, v195, v5
    v_mul_f32 v196, v196, v5
    v_mul_f32 v197, v197, v5
    v_mul_f32 v198, v198, v5
    v_mul_f32 v199, v199, v5
    v_mul_f32 v200, v200, v5
    v_mul_f32 v201, v201, v5
    v_mul_f32 v202, v202, v5
    v_mul_f32 v203, v203, v5
    v_mul_f32 v204, v204, v5
    v_mul_f32 v205, v205, v5
    v_mul_f32 v206, v206, v5
    v_mul_f32 v207, v207, v5
    v_mul_f32 v208, v208, v5
    v_mul_f32 v209, v209, v5
    v_mul_f32 v210, v210, v5
    v_mul_f32 v211, v211, v5
    v_mul_f32 v212, v212, v5
    v_mul_f32 v213, v213, v5
    v_mul_f32 v214, v214, v5
    v_mul_f32 v215, v215, v5
    v_mul_f32 v216, v216, v5
    v_mul_f32 v217, v217, v5
    v_mul_f32 v218, v218, v5
    v_mul_f32 v219, v219, v5
    v_mul_f32 v220, v220, v5
    v_mul_f32 v221, v221, v5
    v_mul_f32 v222, v222, v5
    v_mul_f32 v223, v223, v5
    v_mul_f32 v224, v224, v5
    v_mul_f32 v225, v225, v5
    v_mul_f32 v226, v226, v5
    v_mul_f32 v227, v227, v5
    v_mul_f32 v228, v228, v5
    v_mul_f32 v229, v229, v5
    v_mul_f32 v230, v230, v5
    v_mul_f32 v231, v231, v5
    v_mul_f32 v232, v232, v5
    v_mul_f32 v233, v233, v5
    v_mul_f32 v234, v234, v5
    v_mul_f32 v235, v235, v5
    v_mul_f32 v236, v236, v5
    v_mul_f32 v237, v237, v5
    v_mul_f32 v238, v238, v5
    v_mul_f32 v239, v239, v5
    v_mul_f32 v240, v240, v5
    v_mul_f32 v241, v241, v5
    v_mul_f32 v242, v242, v5
    v_mul_f32 v243, v243, v5
    v_mul_f32 v244, v244, v5
    v_mul_f32 v245, v245, v5
    v_mul_f32 v246, v246, v5
    v_mul_f32 v247, v247, v5
    v_mul_f32 v248, v248, v5
    v_mul_f32 v249, v249, v5
    v_mul_f32 v250, v250, v5
    v_mul_f32 v251, v251, v5
    v_mul_f32 v252, v252, v5
    v_mul_f32 v253, v253, v5
    v_mul_f32 v254, v254, v5
    v_mul_f32 v255, v255, v5
    v_mul_f32 v53, v53, v5
    v_exp_f32 v56, v160
    v_exp_f32 v57, v161
    s_nop 0
    v_add_f32 v54, v56, v57
    v_exp_f32 v58, v162
    v_cvt_pk_bf16_f32 v64, v56, v57
    v_add_f32 v54, v54, v58
    v_exp_f32 v59, v163
    s_nop 0
    v_add_f32 v54, v54, v59
    v_exp_f32_e64 v56, v168
    v_cvt_pk_bf16_f32 v65, v58, v59
    v_add_f32 v54, v54, v56
    v_exp_f32 v57, v169
    s_nop 0
    v_add_f32 v54, v54, v57
    v_exp_f32_e64 v58, v170
    v_cvt_pk_bf16_f32 v66, v56, v57
    v_add_f32 v54, v54, v58
    v_exp_f32 v59, v171
    s_nop 0
    v_add_f32 v54, v54, v59
    v_exp_f32_e64 v56, v164
    v_cvt_pk_bf16_f32 v67, v58, v59
    v_add_f32 v54, v54, v56
    v_exp_f32 v57, v165
    s_nop 0
    v_add_f32 v54, v54, v57
    v_exp_f32_e64 v58, v166
    v_cvt_pk_bf16_f32 v68, v56, v57
    v_add_f32 v54, v54, v58
    v_exp_f32 v59, v167
    s_nop 0
    v_add_f32 v54, v54, v59
    v_exp_f32_e64 v56, v172
    v_cvt_pk_bf16_f32 v69, v58, v59
    v_add_f32 v54, v54, v56
    v_exp_f32 v57, v173
    s_nop 0
    v_add_f32 v54, v54, v57
    v_exp_f32_e64 v58, v174
    v_cvt_pk_bf16_f32 v70, v56, v57
    v_add_f32 v54, v54, v58
    v_exp_f32 v59, v175
    s_nop 0
    v_add_f32 v54, v54, v59
    v_cvt_pk_bf16_f32 v71, v58, v59
    v_exp_f32 v56, v176
    v_exp_f32 v57, v177
    s_nop 0
    v_add_f32 v55, v56, v57
    v_exp_f32_e64 v58, v178
    v_cvt_pk_bf16_f32 v72, v56, v57
    v_add_f32 v55, v55, v58
    v_exp_f32 v59, v179
    s_nop 0
    v_add_f32 v55, v55, v59
    v_exp_f32_e64 v56, v184
    v_cvt_pk_bf16_f32 v73, v58, v59
    s_nop 3
    s_setpc_b64 s[62:63]
parallel_sum__compressed_kv_cla__mixer_gmlp__prompt_kernel_rare1:
    s_nop 15
    v_max3_f32 v4, v176, v177, v178
    v_max3_f32 v4, v4, v179, v180
    v_max3_f32 v4, v4, v181, v182
    v_max3_f32 v4, v4, v183, v184
    v_max3_f32 v4, v4, v185, v186
    v_max3_f32 v4, v4, v187, v188
    v_max3_f32 v4, v4, v189, v190
    v_max_f32 v4, v4, v191
    v_mov_b32 v5, v4
    s_nop 1
    v_permlane32_swap_b32 v4, v5
    v_max_f32 v4, v4, v5
    v_max_f32 v4, 0, v4
    v_sub_f32 v5, 0, v4
    v_exp_f32 v5, v5
    v_sub_f32 v144, v144, v4
    v_sub_f32 v145, v145, v4
    v_sub_f32 v146, v146, v4
    v_sub_f32 v147, v147, v4
    v_sub_f32 v148, v148, v4
    v_sub_f32 v149, v149, v4
    v_sub_f32 v150, v150, v4
    v_sub_f32 v151, v151, v4
    v_sub_f32 v152, v152, v4
    v_sub_f32 v153, v153, v4
    v_sub_f32 v154, v154, v4
    v_sub_f32 v155, v155, v4
    v_sub_f32 v156, v156, v4
    v_sub_f32 v157, v157, v4
    v_sub_f32 v158, v158, v4
    v_sub_f32 v159, v159, v4
    v_sub_f32 v176, v176, v4
    v_sub_f32 v177, v177, v4
    v_sub_f32 v178, v178, v4
    v_sub_f32 v179, v179, v4
    v_sub_f32 v180, v180, v4
    v_sub_f32 v181, v181, v4
    v_sub_f32 v182, v182, v4
    v_sub_f32 v183, v183, v4
    v_sub_f32 v184, v184, v4
    v_sub_f32 v185, v185, v4
    v_sub_f32 v186, v186, v4
    v_sub_f32 v187, v187, v4
    v_sub_f32 v188, v188, v4
    v_sub_f32 v189, v189, v4
    v_sub_f32 v190, v190, v4
    v_sub_f32 v191, v191, v4
    v_sub_f32 v160, v160, v4
    v_sub_f32 v161, v161, v4
    v_sub_f32 v162, v162, v4
    v_sub_f32 v163, v163, v4
    v_sub_f32 v164, v164, v4
    v_sub_f32 v165, v165, v4
    v_sub_f32 v166, v166, v4
    v_sub_f32 v167, v167, v4
    v_sub_f32 v168, v168, v4
    v_sub_f32 v169, v169, v4
    v_sub_f32 v170, v170, v4
    v_sub_f32 v171, v171, v4
    v_sub_f32 v172, v172, v4
    v_sub_f32 v173, v173, v4
    v_sub_f32 v174, v174, v4
    v_sub_f32 v175, v175, v4
    v_mul_f32 v192, v192, v5
    v_mul_f32 v193, v193, v5
    v_mul_f32 v194, v194, v5
    v_mul_f32 v195, v195, v5
    v_mul_f32 v196, v196, v5
    v_mul_f32 v197, v197, v5
    v_mul_f32 v198, v198, v5
    v_mul_f32 v199, v199, v5
    v_mul_f32 v200, v200, v5
    v_mul_f32 v201, v201, v5
    v_mul_f32 v202, v202, v5
    v_mul_f32 v203, v203, v5
    v_mul_f32 v204, v204, v5
    v_mul_f32 v205, v205, v5
    v_mul_f32 v206, v206, v5
    v_mul_f32 v207, v207, v5
    v_mul_f32 v208, v208, v5
    v_mul_f32 v209, v209, v5
    v_mul_f32 v210, v210, v5
    v_mul_f32 v211, v211, v5
    v_mul_f32 v212, v212, v5
    v_mul_f32 v213, v213, v5
    v_mul_f32 v214, v214, v5
    v_mul_f32 v215, v215, v5
    v_mul_f32 v216, v216, v5
    v_mul_f32 v217, v217, v5
    v_mul_f32 v218, v218, v5
    v_mul_f32 v219, v219, v5
    v_mul_f32 v220, v220, v5
    v_mul_f32 v221, v221, v5
    v_mul_f32 v222, v222, v5
    v_mul_f32 v223, v223, v5
    v_mul_f32 v224, v224, v5
    v_mul_f32 v225, v225, v5
    v_mul_f32 v226, v226, v5
    v_mul_f32 v227, v227, v5
    v_mul_f32 v228, v228, v5
    v_mul_f32 v229, v229, v5
    v_mul_f32 v230, v230, v5
    v_mul_f32 v231, v231, v5
    v_mul_f32 v232, v232, v5
    v_mul_f32 v233, v233, v5
    v_mul_f32 v234, v234, v5
    v_mul_f32 v235, v235, v5
    v_mul_f32 v236, v236, v5
    v_mul_f32 v237, v237, v5
    v_mul_f32 v238, v238, v5
    v_mul_f32 v239, v239, v5
    v_mul_f32 v240, v240, v5
    v_mul_f32 v241, v241, v5
    v_mul_f32 v242, v242, v5
    v_mul_f32 v243, v243, v5
    v_mul_f32 v244, v244, v5
    v_mul_f32 v245, v245, v5
    v_mul_f32 v246, v246, v5
    v_mul_f32 v247, v247, v5
    v_mul_f32 v248, v248, v5
    v_mul_f32 v249, v249, v5
    v_mul_f32 v250, v250, v5
    v_mul_f32 v251, v251, v5
    v_mul_f32 v252, v252, v5
    v_mul_f32 v253, v253, v5
    v_mul_f32 v254, v254, v5
    v_mul_f32 v255, v255, v5
    v_mul_f32 v53, v53, v5
    v_exp_f32 v56, v176
    v_exp_f32 v57, v177
    s_nop 0
    v_add_f32 v55, v56, v57
    v_exp_f32_e64 v58, v178
    v_cvt_pk_bf16_f32 v72, v56, v57
    v_add_f32 v55, v55, v58
    v_exp_f32 v59, v179
    s_nop 0
    v_add_f32 v55, v55, v59
    v_exp_f32_e64 v56, v184
    v_cvt_pk_bf16_f32 v73, v58, v59
    v_add_f32 v55, v55, v56
    v_exp_f32 v57, v185
    s_nop 0
    v_add_f32 v55, v55, v57
    v_exp_f32_e64 v58, v186
    v_cvt_pk_bf16_f32 v74, v56, v57
    v_add_f32 v55, v55, v58
    v_exp_f32 v59, v187
    s_nop 0
    v_add_f32 v55, v55, v59
    v_exp_f32_e64 v56, v180
    v_cvt_pk_bf16_f32 v75, v58, v59
    v_add_f32 v55, v55, v56
    v_exp_f32 v57, v181
    s_nop 0
    v_add_f32 v55, v55, v57
    v_exp_f32_e64 v58, v182
    v_cvt_pk_bf16_f32 v76, v56, v57
    v_add_f32 v55, v55, v58
    v_exp_f32 v59, v183
    s_nop 0
    v_add_f32 v55, v55, v59
    v_exp_f32_e64 v56, v188
    v_cvt_pk_bf16_f32 v77, v58, v59
    v_add_f32 v55, v55, v56
    v_exp_f32 v57, v189
    s_nop 0
    v_add_f32 v55, v55, v57
    v_exp_f32_e64 v58, v190
    v_cvt_pk_bf16_f32 v78, v56, v57
    v_add_f32 v55, v55, v58
    v_exp_f32 v59, v191
    s_nop 0
    v_add_f32 v55, v55, v59
    v_cvt_pk_bf16_f32 v79, v58, v59
    v_exp_f32 v56, v160
    v_exp_f32 v57, v161
    s_nop 0
    v_add_f32 v54, v56, v57
    v_exp_f32_e64 v58, v162
    v_cvt_pk_bf16_f32 v64, v56, v57
    v_add_f32 v54, v54, v58
    v_exp_f32 v59, v163
    s_nop 0
    v_add_f32 v54, v54, v59
    v_exp_f32_e64 v56, v168
    v_cvt_pk_bf16_f32 v65, v58, v59
    s_nop 3
    s_setpc_b64 s[62:63]
parallel_sum__compressed_kv_cla__mixer_gmlp__prompt_kernel_hook:
    s_cmp_ge_u32 s3, 4
    s_cbranch_scc1 parallel_sum__compressed_kv_cla__mixer_gmlp__prompt_kernel_hook2
    s_cmp_lt_u32 s41, 5
    s_cbranch_scc1 parallel_sum__compressed_kv_cla__mixer_gmlp__prompt_kernel_hook2
    s_cmp_lt_u32 s41, 9
    s_cbranch_scc1 parallel_sum__compressed_kv_cla__mixer_gmlp__prompt_kernel_hook1
    buffer_load_dword v18, v19, s[28:31], s51 offen
    s_setpc_b64 s[62:63]
parallel_sum__compressed_kv_cla__mixer_gmlp__prompt_kernel_hook1:
    buffer_load_dword v18, v19, s[16:19], s50 offen
    s_setpc_b64 s[62:63]
parallel_sum__compressed_kv_cla__mixer_gmlp__prompt_kernel_hook2:
    s_cmp_lg_u32 s41, 0
    s_cbranch_scc1 hn_152
    s_add_u32 s12, s58, 262144
    buffer_store_dwordx4 v[20:23], v10, s[4:7], s12 offen offset:0 sc1
    s_add_u32 s12, s58, 262144
    buffer_store_dwordx4 v[24:27], v10, s[4:7], s12 offen offset:256 sc1
    s_setpc_b64 s[62:63]
hn_152:
    s_cmp_lg_u32 s41, 1
    s_cbranch_scc1 hn_153
    s_cmp_ge_u32 s3, 4
    s_cbranch_scc1 nw_154
    s_waitcnt vmcnt(2)
nw_154:
    s_add_u32 s12, s58, 262144
    s_add_u32 s12, s12, s59
    buffer_store_dwordx4 v[28:31], v10, s[4:7], s12 offen offset:0 sc1
    s_add_u32 s12, s58, 262144
    s_add_u32 s12, s12, s59
    buffer_store_dwordx4 v[32:35], v10, s[4:7], s12 offen offset:256 sc1
    s_setpc_b64 s[62:63]
hn_153:
    s_cmp_lg_u32 s41, 2
    s_cbranch_scc1 hn_155
    s_add_u32 s8, s33, 80
    s_cmp_lg_u32 s3, 4
    s_cbranch_scc1 sig_156
    s_lshl_b32 s14, s8, 8
    s_add_u32 s14, s14, 117440512
    v_mov_b32_e64 v8, 0
    v_mov_b32 v9, 1
    s_mov_b64 exec, 1
    buffer_atomic_add v9, v8, s[4:7], s14 offen sc1
    s_mov_b64 exec, -1
sig_156:
    s_add_u32 s12, s58, 270336
    buffer_store_dwordx4 v[36:39], v10, s[4:7], s12 offen offset:0 sc1
    s_add_u32 s12, s58, 270336
    buffer_store_dwordx4 v[40:43], v10, s[4:7], s12 offen offset:256 sc1
    s_setpc_b64 s[62:63]
hn_155:
    s_cmp_lg_u32 s41, 3
    s_cbranch_scc1 hn_157
    s_add_u32 s12, s58, 270336
    s_add_u32 s12, s12, s59
    buffer_store_dwordx4 v[44:47], v10, s[4:7], s12 offen offset:0 sc1
    s_add_u32 s12, s58, 270336
    s_add_u32 s12, s12, s59
    buffer_store_dwordx4 v[48:51], v10, s[4:7], s12 offen offset:256 sc1
    s_setpc_b64 s[62:63]
hn_157:
    s_cmp_lg_u32 s41, 4
    s_cbranch_scc1 hn_158
    s_waitcnt vmcnt(0)
    s_setpc_b64 s[62:63]
hn_158:
    s_cmp_lg_u32 s41, 5
    s_cbranch_scc1 hn_159
    s_add_u32 s8, s60, 32
    s_cmp_lg_u32 s3, 4
    s_cbranch_scc1 sig_160
    s_lshl_b32 s14, s8, 8
    s_add_u32 s14, s14, 117440512
    v_mov_b32 v8, 0
    v_mov_b32 v9, 1
    s_mov_b64 exec, 1
    buffer_atomic_add v9, v8, s[4:7], s14 offen sc1
    s_mov_b64 exec, -1
sig_160:
    s_setpc_b64 s[62:63]
hn_159:
    s_cmp_lg_u32 s41, 10
    s_cbranch_scc1 hn_161
    s_lshr_b32 s8, s32, 1
    s_add_u32 s8, s8, 48
    s_lshl_b32 s14, s8, 8
    s_add_u32 s14, s14, 117440512
    v_and_b32 v8, 0, v1
    v_lshlrev_b32_e64 v8, 8, v8
    buffer_load_dword v17, v8, s[4:7], s14 offen sc1
    s_setpc_b64 s[62:63]
hn_161:
    s_cmp_lg_u32 s41, 12
    s_cbranch_scc1 hn_162
    s_lshr_b32 s8, s32, 1
    s_add_u32 s8, s8, 48
    s_mov_b32 s15, 0x20000
poll_163:
    v_cmp_gt_u32 vcc, 16, v17
    s_cbranch_vccz polld_164
    s_sleep 2
    s_lshl_b32 s14, s8, 8
    s_add_u32 s14, s14, 117440512
    v_and_b32 v8, 0, v1
    v_lshlrev_b32_e64 v8, 8, v8
    buffer_load_dword v17, v8, s[4:7], s14 offen sc1
    s_waitcnt vmcnt(0)
    s_sub_u32 s15, s15, 1
    s_cmp_lg_u32 s15, 0
    s_cbranch_scc1 poll_163
polld_164:
    s_setpc_b64 s[62:63]
hn_162:
parallel_sum__compressed_kv_cla__mixer_gmlp__prompt_kernel_hookret:
    s_setpc_b64 s[62:63]
parallel_sum__compressed_kv_cla__mixer_gmlp__prompt_kernel_at_done:
    s_load_dwordx2 s[10:11], s[0:1], 72
    s_load_dwordx2 s[12:13], s[0:1], 88
    s_load_dwordx2 s[64:65], s[0:1], 0
    s_mov_b32 s8, 88
    s_lshl_b32 s14, s8, 8
    s_add_u32 s14, s14, 117440512
    v_and_b32 v8, 7, v1
    v_lshlrev_b32_e64 v8, 8, v8
    buffer_load_dword v26, v8, s[4:7], s14 offen sc1
    s_and_b32 s34, s2, 7
    s_bfe_u32 s35, s2, 0x20003
    s_lshr_b32 s36, s2, 5
    s_lshl_b32 s33, s34, 2
    s_add_u32 s33, s33, s35
    s_lshl_b32 s8, s34, 2
    s_lshr_b32 s9, s36, 1
    s_add_u32 s8, s8, s9
    s_add_u32 s37, s8, 96
    v_lshrrev_b32 v6, 4, v1
    v_lshrrev_b32 v4, 3, v1
    v_and_b32 v5, 7, v1
    v_lshrrev_b32 v7, 1, v5
    v_and_b32 v5, 1, v5
    v_xor_b32 v7, v7, v6
    v_lshlrev_b32 v7, 5, v7
    v_lshl_add_u32 v7, v5, 4, v7
    v_lshl_add_u32 v27, v4, 10, v7
    s_lshl_b32 s30, s3, 13
    s_lshl_b32 s8, s36, 7
    s_add_u32 s100, s30, s8
    s_lshl_b32 s101, s3, 10
    s_and_b32 s32, s36, 3
    s_bitcmp1_b32 s36, 2
    s_cbranch_scc1 parallel_sum__compressed_kv_cla__mixer_gmlp__prompt_kernel_t_s
    v_and_b32 v5, 15, v1
    v_lshrrev_b32 v4, 1, v5
    v_and_b32 v5, 1, v5
    v_xor_b32 v4, v4, v6
    v_lshlrev_b32 v4, 5, v4
    v_lshl_add_u32 v4, v5, 4, v4
    v_lshl_add_u32 v24, v6, 10, v4
    v_xor_b32 v25, 128, v24
    s_lshl_b32 s40, s34, 19
    s_lshl_b32 s8, s3, 14
    s_add_u32 s40, s40, s8
    s_lshl_b32 s8, s35, 8
    s_add_u32 s40, s40, s8
    s_lshl_b32 s41, s3, 12
    s_bfe_u32 s8, s3, 0x10001
    s_lshl_b32 s9, s32, 1
    s_add_u32 s8, s8, s9
    s_lshl_b32 s43, s34, 2
    s_add_u32 s43, s43, s32
    s_add_u32 s43, s43, 96
    s_sub_u32 s9, 15, s8
    s_cmp_ge_u32 s3, 4
    s_cselect_b32 s8, s9, s8
    s_lshl_b32 s8, s8, 3
    s_and_b32 s9, s3, 1
    s_lshl_b32 s9, s9, 2
    s_add_u32 s44, s8, s9
    s_mul_i32 s42, s44, 150
    s_lshl_b32 s8, s34, 4
    s_add_u32 s42, s42, s8
    s_lshl_b32 s42, s42, 10
    s_add_u32 s42, s42, 35651584
    v_and_b32 v4, 15, v1
    v_lshrrev_b32 v4, 2, v4
    v_lshl_add_u32 v7, v6, 2, v4
    v_and_b32 v5, 7, v7
    v_and_b32 v4, 3, v1
    v_lshlrev_b32_e64 v4, 3, v4
    v_lshl_add_u32 v4, v7, 8, v4
    v_xor_b32_e64 v3, 0, v5
    v_lshl_add_u32 v16, v3, 5, v4
    v_xor_b32_e64 v3, 1, v5
    v_lshl_add_u32 v17, v3, 5, v4
    v_xor_b32_e64 v3, 2, v5
    v_lshl_add_u32 v18, v3, 5, v4
    v_xor_b32_e64 v3, 3, v5
    v_lshl_add_u32 v19, v3, 5, v4
    v_xor_b32_e64 v3, 4, v5
    v_lshl_add_u32 v20, v3, 5, v4
    v_xor_b32_e64 v3, 5, v5
    v_lshl_add_u32 v21, v3, 5, v4
    v_xor_b32_e64 v3, 6, v5
    v_lshl_add_u32 v22, v3, 5, v4
    v_xor_b32_e64 v3, 7, v5
    v_lshl_add_u32 v23, v3, 5, v4
    s_waitcnt vmcnt(0) lgkmcnt(0)
    s_mov_b32 s28, s10
    s_and_b32 s29, s11, 0xffff
    s_mov_b32 s30, 0x1000
    s_mov_b32 s31, 0x00020000
    s_mov_b32 s60, s12
    s_and_b32 s61, s13, 0xffff
    s_mov_b32 s62, 0x200000
    s_mov_b32 s63, 0x00020000
    s_mov_b32 s64, s64
    s_and_b32 s65, s65, 0xffff
    s_mov_b32 s66, 0x200000
    s_mov_b32 s67, 0x00020000
    s_barrier
    s_cmp_lg_u32 s3, 0
    s_cbranch_scc1 sig_165
    s_lshl_b32 s14, s37, 8
    s_add_u32 s14, s14, 117440512
    v_mov_b32_e64 v8, 0
    v_mov_b32 v9, 1
    s_mov_b64 exec, 1
    buffer_atomic_add v9, v8, s[4:7], s14 offen sc1
    s_mov_b64 exec, -1
sig_165:
    s_lshl_b32 s14, s43, 8
    s_add_u32 s14, s14, 117440512
    v_and_b32 v8, 0, v1
    v_lshlrev_b32 v8, 8, v8
    buffer_load_dword v26, v8, s[4:7], s14 offen sc1
    s_add_u32 m0, s41, 0
    s_add_u32 s12, s40, 0
    buffer_load_dwordx4 v24, s[20:23], s12 offen lds
    s_add_u32 m0, s41, 1024
    s_add_u32 s12, s40, 4096
    buffer_load_dwordx4 v25, s[20:23], s12 offen lds
    s_add_u32 m0, s41, 2048
    s_add_u32 s12, s40, 8192
    buffer_load_dwordx4 v24, s[20:23], s12 offen lds
    s_add_u32 m0, s41, 3072
    s_add_u32 s12, s40, 12288
    buffer_load_dwordx4 v25, s[20:23], s12 offen lds
    s_waitcnt vmcnt(4)
    s_mov_b32 s15, 0x20000
poll_166:
    v_cmp_gt_u32 vcc, 8, v26
    s_cbranch_vccz polld_167
    s_sleep 2
    s_lshl_b32 s14, s43, 8
    s_add_u32 s14, s14, 117440512
    v_and_b32 v8, 0, v1
    v_lshlrev_b32_e64 v8, 8, v8
    buffer_load_dword v26, v8, s[4:7], s14 offen sc1
    s_waitcnt vmcnt(0)
    s_sub_u32 s15, s15, 1
    s_cmp_lg_u32 s15, 0
    s_cbranch_scc1 poll_166
polld_167:
    s_add_u32 s12, s42, 0
    buffer_load_dwordx4 v[64:67], v2, s[4:7], s12 offen offset:0 sc1
    s_add_u32 s12, s42, 153600
    buffer_load_dwordx4 v[68:71], v2, s[4:7], s12 offen offset:0 sc1
    s_add_u32 s12, s42, 307200
    buffer_load_dwordx4 v[72:75], v2, s[4:7], s12 offen offset:0 sc1
    s_add_u32 s12, s42, 460800
    buffer_load_dwordx4 v[76:79], v2, s[4:7], s12 offen offset:0 sc1
    s_add_u32 s12, s42, 0
    buffer_load_dwordx4 v[80:83], v2, s[4:7], s12 offen offset:1024 sc1
    s_add_u32 s12, s42, 153600
    buffer_load_dwordx4 v[84:87], v2, s[4:7], s12 offen offset:1024 sc1
    s_add_u32 s12, s42, 307200
    buffer_load_dwordx4 v[88:91], v2, s[4:7], s12 offen offset:1024 sc1
    s_add_u32 s12, s42, 460800
    buffer_load_dwordx4 v[92:95], v2, s[4:7], s12 offen offset:1024 sc1
    s_waitcnt vmcnt(8)
    s_barrier
    ds_read_b64_tr_b16 v[32:33], v16 offset:0
    ds_read_b64_tr_b16 v[34:35], v16 offset:4096
    ds_read_b64_tr_b16 v[36:37], v17 offset:0
    ds_read_b64_tr_b16 v[38:39], v17 offset:4096
    ds_read_b64_tr_b16 v[40:41], v18 offset:0
    ds_read_b64_tr_b16 v[42:43], v18 offset:4096
    ds_read_b64_tr_b16 v[44:45], v19 offset:0
    ds_read_b64_tr_b16 v[46:47], v19 offset:4096
    ds_read_b64_tr_b16 v[48:49], v20 offset:0
    ds_read_b64_tr_b16 v[50:51], v20 offset:4096
    ds_read_b64_tr_b16 v[52:53], v21 offset:0
    ds_read_b64_tr_b16 v[54:55], v21 offset:4096
    ds_read_b64_tr_b16 v[56:57], v22 offset:0
    ds_read_b64_tr_b16 v[58:59], v22 offset:4096
    ds_read_b64_tr_b16 v[60:61], v23 offset:0
    ds_read_b64_tr_b16 v[62:63], v23 offset:4096
    s_waitcnt vmcnt(4)
    s_waitcnt lgkmcnt(12)
    v_mfma_f32_16x16x32_bf16 v[128:131], v[32:35], v[64:67], 0
    v_mfma_f32_16x16x32_bf16 v[132:135], v[32:35], v[68:71], 0
    v_mfma_f32_16x16x32_bf16 v[136:139], v[32:35], v[72:75], 0
    v_mfma_f32_16x16x32_bf16 v[140:143], v[32:35], v[76:79], 0
    ds_read_b64_tr_b16 v[32:33], v16 offset:8192
    ds_read_b64_tr_b16 v[34:35], v16 offset:12288
    s_add_u32 m0, s41, 32768
    s_add_u32 s12, s40, 131072
    buffer_load_dwordx4 v24, s[20:23], s12 offen lds
    v_mfma_f32_16x16x32_bf16 v[144:147], v[36:39], v[64:67], 0
    v_mfma_f32_16x16x32_bf16 v[148:151], v[36:39], v[68:71], 0
    v_mfma_f32_16x16x32_bf16 v[152:155], v[36:39], v[72:75], 0
    v_mfma_f32_16x16x32_bf16 v[156:159], v[36:39], v[76:79], 0
    ds_read_b64_tr_b16 v[36:37], v17 offset:8192
    ds_read_b64_tr_b16 v[38:39], v17 offset:12288
    s_add_u32 m0, s41, 33792
    s_add_u32 s12, s40, 135168
    buffer_load_dwordx4 v25, s[20:23], s12 offen lds
    s_waitcnt lgkmcnt(12)
    v_mfma_f32_16x16x32_bf16 v[160:163], v[40:43], v[64:67], 0
    v_mfma_f32_16x16x32_bf16 v[164:167], v[40:43], v[68:71], 0
    v_mfma_f32_16x16x32_bf16 v[168:171], v[40:43], v[72:75], 0
    v_mfma_f32_16x16x32_bf16 v[172:175], v[40:43], v[76:79], 0
    ds_read_b64_tr_b16 v[40:41], v18 offset:8192
    ds_read_b64_tr_b16 v[42:43], v18 offset:12288
    s_add_u32 m0, s41, 34816
    s_add_u32 s12, s40, 139264
    buffer_load_dwordx4 v24, s[20:23], s12 offen lds
    v_mfma_f32_16x16x32_bf16 v[176:179], v[44:47], v[64:67], 0
    v_mfma_f32_16x16x32_bf16 v[180:183], v[44:47], v[68:71], 0
    v_mfma_f32_16x16x32_bf16 v[184:187], v[44:47], v[72:75], 0
    v_mfma_f32_16x16x32_bf16 v[188:191], v[44:47], v[76:79], 0
    ds_read_b64_tr_b16 v[44:45], v19 offset:8192
    ds_read_b64_tr_b16 v[46:47], v19 offset:12288
    s_add_u32 m0, s41, 35840
    s_add_u32 s12, s40, 143360
    buffer_load_dwordx4 v25, s[20:23], s12 offen lds
    s_waitcnt lgkmcnt(12)
    v_mfma_f32_16x16x32_bf16 v[192:195], v[48:51], v[64:67], 0
    v_mfma_f32_16x16x32_bf16 v[196:199], v[48:51], v[68:71], 0
    v_mfma_f32_16x16x32_bf16 v[200:203], v[48:51], v[72:75], 0
    v_mfma_f32_16x16x32_bf16 v[204:207], v[48:51], v[76:79], 0
    ds_read_b64_tr_b16 v[48:49], v20 offset:8192
    ds_read_b64_tr_b16 v[50:51], v20 offset:12288
    s_add_u32 s12, s42, 0
    buffer_load_dwordx4 v[96:99], v2, s[4:7], s12 offen offset:2048 sc1
    v_mfma_f32_16x16x32_bf16 v[208:211], v[52:55], v[64:67], 0
    v_mfma_f32_16x16x32_bf16 v[212:215], v[52:55], v[68:71], 0
    v_mfma_f32_16x16x32_bf16 v[216:219], v[52:55], v[72:75], 0
    v_mfma_f32_16x16x32_bf16 v[220:223], v[52:55], v[76:79], 0
    ds_read_b64_tr_b16 v[52:53], v21 offset:8192
    ds_read_b64_tr_b16 v[54:55], v21 offset:12288
    s_add_u32 s12, s42, 153600
    buffer_load_dwordx4 v[100:103], v2, s[4:7], s12 offen offset:2048 sc1
    s_waitcnt lgkmcnt(12)
    v_mfma_f32_16x16x32_bf16 v[224:227], v[56:59], v[64:67], 0
    v_mfma_f32_16x16x32_bf16 v[228:231], v[56:59], v[68:71], 0
    v_mfma_f32_16x16x32_bf16 v[232:235], v[56:59], v[72:75], 0
    v_mfma_f32_16x16x32_bf16 v[236:239], v[56:59], v[76:79], 0
    ds_read_b64_tr_b16 v[56:57], v22 offset:8192
    ds_read_b64_tr_b16 v[58:59], v22 offset:12288
    s_add_u32 s12, s42, 307200
    buffer_load_dwordx4 v[104:107], v2, s[4:7], s12 offen offset:2048 sc1
    v_mfma_f32_16x16x32_bf16 v[240:243], v[60:63], v[64:67], 0
    v_mfma_f32_16x16x32_bf16 v[244:247], v[60:63], v[68:71], 0
    v_mfma_f32_16x16x32_bf16 v[248:251], v[60:63], v[72:75], 0
    v_mfma_f32_16x16x32_bf16 v[252:255], v[60:63], v[76:79], 0
    ds_read_b64_tr_b16 v[60:61], v23 offset:8192
    ds_read_b64_tr_b16 v[62:63], v23 offset:12288
    s_add_u32 s12, s42, 460800
    buffer_load_dwordx4 v[108:111], v2, s[4:7], s12 offen offset:2048 sc1
    s_add_u32 s12, s42, 4096
    buffer_load_dwordx4 v[64:67], v2, s[4:7], s12 offen offset:0 sc1
    s_add_u32 s12, s42, 157696
    buffer_load_dwordx4 v[68:71], v2, s[4:7], s12 offen offset:0 sc1
    s_add_u32 s12, s42, 311296
    buffer_load_dwordx4 v[72:75], v2, s[4:7], s12 offen offset:0 sc1
    s_add_u32 s12, s42, 464896
    buffer_load_dwordx4 v[76:79], v2, s[4:7], s12 offen offset:0 sc1
    s_waitcnt vmcnt(12)
    s_waitcnt lgkmcnt(12)
    v_mfma_f32_16x16x32_bf16 v[128:131], v[32:35], v[80:83], v[128:131]
    v_mfma_f32_16x16x32_bf16 v[132:135], v[32:35], v[84:87], v[132:135]
    v_mfma_f32_16x16x32_bf16 v[136:139], v[32:35], v[88:91], v[136:139]
    v_mfma_f32_16x16x32_bf16 v[140:143], v[32:35], v[92:95], v[140:143]
    ds_read_b64_tr_b16 v[32:33], v16 offset:16384
    ds_read_b64_tr_b16 v[34:35], v16 offset:20480
    s_add_u32 s12, s42, 0
    buffer_load_dwordx4 v[112:115], v2, s[4:7], s12 offen offset:3072 sc1
    v_mfma_f32_16x16x32_bf16 v[144:147], v[36:39], v[80:83], v[144:147]
    v_mfma_f32_16x16x32_bf16 v[148:151], v[36:39], v[84:87], v[148:151]
    v_mfma_f32_16x16x32_bf16 v[152:155], v[36:39], v[88:91], v[152:155]
    v_mfma_f32_16x16x32_bf16 v[156:159], v[36:39], v[92:95], v[156:159]
    ds_read_b64_tr_b16 v[36:37], v17 offset:16384
    ds_read_b64_tr_b16 v[38:39], v17 offset:20480
    s_add_u32 s12, s42, 153600
    buffer_load_dwordx4 v[116:119], v2, s[4:7], s12 offen offset:3072 sc1
    s_waitcnt lgkmcnt(12)
    v_mfma_f32_16x16x32_bf16 v[160:163], v[40:43], v[80:83], v[160:163]
    v_mfma_f32_16x16x32_bf16 v[164:167], v[40:43], v[84:87], v[164:167]
    v_mfma_f32_16x16x32_bf16 v[168:171], v[40:43], v[88:91], v[168:171]
    v_mfma_f32_16x16x32_bf16 v[172:175], v[40:43], v[92:95], v[172:175]
    ds_read_b64_tr_b16 v[40:41], v18 offset:16384
    ds_read_b64_tr_b16 v[42:43], v18 offset:20480
    s_add_u32 s12, s42, 307200
    buffer_load_dwordx4 v[120:123], v2, s[4:7], s12 offen offset:3072 sc1
    v_mfma_f32_16x16x32_bf16 v[176:179], v[44:47], v[80:83], v[176:179]
    v_mfma_f32_16x16x32_bf16 v[180:183], v[44:47], v[84:87], v[180:183]
    v_mfma_f32_16x16x32_bf16 v[184:187], v[44:47], v[88:91], v[184:187]
    v_mfma_f32_16x16x32_bf16 v[188:191], v[44:47], v[92:95], v[188:191]
    ds_read_b64_tr_b16 v[44:45], v19 offset:16384
    ds_read_b64_tr_b16 v[46:47], v19 offset:20480
    s_add_u32 s12, s42, 460800
    buffer_load_dwordx4 v[124:127], v2, s[4:7], s12 offen offset:3072 sc1
    s_waitcnt lgkmcnt(12)
    v_mfma_f32_16x16x32_bf16 v[192:195], v[48:51], v[80:83], v[192:195]
    v_mfma_f32_16x16x32_bf16 v[196:199], v[48:51], v[84:87], v[196:199]
    v_mfma_f32_16x16x32_bf16 v[200:203], v[48:51], v[88:91], v[200:203]
    v_mfma_f32_16x16x32_bf16 v[204:207], v[48:51], v[92:95], v[204:207]
    ds_read_b64_tr_b16 v[48:49], v20 offset:16384
    ds_read_b64_tr_b16 v[50:51], v20 offset:20480
    s_add_u32 m0, s41, 65536
    s_add_u32 s12, s40, 262144
    buffer_load_dwordx4 v24, s[20:23], s12 offen lds
    v_mfma_f32_16x16x32_bf16 v[208:211], v[52:55], v[80:83], v[208:211]
    v_mfma_f32_16x16x32_bf16 v[212:215], v[52:55], v[84:87], v[212:215]
    v_mfma_f32_16x16x32_bf16 v[216:219], v[52:55], v[88:91], v[216:219]
    v_mfma_f32_16x16x32_bf16 v[220:223], v[52:55], v[92:95], v[220:223]
    ds_read_b64_tr_b16 v[52:53], v21 offset:16384
    ds_read_b64_tr_b16 v[54:55], v21 offset:20480
    s_add_u32 m0, s41, 66560
    s_add_u32 s12, s40, 266240
    buffer_load_dwordx4 v25, s[20:23], s12 offen lds
    s_waitcnt lgkmcnt(12)
    v_mfma_f32_16x16x32_bf16 v[224:227], v[56:59], v[80:83], v[224:227]
    v_mfma_f32_16x16x32_bf16 v[228:231], v[56:59], v[84:87], v[228:231]
    v_mfma_f32_16x16x32_bf16 v[232:235], v[56:59], v[88:91], v[232:235]
    v_mfma_f32_16x16x32_bf16 v[236:239], v[56:59], v[92:95], v[236:239]
    ds_read_b64_tr_b16 v[56:57], v22 offset:16384
    ds_read_b64_tr_b16 v[58:59], v22 offset:20480
    s_add_u32 m0, s41, 67584
    s_add_u32 s12, s40, 270336
    buffer_load_dwordx4 v24, s[20:23], s12 offen lds
    v_mfma_f32_16x16x32_bf16 v[240:243], v[60:63], v[80:83], v[240:243]
    v_mfma_f32_16x16x32_bf16 v[244:247], v[60:63], v[84:87], v[244:247]
    v_mfma_f32_16x16x32_bf16 v[248:251], v[60:63], v[88:91], v[248:251]
    v_mfma_f32_16x16x32_bf16 v[252:255], v[60:63], v[92:95], v[252:255]
    ds_read_b64_tr_b16 v[60:61], v23 offset:16384
    ds_read_b64_tr_b16 v[62:63], v23 offset:20480
    s_add_u32 m0, s41, 68608
    s_add_u32 s12, s40, 274432
    buffer_load_dwordx4 v25, s[20:23], s12 offen lds
    s_add_u32 s12, s42, 4096
    buffer_load_dwordx4 v[80:83], v2, s[4:7], s12 offen offset:1024 sc1
    s_add_u32 s12, s42, 157696
    buffer_load_dwordx4 v[84:87], v2, s[4:7], s12 offen offset:1024 sc1
    s_add_u32 s12, s42, 311296
    buffer_load_dwordx4 v[88:91], v2, s[4:7], s12 offen offset:1024 sc1
    s_add_u32 s12, s42, 464896
    buffer_load_dwordx4 v[92:95], v2, s[4:7], s12 offen offset:1024 sc1
    s_waitcnt vmcnt(16)
    s_waitcnt lgkmcnt(12)
    v_mfma_f32_16x16x32_bf16 v[128:131], v[32:35], v[96:99], v[128:131]
    v_mfma_f32_16x16x32_bf16 v[132:135], v[32:35], v[100:103], v[132:135]
    v_mfma_f32_16x16x32_bf16 v[136:139], v[32:35], v[104:107], v[136:139]
    v_mfma_f32_16x16x32_bf16 v[140:143], v[32:35], v[108:111], v[140:143]
    ds_read_b64_tr_b16 v[32:33], v16 offset:24576
    ds_read_b64_tr_b16 v[34:35], v16 offset:28672
    s_add_u32 m0, s41, 98304
    s_add_u32 s12, s40, 393216
    buffer_load_dwordx4 v24, s[20:23], s12 offen lds
    v_mfma_f32_16x16x32_bf16 v[144:147], v[36:39], v[96:99], v[144:147]
    v_mfma_f32_16x16x32_bf16 v[148:151], v[36:39], v[100:103], v[148:151]
    v_mfma_f32_16x16x32_bf16 v[152:155], v[36:39], v[104:107], v[152:155]
    v_mfma_f32_16x16x32_bf16 v[156:159], v[36:39], v[108:111], v[156:159]
    ds_read_b64_tr_b16 v[36:37], v17 offset:24576
    ds_read_b64_tr_b16 v[38:39], v17 offset:28672
    s_add_u32 m0, s41, 99328
    s_add_u32 s12, s40, 397312
    buffer_load_dwordx4 v25, s[20:23], s12 offen lds
    s_waitcnt lgkmcnt(12)
    v_mfma_f32_16x16x32_bf16 v[160:163], v[40:43], v[96:99], v[160:163]
    v_mfma_f32_16x16x32_bf16 v[164:167], v[40:43], v[100:103], v[164:167]
    v_mfma_f32_16x16x32_bf16 v[168:171], v[40:43], v[104:107], v[168:171]
    v_mfma_f32_16x16x32_bf16 v[172:175], v[40:43], v[108:111], v[172:175]
    ds_read_b64_tr_b16 v[40:41], v18 offset:24576
    ds_read_b64_tr_b16 v[42:43], v18 offset:28672
    s_add_u32 m0, s41, 100352
    s_add_u32 s12, s40, 401408
    buffer_load_dwordx4 v24, s[20:23], s12 offen lds
    v_mfma_f32_16x16x32_bf16 v[176:179], v[44:47], v[96:99], v[176:179]
    v_mfma_f32_16x16x32_bf16 v[180:183], v[44:47], v[100:103], v[180:183]
    v_mfma_f32_16x16x32_bf16 v[184:187], v[44:47], v[104:107], v[184:187]
    v_mfma_f32_16x16x32_bf16 v[188:191], v[44:47], v[108:111], v[188:191]
    ds_read_b64_tr_b16 v[44:45], v19 offset:24576
    ds_read_b64_tr_b16 v[46:47], v19 offset:28672
    s_add_u32 m0, s41, 101376
    s_add_u32 s12, s40, 405504
    buffer_load_dwordx4 v25, s[20:23], s12 offen lds
    s_waitcnt lgkmcnt(12)
    v_mfma_f32_16x16x32_bf16 v[192:195], v[48:51], v[96:99], v[192:195]
    v_mfma_f32_16x16x32_bf16 v[196:199], v[48:51], v[100:103], v[196:199]
    v_mfma_f32_16x16x32_bf16 v[200:203], v[48:51], v[104:107], v[200:203]
    v_mfma_f32_16x16x32_bf16 v[204:207], v[48:51], v[108:111], v[204:207]
    ds_read_b64_tr_b16 v[48:49], v20 offset:24576
    ds_read_b64_tr_b16 v[50:51], v20 offset:28672
    v_mfma_f32_16x16x32_bf16 v[208:211], v[52:55], v[96:99], v[208:211]
    v_mfma_f32_16x16x32_bf16 v[212:215], v[52:55], v[100:103], v[212:215]
    v_mfma_f32_16x16x32_bf16 v[216:219], v[52:55], v[104:107], v[216:219]
    v_mfma_f32_16x16x32_bf16 v[220:223], v[52:55], v[108:111], v[220:223]
    ds_read_b64_tr_b16 v[52:53], v21 offset:24576
    ds_read_b64_tr_b16 v[54:55], v21 offset:28672
    s_waitcnt lgkmcnt(12)
    v_mfma_f32_16x16x32_bf16 v[224:227], v[56:59], v[96:99], v[224:227]
    v_mfma_f32_16x16x32_bf16 v[228:231], v[56:59], v[100:103], v[228:231]
    v_mfma_f32_16x16x32_bf16 v[232:235], v[56:59], v[104:107], v[232:235]
    v_mfma_f32_16x16x32_bf16 v[236:239], v[56:59], v[108:111], v[236:239]
    ds_read_b64_tr_b16 v[56:57], v22 offset:24576
    ds_read_b64_tr_b16 v[58:59], v22 offset:28672
    v_mfma_f32_16x16x32_bf16 v[240:243], v[60:63], v[96:99], v[240:243]
    v_mfma_f32_16x16x32_bf16 v[244:247], v[60:63], v[100:103], v[244:247]
    v_mfma_f32_16x16x32_bf16 v[248:251], v[60:63], v[104:107], v[248:251]
    v_mfma_f32_16x16x32_bf16 v[252:255], v[60:63], v[108:111], v[252:255]
    ds_read_b64_tr_b16 v[60:61], v23 offset:24576
    ds_read_b64_tr_b16 v[62:63], v23 offset:28672
    s_add_u32 s12, s42, 4096
    buffer_load_dwordx4 v[96:99], v2, s[4:7], s12 offen offset:2048 sc1
    s_add_u32 s12, s42, 157696
    buffer_load_dwordx4 v[100:103], v2, s[4:7], s12 offen offset:2048 sc1
    s_add_u32 s12, s42, 311296
    buffer_load_dwordx4 v[104:107], v2, s[4:7], s12 offen offset:2048 sc1
    s_add_u32 s12, s42, 464896
    buffer_load_dwordx4 v[108:111], v2, s[4:7], s12 offen offset:2048 sc1
    s_waitcnt vmcnt(16)
    s_waitcnt vmcnt(28)
    s_barrier
    s_waitcnt lgkmcnt(12)
    v_mfma_f32_16x16x32_bf16 v[128:131], v[32:35], v[112:115], v[128:131]
    v_mfma_f32_16x16x32_bf16 v[132:135], v[32:35], v[116:119], v[132:135]
    v_mfma_f32_16x16x32_bf16 v[136:139], v[32:35], v[120:123], v[136:139]
    v_mfma_f32_16x16x32_bf16 v[140:143], v[32:35], v[124:127], v[140:143]
    ds_read_b64_tr_b16 v[32:33], v16 offset:32768
    ds_read_b64_tr_b16 v[34:35], v16 offset:36864
    v_mfma_f32_16x16x32_bf16 v[144:147], v[36:39], v[112:115], v[144:147]
    v_mfma_f32_16x16x32_bf16 v[148:151], v[36:39], v[116:119], v[148:151]
    v_mfma_f32_16x16x32_bf16 v[152:155], v[36:39], v[120:123], v[152:155]
    v_mfma_f32_16x16x32_bf16 v[156:159], v[36:39], v[124:127], v[156:159]
    ds_read_b64_tr_b16 v[36:37], v17 offset:32768
    ds_read_b64_tr_b16 v[38:39], v17 offset:36864
    s_waitcnt lgkmcnt(12)
    v_mfma_f32_16x16x32_bf16 v[160:163], v[40:43], v[112:115], v[160:163]
    v_mfma_f32_16x16x32_bf16 v[164:167], v[40:43], v[116:119], v[164:167]
    v_mfma_f32_16x16x32_bf16 v[168:171], v[40:43], v[120:123], v[168:171]
    v_mfma_f32_16x16x32_bf16 v[172:175], v[40:43], v[124:127], v[172:175]
    ds_read_b64_tr_b16 v[40:41], v18 offset:32768
    ds_read_b64_tr_b16 v[42:43], v18 offset:36864
    v_mfma_f32_16x16x32_bf16 v[176:179], v[44:47], v[112:115], v[176:179]
    v_mfma_f32_16x16x32_bf16 v[180:183], v[44:47], v[116:119], v[180:183]
    v_mfma_f32_16x16x32_bf16 v[184:187], v[44:47], v[120:123], v[184:187]
    v_mfma_f32_16x16x32_bf16 v[188:191], v[44:47], v[124:127], v[188:191]
    ds_read_b64_tr_b16 v[44:45], v19 offset:32768
    ds_read_b64_tr_b16 v[46:47], v19 offset:36864
    s_waitcnt lgkmcnt(12)
    v_mfma_f32_16x16x32_bf16 v[192:195], v[48:51], v[112:115], v[192:195]
    v_mfma_f32_16x16x32_bf16 v[196:199], v[48:51], v[116:119], v[196:199]
    v_mfma_f32_16x16x32_bf16 v[200:203], v[48:51], v[120:123], v[200:203]
    v_mfma_f32_16x16x32_bf16 v[204:207], v[48:51], v[124:127], v[204:207]
    ds_read_b64_tr_b16 v[48:49], v20 offset:32768
    ds_read_b64_tr_b16 v[50:51], v20 offset:36864
    v_mfma_f32_16x16x32_bf16 v[208:211], v[52:55], v[112:115], v[208:211]
    v_mfma_f32_16x16x32_bf16 v[212:215], v[52:55], v[116:119], v[212:215]
    v_mfma_f32_16x16x32_bf16 v[216:219], v[52:55], v[120:123], v[216:219]
    v_mfma_f32_16x16x32_bf16 v[220:223], v[52:55], v[124:127], v[220:223]
    ds_read_b64_tr_b16 v[52:53], v21 offset:32768
    ds_read_b64_tr_b16 v[54:55], v21 offset:36864
    s_waitcnt lgkmcnt(12)
    v_mfma_f32_16x16x32_bf16 v[224:227], v[56:59], v[112:115], v[224:227]
    v_mfma_f32_16x16x32_bf16 v[228:231], v[56:59], v[116:119], v[228:231]
    v_mfma_f32_16x16x32_bf16 v[232:235], v[56:59], v[120:123], v[232:235]
    v_mfma_f32_16x16x32_bf16 v[236:239], v[56:59], v[124:127], v[236:239]
    ds_read_b64_tr_b16 v[56:57], v22 offset:32768
    ds_read_b64_tr_b16 v[58:59], v22 offset:36864
    v_mfma_f32_16x16x32_bf16 v[240:243], v[60:63], v[112:115], v[240:243]
    v_mfma_f32_16x16x32_bf16 v[244:247], v[60:63], v[116:119], v[244:247]
    v_mfma_f32_16x16x32_bf16 v[248:251], v[60:63], v[120:123], v[248:251]
    v_mfma_f32_16x16x32_bf16 v[252:255], v[60:63], v[124:127], v[252:255]
    ds_read_b64_tr_b16 v[60:61], v23 offset:32768
    ds_read_b64_tr_b16 v[62:63], v23 offset:36864
    s_add_u32 s12, s42, 4096
    buffer_load_dwordx4 v[112:115], v2, s[4:7], s12 offen offset:3072 sc1
    s_add_u32 s12, s42, 157696
    buffer_load_dwordx4 v[116:119], v2, s[4:7], s12 offen offset:3072 sc1
    s_add_u32 s12, s42, 311296
    buffer_load_dwordx4 v[120:123], v2, s[4:7], s12 offen offset:3072 sc1
    s_add_u32 s12, s42, 464896
    buffer_load_dwordx4 v[124:127], v2, s[4:7], s12 offen offset:3072 sc1
    s_waitcnt vmcnt(24)
    s_waitcnt lgkmcnt(12)
    v_mfma_f32_16x16x32_bf16 v[128:131], v[32:35], v[64:67], v[128:131]
    v_mfma_f32_16x16x32_bf16 v[132:135], v[32:35], v[68:71], v[132:135]
    v_mfma_f32_16x16x32_bf16 v[136:139], v[32:35], v[72:75], v[136:139]
    v_mfma_f32_16x16x32_bf16 v[140:143], v[32:35], v[76:79], v[140:143]
    ds_read_b64_tr_b16 v[32:33], v16 offset:40960
    ds_read_b64_tr_b16 v[34:35], v16 offset:45056
    v_mfma_f32_16x16x32_bf16 v[144:147], v[36:39], v[64:67], v[144:147]
    v_mfma_f32_16x16x32_bf16 v[148:151], v[36:39], v[68:71], v[148:151]
    v_mfma_f32_16x16x32_bf16 v[152:155], v[36:39], v[72:75], v[152:155]
    v_mfma_f32_16x16x32_bf16 v[156:159], v[36:39], v[76:79], v[156:159]
    ds_read_b64_tr_b16 v[36:37], v17 offset:40960
    ds_read_b64_tr_b16 v[38:39], v17 offset:45056
    s_waitcnt lgkmcnt(12)
    v_mfma_f32_16x16x32_bf16 v[160:163], v[40:43], v[64:67], v[160:163]
    v_mfma_f32_16x16x32_bf16 v[164:167], v[40:43], v[68:71], v[164:167]
    v_mfma_f32_16x16x32_bf16 v[168:171], v[40:43], v[72:75], v[168:171]
    v_mfma_f32_16x16x32_bf16 v[172:175], v[40:43], v[76:79], v[172:175]
    ds_read_b64_tr_b16 v[40:41], v18 offset:40960
    ds_read_b64_tr_b16 v[42:43], v18 offset:45056
    v_mfma_f32_16x16x32_bf16 v[176:179], v[44:47], v[64:67], v[176:179]
    v_mfma_f32_16x16x32_bf16 v[180:183], v[44:47], v[68:71], v[180:183]
    v_mfma_f32_16x16x32_bf16 v[184:187], v[44:47], v[72:75], v[184:187]
    v_mfma_f32_16x16x32_bf16 v[188:191], v[44:47], v[76:79], v[188:191]
    ds_read_b64_tr_b16 v[44:45], v19 offset:40960
    ds_read_b64_tr_b16 v[46:47], v19 offset:45056
    s_waitcnt lgkmcnt(12)
    v_mfma_f32_16x16x32_bf16 v[192:195], v[48:51], v[64:67], v[192:195]
    v_mfma_f32_16x16x32_bf16 v[196:199], v[48:51], v[68:71], v[196:199]
    v_mfma_f32_16x16x32_bf16 v[200:203], v[48:51], v[72:75], v[200:203]
    v_mfma_f32_16x16x32_bf16 v[204:207], v[48:51], v[76:79], v[204:207]
    ds_read_b64_tr_b16 v[48:49], v20 offset:40960
    ds_read_b64_tr_b16 v[50:51], v20 offset:45056
    v_mfma_f32_16x16x32_bf16 v[208:211], v[52:55], v[64:67], v[208:211]
    v_mfma_f32_16x16x32_bf16 v[212:215], v[52:55], v[68:71], v[212:215]
    v_mfma_f32_16x16x32_bf16 v[216:219], v[52:55], v[72:75], v[216:219]
    v_mfma_f32_16x16x32_bf16 v[220:223], v[52:55], v[76:79], v[220:223]
    ds_read_b64_tr_b16 v[52:53], v21 offset:40960
    ds_read_b64_tr_b16 v[54:55], v21 offset:45056
    s_waitcnt lgkmcnt(12)
    v_mfma_f32_16x16x32_bf16 v[224:227], v[56:59], v[64:67], v[224:227]
    v_mfma_f32_16x16x32_bf16 v[228:231], v[56:59], v[68:71], v[228:231]
    v_mfma_f32_16x16x32_bf16 v[232:235], v[56:59], v[72:75], v[232:235]
    v_mfma_f32_16x16x32_bf16 v[236:239], v[56:59], v[76:79], v[236:239]
    ds_read_b64_tr_b16 v[56:57], v22 offset:40960
    ds_read_b64_tr_b16 v[58:59], v22 offset:45056
    v_mfma_f32_16x16x32_bf16 v[240:243], v[60:63], v[64:67], v[240:243]
    v_mfma_f32_16x16x32_bf16 v[244:247], v[60:63], v[68:71], v[244:247]
    v_mfma_f32_16x16x32_bf16 v[248:251], v[60:63], v[72:75], v[248:251]
    v_mfma_f32_16x16x32_bf16 v[252:255], v[60:63], v[76:79], v[252:255]
    ds_read_b64_tr_b16 v[60:61], v23 offset:40960
    ds_read_b64_tr_b16 v[62:63], v23 offset:45056
    s_add_u32 s12, s42, 8192
    buffer_load_dwordx4 v[64:67], v2, s[4:7], s12 offen offset:0 sc1
    s_add_u32 s12, s42, 161792
    buffer_load_dwordx4 v[68:71], v2, s[4:7], s12 offen offset:0 sc1
    s_add_u32 s12, s42, 315392
    buffer_load_dwordx4 v[72:75], v2, s[4:7], s12 offen offset:0 sc1
    s_add_u32 s12, s42, 468992
    buffer_load_dwordx4 v[76:79], v2, s[4:7], s12 offen offset:0 sc1
    s_waitcnt vmcnt(16)
    s_waitcnt lgkmcnt(12)
    v_mfma_f32_16x16x32_bf16 v[128:131], v[32:35], v[80:83], v[128:131]
    v_mfma_f32_16x16x32_bf16 v[132:135], v[32:35], v[84:87], v[132:135]
    v_mfma_f32_16x16x32_bf16 v[136:139], v[32:35], v[88:91], v[136:139]
    v_mfma_f32_16x16x32_bf16 v[140:143], v[32:35], v[92:95], v[140:143]
    ds_read_b64_tr_b16 v[32:33], v16 offset:49152
    ds_read_b64_tr_b16 v[34:35], v16 offset:53248
    s_add_u32 m0, s101, 131072
    s_add_u32 s12, s100, 0
    buffer_load_dwordx4 v27, s[24:27], s12 offen lds
    v_mfma_f32_16x16x32_bf16 v[144:147], v[36:39], v[80:83], v[144:147]
    v_mfma_f32_16x16x32_bf16 v[148:151], v[36:39], v[84:87], v[148:151]
    v_mfma_f32_16x16x32_bf16 v[152:155], v[36:39], v[88:91], v[152:155]
    v_mfma_f32_16x16x32_bf16 v[156:159], v[36:39], v[92:95], v[156:159]
    ds_read_b64_tr_b16 v[36:37], v17 offset:49152
    ds_read_b64_tr_b16 v[38:39], v17 offset:53248
    s_add_u32 m0, s101, 139264
    s_add_u32 s12, s100, 65536
    buffer_load_dwordx4 v27, s[24:27], s12 offen lds
    s_waitcnt lgkmcnt(12)
    v_mfma_f32_16x16x32_bf16 v[160:163], v[40:43], v[80:83], v[160:163]
    v_mfma_f32_16x16x32_bf16 v[164:167], v[40:43], v[84:87], v[164:167]
    v_mfma_f32_16x16x32_bf16 v[168:171], v[40:43], v[88:91], v[168:171]
    v_mfma_f32_16x16x32_bf16 v[172:175], v[40:43], v[92:95], v[172:175]
    ds_read_b64_tr_b16 v[40:41], v18 offset:49152
    ds_read_b64_tr_b16 v[42:43], v18 offset:53248
    s_add_u32 m0, s101, 147456
    s_add_u32 s12, s100, 131072
    buffer_load_dwordx4 v27, s[24:27], s12 offen lds
    v_mfma_f32_16x16x32_bf16 v[176:179], v[44:47], v[80:83], v[176:179]
    v_mfma_f32_16x16x32_bf16 v[180:183], v[44:47], v[84:87], v[180:183]
    v_mfma_f32_16x16x32_bf16 v[184:187], v[44:47], v[88:91], v[184:187]
    v_mfma_f32_16x16x32_bf16 v[188:191], v[44:47], v[92:95], v[188:191]
    ds_read_b64_tr_b16 v[44:45], v19 offset:49152
    ds_read_b64_tr_b16 v[46:47], v19 offset:53248
    s_add_u32 m0, s101, 155648
    s_add_u32 s12, s100, 196608
    buffer_load_dwordx4 v27, s[24:27], s12 offen lds
    s_waitcnt lgkmcnt(12)
    v_mfma_f32_16x16x32_bf16 v[192:195], v[48:51], v[80:83], v[192:195]
    v_mfma_f32_16x16x32_bf16 v[196:199], v[48:51], v[84:87], v[196:199]
    v_mfma_f32_16x16x32_bf16 v[200:203], v[48:51], v[88:91], v[200:203]
    v_mfma_f32_16x16x32_bf16 v[204:207], v[48:51], v[92:95], v[204:207]
    ds_read_b64_tr_b16 v[48:49], v20 offset:49152
    ds_read_b64_tr_b16 v[50:51], v20 offset:53248
    v_mfma_f32_16x16x32_bf16 v[208:211], v[52:55], v[80:83], v[208:211]
    v_mfma_f32_16x16x32_bf16 v[212:215], v[52:55], v[84:87], v[212:215]
    v_mfma_f32_16x16x32_bf16 v[216:219], v[52:55], v[88:91], v[216:219]
    v_mfma_f32_16x16x32_bf16 v[220:223], v[52:55], v[92:95], v[220:223]
    ds_read_b64_tr_b16 v[52:53], v21 offset:49152
    ds_read_b64_tr_b16 v[54:55], v21 offset:53248
    s_waitcnt lgkmcnt(12)
    v_mfma_f32_16x16x32_bf16 v[224:227], v[56:59], v[80:83], v[224:227]
    v_mfma_f32_16x16x32_bf16 v[228:231], v[56:59], v[84:87], v[228:231]
    v_mfma_f32_16x16x32_bf16 v[232:235], v[56:59], v[88:91], v[232:235]
    v_mfma_f32_16x16x32_bf16 v[236:239], v[56:59], v[92:95], v[236:239]
    ds_read_b64_tr_b16 v[56:57], v22 offset:49152
    ds_read_b64_tr_b16 v[58:59], v22 offset:53248
    v_mfma_f32_16x16x32_bf16 v[240:243], v[60:63], v[80:83], v[240:243]
    v_mfma_f32_16x16x32_bf16 v[244:247], v[60:63], v[84:87], v[244:247]
    v_mfma_f32_16x16x32_bf16 v[248:251], v[60:63], v[88:91], v[248:251]
    v_mfma_f32_16x16x32_bf16 v[252:255], v[60:63], v[92:95], v[252:255]
    ds_read_b64_tr_b16 v[60:61], v23 offset:49152
    ds_read_b64_tr_b16 v[62:63], v23 offset:53248
    s_add_u32 s12, s42, 8192
    buffer_load_dwordx4 v[80:83], v2, s[4:7], s12 offen offset:1024 sc1
    s_add_u32 s12, s42, 161792
    buffer_load_dwordx4 v[84:87], v2, s[4:7], s12 offen offset:1024 sc1
    s_add_u32 s12, s42, 315392
    buffer_load_dwordx4 v[88:91], v2, s[4:7], s12 offen offset:1024 sc1
    s_add_u32 s12, s42, 468992
    buffer_load_dwordx4 v[92:95], v2, s[4:7], s12 offen offset:1024 sc1
    s_waitcnt vmcnt(16)
    s_waitcnt lgkmcnt(12)
    v_mfma_f32_16x16x32_bf16 v[128:131], v[32:35], v[96:99], v[128:131]
    v_mfma_f32_16x16x32_bf16 v[132:135], v[32:35], v[100:103], v[132:135]
    v_mfma_f32_16x16x32_bf16 v[136:139], v[32:35], v[104:107], v[136:139]
    v_mfma_f32_16x16x32_bf16 v[140:143], v[32:35], v[108:111], v[140:143]
    ds_read_b64_tr_b16 v[32:33], v16 offset:57344
    ds_read_b64_tr_b16 v[34:35], v16 offset:61440
    v_mfma_f32_16x16x32_bf16 v[144:147], v[36:39], v[96:99], v[144:147]
    v_mfma_f32_16x16x32_bf16 v[148:151], v[36:39], v[100:103], v[148:151]
    v_mfma_f32_16x16x32_bf16 v[152:155], v[36:39], v[104:107], v[152:155]
    v_mfma_f32_16x16x32_bf16 v[156:159], v[36:39], v[108:111], v[156:159]
    ds_read_b64_tr_b16 v[36:37], v17 offset:57344
    ds_read_b64_tr_b16 v[38:39], v17 offset:61440
    s_waitcnt lgkmcnt(12)
    v_mfma_f32_16x16x32_bf16 v[160:163], v[40:43], v[96:99], v[160:163]
    v_mfma_f32_16x16x32_bf16 v[164:167], v[40:43], v[100:103], v[164:167]
    v_mfma_f32_16x16x32_bf16 v[168:171], v[40:43], v[104:107], v[168:171]
    v_mfma_f32_16x16x32_bf16 v[172:175], v[40:43], v[108:111], v[172:175]
    ds_read_b64_tr_b16 v[40:41], v18 offset:57344
    ds_read_b64_tr_b16 v[42:43], v18 offset:61440
    v_mfma_f32_16x16x32_bf16 v[176:179], v[44:47], v[96:99], v[176:179]
    v_mfma_f32_16x16x32_bf16 v[180:183], v[44:47], v[100:103], v[180:183]
    v_mfma_f32_16x16x32_bf16 v[184:187], v[44:47], v[104:107], v[184:187]
    v_mfma_f32_16x16x32_bf16 v[188:191], v[44:47], v[108:111], v[188:191]
    ds_read_b64_tr_b16 v[44:45], v19 offset:57344
    ds_read_b64_tr_b16 v[46:47], v19 offset:61440
    s_waitcnt lgkmcnt(12)
    v_mfma_f32_16x16x32_bf16 v[192:195], v[48:51], v[96:99], v[192:195]
    v_mfma_f32_16x16x32_bf16 v[196:199], v[48:51], v[100:103], v[196:199]
    v_mfma_f32_16x16x32_bf16 v[200:203], v[48:51], v[104:107], v[200:203]
    v_mfma_f32_16x16x32_bf16 v[204:207], v[48:51], v[108:111], v[204:207]
    ds_read_b64_tr_b16 v[48:49], v20 offset:57344
    ds_read_b64_tr_b16 v[50:51], v20 offset:61440
    v_mfma_f32_16x16x32_bf16 v[208:211], v[52:55], v[96:99], v[208:211]
    v_mfma_f32_16x16x32_bf16 v[212:215], v[52:55], v[100:103], v[212:215]
    v_mfma_f32_16x16x32_bf16 v[216:219], v[52:55], v[104:107], v[216:219]
    v_mfma_f32_16x16x32_bf16 v[220:223], v[52:55], v[108:111], v[220:223]
    ds_read_b64_tr_b16 v[52:53], v21 offset:57344
    ds_read_b64_tr_b16 v[54:55], v21 offset:61440
    s_waitcnt lgkmcnt(12)
    v_mfma_f32_16x16x32_bf16 v[224:227], v[56:59], v[96:99], v[224:227]
    v_mfma_f32_16x16x32_bf16 v[228:231], v[56:59], v[100:103], v[228:231]
    v_mfma_f32_16x16x32_bf16 v[232:235], v[56:59], v[104:107], v[232:235]
    v_mfma_f32_16x16x32_bf16 v[236:239], v[56:59], v[108:111], v[236:239]
    ds_read_b64_tr_b16 v[56:57], v22 offset:57344
    ds_read_b64_tr_b16 v[58:59], v22 offset:61440
    v_mfma_f32_16x16x32_bf16 v[240:243], v[60:63], v[96:99], v[240:243]
    v_mfma_f32_16x16x32_bf16 v[244:247], v[60:63], v[100:103], v[244:247]
    v_mfma_f32_16x16x32_bf16 v[248:251], v[60:63], v[104:107], v[248:251]
    v_mfma_f32_16x16x32_bf16 v[252:255], v[60:63], v[108:111], v[252:255]
    ds_read_b64_tr_b16 v[60:61], v23 offset:57344
    ds_read_b64_tr_b16 v[62:63], v23 offset:61440
    s_add_u32 s12, s42, 8192
    buffer_load_dwordx4 v[96:99], v2, s[4:7], s12 offen offset:2048 sc1
    s_add_u32 s12, s42, 161792
    buffer_load_dwordx4 v[100:103], v2, s[4:7], s12 offen offset:2048 sc1
    s_add_u32 s12, s42, 315392
    buffer_load_dwordx4 v[104:107], v2, s[4:7], s12 offen offset:2048 sc1
    s_add_u32 s12, s42, 468992
    buffer_load_dwordx4 v[108:111], v2, s[4:7], s12 offen offset:2048 sc1
    s_waitcnt vmcnt(16)
    s_waitcnt vmcnt(32)
    s_barrier
    v_add_u32 v16, 0x10000, v16
    v_add_u32 v17, 0x10000, v17
    v_add_u32 v18, 0x10000, v18
    v_add_u32 v19, 0x10000, v19
    v_add_u32 v20, 0x10000, v20
    v_add_u32 v21, 0x10000, v21
    v_add_u32 v22, 0x10000, v22
    v_add_u32 v23, 0x10000, v23
    s_waitcnt lgkmcnt(12)
    v_mfma_f32_16x16x32_bf16 v[128:131], v[32:35], v[112:115], v[128:131]
    v_mfma_f32_16x16x32_bf16 v[132:135], v[32:35], v[116:119], v[132:135]
    v_mfma_f32_16x16x32_bf16 v[136:139], v[32:35], v[120:123], v[136:139]
    v_mfma_f32_16x16x32_bf16 v[140:143], v[32:35], v[124:127], v[140:143]
    ds_read_b64_tr_b16 v[32:33], v16 offset:0
    ds_read_b64_tr_b16 v[34:35], v16 offset:4096
    v_mfma_f32_16x16x32_bf16 v[144:147], v[36:39], v[112:115], v[144:147]
    v_mfma_f32_16x16x32_bf16 v[148:151], v[36:39], v[116:119], v[148:151]
    v_mfma_f32_16x16x32_bf16 v[152:155], v[36:39], v[120:123], v[152:155]
    v_mfma_f32_16x16x32_bf16 v[156:159], v[36:39], v[124:127], v[156:159]
    ds_read_b64_tr_b16 v[36:37], v17 offset:0
    ds_read_b64_tr_b16 v[38:39], v17 offset:4096
    s_waitcnt lgkmcnt(12)
    v_mfma_f32_16x16x32_bf16 v[160:163], v[40:43], v[112:115], v[160:163]
    v_mfma_f32_16x16x32_bf16 v[164:167], v[40:43], v[116:119], v[164:167]
    v_mfma_f32_16x16x32_bf16 v[168:171], v[40:43], v[120:123], v[168:171]
    v_mfma_f32_16x16x32_bf16 v[172:175], v[40:43], v[124:127], v[172:175]
    ds_read_b64_tr_b16 v[40:41], v18 offset:0
    ds_read_b64_tr_b16 v[42:43], v18 offset:4096
    v_mfma_f32_16x16x32_bf16 v[176:179], v[44:47], v[112:115], v[176:179]
    v_mfma_f32_16x16x32_bf16 v[180:183], v[44:47], v[116:119], v[180:183]
    v_mfma_f32_16x16x32_bf16 v[184:187], v[44:47], v[120:123], v[184:187]
    v_mfma_f32_16x16x32_bf16 v[188:191], v[44:47], v[124:127], v[188:191]
    ds_read_b64_tr_b16 v[44:45], v19 offset:0
    ds_read_b64_tr_b16 v[46:47], v19 offset:4096
    s_waitcnt lgkmcnt(12)
    v_mfma_f32_16x16x32_bf16 v[192:195], v[48:51], v[112:115], v[192:195]
    v_mfma_f32_16x16x32_bf16 v[196:199], v[48:51], v[116:119], v[196:199]
    v_mfma_f32_16x16x32_bf16 v[200:203], v[48:51], v[120:123], v[200:203]
    v_mfma_f32_16x16x32_bf16 v[204:207], v[48:51], v[124:127], v[204:207]
    ds_read_b64_tr_b16 v[48:49], v20 offset:0
    ds_read_b64_tr_b16 v[50:51], v20 offset:4096
    v_mfma_f32_16x16x32_bf16 v[208:211], v[52:55], v[112:115], v[208:211]
    v_mfma_f32_16x16x32_bf16 v[212:215], v[52:55], v[116:119], v[212:215]
    v_mfma_f32_16x16x32_bf16 v[216:219], v[52:55], v[120:123], v[216:219]
    v_mfma_f32_16x16x32_bf16 v[220:223], v[52:55], v[124:127], v[220:223]
    ds_read_b64_tr_b16 v[52:53], v21 offset:0
    ds_read_b64_tr_b16 v[54:55], v21 offset:4096
    s_waitcnt lgkmcnt(12)
    v_mfma_f32_16x16x32_bf16 v[224:227], v[56:59], v[112:115], v[224:227]
    v_mfma_f32_16x16x32_bf16 v[228:231], v[56:59], v[116:119], v[228:231]
    v_mfma_f32_16x16x32_bf16 v[232:235], v[56:59], v[120:123], v[232:235]
    v_mfma_f32_16x16x32_bf16 v[236:239], v[56:59], v[124:127], v[236:239]
    ds_read_b64_tr_b16 v[56:57], v22 offset:0
    ds_read_b64_tr_b16 v[58:59], v22 offset:4096
    v_mfma_f32_16x16x32_bf16 v[240:243], v[60:63], v[112:115], v[240:243]
    v_mfma_f32_16x16x32_bf16 v[244:247], v[60:63], v[116:119], v[244:247]
    v_mfma_f32_16x16x32_bf16 v[248:251], v[60:63], v[120:123], v[248:251]
    v_mfma_f32_16x16x32_bf16 v[252:255], v[60:63], v[124:127], v[252:255]
    ds_read_b64_tr_b16 v[60:61], v23 offset:0
    ds_read_b64_tr_b16 v[62:63], v23 offset:4096
    s_add_u32 s12, s42, 8192
    buffer_load_dwordx4 v[112:115], v2, s[4:7], s12 offen offset:3072 sc1
    s_add_u32 s12, s42, 161792
    buffer_load_dwordx4 v[116:119], v2, s[4:7], s12 offen offset:3072 sc1
    s_add_u32 s12, s42, 315392
    buffer_load_dwordx4 v[120:123], v2, s[4:7], s12 offen offset:3072 sc1
    s_add_u32 s12, s42, 468992
    buffer_load_dwordx4 v[124:127], v2, s[4:7], s12 offen offset:3072 sc1
    s_waitcnt vmcnt(16)
    s_waitcnt lgkmcnt(12)
    v_mfma_f32_16x16x32_bf16 v[128:131], v[32:35], v[64:67], v[128:131]
    v_mfma_f32_16x16x32_bf16 v[132:135], v[32:35], v[68:71], v[132:135]
    v_mfma_f32_16x16x32_bf16 v[136:139], v[32:35], v[72:75], v[136:139]
    v_mfma_f32_16x16x32_bf16 v[140:143], v[32:35], v[76:79], v[140:143]
    ds_read_b64_tr_b16 v[32:33], v16 offset:8192
    ds_read_b64_tr_b16 v[34:35], v16 offset:12288
    v_mfma_f32_16x16x32_bf16 v[144:147], v[36:39], v[64:67], v[144:147]
    v_mfma_f32_16x16x32_bf16 v[148:151], v[36:39], v[68:71], v[148:151]
    v_mfma_f32_16x16x32_bf16 v[152:155], v[36:39], v[72:75], v[152:155]
    v_mfma_f32_16x16x32_bf16 v[156:159], v[36:39], v[76:79], v[156:159]
    ds_read_b64_tr_b16 v[36:37], v17 offset:8192
    ds_read_b64_tr_b16 v[38:39], v17 offset:12288
    s_waitcnt lgkmcnt(12)
    v_mfma_f32_16x16x32_bf16 v[160:163], v[40:43], v[64:67], v[160:163]
    v_mfma_f32_16x16x32_bf16 v[164:167], v[40:43], v[68:71], v[164:167]
    v_mfma_f32_16x16x32_bf16 v[168:171], v[40:43], v[72:75], v[168:171]
    v_mfma_f32_16x16x32_bf16 v[172:175], v[40:43], v[76:79], v[172:175]
    ds_read_b64_tr_b16 v[40:41], v18 offset:8192
    ds_read_b64_tr_b16 v[42:43], v18 offset:12288
    v_mfma_f32_16x16x32_bf16 v[176:179], v[44:47], v[64:67], v[176:179]
    v_mfma_f32_16x16x32_bf16 v[180:183], v[44:47], v[68:71], v[180:183]
    v_mfma_f32_16x16x32_bf16 v[184:187], v[44:47], v[72:75], v[184:187]
    v_mfma_f32_16x16x32_bf16 v[188:191], v[44:47], v[76:79], v[188:191]
    ds_read_b64_tr_b16 v[44:45], v19 offset:8192
    ds_read_b64_tr_b16 v[46:47], v19 offset:12288
    s_waitcnt lgkmcnt(12)
    v_mfma_f32_16x16x32_bf16 v[192:195], v[48:51], v[64:67], v[192:195]
    v_mfma_f32_16x16x32_bf16 v[196:199], v[48:51], v[68:71], v[196:199]
    v_mfma_f32_16x16x32_bf16 v[200:203], v[48:51], v[72:75], v[200:203]
    v_mfma_f32_16x16x32_bf16 v[204:207], v[48:51], v[76:79], v[204:207]
    ds_read_b64_tr_b16 v[48:49], v20 offset:8192
    ds_read_b64_tr_b16 v[50:51], v20 offset:12288
    v_mfma_f32_16x16x32_bf16 v[208:211], v[52:55], v[64:67], v[208:211]
    v_mfma_f32_16x16x32_bf16 v[212:215], v[52:55], v[68:71], v[212:215]
    v_mfma_f32_16x16x32_bf16 v[216:219], v[52:55], v[72:75], v[216:219]
    v_mfma_f32_16x16x32_bf16 v[220:223], v[52:55], v[76:79], v[220:223]
    ds_read_b64_tr_b16 v[52:53], v21 offset:8192
    ds_read_b64_tr_b16 v[54:55], v21 offset:12288
    s_waitcnt lgkmcnt(12)
    v_mfma_f32_16x16x32_bf16 v[224:227], v[56:59], v[64:67], v[224:227]
    v_mfma_f32_16x16x32_bf16 v[228:231], v[56:59], v[68:71], v[228:231]
    v_mfma_f32_16x16x32_bf16 v[232:235], v[56:59], v[72:75], v[232:235]
    v_mfma_f32_16x16x32_bf16 v[236:239], v[56:59], v[76:79], v[236:239]
    ds_read_b64_tr_b16 v[56:57], v22 offset:8192
    ds_read_b64_tr_b16 v[58:59], v22 offset:12288
    v_mfma_f32_16x16x32_bf16 v[240:243], v[60:63], v[64:67], v[240:243]
    v_mfma_f32_16x16x32_bf16 v[244:247], v[60:63], v[68:71], v[244:247]
    v_mfma_f32_16x16x32_bf16 v[248:251], v[60:63], v[72:75], v[248:251]
    v_mfma_f32_16x16x32_bf16 v[252:255], v[60:63], v[76:79], v[252:255]
    ds_read_b64_tr_b16 v[60:61], v23 offset:8192
    ds_read_b64_tr_b16 v[62:63], v23 offset:12288
    s_add_u32 s12, s42, 12288
    buffer_load_dwordx4 v[64:67], v2, s[4:7], s12 offen offset:0 sc1
    s_add_u32 s12, s42, 165888
    buffer_load_dwordx4 v[68:71], v2, s[4:7], s12 offen offset:0 sc1
    s_add_u32 s12, s42, 319488
    buffer_load_dwordx4 v[72:75], v2, s[4:7], s12 offen offset:0 sc1
    s_add_u32 s12, s42, 473088
    buffer_load_dwordx4 v[76:79], v2, s[4:7], s12 offen offset:0 sc1
    s_waitcnt vmcnt(12)
    s_waitcnt lgkmcnt(12)
    v_mfma_f32_16x16x32_bf16 v[128:131], v[32:35], v[80:83], v[128:131]
    v_mfma_f32_16x16x32_bf16 v[132:135], v[32:35], v[84:87], v[132:135]
    v_mfma_f32_16x16x32_bf16 v[136:139], v[32:35], v[88:91], v[136:139]
    v_mfma_f32_16x16x32_bf16 v[140:143], v[32:35], v[92:95], v[140:143]
    ds_read_b64_tr_b16 v[32:33], v16 offset:16384
    ds_read_b64_tr_b16 v[34:35], v16 offset:20480
    v_mfma_f32_16x16x32_bf16 v[144:147], v[36:39], v[80:83], v[144:147]
    v_mfma_f32_16x16x32_bf16 v[148:151], v[36:39], v[84:87], v[148:151]
    v_mfma_f32_16x16x32_bf16 v[152:155], v[36:39], v[88:91], v[152:155]
    v_mfma_f32_16x16x32_bf16 v[156:159], v[36:39], v[92:95], v[156:159]
    ds_read_b64_tr_b16 v[36:37], v17 offset:16384
    ds_read_b64_tr_b16 v[38:39], v17 offset:20480
    s_waitcnt lgkmcnt(12)
    v_mfma_f32_16x16x32_bf16 v[160:163], v[40:43], v[80:83], v[160:163]
    v_mfma_f32_16x16x32_bf16 v[164:167], v[40:43], v[84:87], v[164:167]
    v_mfma_f32_16x16x32_bf16 v[168:171], v[40:43], v[88:91], v[168:171]
    v_mfma_f32_16x16x32_bf16 v[172:175], v[40:43], v[92:95], v[172:175]
    ds_read_b64_tr_b16 v[40:41], v18 offset:16384
    ds_read_b64_tr_b16 v[42:43], v18 offset:20480
    v_mfma_f32_16x16x32_bf16 v[176:179], v[44:47], v[80:83], v[176:179]
    v_mfma_f32_16x16x32_bf16 v[180:183], v[44:47], v[84:87], v[180:183]
    v_mfma_f32_16x16x32_bf16 v[184:187], v[44:47], v[88:91], v[184:187]
    v_mfma_f32_16x16x32_bf16 v[188:191], v[44:47], v[92:95], v[188:191]
    ds_read_b64_tr_b16 v[44:45], v19 offset:16384
    ds_read_b64_tr_b16 v[46:47], v19 offset:20480
    s_waitcnt lgkmcnt(12)
    v_mfma_f32_16x16x32_bf16 v[192:195], v[48:51], v[80:83], v[192:195]
    v_mfma_f32_16x16x32_bf16 v[196:199], v[48:51], v[84:87], v[196:199]
    v_mfma_f32_16x16x32_bf16 v[200:203], v[48:51], v[88:91], v[200:203]
    v_mfma_f32_16x16x32_bf16 v[204:207], v[48:51], v[92:95], v[204:207]
    ds_read_b64_tr_b16 v[48:49], v20 offset:16384
    ds_read_b64_tr_b16 v[50:51], v20 offset:20480
    v_mfma_f32_16x16x32_bf16 v[208:211], v[52:55], v[80:83], v[208:211]
    v_mfma_f32_16x16x32_bf16 v[212:215], v[52:55], v[84:87], v[212:215]
    v_mfma_f32_16x16x32_bf16 v[216:219], v[52:55], v[88:91], v[216:219]
    v_mfma_f32_16x16x32_bf16 v[220:223], v[52:55], v[92:95], v[220:223]
    ds_read_b64_tr_b16 v[52:53], v21 offset:16384
    ds_read_b64_tr_b16 v[54:55], v21 offset:20480
    s_waitcnt lgkmcnt(12)
    v_mfma_f32_16x16x32_bf16 v[224:227], v[56:59], v[80:83], v[224:227]
    v_mfma_f32_16x16x32_bf16 v[228:231], v[56:59], v[84:87], v[228:231]
    v_mfma_f32_16x16x32_bf16 v[232:235], v[56:59], v[88:91], v[232:235]
    v_mfma_f32_16x16x32_bf16 v[236:239], v[56:59], v[92:95], v[236:239]
    ds_read_b64_tr_b16 v[56:57], v22 offset:16384
    ds_read_b64_tr_b16 v[58:59], v22 offset:20480
    v_mfma_f32_16x16x32_bf16 v[240:243], v[60:63], v[80:83], v[240:243]
    v_mfma_f32_16x16x32_bf16 v[244:247], v[60:63], v[84:87], v[244:247]
    v_mfma_f32_16x16x32_bf16 v[248:251], v[60:63], v[88:91], v[248:251]
    v_mfma_f32_16x16x32_bf16 v[252:255], v[60:63], v[92:95], v[252:255]
    ds_read_b64_tr_b16 v[60:61], v23 offset:16384
    ds_read_b64_tr_b16 v[62:63], v23 offset:20480
    s_add_u32 s12, s42, 12288
    buffer_load_dwordx4 v[80:83], v2, s[4:7], s12 offen offset:1024 sc1
    s_add_u32 s12, s42, 165888
    buffer_load_dwordx4 v[84:87], v2, s[4:7], s12 offen offset:1024 sc1
    s_add_u32 s12, s42, 319488
    buffer_load_dwordx4 v[88:91], v2, s[4:7], s12 offen offset:1024 sc1
    s_add_u32 s12, s42, 473088
    buffer_load_dwordx4 v[92:95], v2, s[4:7], s12 offen offset:1024 sc1
    s_waitcnt vmcnt(12)
    s_waitcnt lgkmcnt(12)
    v_mfma_f32_16x16x32_bf16 v[128:131], v[32:35], v[96:99], v[128:131]
    v_mfma_f32_16x16x32_bf16 v[132:135], v[32:35], v[100:103], v[132:135]
    v_mfma_f32_16x16x32_bf16 v[136:139], v[32:35], v[104:107], v[136:139]
    v_mfma_f32_16x16x32_bf16 v[140:143], v[32:35], v[108:111], v[140:143]
    ds_read_b64_tr_b16 v[32:33], v16 offset:24576
    ds_read_b64_tr_b16 v[34:35], v16 offset:28672
    v_mfma_f32_16x16x32_bf16 v[144:147], v[36:39], v[96:99], v[144:147]
    v_mfma_f32_16x16x32_bf16 v[148:151], v[36:39], v[100:103], v[148:151]
    v_mfma_f32_16x16x32_bf16 v[152:155], v[36:39], v[104:107], v[152:155]
    v_mfma_f32_16x16x32_bf16 v[156:159], v[36:39], v[108:111], v[156:159]
    ds_read_b64_tr_b16 v[36:37], v17 offset:24576
    ds_read_b64_tr_b16 v[38:39], v17 offset:28672
    s_waitcnt lgkmcnt(12)
    v_mfma_f32_16x16x32_bf16 v[160:163], v[40:43], v[96:99], v[160:163]
    v_mfma_f32_16x16x32_bf16 v[164:167], v[40:43], v[100:103], v[164:167]
    v_mfma_f32_16x16x32_bf16 v[168:171], v[40:43], v[104:107], v[168:171]
    v_mfma_f32_16x16x32_bf16 v[172:175], v[40:43], v[108:111], v[172:175]
    ds_read_b64_tr_b16 v[40:41], v18 offset:24576
    ds_read_b64_tr_b16 v[42:43], v18 offset:28672
    v_mfma_f32_16x16x32_bf16 v[176:179], v[44:47], v[96:99], v[176:179]
    v_mfma_f32_16x16x32_bf16 v[180:183], v[44:47], v[100:103], v[180:183]
    v_mfma_f32_16x16x32_bf16 v[184:187], v[44:47], v[104:107], v[184:187]
    v_mfma_f32_16x16x32_bf16 v[188:191], v[44:47], v[108:111], v[188:191]
    ds_read_b64_tr_b16 v[44:45], v19 offset:24576
    ds_read_b64_tr_b16 v[46:47], v19 offset:28672
    s_waitcnt lgkmcnt(12)
    v_mfma_f32_16x16x32_bf16 v[192:195], v[48:51], v[96:99], v[192:195]
    v_mfma_f32_16x16x32_bf16 v[196:199], v[48:51], v[100:103], v[196:199]
    v_mfma_f32_16x16x32_bf16 v[200:203], v[48:51], v[104:107], v[200:203]
    v_mfma_f32_16x16x32_bf16 v[204:207], v[48:51], v[108:111], v[204:207]
    ds_read_b64_tr_b16 v[48:49], v20 offset:24576
    ds_read_b64_tr_b16 v[50:51], v20 offset:28672
    v_mfma_f32_16x16x32_bf16 v[208:211], v[52:55], v[96:99], v[208:211]
    v_mfma_f32_16x16x32_bf16 v[212:215], v[52:55], v[100:103], v[212:215]
    v_mfma_f32_16x16x32_bf16 v[216:219], v[52:55], v[104:107], v[216:219]
    v_mfma_f32_16x16x32_bf16 v[220:223], v[52:55], v[108:111], v[220:223]
    ds_read_b64_tr_b16 v[52:53], v21 offset:24576
    ds_read_b64_tr_b16 v[54:55], v21 offset:28672
    s_waitcnt lgkmcnt(12)
    v_mfma_f32_16x16x32_bf16 v[224:227], v[56:59], v[96:99], v[224:227]
    v_mfma_f32_16x16x32_bf16 v[228:231], v[56:59], v[100:103], v[228:231]
    v_mfma_f32_16x16x32_bf16 v[232:235], v[56:59], v[104:107], v[232:235]
    v_mfma_f32_16x16x32_bf16 v[236:239], v[56:59], v[108:111], v[236:239]
    ds_read_b64_tr_b16 v[56:57], v22 offset:24576
    ds_read_b64_tr_b16 v[58:59], v22 offset:28672
    v_mfma_f32_16x16x32_bf16 v[240:243], v[60:63], v[96:99], v[240:243]
    v_mfma_f32_16x16x32_bf16 v[244:247], v[60:63], v[100:103], v[244:247]
    v_mfma_f32_16x16x32_bf16 v[248:251], v[60:63], v[104:107], v[248:251]
    v_mfma_f32_16x16x32_bf16 v[252:255], v[60:63], v[108:111], v[252:255]
    ds_read_b64_tr_b16 v[60:61], v23 offset:24576
    ds_read_b64_tr_b16 v[62:63], v23 offset:28672
    s_add_u32 s12, s42, 12288
    buffer_load_dwordx4 v[96:99], v2, s[4:7], s12 offen offset:2048 sc1
    s_add_u32 s12, s42, 165888
    buffer_load_dwordx4 v[100:103], v2, s[4:7], s12 offen offset:2048 sc1
    s_add_u32 s12, s42, 319488
    buffer_load_dwordx4 v[104:107], v2, s[4:7], s12 offen offset:2048 sc1
    s_add_u32 s12, s42, 473088
    buffer_load_dwordx4 v[108:111], v2, s[4:7], s12 offen offset:2048 sc1
    s_waitcnt vmcnt(12)
    s_waitcnt vmcnt(40)
    s_barrier
    s_waitcnt lgkmcnt(12)
    v_mfma_f32_16x16x32_bf16 v[128:131], v[32:35], v[112:115], v[128:131]
    v_mfma_f32_16x16x32_bf16 v[132:135], v[32:35], v[116:119], v[132:135]
    v_mfma_f32_16x16x32_bf16 v[136:139], v[32:35], v[120:123], v[136:139]
    v_mfma_f32_16x16x32_bf16 v[140:143], v[32:35], v[124:127], v[140:143]
    ds_read_b64_tr_b16 v[32:33], v16 offset:32768
    ds_read_b64_tr_b16 v[34:35], v16 offset:36864
    s_add_u32 m0, s101, 0
    s_add_u32 s12, s100, 262144
    buffer_load_dwordx4 v27, s[24:27], s12 offen lds
    v_mfma_f32_16x16x32_bf16 v[144:147], v[36:39], v[112:115], v[144:147]
    v_mfma_f32_16x16x32_bf16 v[148:151], v[36:39], v[116:119], v[148:151]
    v_mfma_f32_16x16x32_bf16 v[152:155], v[36:39], v[120:123], v[152:155]
    v_mfma_f32_16x16x32_bf16 v[156:159], v[36:39], v[124:127], v[156:159]
    ds_read_b64_tr_b16 v[36:37], v17 offset:32768
    ds_read_b64_tr_b16 v[38:39], v17 offset:36864
    s_add_u32 m0, s101, 8192
    s_add_u32 s12, s100, 327680
    buffer_load_dwordx4 v27, s[24:27], s12 offen lds
    s_waitcnt lgkmcnt(12)
    v_mfma_f32_16x16x32_bf16 v[160:163], v[40:43], v[112:115], v[160:163]
    v_mfma_f32_16x16x32_bf16 v[164:167], v[40:43], v[116:119], v[164:167]
    v_mfma_f32_16x16x32_bf16 v[168:171], v[40:43], v[120:123], v[168:171]
    v_mfma_f32_16x16x32_bf16 v[172:175], v[40:43], v[124:127], v[172:175]
    ds_read_b64_tr_b16 v[40:41], v18 offset:32768
    ds_read_b64_tr_b16 v[42:43], v18 offset:36864
    s_add_u32 m0, s101, 16384
    s_add_u32 s12, s100, 393216
    buffer_load_dwordx4 v27, s[24:27], s12 offen lds
    v_mfma_f32_16x16x32_bf16 v[176:179], v[44:47], v[112:115], v[176:179]
    v_mfma_f32_16x16x32_bf16 v[180:183], v[44:47], v[116:119], v[180:183]
    v_mfma_f32_16x16x32_bf16 v[184:187], v[44:47], v[120:123], v[184:187]
    v_mfma_f32_16x16x32_bf16 v[188:191], v[44:47], v[124:127], v[188:191]
    ds_read_b64_tr_b16 v[44:45], v19 offset:32768
    ds_read_b64_tr_b16 v[46:47], v19 offset:36864
    s_add_u32 m0, s101, 24576
    s_add_u32 s12, s100, 458752
    buffer_load_dwordx4 v27, s[24:27], s12 offen lds
    s_waitcnt lgkmcnt(12)
    v_mfma_f32_16x16x32_bf16 v[192:195], v[48:51], v[112:115], v[192:195]
    v_mfma_f32_16x16x32_bf16 v[196:199], v[48:51], v[116:119], v[196:199]
    v_mfma_f32_16x16x32_bf16 v[200:203], v[48:51], v[120:123], v[200:203]
    v_mfma_f32_16x16x32_bf16 v[204:207], v[48:51], v[124:127], v[204:207]
    ds_read_b64_tr_b16 v[48:49], v20 offset:32768
    ds_read_b64_tr_b16 v[50:51], v20 offset:36864
    s_add_u32 m0, s101, 32768
    s_add_u32 s12, s100, 524288
    buffer_load_dwordx4 v27, s[24:27], s12 offen lds
    v_mfma_f32_16x16x32_bf16 v[208:211], v[52:55], v[112:115], v[208:211]
    v_mfma_f32_16x16x32_bf16 v[212:215], v[52:55], v[116:119], v[212:215]
    v_mfma_f32_16x16x32_bf16 v[216:219], v[52:55], v[120:123], v[216:219]
    v_mfma_f32_16x16x32_bf16 v[220:223], v[52:55], v[124:127], v[220:223]
    ds_read_b64_tr_b16 v[52:53], v21 offset:32768
    ds_read_b64_tr_b16 v[54:55], v21 offset:36864
    s_add_u32 m0, s101, 40960
    s_add_u32 s12, s100, 589824
    buffer_load_dwordx4 v27, s[24:27], s12 offen lds
    s_waitcnt lgkmcnt(12)
    v_mfma_f32_16x16x32_bf16 v[224:227], v[56:59], v[112:115], v[224:227]
    v_mfma_f32_16x16x32_bf16 v[228:231], v[56:59], v[116:119], v[228:231]
    v_mfma_f32_16x16x32_bf16 v[232:235], v[56:59], v[120:123], v[232:235]
    v_mfma_f32_16x16x32_bf16 v[236:239], v[56:59], v[124:127], v[236:239]
    ds_read_b64_tr_b16 v[56:57], v22 offset:32768
    ds_read_b64_tr_b16 v[58:59], v22 offset:36864
    s_add_u32 m0, s101, 49152
    s_add_u32 s12, s100, 655360
    buffer_load_dwordx4 v27, s[24:27], s12 offen lds
    v_mfma_f32_16x16x32_bf16 v[240:243], v[60:63], v[112:115], v[240:243]
    v_mfma_f32_16x16x32_bf16 v[244:247], v[60:63], v[116:119], v[244:247]
    v_mfma_f32_16x16x32_bf16 v[248:251], v[60:63], v[120:123], v[248:251]
    v_mfma_f32_16x16x32_bf16 v[252:255], v[60:63], v[124:127], v[252:255]
    ds_read_b64_tr_b16 v[60:61], v23 offset:32768
    ds_read_b64_tr_b16 v[62:63], v23 offset:36864
    s_add_u32 s12, s42, 12288
    buffer_load_dwordx4 v[112:115], v2, s[4:7], s12 offen offset:3072 sc1
    s_add_u32 s12, s42, 165888
    buffer_load_dwordx4 v[116:119], v2, s[4:7], s12 offen offset:3072 sc1
    s_add_u32 s12, s42, 319488
    buffer_load_dwordx4 v[120:123], v2, s[4:7], s12 offen offset:3072 sc1
    s_add_u32 s12, s42, 473088
    buffer_load_dwordx4 v[124:127], v2, s[4:7], s12 offen offset:3072 sc1
    s_waitcnt vmcnt(19)
    s_waitcnt lgkmcnt(12)
    v_mfma_f32_16x16x32_bf16 v[128:131], v[32:35], v[64:67], v[128:131]
    v_mfma_f32_16x16x32_bf16 v[132:135], v[32:35], v[68:71], v[132:135]
    v_mfma_f32_16x16x32_bf16 v[136:139], v[32:35], v[72:75], v[136:139]
    v_mfma_f32_16x16x32_bf16 v[140:143], v[32:35], v[76:79], v[140:143]
    ds_read_b64_tr_b16 v[32:33], v16 offset:40960
    ds_read_b64_tr_b16 v[34:35], v16 offset:45056
    v_mfma_f32_16x16x32_bf16 v[144:147], v[36:39], v[64:67], v[144:147]
    v_mfma_f32_16x16x32_bf16 v[148:151], v[36:39], v[68:71], v[148:151]
    v_mfma_f32_16x16x32_bf16 v[152:155], v[36:39], v[72:75], v[152:155]
    v_mfma_f32_16x16x32_bf16 v[156:159], v[36:39], v[76:79], v[156:159]
    ds_read_b64_tr_b16 v[36:37], v17 offset:40960
    ds_read_b64_tr_b16 v[38:39], v17 offset:45056
    s_waitcnt lgkmcnt(12)
    v_mfma_f32_16x16x32_bf16 v[160:163], v[40:43], v[64:67], v[160:163]
    v_mfma_f32_16x16x32_bf16 v[164:167], v[40:43], v[68:71], v[164:167]
    v_mfma_f32_16x16x32_bf16 v[168:171], v[40:43], v[72:75], v[168:171]
    v_mfma_f32_16x16x32_bf16 v[172:175], v[40:43], v[76:79], v[172:175]
    ds_read_b64_tr_b16 v[40:41], v18 offset:40960
    ds_read_b64_tr_b16 v[42:43], v18 offset:45056
    v_mfma_f32_16x16x32_bf16 v[176:179], v[44:47], v[64:67], v[176:179]
    v_mfma_f32_16x16x32_bf16 v[180:183], v[44:47], v[68:71], v[180:183]
    v_mfma_f32_16x16x32_bf16 v[184:187], v[44:47], v[72:75], v[184:187]
    v_mfma_f32_16x16x32_bf16 v[188:191], v[44:47], v[76:79], v[188:191]
    ds_read_b64_tr_b16 v[44:45], v19 offset:40960
    ds_read_b64_tr_b16 v[46:47], v19 offset:45056
    s_waitcnt lgkmcnt(12)
    v_mfma_f32_16x16x32_bf16 v[192:195], v[48:51], v[64:67], v[192:195]
    v_mfma_f32_16x16x32_bf16 v[196:199], v[48:51], v[68:71], v[196:199]
    v_mfma_f32_16x16x32_bf16 v[200:203], v[48:51], v[72:75], v[200:203]
    v_mfma_f32_16x16x32_bf16 v[204:207], v[48:51], v[76:79], v[204:207]
    ds_read_b64_tr_b16 v[48:49], v20 offset:40960
    ds_read_b64_tr_b16 v[50:51], v20 offset:45056
    v_mfma_f32_16x16x32_bf16 v[208:211], v[52:55], v[64:67], v[208:211]
    v_mfma_f32_16x16x32_bf16 v[212:215], v[52:55], v[68:71], v[212:215]
    v_mfma_f32_16x16x32_bf16 v[216:219], v[52:55], v[72:75], v[216:219]
    v_mfma_f32_16x16x32_bf16 v[220:223], v[52:55], v[76:79], v[220:223]
    ds_read_b64_tr_b16 v[52:53], v21 offset:40960
    ds_read_b64_tr_b16 v[54:55], v21 offset:45056
    s_waitcnt lgkmcnt(12)
    v_mfma_f32_16x16x32_bf16 v[224:227], v[56:59], v[64:67], v[224:227]
    v_mfma_f32_16x16x32_bf16 v[228:231], v[56:59], v[68:71], v[228:231]
    v_mfma_f32_16x16x32_bf16 v[232:235], v[56:59], v[72:75], v[232:235]
    v_mfma_f32_16x16x32_bf16 v[236:239], v[56:59], v[76:79], v[236:239]
    ds_read_b64_tr_b16 v[56:57], v22 offset:40960
    ds_read_b64_tr_b16 v[58:59], v22 offset:45056
    v_mfma_f32_16x16x32_bf16 v[240:243], v[60:63], v[64:67], v[240:243]
    v_mfma_f32_16x16x32_bf16 v[244:247], v[60:63], v[68:71], v[244:247]
    v_mfma_f32_16x16x32_bf16 v[248:251], v[60:63], v[72:75], v[248:251]
    v_mfma_f32_16x16x32_bf16 v[252:255], v[60:63], v[76:79], v[252:255]
    ds_read_b64_tr_b16 v[60:61], v23 offset:40960
    ds_read_b64_tr_b16 v[62:63], v23 offset:45056
    s_waitcnt vmcnt(15)
    s_waitcnt lgkmcnt(12)
    v_mfma_f32_16x16x32_bf16 v[128:131], v[32:35], v[80:83], v[128:131]
    v_mfma_f32_16x16x32_bf16 v[132:135], v[32:35], v[84:87], v[132:135]
    v_mfma_f32_16x16x32_bf16 v[136:139], v[32:35], v[88:91], v[136:139]
    v_mfma_f32_16x16x32_bf16 v[140:143], v[32:35], v[92:95], v[140:143]
    ds_read_b64_tr_b16 v[32:33], v16 offset:49152
    ds_read_b64_tr_b16 v[34:35], v16 offset:53248
    v_mfma_f32_16x16x32_bf16 v[144:147], v[36:39], v[80:83], v[144:147]
    v_mfma_f32_16x16x32_bf16 v[148:151], v[36:39], v[84:87], v[148:151]
    v_mfma_f32_16x16x32_bf16 v[152:155], v[36:39], v[88:91], v[152:155]
    v_mfma_f32_16x16x32_bf16 v[156:159], v[36:39], v[92:95], v[156:159]
    ds_read_b64_tr_b16 v[36:37], v17 offset:49152
    ds_read_b64_tr_b16 v[38:39], v17 offset:53248
    s_waitcnt lgkmcnt(12)
    v_mfma_f32_16x16x32_bf16 v[160:163], v[40:43], v[80:83], v[160:163]
    v_mfma_f32_16x16x32_bf16 v[164:167], v[40:43], v[84:87], v[164:167]
    v_mfma_f32_16x16x32_bf16 v[168:171], v[40:43], v[88:91], v[168:171]
    v_mfma_f32_16x16x32_bf16 v[172:175], v[40:43], v[92:95], v[172:175]
    ds_read_b64_tr_b16 v[40:41], v18 offset:49152
    ds_read_b64_tr_b16 v[42:43], v18 offset:53248
    v_mfma_f32_16x16x32_bf16 v[176:179], v[44:47], v[80:83], v[176:179]
    v_mfma_f32_16x16x32_bf16 v[180:183], v[44:47], v[84:87], v[180:183]
    v_mfma_f32_16x16x32_bf16 v[184:187], v[44:47], v[88:91], v[184:187]
    v_mfma_f32_16x16x32_bf16 v[188:191], v[44:47], v[92:95], v[188:191]
    ds_read_b64_tr_b16 v[44:45], v19 offset:49152
    ds_read_b64_tr_b16 v[46:47], v19 offset:53248
    s_waitcnt lgkmcnt(12)
    v_mfma_f32_16x16x32_bf16 v[192:195], v[48:51], v[80:83], v[192:195]
    v_mfma_f32_16x16x32_bf16 v[196:199], v[48:51], v[84:87], v[196:199]
    v_mfma_f32_16x16x32_bf16 v[200:203], v[48:51], v[88:91], v[200:203]
    v_mfma_f32_16x16x32_bf16 v[204:207], v[48:51], v[92:95], v[204:207]
    ds_read_b64_tr_b16 v[48:49], v20 offset:49152
    ds_read_b64_tr_b16 v[50:51], v20 offset:53248
    v_mfma_f32_16x16x32_bf16 v[208:211], v[52:55], v[80:83], v[208:211]
    v_mfma_f32_16x16x32_bf16 v[212:215], v[52:55], v[84:87], v[212:215]
    v_mfma_f32_16x16x32_bf16 v[216:219], v[52:55], v[88:91], v[216:219]
    v_mfma_f32_16x16x32_bf16 v[220:223], v[52:55], v[92:95], v[220:223]
    ds_read_b64_tr_b16 v[52:53], v21 offset:49152
    ds_read_b64_tr_b16 v[54:55], v21 offset:53248
    s_waitcnt lgkmcnt(12)
    v_mfma_f32_16x16x32_bf16 v[224:227], v[56:59], v[80:83], v[224:227]
    v_mfma_f32_16x16x32_bf16 v[228:231], v[56:59], v[84:87], v[228:231]
    v_mfma_f32_16x16x32_bf16 v[232:235], v[56:59], v[88:91], v[232:235]
    v_mfma_f32_16x16x32_bf16 v[236:239], v[56:59], v[92:95], v[236:239]
    ds_read_b64_tr_b16 v[56:57], v22 offset:49152
    ds_read_b64_tr_b16 v[58:59], v22 offset:53248
    v_mfma_f32_16x16x32_bf16 v[240:243], v[60:63], v[80:83], v[240:243]
    v_mfma_f32_16x16x32_bf16 v[244:247], v[60:63], v[84:87], v[244:247]
    v_mfma_f32_16x16x32_bf16 v[248:251], v[60:63], v[88:91], v[248:251]
    v_mfma_f32_16x16x32_bf16 v[252:255], v[60:63], v[92:95], v[252:255]
    ds_read_b64_tr_b16 v[60:61], v23 offset:49152
    ds_read_b64_tr_b16 v[62:63], v23 offset:53248
    s_waitcnt vmcnt(11)
    s_waitcnt lgkmcnt(12)
    v_mfma_f32_16x16x32_bf16 v[128:131], v[32:35], v[96:99], v[128:131]
    v_mfma_f32_16x16x32_bf16 v[132:135], v[32:35], v[100:103], v[132:135]
    v_mfma_f32_16x16x32_bf16 v[136:139], v[32:35], v[104:107], v[136:139]
    v_mfma_f32_16x16x32_bf16 v[140:143], v[32:35], v[108:111], v[140:143]
    ds_read_b64_tr_b16 v[32:33], v16 offset:57344
    ds_read_b64_tr_b16 v[34:35], v16 offset:61440
    v_mfma_f32_16x16x32_bf16 v[144:147], v[36:39], v[96:99], v[144:147]
    v_mfma_f32_16x16x32_bf16 v[148:151], v[36:39], v[100:103], v[148:151]
    v_mfma_f32_16x16x32_bf16 v[152:155], v[36:39], v[104:107], v[152:155]
    v_mfma_f32_16x16x32_bf16 v[156:159], v[36:39], v[108:111], v[156:159]
    ds_read_b64_tr_b16 v[36:37], v17 offset:57344
    ds_read_b64_tr_b16 v[38:39], v17 offset:61440
    s_waitcnt lgkmcnt(12)
    v_mfma_f32_16x16x32_bf16 v[160:163], v[40:43], v[96:99], v[160:163]
    v_mfma_f32_16x16x32_bf16 v[164:167], v[40:43], v[100:103], v[164:167]
    v_mfma_f32_16x16x32_bf16 v[168:171], v[40:43], v[104:107], v[168:171]
    v_mfma_f32_16x16x32_bf16 v[172:175], v[40:43], v[108:111], v[172:175]
    ds_read_b64_tr_b16 v[40:41], v18 offset:57344
    ds_read_b64_tr_b16 v[42:43], v18 offset:61440
    v_mfma_f32_16x16x32_bf16 v[176:179], v[44:47], v[96:99], v[176:179]
    v_mfma_f32_16x16x32_bf16 v[180:183], v[44:47], v[100:103], v[180:183]
    v_mfma_f32_16x16x32_bf16 v[184:187], v[44:47], v[104:107], v[184:187]
    v_mfma_f32_16x16x32_bf16 v[188:191], v[44:47], v[108:111], v[188:191]
    ds_read_b64_tr_b16 v[44:45], v19 offset:57344
    ds_read_b64_tr_b16 v[46:47], v19 offset:61440
    s_waitcnt lgkmcnt(12)
    v_mfma_f32_16x16x32_bf16 v[192:195], v[48:51], v[96:99], v[192:195]
    v_mfma_f32_16x16x32_bf16 v[196:199], v[48:51], v[100:103], v[196:199]
    v_mfma_f32_16x16x32_bf16 v[200:203], v[48:51], v[104:107], v[200:203]
    v_mfma_f32_16x16x32_bf16 v[204:207], v[48:51], v[108:111], v[204:207]
    ds_read_b64_tr_b16 v[48:49], v20 offset:57344
    ds_read_b64_tr_b16 v[50:51], v20 offset:61440
    v_mfma_f32_16x16x32_bf16 v[208:211], v[52:55], v[96:99], v[208:211]
    v_mfma_f32_16x16x32_bf16 v[212:215], v[52:55], v[100:103], v[212:215]
    v_mfma_f32_16x16x32_bf16 v[216:219], v[52:55], v[104:107], v[216:219]
    v_mfma_f32_16x16x32_bf16 v[220:223], v[52:55], v[108:111], v[220:223]
    ds_read_b64_tr_b16 v[52:53], v21 offset:57344
    ds_read_b64_tr_b16 v[54:55], v21 offset:61440
    s_waitcnt lgkmcnt(12)
    v_mfma_f32_16x16x32_bf16 v[224:227], v[56:59], v[96:99], v[224:227]
    v_mfma_f32_16x16x32_bf16 v[228:231], v[56:59], v[100:103], v[228:231]
    v_mfma_f32_16x16x32_bf16 v[232:235], v[56:59], v[104:107], v[232:235]
    v_mfma_f32_16x16x32_bf16 v[236:239], v[56:59], v[108:111], v[236:239]
    ds_read_b64_tr_b16 v[56:57], v22 offset:57344
    ds_read_b64_tr_b16 v[58:59], v22 offset:61440
    v_mfma_f32_16x16x32_bf16 v[240:243], v[60:63], v[96:99], v[240:243]
    v_mfma_f32_16x16x32_bf16 v[244:247], v[60:63], v[100:103], v[244:247]
    v_mfma_f32_16x16x32_bf16 v[248:251], v[60:63], v[104:107], v[248:251]
    v_mfma_f32_16x16x32_bf16 v[252:255], v[60:63], v[108:111], v[252:255]
    ds_read_b64_tr_b16 v[60:61], v23 offset:57344
    ds_read_b64_tr_b16 v[62:63], v23 offset:61440
    s_waitcnt vmcnt(0)
    s_waitcnt lgkmcnt(12)
    v_mfma_f32_16x16x32_bf16 v[128:131], v[32:35], v[112:115], v[128:131]
    v_mfma_f32_16x16x32_bf16 v[132:135], v[32:35], v[116:119], v[132:135]
    v_mfma_f32_16x16x32_bf16 v[136:139], v[32:35], v[120:123], v[136:139]
    v_mfma_f32_16x16x32_bf16 v[140:143], v[32:35], v[124:127], v[140:143]
    v_mfma_f32_16x16x32_bf16 v[144:147], v[36:39], v[112:115], v[144:147]
    v_mfma_f32_16x16x32_bf16 v[148:151], v[36:39], v[116:119], v[148:151]
    v_mfma_f32_16x16x32_bf16 v[152:155], v[36:39], v[120:123], v[152:155]
    v_mfma_f32_16x16x32_bf16 v[156:159], v[36:39], v[124:127], v[156:159]
    s_waitcnt lgkmcnt(8)
    v_mfma_f32_16x16x32_bf16 v[160:163], v[40:43], v[112:115], v[160:163]
    v_mfma_f32_16x16x32_bf16 v[164:167], v[40:43], v[116:119], v[164:167]
    v_mfma_f32_16x16x32_bf16 v[168:171], v[40:43], v[120:123], v[168:171]
    v_mfma_f32_16x16x32_bf16 v[172:175], v[40:43], v[124:127], v[172:175]
    v_mfma_f32_16x16x32_bf16 v[176:179], v[44:47], v[112:115], v[176:179]
    v_mfma_f32_16x16x32_bf16 v[180:183], v[44:47], v[116:119], v[180:183]
    v_mfma_f32_16x16x32_bf16 v[184:187], v[44:47], v[120:123], v[184:187]
    v_mfma_f32_16x16x32_bf16 v[188:191], v[44:47], v[124:127], v[188:191]
    s_waitcnt lgkmcnt(4)
    v_mfma_f32_16x16x32_bf16 v[192:195], v[48:51], v[112:115], v[192:195]
    v_mfma_f32_16x16x32_bf16 v[196:199], v[48:51], v[116:119], v[196:199]
    v_mfma_f32_16x16x32_bf16 v[200:203], v[48:51], v[120:123], v[200:203]
    v_mfma_f32_16x16x32_bf16 v[204:207], v[48:51], v[124:127], v[204:207]
    v_mfma_f32_16x16x32_bf16 v[208:211], v[52:55], v[112:115], v[208:211]
    v_mfma_f32_16x16x32_bf16 v[212:215], v[52:55], v[116:119], v[212:215]
    v_mfma_f32_16x16x32_bf16 v[216:219], v[52:55], v[120:123], v[216:219]
    v_mfma_f32_16x16x32_bf16 v[220:223], v[52:55], v[124:127], v[220:223]
    s_waitcnt lgkmcnt(0)
    v_mfma_f32_16x16x32_bf16 v[224:227], v[56:59], v[112:115], v[224:227]
    v_mfma_f32_16x16x32_bf16 v[228:231], v[56:59], v[116:119], v[228:231]
    v_mfma_f32_16x16x32_bf16 v[232:235], v[56:59], v[120:123], v[232:235]
    v_mfma_f32_16x16x32_bf16 v[236:239], v[56:59], v[124:127], v[236:239]
    v_mfma_f32_16x16x32_bf16 v[240:243], v[60:63], v[112:115], v[240:243]
    v_mfma_f32_16x16x32_bf16 v[244:247], v[60:63], v[116:119], v[244:247]
    v_mfma_f32_16x16x32_bf16 v[248:251], v[60:63], v[120:123], v[248:251]
    v_mfma_f32_16x16x32_bf16 v[252:255], v[60:63], v[124:127], v[252:255]
    s_lshl_b32 s8, s34, 7
    s_add_u32 s8, s8, s44
    s_lshl_b32 s8, s8, 14
    s_lshl_b32 s9, s35, 12
    s_add_u32 s8, s8, s9
    s_add_u32 s8, s8, 69206016
    v_cvt_pk_bf16_f32 v32, v128, v129
    v_cvt_pk_bf16_f32 v33, v130, v131
    v_cvt_pk_bf16_f32 v34, v144, v145
    v_cvt_pk_bf16_f32 v35, v146, v147
    buffer_store_dwordx4 v[32:35], v2, s[4:7], s8 offen offset:0 sc1
    v_cvt_pk_bf16_f32 v36, v160, v161
    v_cvt_pk_bf16_f32 v37, v162, v163
    v_cvt_pk_bf16_f32 v38, v176, v177
    v_cvt_pk_bf16_f32 v39, v178, v179
    buffer_store_dwordx4 v[36:39], v2, s[4:7], s8 offen offset:1024 sc1
    v_cvt_pk_bf16_f32 v40, v192, v193
    v_cvt_pk_bf16_f32 v41, v194, v195
    v_cvt_pk_bf16_f32 v42, v208, v209
    v_cvt_pk_bf16_f32 v43, v210, v211
    buffer_store_dwordx4 v[40:43], v2, s[4:7], s8 offen offset:2048 sc1
    v_cvt_pk_bf16_f32 v44, v224, v225
    v_cvt_pk_bf16_f32 v45, v226, v227
    v_cvt_pk_bf16_f32 v46, v240, v241
    v_cvt_pk_bf16_f32 v47, v242, v243
    buffer_store_dwordx4 v[44:47], v2, s[4:7], s8 offen offset:3072 sc1
    s_add_u32 s8, s8, 16384
    v_cvt_pk_bf16_f32 v48, v132, v133
    v_cvt_pk_bf16_f32 v49, v134, v135
    v_cvt_pk_bf16_f32 v50, v148, v149
    v_cvt_pk_bf16_f32 v51, v150, v151
    buffer_store_dwordx4 v[48:51], v2, s[4:7], s8 offen offset:0 sc1
    v_cvt_pk_bf16_f32 v52, v164, v165
    v_cvt_pk_bf16_f32 v53, v166, v167
    v_cvt_pk_bf16_f32 v54, v180, v181
    v_cvt_pk_bf16_f32 v55, v182, v183
    buffer_store_dwordx4 v[52:55], v2, s[4:7], s8 offen offset:1024 sc1
    v_cvt_pk_bf16_f32 v56, v196, v197
    v_cvt_pk_bf16_f32 v57, v198, v199
    v_cvt_pk_bf16_f32 v58, v212, v213
    v_cvt_pk_bf16_f32 v59, v214, v215
    buffer_store_dwordx4 v[56:59], v2, s[4:7], s8 offen offset:2048 sc1
    v_cvt_pk_bf16_f32 v60, v228, v229
    v_cvt_pk_bf16_f32 v61, v230, v231
    v_cvt_pk_bf16_f32 v62, v244, v245
    v_cvt_pk_bf16_f32 v63, v246, v247
    buffer_store_dwordx4 v[60:63], v2, s[4:7], s8 offen offset:3072 sc1
    s_add_u32 s8, s8, 16384
    v_cvt_pk_bf16_f32 v32, v136, v137
    v_cvt_pk_bf16_f32 v33, v138, v139
    v_cvt_pk_bf16_f32 v34, v152, v153
    v_cvt_pk_bf16_f32 v35, v154, v155
    buffer_store_dwordx4 v[32:35], v2, s[4:7], s8 offen offset:0 sc1
    v_cvt_pk_bf16_f32 v36, v168, v169
    v_cvt_pk_bf16_f32 v37, v170, v171
    v_cvt_pk_bf16_f32 v38, v184, v185
    v_cvt_pk_bf16_f32 v39, v186, v187
    buffer_store_dwordx4 v[36:39], v2, s[4:7], s8 offen offset:1024 sc1
    v_cvt_pk_bf16_f32 v40, v200, v201
    v_cvt_pk_bf16_f32 v41, v202, v203
    v_cvt_pk_bf16_f32 v42, v216, v217
    v_cvt_pk_bf16_f32 v43, v218, v219
    buffer_store_dwordx4 v[40:43], v2, s[4:7], s8 offen offset:2048 sc1
    v_cvt_pk_bf16_f32 v44, v232, v233
    v_cvt_pk_bf16_f32 v45, v234, v235
    v_cvt_pk_bf16_f32 v46, v248, v249
    v_cvt_pk_bf16_f32 v47, v250, v251
    buffer_store_dwordx4 v[44:47], v2, s[4:7], s8 offen offset:3072 sc1
    s_add_u32 s8, s8, 16384
    v_cvt_pk_bf16_f32 v48, v140, v141
    v_cvt_pk_bf16_f32 v49, v142, v143
    v_cvt_pk_bf16_f32 v50, v156, v157
    v_cvt_pk_bf16_f32 v51, v158, v159
    buffer_store_dwordx4 v[48:51], v2, s[4:7], s8 offen offset:0 sc1
    v_cvt_pk_bf16_f32 v52, v172, v173
    v_cvt_pk_bf16_f32 v53, v174, v175
    v_cvt_pk_bf16_f32 v54, v188, v189
    v_cvt_pk_bf16_f32 v55, v190, v191
    buffer_store_dwordx4 v[52:55], v2, s[4:7], s8 offen offset:1024 sc1
    v_cvt_pk_bf16_f32 v56, v204, v205
    v_cvt_pk_bf16_f32 v57, v206, v207
    v_cvt_pk_bf16_f32 v58, v220, v221
    v_cvt_pk_bf16_f32 v59, v222, v223
    buffer_store_dwordx4 v[56:59], v2, s[4:7], s8 offen offset:2048 sc1
    v_cvt_pk_bf16_f32 v60, v236, v237
    v_cvt_pk_bf16_f32 v61, v238, v239
    v_cvt_pk_bf16_f32 v62, v252, v253
    v_cvt_pk_bf16_f32 v63, v254, v255
    buffer_store_dwordx4 v[60:63], v2, s[4:7], s8 offen offset:3072 sc1
    s_add_u32 s8, s8, 16384
    s_waitcnt vmcnt(0)
    s_barrier
    s_lshl_b32 s8, s32, 2
    s_add_u32 s8, s8, s35
    s_add_u32 s8, s8, 192
    s_cmp_lg_u32 s3, 0
    s_cbranch_scc1 sig_168
    s_lshl_b32 s14, s8, 8
    s_add_u32 s14, s14, 117440512
    v_mov_b32_e64 v8, 0
    v_mov_b32 v9, 1
    s_mov_b64 exec, 1
    buffer_atomic_add v9, v8, s[4:7], s14 offen sc1
    s_mov_b64 exec, -1
sig_168:
    s_mov_b32 s40, 0
    s_mov_b32 s41, 32768
    s_branch parallel_sum__compressed_kv_cla__mixer_gmlp__prompt_kernel_t_f
parallel_sum__compressed_kv_cla__mixer_gmlp__prompt_kernel_t_s:
    s_lshl_b32 s42, s34, 1
    s_and_b32 s8, s35, 1
    s_add_u32 s42, s42, s8
    s_lshr_b32 s8, s35, 1
    s_lshl_b32 s8, s8, 2
    s_add_u32 s43, s8, s32
    s_mul_i32 s44, s43, 6
    s_lshl_b32 s8, s43, 2
    s_add_u32 s8, s8, 12
    s_cmp_lt_u32 s43, 6
    s_cselect_b32 s44, s44, s8
    s_cmp_eq_u32 s43, 6
    s_cselect_b32 s45, 40, 44
    s_and_b32 s8, s3, 1
    s_add_u32 s44, s44, s8
    v_lshrrev_b32 v4, 3, v1
    v_lshlrev_b32 v4, 12, v4
    v_and_b32 v5, 7, v1
    v_xor_b32 v5, v5, v6
    v_lshl_add_u32 v14, v5, 4, v4
    v_xor_b32_e64 v15, 64, v14
    s_lshr_b32 s50, s3, 1
    s_lshl_b32 s46, s42, 19
    s_lshl_b32 s8, s50, 10
    s_add_u32 s46, s46, s8
    s_and_b32 s8, s3, 1
    s_lshl_b32 s8, s8, 18
    s_add_u32 s46, s46, s8
    s_lshl_b32 s51, s50, 15
    s_and_b32 s8, s3, 1
    s_lshl_b32 s8, s8, 13
    s_add_u32 s47, s51, s8
    s_add_u32 s9, s44, 0
    s_min_u32 s9, s9, 42
    s_lshl_b32 s9, s9, 16
    s_lshl_b32 s8, s50, 14
    s_add_u32 s9, s9, s8
    s_add_u32 s52, s9, 65011712
    s_add_u32 s9, s44, 2
    s_min_u32 s9, s9, 42
    s_lshl_b32 s9, s9, 16
    s_lshl_b32 s8, s50, 14
    s_add_u32 s9, s9, s8
    s_add_u32 s53, s9, 65011712
    s_add_u32 s9, s44, 4
    s_min_u32 s9, s9, 42
    s_lshl_b32 s9, s9, 16
    s_lshl_b32 s8, s50, 14
    s_add_u32 s9, s9, s8
    s_add_u32 s54, s9, 65011712
    v_and_b32 v4, 15, v1
    v_lshrrev_b32 v5, 1, v4
    v_xor_b32 v5, v5, v6
    v_lshlrev_b32 v5, 4, v5
    v_lshl_add_u32 v5, v4, 7, v5
    v_add_u32 v16, s51, v5
    v_xor_b32 v17, 64, v16
    s_waitcnt vmcnt(0) lgkmcnt(0)
    s_mov_b32 s28, s10
    s_and_b32 s29, s11, 0xffff
    s_mov_b32 s30, 0x1000
    s_mov_b32 s31, 0x00020000
    s_mov_b32 s60, s12
    s_and_b32 s61, s13, 0xffff
    s_mov_b32 s62, 0x200000
    s_mov_b32 s63, 0x00020000
    s_mov_b32 s64, s64
    s_and_b32 s65, s65, 0xffff
    s_mov_b32 s66, 0x200000
    s_mov_b32 s67, 0x00020000
    s_barrier
    s_cmp_lg_u32 s3, 0
    s_cbranch_scc1 sig_169
    s_lshl_b32 s14, s37, 8
    s_add_u32 s14, s14, 117440512
    v_mov_b32_e64 v8, 0
    v_mov_b32 v9, 1
    s_mov_b64 exec, 1
    buffer_atomic_add v9, v8, s[4:7], s14 offen sc1
    s_mov_b64 exec, -1
sig_169:
    s_add_u32 m0, s47, 0
    s_add_u32 s12, s46, 0
    buffer_load_dwordx4 v14, s[16:19], s12 offen lds
    s_add_u32 m0, s47, 1024
    s_add_u32 s12, s46, 32768
    buffer_load_dwordx4 v15, s[16:19], s12 offen lds
    s_add_u32 m0, s47, 2048
    s_add_u32 s12, s46, 65536
    buffer_load_dwordx4 v14, s[16:19], s12 offen lds
    s_add_u32 m0, s47, 3072
    s_add_u32 s12, s46, 98304
    buffer_load_dwordx4 v15, s[16:19], s12 offen lds
    s_add_u32 m0, s47, 4096
    s_add_u32 s12, s46, 131072
    buffer_load_dwordx4 v14, s[16:19], s12 offen lds
    s_add_u32 m0, s47, 5120
    s_add_u32 s12, s46, 163840
    buffer_load_dwordx4 v15, s[16:19], s12 offen lds
    s_add_u32 m0, s47, 6144
    s_add_u32 s12, s46, 196608
    buffer_load_dwordx4 v14, s[16:19], s12 offen lds
    s_add_u32 m0, s47, 7168
    s_add_u32 s12, s46, 229376
    buffer_load_dwordx4 v15, s[16:19], s12 offen lds
    s_mov_b32 s8, 88
    s_mov_b32 s15, 0x20000
poll_170:
    v_cmp_gt_u32 vcc, 32, v26
    s_cbranch_vccz polld_171
    s_sleep 2
    s_lshl_b32 s14, s8, 8
    s_add_u32 s14, s14, 117440512
    v_and_b32 v8, 7, v1
    v_lshlrev_b32_e64 v8, 8, v8
    buffer_load_dword v26, v8, s[4:7], s14 offen sc1
    s_waitcnt vmcnt(0)
    s_sub_u32 s15, s15, 1
    s_cmp_lg_u32 s15, 0
    s_cbranch_scc1 poll_170
polld_171:
    s_add_u32 s12, s52, 0
    buffer_load_dwordx4 v[32:35], v2, s[4:7], s12 offen offset:0 sc1
    s_add_u32 s12, s53, 0
    buffer_load_dwordx4 v[36:39], v2, s[4:7], s12 offen offset:0 sc1
    s_add_u32 s12, s54, 0
    buffer_load_dwordx4 v[40:43], v2, s[4:7], s12 offen offset:0 sc1
    s_add_u32 s12, s52, 0
    buffer_load_dwordx4 v[44:47], v2, s[4:7], s12 offen offset:1024 sc1
    s_add_u32 s12, s53, 0
    buffer_load_dwordx4 v[48:51], v2, s[4:7], s12 offen offset:1024 sc1
    s_add_u32 s12, s54, 0
    buffer_load_dwordx4 v[52:55], v2, s[4:7], s12 offen offset:1024 sc1
    s_add_u32 m0, s47, 16384
    s_add_u32 s12, s46, 128
    buffer_load_dwordx4 v14, s[16:19], s12 offen lds
    s_add_u32 m0, s47, 17408
    s_add_u32 s12, s46, 32896
    buffer_load_dwordx4 v15, s[16:19], s12 offen lds
    s_add_u32 m0, s47, 18432
    s_add_u32 s12, s46, 65664
    buffer_load_dwordx4 v14, s[16:19], s12 offen lds
    s_add_u32 m0, s47, 19456
    s_add_u32 s12, s46, 98432
    buffer_load_dwordx4 v15, s[16:19], s12 offen lds
    s_add_u32 m0, s47, 20480
    s_add_u32 s12, s46, 131200
    buffer_load_dwordx4 v14, s[16:19], s12 offen lds
    s_add_u32 m0, s47, 21504
    s_add_u32 s12, s46, 163968
    buffer_load_dwordx4 v15, s[16:19], s12 offen lds
    s_add_u32 m0, s47, 22528
    s_add_u32 s12, s46, 196736
    buffer_load_dwordx4 v14, s[16:19], s12 offen lds
    s_add_u32 m0, s47, 23552
    s_add_u32 s12, s46, 229504
    buffer_load_dwordx4 v15, s[16:19], s12 offen lds
    v_lshlrev_b32_e64 v10, 6, v1
    buffer_load_dword v92, v10, s[28:31], 0 offen
    s_waitcnt vmcnt(15)
    s_barrier
    ds_read_b128 v[96:99], v16 offset:0
    ds_read_b128 v[100:103], v16 offset:2048
    ds_read_b128 v[104:107], v16 offset:4096
    ds_read_b128 v[108:111], v16 offset:6144
    ds_read_b128 v[112:115], v16 offset:8192
    ds_read_b128 v[116:119], v16 offset:10240
    ds_read_b128 v[120:123], v16 offset:12288
    ds_read_b128 v[124:127], v16 offset:14336
    s_add_u32 s12, s52, 0
    buffer_load_dwordx4 v[56:59], v2, s[4:7], s12 offen offset:2048 sc1
    s_add_u32 s12, s53, 0
    buffer_load_dwordx4 v[60:63], v2, s[4:7], s12 offen offset:2048 sc1
    s_add_u32 s12, s54, 0
    buffer_load_dwordx4 v[64:67], v2, s[4:7], s12 offen offset:2048 sc1
    s_add_u32 s12, s52, 0
    buffer_load_dwordx4 v[68:71], v2, s[4:7], s12 offen offset:3072 sc1
    s_add_u32 s12, s53, 0
    buffer_load_dwordx4 v[72:75], v2, s[4:7], s12 offen offset:3072 sc1
    s_add_u32 s12, s54, 0
    buffer_load_dwordx4 v[76:79], v2, s[4:7], s12 offen offset:3072 sc1
    s_add_u32 s12, s52, 4096
    buffer_load_dwordx4 v[80:83], v2, s[4:7], s12 offen offset:0 sc1
    s_add_u32 s12, s53, 4096
    buffer_load_dwordx4 v[84:87], v2, s[4:7], s12 offen offset:0 sc1
    s_add_u32 s12, s54, 4096
    buffer_load_dwordx4 v[88:91], v2, s[4:7], s12 offen offset:0 sc1
    s_waitcnt vmcnt(21) lgkmcnt(0)
    v_mfma_f32_16x16x32_bf16 v[160:163], v[32:35], v[96:99], 0
    ds_read_b128 v[128:131], v17 offset:0
    v_mfma_f32_16x16x32_bf16 v[164:167], v[32:35], v[100:103], 0
    ds_read_b128 v[132:135], v17 offset:2048
    v_mfma_f32_16x16x32_bf16 v[168:171], v[32:35], v[104:107], 0
    ds_read_b128 v[136:139], v17 offset:4096
    v_mfma_f32_16x16x32_bf16 v[172:175], v[32:35], v[108:111], 0
    ds_read_b128 v[140:143], v17 offset:6144
    v_mfma_f32_16x16x32_bf16 v[176:179], v[32:35], v[112:115], 0
    ds_read_b128 v[144:147], v17 offset:8192
    v_mfma_f32_16x16x32_bf16 v[180:183], v[32:35], v[116:119], 0
    ds_read_b128 v[148:151], v17 offset:10240
    v_mfma_f32_16x16x32_bf16 v[184:187], v[32:35], v[120:123], 0
    ds_read_b128 v[152:155], v17 offset:12288
    v_mfma_f32_16x16x32_bf16 v[188:191], v[32:35], v[124:127], 0
    ds_read_b128 v[156:159], v17 offset:14336
    s_add_u32 s12, s52, 4096
    buffer_load_dwordx4 v[32:35], v2, s[4:7], s12 offen offset:1024 sc1
    v_mfma_f32_16x16x32_bf16 v[192:195], v[36:39], v[96:99], 0
    v_mfma_f32_16x16x32_bf16 v[196:199], v[36:39], v[100:103], 0
    v_mfma_f32_16x16x32_bf16 v[200:203], v[36:39], v[104:107], 0
    v_mfma_f32_16x16x32_bf16 v[204:207], v[36:39], v[108:111], 0
    v_mfma_f32_16x16x32_bf16 v[208:211], v[36:39], v[112:115], 0
    v_mfma_f32_16x16x32_bf16 v[212:215], v[36:39], v[116:119], 0
    v_mfma_f32_16x16x32_bf16 v[216:219], v[36:39], v[120:123], 0
    v_mfma_f32_16x16x32_bf16 v[220:223], v[36:39], v[124:127], 0
    s_add_u32 s12, s53, 4096
    buffer_load_dwordx4 v[36:39], v2, s[4:7], s12 offen offset:1024 sc1
    v_mfma_f32_16x16x32_bf16 v[224:227], v[40:43], v[96:99], 0
    v_mfma_f32_16x16x32_bf16 v[228:231], v[40:43], v[100:103], 0
    v_mfma_f32_16x16x32_bf16 v[232:235], v[40:43], v[104:107], 0
    v_mfma_f32_16x16x32_bf16 v[236:239], v[40:43], v[108:111], 0
    v_mfma_f32_16x16x32_bf16 v[240:243], v[40:43], v[112:115], 0
    v_mfma_f32_16x16x32_bf16 v[244:247], v[40:43], v[116:119], 0
    v_mfma_f32_16x16x32_bf16 v[248:251], v[40:43], v[120:123], 0
    v_mfma_f32_16x16x32_bf16 v[252:255], v[40:43], v[124:127], 0
    s_add_u32 s12, s54, 4096
    buffer_load_dwordx4 v[40:43], v2, s[4:7], s12 offen offset:1024 sc1
    s_waitcnt vmcnt(13) lgkmcnt(0)
    s_barrier
    v_mfma_f32_16x16x32_bf16 v[160:163], v[44:47], v[128:131], v[160:163]
    s_add_u32 m0, s47, 0
    s_add_u32 s12, s46, 256
    buffer_load_dwordx4 v14, s[16:19], s12 offen lds
    v_mfma_f32_16x16x32_bf16 v[164:167], v[44:47], v[132:135], v[164:167]
    s_add_u32 m0, s47, 1024
    s_add_u32 s12, s46, 33024
    buffer_load_dwordx4 v15, s[16:19], s12 offen lds
    v_mfma_f32_16x16x32_bf16 v[168:171], v[44:47], v[136:139], v[168:171]
    s_add_u32 m0, s47, 2048
    s_add_u32 s12, s46, 65792
    buffer_load_dwordx4 v14, s[16:19], s12 offen lds
    v_mfma_f32_16x16x32_bf16 v[172:175], v[44:47], v[140:143], v[172:175]
    s_add_u32 m0, s47, 3072
    s_add_u32 s12, s46, 98560
    buffer_load_dwordx4 v15, s[16:19], s12 offen lds
    v_mfma_f32_16x16x32_bf16 v[176:179], v[44:47], v[144:147], v[176:179]
    s_add_u32 m0, s47, 4096
    s_add_u32 s12, s46, 131328
    buffer_load_dwordx4 v14, s[16:19], s12 offen lds
    v_mfma_f32_16x16x32_bf16 v[180:183], v[44:47], v[148:151], v[180:183]
    s_add_u32 m0, s47, 5120
    s_add_u32 s12, s46, 164096
    buffer_load_dwordx4 v15, s[16:19], s12 offen lds
    v_mfma_f32_16x16x32_bf16 v[184:187], v[44:47], v[152:155], v[184:187]
    s_add_u32 m0, s47, 6144
    s_add_u32 s12, s46, 196864
    buffer_load_dwordx4 v14, s[16:19], s12 offen lds
    v_mfma_f32_16x16x32_bf16 v[188:191], v[44:47], v[156:159], v[188:191]
    s_add_u32 m0, s47, 7168
    s_add_u32 s12, s46, 229632
    buffer_load_dwordx4 v15, s[16:19], s12 offen lds
    s_add_u32 s12, s52, 4096
    buffer_load_dwordx4 v[44:47], v2, s[4:7], s12 offen offset:2048 sc1
    v_mfma_f32_16x16x32_bf16 v[192:195], v[48:51], v[128:131], v[192:195]
    ds_read_b128 v[96:99], v16 offset:16384
    v_mfma_f32_16x16x32_bf16 v[196:199], v[48:51], v[132:135], v[196:199]
    ds_read_b128 v[100:103], v16 offset:18432
    v_mfma_f32_16x16x32_bf16 v[200:203], v[48:51], v[136:139], v[200:203]
    ds_read_b128 v[104:107], v16 offset:20480
    v_mfma_f32_16x16x32_bf16 v[204:207], v[48:51], v[140:143], v[204:207]
    ds_read_b128 v[108:111], v16 offset:22528
    v_mfma_f32_16x16x32_bf16 v[208:211], v[48:51], v[144:147], v[208:211]
    ds_read_b128 v[112:115], v16 offset:24576
    v_mfma_f32_16x16x32_bf16 v[212:215], v[48:51], v[148:151], v[212:215]
    ds_read_b128 v[116:119], v16 offset:26624
    v_mfma_f32_16x16x32_bf16 v[216:219], v[48:51], v[152:155], v[216:219]
    ds_read_b128 v[120:123], v16 offset:28672
    v_mfma_f32_16x16x32_bf16 v[220:223], v[48:51], v[156:159], v[220:223]
    ds_read_b128 v[124:127], v16 offset:30720
    s_add_u32 s12, s53, 4096
    buffer_load_dwordx4 v[48:51], v2, s[4:7], s12 offen offset:2048 sc1
    v_mfma_f32_16x16x32_bf16 v[224:227], v[52:55], v[128:131], v[224:227]
    v_mfma_f32_16x16x32_bf16 v[228:231], v[52:55], v[132:135], v[228:231]
    v_mfma_f32_16x16x32_bf16 v[232:235], v[52:55], v[136:139], v[232:235]
    v_mfma_f32_16x16x32_bf16 v[236:239], v[52:55], v[140:143], v[236:239]
    v_mfma_f32_16x16x32_bf16 v[240:243], v[52:55], v[144:147], v[240:243]
    v_mfma_f32_16x16x32_bf16 v[244:247], v[52:55], v[148:151], v[244:247]
    v_mfma_f32_16x16x32_bf16 v[248:251], v[52:55], v[152:155], v[248:251]
    v_mfma_f32_16x16x32_bf16 v[252:255], v[52:55], v[156:159], v[252:255]
    s_add_u32 s12, s54, 4096
    buffer_load_dwordx4 v[52:55], v2, s[4:7], s12 offen offset:2048 sc1
    s_waitcnt vmcnt(20) lgkmcnt(0)
    v_mfma_f32_16x16x32_bf16 v[160:163], v[56:59], v[96:99], v[160:163]
    ds_read_b128 v[128:131], v17 offset:16384
    v_mfma_f32_16x16x32_bf16 v[164:167], v[56:59], v[100:103], v[164:167]
    ds_read_b128 v[132:135], v17 offset:18432
    v_mfma_f32_16x16x32_bf16 v[168:171], v[56:59], v[104:107], v[168:171]
    ds_read_b128 v[136:139], v17 offset:20480
    v_mfma_f32_16x16x32_bf16 v[172:175], v[56:59], v[108:111], v[172:175]
    ds_read_b128 v[140:143], v17 offset:22528
    v_mfma_f32_16x16x32_bf16 v[176:179], v[56:59], v[112:115], v[176:179]
    ds_read_b128 v[144:147], v17 offset:24576
    v_mfma_f32_16x16x32_bf16 v[180:183], v[56:59], v[116:119], v[180:183]
    ds_read_b128 v[148:151], v17 offset:26624
    v_mfma_f32_16x16x32_bf16 v[184:187], v[56:59], v[120:123], v[184:187]
    ds_read_b128 v[152:155], v17 offset:28672
    v_mfma_f32_16x16x32_bf16 v[188:191], v[56:59], v[124:127], v[188:191]
    ds_read_b128 v[156:159], v17 offset:30720
    s_add_u32 s12, s52, 4096
    buffer_load_dwordx4 v[56:59], v2, s[4:7], s12 offen offset:3072 sc1
    v_mfma_f32_16x16x32_bf16 v[192:195], v[60:63], v[96:99], v[192:195]
    v_mfma_f32_16x16x32_bf16 v[196:199], v[60:63], v[100:103], v[196:199]
    v_mfma_f32_16x16x32_bf16 v[200:203], v[60:63], v[104:107], v[200:203]
    v_mfma_f32_16x16x32_bf16 v[204:207], v[60:63], v[108:111], v[204:207]
    v_mfma_f32_16x16x32_bf16 v[208:211], v[60:63], v[112:115], v[208:211]
    v_mfma_f32_16x16x32_bf16 v[212:215], v[60:63], v[116:119], v[212:215]
    v_mfma_f32_16x16x32_bf16 v[216:219], v[60:63], v[120:123], v[216:219]
    v_mfma_f32_16x16x32_bf16 v[220:223], v[60:63], v[124:127], v[220:223]
    s_add_u32 s12, s53, 4096
    buffer_load_dwordx4 v[60:63], v2, s[4:7], s12 offen offset:3072 sc1
    v_mfma_f32_16x16x32_bf16 v[224:227], v[64:67], v[96:99], v[224:227]
    v_mfma_f32_16x16x32_bf16 v[228:231], v[64:67], v[100:103], v[228:231]
    v_mfma_f32_16x16x32_bf16 v[232:235], v[64:67], v[104:107], v[232:235]
    v_mfma_f32_16x16x32_bf16 v[236:239], v[64:67], v[108:111], v[236:239]
    v_mfma_f32_16x16x32_bf16 v[240:243], v[64:67], v[112:115], v[240:243]
    v_mfma_f32_16x16x32_bf16 v[244:247], v[64:67], v[116:119], v[244:247]
    v_mfma_f32_16x16x32_bf16 v[248:251], v[64:67], v[120:123], v[248:251]
    v_mfma_f32_16x16x32_bf16 v[252:255], v[64:67], v[124:127], v[252:255]
    s_add_u32 s12, s54, 4096
    buffer_load_dwordx4 v[64:67], v2, s[4:7], s12 offen offset:3072 sc1
    s_waitcnt vmcnt(6) lgkmcnt(0)
    s_barrier
    v_mfma_f32_16x16x32_bf16 v[160:163], v[68:71], v[128:131], v[160:163]
    s_add_u32 m0, s47, 16384
    s_add_u32 s12, s46, 384
    buffer_load_dwordx4 v14, s[16:19], s12 offen lds
    v_mfma_f32_16x16x32_bf16 v[164:167], v[68:71], v[132:135], v[164:167]
    s_add_u32 m0, s47, 17408
    s_add_u32 s12, s46, 33152
    buffer_load_dwordx4 v15, s[16:19], s12 offen lds
    v_mfma_f32_16x16x32_bf16 v[168:171], v[68:71], v[136:139], v[168:171]
    s_add_u32 m0, s47, 18432
    s_add_u32 s12, s46, 65920
    buffer_load_dwordx4 v14, s[16:19], s12 offen lds
    v_mfma_f32_16x16x32_bf16 v[172:175], v[68:71], v[140:143], v[172:175]
    s_add_u32 m0, s47, 19456
    s_add_u32 s12, s46, 98688
    buffer_load_dwordx4 v15, s[16:19], s12 offen lds
    v_mfma_f32_16x16x32_bf16 v[176:179], v[68:71], v[144:147], v[176:179]
    s_add_u32 m0, s47, 20480
    s_add_u32 s12, s46, 131456
    buffer_load_dwordx4 v14, s[16:19], s12 offen lds
    v_mfma_f32_16x16x32_bf16 v[180:183], v[68:71], v[148:151], v[180:183]
    s_add_u32 m0, s47, 21504
    s_add_u32 s12, s46, 164224
    buffer_load_dwordx4 v15, s[16:19], s12 offen lds
    v_mfma_f32_16x16x32_bf16 v[184:187], v[68:71], v[152:155], v[184:187]
    s_add_u32 m0, s47, 22528
    s_add_u32 s12, s46, 196992
    buffer_load_dwordx4 v14, s[16:19], s12 offen lds
    v_mfma_f32_16x16x32_bf16 v[188:191], v[68:71], v[156:159], v[188:191]
    s_add_u32 m0, s47, 23552
    s_add_u32 s12, s46, 229760
    buffer_load_dwordx4 v15, s[16:19], s12 offen lds
    s_add_u32 s12, s52, 8192
    buffer_load_dwordx4 v[68:71], v2, s[4:7], s12 offen offset:0 sc1
    v_mfma_f32_16x16x32_bf16 v[192:195], v[72:75], v[128:131], v[192:195]
    ds_read_b128 v[96:99], v16 offset:0
    v_mfma_f32_16x16x32_bf16 v[196:199], v[72:75], v[132:135], v[196:199]
    ds_read_b128 v[100:103], v16 offset:2048
    v_mfma_f32_16x16x32_bf16 v[200:203], v[72:75], v[136:139], v[200:203]
    ds_read_b128 v[104:107], v16 offset:4096
    v_mfma_f32_16x16x32_bf16 v[204:207], v[72:75], v[140:143], v[204:207]
    ds_read_b128 v[108:111], v16 offset:6144
    v_mfma_f32_16x16x32_bf16 v[208:211], v[72:75], v[144:147], v[208:211]
    ds_read_b128 v[112:115], v16 offset:8192
    v_mfma_f32_16x16x32_bf16 v[212:215], v[72:75], v[148:151], v[212:215]
    ds_read_b128 v[116:119], v16 offset:10240
    v_mfma_f32_16x16x32_bf16 v[216:219], v[72:75], v[152:155], v[216:219]
    ds_read_b128 v[120:123], v16 offset:12288
    v_mfma_f32_16x16x32_bf16 v[220:223], v[72:75], v[156:159], v[220:223]
    ds_read_b128 v[124:127], v16 offset:14336
    s_add_u32 s12, s53, 8192
    buffer_load_dwordx4 v[72:75], v2, s[4:7], s12 offen offset:0 sc1
    v_mfma_f32_16x16x32_bf16 v[224:227], v[76:79], v[128:131], v[224:227]
    v_mfma_f32_16x16x32_bf16 v[228:231], v[76:79], v[132:135], v[228:231]
    v_mfma_f32_16x16x32_bf16 v[232:235], v[76:79], v[136:139], v[232:235]
    v_mfma_f32_16x16x32_bf16 v[236:239], v[76:79], v[140:143], v[236:239]
    v_mfma_f32_16x16x32_bf16 v[240:243], v[76:79], v[144:147], v[240:243]
    v_mfma_f32_16x16x32_bf16 v[244:247], v[76:79], v[148:151], v[244:247]
    v_mfma_f32_16x16x32_bf16 v[248:251], v[76:79], v[152:155], v[248:251]
    v_mfma_f32_16x16x32_bf16 v[252:255], v[76:79], v[156:159], v[252:255]
    s_add_u32 s12, s54, 8192
    buffer_load_dwordx4 v[76:79], v2, s[4:7], s12 offen offset:0 sc1
    s_waitcnt vmcnt(28) lgkmcnt(0)
    v_mfma_f32_16x16x32_bf16 v[160:163], v[80:83], v[96:99], v[160:163]
    ds_read_b128 v[128:131], v17 offset:0
    v_mfma_f32_16x16x32_bf16 v[164:167], v[80:83], v[100:103], v[164:167]
    ds_read_b128 v[132:135], v17 offset:2048
    v_mfma_f32_16x16x32_bf16 v[168:171], v[80:83], v[104:107], v[168:171]
    ds_read_b128 v[136:139], v17 offset:4096
    v_mfma_f32_16x16x32_bf16 v[172:175], v[80:83], v[108:111], v[172:175]
    ds_read_b128 v[140:143], v17 offset:6144
    v_mfma_f32_16x16x32_bf16 v[176:179], v[80:83], v[112:115], v[176:179]
    ds_read_b128 v[144:147], v17 offset:8192
    v_mfma_f32_16x16x32_bf16 v[180:183], v[80:83], v[116:119], v[180:183]
    ds_read_b128 v[148:151], v17 offset:10240
    v_mfma_f32_16x16x32_bf16 v[184:187], v[80:83], v[120:123], v[184:187]
    ds_read_b128 v[152:155], v17 offset:12288
    v_mfma_f32_16x16x32_bf16 v[188:191], v[80:83], v[124:127], v[188:191]
    ds_read_b128 v[156:159], v17 offset:14336
    s_add_u32 s12, s52, 8192
    buffer_load_dwordx4 v[80:83], v2, s[4:7], s12 offen offset:1024 sc1
    v_mfma_f32_16x16x32_bf16 v[192:195], v[84:87], v[96:99], v[192:195]
    v_mfma_f32_16x16x32_bf16 v[196:199], v[84:87], v[100:103], v[196:199]
    v_mfma_f32_16x16x32_bf16 v[200:203], v[84:87], v[104:107], v[200:203]
    v_mfma_f32_16x16x32_bf16 v[204:207], v[84:87], v[108:111], v[204:207]
    v_mfma_f32_16x16x32_bf16 v[208:211], v[84:87], v[112:115], v[208:211]
    v_mfma_f32_16x16x32_bf16 v[212:215], v[84:87], v[116:119], v[212:215]
    v_mfma_f32_16x16x32_bf16 v[216:219], v[84:87], v[120:123], v[216:219]
    v_mfma_f32_16x16x32_bf16 v[220:223], v[84:87], v[124:127], v[220:223]
    s_add_u32 s12, s53, 8192
    buffer_load_dwordx4 v[84:87], v2, s[4:7], s12 offen offset:1024 sc1
    v_mfma_f32_16x16x32_bf16 v[224:227], v[88:91], v[96:99], v[224:227]
    v_mfma_f32_16x16x32_bf16 v[228:231], v[88:91], v[100:103], v[228:231]
    v_mfma_f32_16x16x32_bf16 v[232:235], v[88:91], v[104:107], v[232:235]
    v_mfma_f32_16x16x32_bf16 v[236:239], v[88:91], v[108:111], v[236:239]
    v_mfma_f32_16x16x32_bf16 v[240:243], v[88:91], v[112:115], v[240:243]
    v_mfma_f32_16x16x32_bf16 v[244:247], v[88:91], v[116:119], v[244:247]
    v_mfma_f32_16x16x32_bf16 v[248:251], v[88:91], v[120:123], v[248:251]
    v_mfma_f32_16x16x32_bf16 v[252:255], v[88:91], v[124:127], v[252:255]
    s_add_u32 s12, s54, 8192
    buffer_load_dwordx4 v[88:91], v2, s[4:7], s12 offen offset:1024 sc1
    s_waitcnt vmcnt(6) lgkmcnt(0)
    s_barrier
    v_mfma_f32_16x16x32_bf16 v[160:163], v[32:35], v[128:131], v[160:163]
    s_add_u32 m0, s47, 0
    s_add_u32 s12, s46, 512
    buffer_load_dwordx4 v14, s[16:19], s12 offen lds
    v_mfma_f32_16x16x32_bf16 v[164:167], v[32:35], v[132:135], v[164:167]
    s_add_u32 m0, s47, 1024
    s_add_u32 s12, s46, 33280
    buffer_load_dwordx4 v15, s[16:19], s12 offen lds
    v_mfma_f32_16x16x32_bf16 v[168:171], v[32:35], v[136:139], v[168:171]
    s_add_u32 m0, s47, 2048
    s_add_u32 s12, s46, 66048
    buffer_load_dwordx4 v14, s[16:19], s12 offen lds
    v_mfma_f32_16x16x32_bf16 v[172:175], v[32:35], v[140:143], v[172:175]
    s_add_u32 m0, s47, 3072
    s_add_u32 s12, s46, 98816
    buffer_load_dwordx4 v15, s[16:19], s12 offen lds
    v_mfma_f32_16x16x32_bf16 v[176:179], v[32:35], v[144:147], v[176:179]
    s_add_u32 m0, s47, 4096
    s_add_u32 s12, s46, 131584
    buffer_load_dwordx4 v14, s[16:19], s12 offen lds
    v_mfma_f32_16x16x32_bf16 v[180:183], v[32:35], v[148:151], v[180:183]
    s_add_u32 m0, s47, 5120
    s_add_u32 s12, s46, 164352
    buffer_load_dwordx4 v15, s[16:19], s12 offen lds
    v_mfma_f32_16x16x32_bf16 v[184:187], v[32:35], v[152:155], v[184:187]
    s_add_u32 m0, s47, 6144
    s_add_u32 s12, s46, 197120
    buffer_load_dwordx4 v14, s[16:19], s12 offen lds
    v_mfma_f32_16x16x32_bf16 v[188:191], v[32:35], v[156:159], v[188:191]
    s_add_u32 m0, s47, 7168
    s_add_u32 s12, s46, 229888
    buffer_load_dwordx4 v15, s[16:19], s12 offen lds
    s_add_u32 s12, s52, 8192
    buffer_load_dwordx4 v[32:35], v2, s[4:7], s12 offen offset:2048 sc1
    v_mfma_f32_16x16x32_bf16 v[192:195], v[36:39], v[128:131], v[192:195]
    ds_read_b128 v[96:99], v16 offset:16384
    v_mfma_f32_16x16x32_bf16 v[196:199], v[36:39], v[132:135], v[196:199]
    ds_read_b128 v[100:103], v16 offset:18432
    v_mfma_f32_16x16x32_bf16 v[200:203], v[36:39], v[136:139], v[200:203]
    ds_read_b128 v[104:107], v16 offset:20480
    v_mfma_f32_16x16x32_bf16 v[204:207], v[36:39], v[140:143], v[204:207]
    ds_read_b128 v[108:111], v16 offset:22528
    v_mfma_f32_16x16x32_bf16 v[208:211], v[36:39], v[144:147], v[208:211]
    ds_read_b128 v[112:115], v16 offset:24576
    v_mfma_f32_16x16x32_bf16 v[212:215], v[36:39], v[148:151], v[212:215]
    ds_read_b128 v[116:119], v16 offset:26624
    v_mfma_f32_16x16x32_bf16 v[216:219], v[36:39], v[152:155], v[216:219]
    ds_read_b128 v[120:123], v16 offset:28672
    v_mfma_f32_16x16x32_bf16 v[220:223], v[36:39], v[156:159], v[220:223]
    ds_read_b128 v[124:127], v16 offset:30720
    s_add_u32 s12, s53, 8192
    buffer_load_dwordx4 v[36:39], v2, s[4:7], s12 offen offset:2048 sc1
    v_mfma_f32_16x16x32_bf16 v[224:227], v[40:43], v[128:131], v[224:227]
    v_mfma_f32_16x16x32_bf16 v[228:231], v[40:43], v[132:135], v[228:231]
    v_mfma_f32_16x16x32_bf16 v[232:235], v[40:43], v[136:139], v[232:235]
    v_mfma_f32_16x16x32_bf16 v[236:239], v[40:43], v[140:143], v[236:239]
    v_mfma_f32_16x16x32_bf16 v[240:243], v[40:43], v[144:147], v[240:243]
    v_mfma_f32_16x16x32_bf16 v[244:247], v[40:43], v[148:151], v[244:247]
    v_mfma_f32_16x16x32_bf16 v[248:251], v[40:43], v[152:155], v[248:251]
    v_mfma_f32_16x16x32_bf16 v[252:255], v[40:43], v[156:159], v[252:255]
    s_add_u32 s12, s54, 8192
    buffer_load_dwordx4 v[40:43], v2, s[4:7], s12 offen offset:2048 sc1
    s_waitcnt vmcnt(28) lgkmcnt(0)
    v_mfma_f32_16x16x32_bf16 v[160:163], v[44:47], v[96:99], v[160:163]
    ds_read_b128 v[128:131], v17 offset:16384
    v_mfma_f32_16x16x32_bf16 v[164:167], v[44:47], v[100:103], v[164:167]
    ds_read_b128 v[132:135], v17 offset:18432
    v_mfma_f32_16x16x32_bf16 v[168:171], v[44:47], v[104:107], v[168:171]
    ds_read_b128 v[136:139], v17 offset:20480
    v_mfma_f32_16x16x32_bf16 v[172:175], v[44:47], v[108:111], v[172:175]
    ds_read_b128 v[140:143], v17 offset:22528
    v_mfma_f32_16x16x32_bf16 v[176:179], v[44:47], v[112:115], v[176:179]
    ds_read_b128 v[144:147], v17 offset:24576
    v_mfma_f32_16x16x32_bf16 v[180:183], v[44:47], v[116:119], v[180:183]
    ds_read_b128 v[148:151], v17 offset:26624
    v_mfma_f32_16x16x32_bf16 v[184:187], v[44:47], v[120:123], v[184:187]
    ds_read_b128 v[152:155], v17 offset:28672
    v_mfma_f32_16x16x32_bf16 v[188:191], v[44:47], v[124:127], v[188:191]
    ds_read_b128 v[156:159], v17 offset:30720
    s_add_u32 s12, s52, 8192
    buffer_load_dwordx4 v[44:47], v2, s[4:7], s12 offen offset:3072 sc1
    v_mfma_f32_16x16x32_bf16 v[192:195], v[48:51], v[96:99], v[192:195]
    v_mfma_f32_16x16x32_bf16 v[196:199], v[48:51], v[100:103], v[196:199]
    v_mfma_f32_16x16x32_bf16 v[200:203], v[48:51], v[104:107], v[200:203]
    v_mfma_f32_16x16x32_bf16 v[204:207], v[48:51], v[108:111], v[204:207]
    v_mfma_f32_16x16x32_bf16 v[208:211], v[48:51], v[112:115], v[208:211]
    v_mfma_f32_16x16x32_bf16 v[212:215], v[48:51], v[116:119], v[212:215]
    v_mfma_f32_16x16x32_bf16 v[216:219], v[48:51], v[120:123], v[216:219]
    v_mfma_f32_16x16x32_bf16 v[220:223], v[48:51], v[124:127], v[220:223]
    s_add_u32 s12, s53, 8192
    buffer_load_dwordx4 v[48:51], v2, s[4:7], s12 offen offset:3072 sc1
    v_mfma_f32_16x16x32_bf16 v[224:227], v[52:55], v[96:99], v[224:227]
    v_mfma_f32_16x16x32_bf16 v[228:231], v[52:55], v[100:103], v[228:231]
    v_mfma_f32_16x16x32_bf16 v[232:235], v[52:55], v[104:107], v[232:235]
    v_mfma_f32_16x16x32_bf16 v[236:239], v[52:55], v[108:111], v[236:239]
    v_mfma_f32_16x16x32_bf16 v[240:243], v[52:55], v[112:115], v[240:243]
    v_mfma_f32_16x16x32_bf16 v[244:247], v[52:55], v[116:119], v[244:247]
    v_mfma_f32_16x16x32_bf16 v[248:251], v[52:55], v[120:123], v[248:251]
    v_mfma_f32_16x16x32_bf16 v[252:255], v[52:55], v[124:127], v[252:255]
    s_add_u32 s12, s54, 8192
    buffer_load_dwordx4 v[52:55], v2, s[4:7], s12 offen offset:3072 sc1
    s_waitcnt vmcnt(6) lgkmcnt(0)
    s_barrier
    v_mfma_f32_16x16x32_bf16 v[160:163], v[56:59], v[128:131], v[160:163]
    s_add_u32 m0, s47, 16384
    s_add_u32 s12, s46, 640
    buffer_load_dwordx4 v14, s[16:19], s12 offen lds
    v_mfma_f32_16x16x32_bf16 v[164:167], v[56:59], v[132:135], v[164:167]
    s_add_u32 m0, s47, 17408
    s_add_u32 s12, s46, 33408
    buffer_load_dwordx4 v15, s[16:19], s12 offen lds
    v_mfma_f32_16x16x32_bf16 v[168:171], v[56:59], v[136:139], v[168:171]
    s_add_u32 m0, s47, 18432
    s_add_u32 s12, s46, 66176
    buffer_load_dwordx4 v14, s[16:19], s12 offen lds
    v_mfma_f32_16x16x32_bf16 v[172:175], v[56:59], v[140:143], v[172:175]
    s_add_u32 m0, s47, 19456
    s_add_u32 s12, s46, 98944
    buffer_load_dwordx4 v15, s[16:19], s12 offen lds
    v_mfma_f32_16x16x32_bf16 v[176:179], v[56:59], v[144:147], v[176:179]
    s_add_u32 m0, s47, 20480
    s_add_u32 s12, s46, 131712
    buffer_load_dwordx4 v14, s[16:19], s12 offen lds
    v_mfma_f32_16x16x32_bf16 v[180:183], v[56:59], v[148:151], v[180:183]
    s_add_u32 m0, s47, 21504
    s_add_u32 s12, s46, 164480
    buffer_load_dwordx4 v15, s[16:19], s12 offen lds
    v_mfma_f32_16x16x32_bf16 v[184:187], v[56:59], v[152:155], v[184:187]
    s_add_u32 m0, s47, 22528
    s_add_u32 s12, s46, 197248
    buffer_load_dwordx4 v14, s[16:19], s12 offen lds
    v_mfma_f32_16x16x32_bf16 v[188:191], v[56:59], v[156:159], v[188:191]
    s_add_u32 m0, s47, 23552
    s_add_u32 s12, s46, 230016
    buffer_load_dwordx4 v15, s[16:19], s12 offen lds
    s_add_u32 s12, s52, 12288
    buffer_load_dwordx4 v[56:59], v2, s[4:7], s12 offen offset:0 sc1
    v_mfma_f32_16x16x32_bf16 v[192:195], v[60:63], v[128:131], v[192:195]
    ds_read_b128 v[96:99], v16 offset:0
    v_mfma_f32_16x16x32_bf16 v[196:199], v[60:63], v[132:135], v[196:199]
    ds_read_b128 v[100:103], v16 offset:2048
    v_mfma_f32_16x16x32_bf16 v[200:203], v[60:63], v[136:139], v[200:203]
    ds_read_b128 v[104:107], v16 offset:4096
    v_mfma_f32_16x16x32_bf16 v[204:207], v[60:63], v[140:143], v[204:207]
    ds_read_b128 v[108:111], v16 offset:6144
    v_mfma_f32_16x16x32_bf16 v[208:211], v[60:63], v[144:147], v[208:211]
    ds_read_b128 v[112:115], v16 offset:8192
    v_mfma_f32_16x16x32_bf16 v[212:215], v[60:63], v[148:151], v[212:215]
    ds_read_b128 v[116:119], v16 offset:10240
    v_mfma_f32_16x16x32_bf16 v[216:219], v[60:63], v[152:155], v[216:219]
    ds_read_b128 v[120:123], v16 offset:12288
    v_mfma_f32_16x16x32_bf16 v[220:223], v[60:63], v[156:159], v[220:223]
    ds_read_b128 v[124:127], v16 offset:14336
    s_add_u32 s12, s53, 12288
    buffer_load_dwordx4 v[60:63], v2, s[4:7], s12 offen offset:0 sc1
    v_mfma_f32_16x16x32_bf16 v[224:227], v[64:67], v[128:131], v[224:227]
    v_mfma_f32_16x16x32_bf16 v[228:231], v[64:67], v[132:135], v[228:231]
    v_mfma_f32_16x16x32_bf16 v[232:235], v[64:67], v[136:139], v[232:235]
    v_mfma_f32_16x16x32_bf16 v[236:239], v[64:67], v[140:143], v[236:239]
    v_mfma_f32_16x16x32_bf16 v[240:243], v[64:67], v[144:147], v[240:243]
    v_mfma_f32_16x16x32_bf16 v[244:247], v[64:67], v[148:151], v[244:247]
    v_mfma_f32_16x16x32_bf16 v[248:251], v[64:67], v[152:155], v[248:251]
    v_mfma_f32_16x16x32_bf16 v[252:255], v[64:67], v[156:159], v[252:255]
    s_add_u32 s12, s54, 12288
    buffer_load_dwordx4 v[64:67], v2, s[4:7], s12 offen offset:0 sc1
    s_waitcnt vmcnt(28) lgkmcnt(0)
    v_mfma_f32_16x16x32_bf16 v[160:163], v[68:71], v[96:99], v[160:163]
    ds_read_b128 v[128:131], v17 offset:0
    v_mfma_f32_16x16x32_bf16 v[164:167], v[68:71], v[100:103], v[164:167]
    ds_read_b128 v[132:135], v17 offset:2048
    v_mfma_f32_16x16x32_bf16 v[168:171], v[68:71], v[104:107], v[168:171]
    ds_read_b128 v[136:139], v17 offset:4096
    v_mfma_f32_16x16x32_bf16 v[172:175], v[68:71], v[108:111], v[172:175]
    ds_read_b128 v[140:143], v17 offset:6144
    v_mfma_f32_16x16x32_bf16 v[176:179], v[68:71], v[112:115], v[176:179]
    ds_read_b128 v[144:147], v17 offset:8192
    v_mfma_f32_16x16x32_bf16 v[180:183], v[68:71], v[116:119], v[180:183]
    ds_read_b128 v[148:151], v17 offset:10240
    v_mfma_f32_16x16x32_bf16 v[184:187], v[68:71], v[120:123], v[184:187]
    ds_read_b128 v[152:155], v17 offset:12288
    v_mfma_f32_16x16x32_bf16 v[188:191], v[68:71], v[124:127], v[188:191]
    ds_read_b128 v[156:159], v17 offset:14336
    s_add_u32 s12, s52, 12288
    buffer_load_dwordx4 v[68:71], v2, s[4:7], s12 offen offset:1024 sc1
    v_mfma_f32_16x16x32_bf16 v[192:195], v[72:75], v[96:99], v[192:195]
    v_mfma_f32_16x16x32_bf16 v[196:199], v[72:75], v[100:103], v[196:199]
    v_mfma_f32_16x16x32_bf16 v[200:203], v[72:75], v[104:107], v[200:203]
    v_mfma_f32_16x16x32_bf16 v[204:207], v[72:75], v[108:111], v[204:207]
    v_mfma_f32_16x16x32_bf16 v[208:211], v[72:75], v[112:115], v[208:211]
    v_mfma_f32_16x16x32_bf16 v[212:215], v[72:75], v[116:119], v[212:215]
    v_mfma_f32_16x16x32_bf16 v[216:219], v[72:75], v[120:123], v[216:219]
    v_mfma_f32_16x16x32_bf16 v[220:223], v[72:75], v[124:127], v[220:223]
    s_add_u32 s12, s53, 12288
    buffer_load_dwordx4 v[72:75], v2, s[4:7], s12 offen offset:1024 sc1
    v_mfma_f32_16x16x32_bf16 v[224:227], v[76:79], v[96:99], v[224:227]
    v_mfma_f32_16x16x32_bf16 v[228:231], v[76:79], v[100:103], v[228:231]
    v_mfma_f32_16x16x32_bf16 v[232:235], v[76:79], v[104:107], v[232:235]
    v_mfma_f32_16x16x32_bf16 v[236:239], v[76:79], v[108:111], v[236:239]
    v_mfma_f32_16x16x32_bf16 v[240:243], v[76:79], v[112:115], v[240:243]
    v_mfma_f32_16x16x32_bf16 v[244:247], v[76:79], v[116:119], v[244:247]
    v_mfma_f32_16x16x32_bf16 v[248:251], v[76:79], v[120:123], v[248:251]
    v_mfma_f32_16x16x32_bf16 v[252:255], v[76:79], v[124:127], v[252:255]
    s_add_u32 s12, s54, 12288
    buffer_load_dwordx4 v[76:79], v2, s[4:7], s12 offen offset:1024 sc1
    s_waitcnt vmcnt(6) lgkmcnt(0)
    s_barrier
    v_mfma_f32_16x16x32_bf16 v[160:163], v[80:83], v[128:131], v[160:163]
    s_add_u32 m0, s47, 0
    s_add_u32 s12, s46, 768
    buffer_load_dwordx4 v14, s[16:19], s12 offen lds
    v_mfma_f32_16x16x32_bf16 v[164:167], v[80:83], v[132:135], v[164:167]
    s_add_u32 m0, s47, 1024
    s_add_u32 s12, s46, 33536
    buffer_load_dwordx4 v15, s[16:19], s12 offen lds
    v_mfma_f32_16x16x32_bf16 v[168:171], v[80:83], v[136:139], v[168:171]
    s_add_u32 m0, s47, 2048
    s_add_u32 s12, s46, 66304
    buffer_load_dwordx4 v14, s[16:19], s12 offen lds
    v_mfma_f32_16x16x32_bf16 v[172:175], v[80:83], v[140:143], v[172:175]
    s_add_u32 m0, s47, 3072
    s_add_u32 s12, s46, 99072
    buffer_load_dwordx4 v15, s[16:19], s12 offen lds
    v_mfma_f32_16x16x32_bf16 v[176:179], v[80:83], v[144:147], v[176:179]
    s_add_u32 m0, s47, 4096
    s_add_u32 s12, s46, 131840
    buffer_load_dwordx4 v14, s[16:19], s12 offen lds
    v_mfma_f32_16x16x32_bf16 v[180:183], v[80:83], v[148:151], v[180:183]
    s_add_u32 m0, s47, 5120
    s_add_u32 s12, s46, 164608
    buffer_load_dwordx4 v15, s[16:19], s12 offen lds
    v_mfma_f32_16x16x32_bf16 v[184:187], v[80:83], v[152:155], v[184:187]
    s_add_u32 m0, s47, 6144
    s_add_u32 s12, s46, 197376
    buffer_load_dwordx4 v14, s[16:19], s12 offen lds
    v_mfma_f32_16x16x32_bf16 v[188:191], v[80:83], v[156:159], v[188:191]
    s_add_u32 m0, s47, 7168
    s_add_u32 s12, s46, 230144
    buffer_load_dwordx4 v15, s[16:19], s12 offen lds
    s_add_u32 s12, s52, 12288
    buffer_load_dwordx4 v[80:83], v2, s[4:7], s12 offen offset:2048 sc1
    v_mfma_f32_16x16x32_bf16 v[192:195], v[84:87], v[128:131], v[192:195]
    ds_read_b128 v[96:99], v16 offset:16384
    v_mfma_f32_16x16x32_bf16 v[196:199], v[84:87], v[132:135], v[196:199]
    ds_read_b128 v[100:103], v16 offset:18432
    v_mfma_f32_16x16x32_bf16 v[200:203], v[84:87], v[136:139], v[200:203]
    ds_read_b128 v[104:107], v16 offset:20480
    v_mfma_f32_16x16x32_bf16 v[204:207], v[84:87], v[140:143], v[204:207]
    ds_read_b128 v[108:111], v16 offset:22528
    v_mfma_f32_16x16x32_bf16 v[208:211], v[84:87], v[144:147], v[208:211]
    ds_read_b128 v[112:115], v16 offset:24576
    v_mfma_f32_16x16x32_bf16 v[212:215], v[84:87], v[148:151], v[212:215]
    ds_read_b128 v[116:119], v16 offset:26624
    v_mfma_f32_16x16x32_bf16 v[216:219], v[84:87], v[152:155], v[216:219]
    ds_read_b128 v[120:123], v16 offset:28672
    v_mfma_f32_16x16x32_bf16 v[220:223], v[84:87], v[156:159], v[220:223]
    ds_read_b128 v[124:127], v16 offset:30720
    s_add_u32 s12, s53, 12288
    buffer_load_dwordx4 v[84:87], v2, s[4:7], s12 offen offset:2048 sc1
    v_mfma_f32_16x16x32_bf16 v[224:227], v[88:91], v[128:131], v[224:227]
    v_mfma_f32_16x16x32_bf16 v[228:231], v[88:91], v[132:135], v[228:231]
    v_mfma_f32_16x16x32_bf16 v[232:235], v[88:91], v[136:139], v[232:235]
    v_mfma_f32_16x16x32_bf16 v[236:239], v[88:91], v[140:143], v[236:239]
    v_mfma_f32_16x16x32_bf16 v[240:243], v[88:91], v[144:147], v[240:243]
    v_mfma_f32_16x16x32_bf16 v[244:247], v[88:91], v[148:151], v[244:247]
    v_mfma_f32_16x16x32_bf16 v[248:251], v[88:91], v[152:155], v[248:251]
    v_mfma_f32_16x16x32_bf16 v[252:255], v[88:91], v[156:159], v[252:255]
    s_add_u32 s12, s54, 12288
    buffer_load_dwordx4 v[88:91], v2, s[4:7], s12 offen offset:2048 sc1
    s_waitcnt vmcnt(28) lgkmcnt(0)
    v_mfma_f32_16x16x32_bf16 v[160:163], v[32:35], v[96:99], v[160:163]
    ds_read_b128 v[128:131], v17 offset:16384
    v_mfma_f32_16x16x32_bf16 v[164:167], v[32:35], v[100:103], v[164:167]
    ds_read_b128 v[132:135], v17 offset:18432
    v_mfma_f32_16x16x32_bf16 v[168:171], v[32:35], v[104:107], v[168:171]
    ds_read_b128 v[136:139], v17 offset:20480
    v_mfma_f32_16x16x32_bf16 v[172:175], v[32:35], v[108:111], v[172:175]
    ds_read_b128 v[140:143], v17 offset:22528
    v_mfma_f32_16x16x32_bf16 v[176:179], v[32:35], v[112:115], v[176:179]
    ds_read_b128 v[144:147], v17 offset:24576
    v_mfma_f32_16x16x32_bf16 v[180:183], v[32:35], v[116:119], v[180:183]
    ds_read_b128 v[148:151], v17 offset:26624
    v_mfma_f32_16x16x32_bf16 v[184:187], v[32:35], v[120:123], v[184:187]
    ds_read_b128 v[152:155], v17 offset:28672
    v_mfma_f32_16x16x32_bf16 v[188:191], v[32:35], v[124:127], v[188:191]
    ds_read_b128 v[156:159], v17 offset:30720
    s_add_u32 s12, s52, 12288
    buffer_load_dwordx4 v[32:35], v2, s[4:7], s12 offen offset:3072 sc1
    v_mfma_f32_16x16x32_bf16 v[192:195], v[36:39], v[96:99], v[192:195]
    v_mfma_f32_16x16x32_bf16 v[196:199], v[36:39], v[100:103], v[196:199]
    v_mfma_f32_16x16x32_bf16 v[200:203], v[36:39], v[104:107], v[200:203]
    v_mfma_f32_16x16x32_bf16 v[204:207], v[36:39], v[108:111], v[204:207]
    v_mfma_f32_16x16x32_bf16 v[208:211], v[36:39], v[112:115], v[208:211]
    v_mfma_f32_16x16x32_bf16 v[212:215], v[36:39], v[116:119], v[212:215]
    v_mfma_f32_16x16x32_bf16 v[216:219], v[36:39], v[120:123], v[216:219]
    v_mfma_f32_16x16x32_bf16 v[220:223], v[36:39], v[124:127], v[220:223]
    s_add_u32 s12, s53, 12288
    buffer_load_dwordx4 v[36:39], v2, s[4:7], s12 offen offset:3072 sc1
    v_mfma_f32_16x16x32_bf16 v[224:227], v[40:43], v[96:99], v[224:227]
    v_mfma_f32_16x16x32_bf16 v[228:231], v[40:43], v[100:103], v[228:231]
    v_mfma_f32_16x16x32_bf16 v[232:235], v[40:43], v[104:107], v[232:235]
    v_mfma_f32_16x16x32_bf16 v[236:239], v[40:43], v[108:111], v[236:239]
    v_mfma_f32_16x16x32_bf16 v[240:243], v[40:43], v[112:115], v[240:243]
    v_mfma_f32_16x16x32_bf16 v[244:247], v[40:43], v[116:119], v[244:247]
    v_mfma_f32_16x16x32_bf16 v[248:251], v[40:43], v[120:123], v[248:251]
    v_mfma_f32_16x16x32_bf16 v[252:255], v[40:43], v[124:127], v[252:255]
    s_add_u32 s12, s54, 12288
    buffer_load_dwordx4 v[40:43], v2, s[4:7], s12 offen offset:3072 sc1
    s_waitcnt vmcnt(6) lgkmcnt(0)
    s_barrier
    v_mfma_f32_16x16x32_bf16 v[160:163], v[44:47], v[128:131], v[160:163]
    s_add_u32 m0, s47, 16384
    s_add_u32 s12, s46, 896
    buffer_load_dwordx4 v14, s[16:19], s12 offen lds
    v_mfma_f32_16x16x32_bf16 v[164:167], v[44:47], v[132:135], v[164:167]
    s_add_u32 m0, s47, 17408
    s_add_u32 s12, s46, 33664
    buffer_load_dwordx4 v15, s[16:19], s12 offen lds
    v_mfma_f32_16x16x32_bf16 v[168:171], v[44:47], v[136:139], v[168:171]
    s_add_u32 m0, s47, 18432
    s_add_u32 s12, s46, 66432
    buffer_load_dwordx4 v14, s[16:19], s12 offen lds
    v_mfma_f32_16x16x32_bf16 v[172:175], v[44:47], v[140:143], v[172:175]
    s_add_u32 m0, s47, 19456
    s_add_u32 s12, s46, 99200
    buffer_load_dwordx4 v15, s[16:19], s12 offen lds
    v_mfma_f32_16x16x32_bf16 v[176:179], v[44:47], v[144:147], v[176:179]
    s_add_u32 m0, s47, 20480
    s_add_u32 s12, s46, 131968
    buffer_load_dwordx4 v14, s[16:19], s12 offen lds
    v_mfma_f32_16x16x32_bf16 v[180:183], v[44:47], v[148:151], v[180:183]
    s_add_u32 m0, s47, 21504
    s_add_u32 s12, s46, 164736
    buffer_load_dwordx4 v15, s[16:19], s12 offen lds
    v_mfma_f32_16x16x32_bf16 v[184:187], v[44:47], v[152:155], v[184:187]
    s_add_u32 m0, s47, 22528
    s_add_u32 s12, s46, 197504
    buffer_load_dwordx4 v14, s[16:19], s12 offen lds
    v_mfma_f32_16x16x32_bf16 v[188:191], v[44:47], v[156:159], v[188:191]
    s_add_u32 m0, s47, 23552
    s_add_u32 s12, s46, 230272
    buffer_load_dwordx4 v15, s[16:19], s12 offen lds
    v_mfma_f32_16x16x32_bf16 v[192:195], v[48:51], v[128:131], v[192:195]
    ds_read_b128 v[96:99], v16 offset:0
    v_mfma_f32_16x16x32_bf16 v[196:199], v[48:51], v[132:135], v[196:199]
    ds_read_b128 v[100:103], v16 offset:2048
    v_mfma_f32_16x16x32_bf16 v[200:203], v[48:51], v[136:139], v[200:203]
    ds_read_b128 v[104:107], v16 offset:4096
    v_mfma_f32_16x16x32_bf16 v[204:207], v[48:51], v[140:143], v[204:207]
    ds_read_b128 v[108:111], v16 offset:6144
    v_mfma_f32_16x16x32_bf16 v[208:211], v[48:51], v[144:147], v[208:211]
    ds_read_b128 v[112:115], v16 offset:8192
    v_mfma_f32_16x16x32_bf16 v[212:215], v[48:51], v[148:151], v[212:215]
    ds_read_b128 v[116:119], v16 offset:10240
    v_mfma_f32_16x16x32_bf16 v[216:219], v[48:51], v[152:155], v[216:219]
    ds_read_b128 v[120:123], v16 offset:12288
    v_mfma_f32_16x16x32_bf16 v[220:223], v[48:51], v[156:159], v[220:223]
    ds_read_b128 v[124:127], v16 offset:14336
    v_mfma_f32_16x16x32_bf16 v[224:227], v[52:55], v[128:131], v[224:227]
    v_mfma_f32_16x16x32_bf16 v[228:231], v[52:55], v[132:135], v[228:231]
    v_mfma_f32_16x16x32_bf16 v[232:235], v[52:55], v[136:139], v[232:235]
    v_mfma_f32_16x16x32_bf16 v[236:239], v[52:55], v[140:143], v[236:239]
    v_mfma_f32_16x16x32_bf16 v[240:243], v[52:55], v[144:147], v[240:243]
    v_mfma_f32_16x16x32_bf16 v[244:247], v[52:55], v[148:151], v[244:247]
    v_mfma_f32_16x16x32_bf16 v[248:251], v[52:55], v[152:155], v[248:251]
    v_mfma_f32_16x16x32_bf16 v[252:255], v[52:55], v[156:159], v[252:255]
    s_waitcnt vmcnt(25) lgkmcnt(0)
    v_mfma_f32_16x16x32_bf16 v[160:163], v[56:59], v[96:99], v[160:163]
    s_add_u32 m0, s101, 131072
    s_add_u32 s12, s100, 0
    buffer_load_dwordx4 v27, s[24:27], s12 offen lds
    v_mfma_f32_16x16x32_bf16 v[164:167], v[56:59], v[100:103], v[164:167]
    s_add_u32 m0, s101, 139264
    s_add_u32 s12, s100, 65536
    buffer_load_dwordx4 v27, s[24:27], s12 offen lds
    v_mfma_f32_16x16x32_bf16 v[168:171], v[56:59], v[104:107], v[168:171]
    s_add_u32 m0, s101, 147456
    s_add_u32 s12, s100, 131072
    buffer_load_dwordx4 v27, s[24:27], s12 offen lds
    v_mfma_f32_16x16x32_bf16 v[172:175], v[56:59], v[108:111], v[172:175]
    s_add_u32 m0, s101, 155648
    s_add_u32 s12, s100, 196608
    buffer_load_dwordx4 v27, s[24:27], s12 offen lds
    v_mfma_f32_16x16x32_bf16 v[176:179], v[56:59], v[112:115], v[176:179]
    ds_read_b128 v[128:131], v17 offset:0
    v_mfma_f32_16x16x32_bf16 v[180:183], v[56:59], v[116:119], v[180:183]
    ds_read_b128 v[132:135], v17 offset:2048
    v_mfma_f32_16x16x32_bf16 v[184:187], v[56:59], v[120:123], v[184:187]
    ds_read_b128 v[136:139], v17 offset:4096
    v_mfma_f32_16x16x32_bf16 v[188:191], v[56:59], v[124:127], v[188:191]
    ds_read_b128 v[140:143], v17 offset:6144
    v_mfma_f32_16x16x32_bf16 v[192:195], v[60:63], v[96:99], v[192:195]
    ds_read_b128 v[144:147], v17 offset:8192
    v_mfma_f32_16x16x32_bf16 v[196:199], v[60:63], v[100:103], v[196:199]
    ds_read_b128 v[148:151], v17 offset:10240
    v_mfma_f32_16x16x32_bf16 v[200:203], v[60:63], v[104:107], v[200:203]
    ds_read_b128 v[152:155], v17 offset:12288
    v_mfma_f32_16x16x32_bf16 v[204:207], v[60:63], v[108:111], v[204:207]
    ds_read_b128 v[156:159], v17 offset:14336
    v_mfma_f32_16x16x32_bf16 v[208:211], v[60:63], v[112:115], v[208:211]
    v_mfma_f32_16x16x32_bf16 v[212:215], v[60:63], v[116:119], v[212:215]
    v_mfma_f32_16x16x32_bf16 v[216:219], v[60:63], v[120:123], v[216:219]
    v_mfma_f32_16x16x32_bf16 v[220:223], v[60:63], v[124:127], v[220:223]
    v_mfma_f32_16x16x32_bf16 v[224:227], v[64:67], v[96:99], v[224:227]
    v_mfma_f32_16x16x32_bf16 v[228:231], v[64:67], v[100:103], v[228:231]
    v_mfma_f32_16x16x32_bf16 v[232:235], v[64:67], v[104:107], v[232:235]
    v_mfma_f32_16x16x32_bf16 v[236:239], v[64:67], v[108:111], v[236:239]
    v_mfma_f32_16x16x32_bf16 v[240:243], v[64:67], v[112:115], v[240:243]
    v_mfma_f32_16x16x32_bf16 v[244:247], v[64:67], v[116:119], v[244:247]
    v_mfma_f32_16x16x32_bf16 v[248:251], v[64:67], v[120:123], v[248:251]
    v_mfma_f32_16x16x32_bf16 v[252:255], v[64:67], v[124:127], v[252:255]
    s_waitcnt vmcnt(4) lgkmcnt(0)
    s_barrier
    v_mfma_f32_16x16x32_bf16 v[160:163], v[68:71], v[128:131], v[160:163]
    ds_read_b128 v[96:99], v16 offset:16384
    v_mfma_f32_16x16x32_bf16 v[164:167], v[68:71], v[132:135], v[164:167]
    ds_read_b128 v[100:103], v16 offset:18432
    v_mfma_f32_16x16x32_bf16 v[168:171], v[68:71], v[136:139], v[168:171]
    ds_read_b128 v[104:107], v16 offset:20480
    v_mfma_f32_16x16x32_bf16 v[172:175], v[68:71], v[140:143], v[172:175]
    ds_read_b128 v[108:111], v16 offset:22528
    v_mfma_f32_16x16x32_bf16 v[176:179], v[68:71], v[144:147], v[176:179]
    ds_read_b128 v[112:115], v16 offset:24576
    v_mfma_f32_16x16x32_bf16 v[180:183], v[68:71], v[148:151], v[180:183]
    ds_read_b128 v[116:119], v16 offset:26624
    v_mfma_f32_16x16x32_bf16 v[184:187], v[68:71], v[152:155], v[184:187]
    ds_read_b128 v[120:123], v16 offset:28672
    v_mfma_f32_16x16x32_bf16 v[188:191], v[68:71], v[156:159], v[188:191]
    ds_read_b128 v[124:127], v16 offset:30720
    s_mul_i32 s49, s50, 6
    v_and_b32 v10, 15, v1
    v_lshlrev_b32 v10, 1, v10
    v_lshlrev_b32_e64 v11, 3, v1
    s_add_u32 s8, s49, 0
    s_lshr_b32 s9, s8, 3
    s_lshl_b32 s9, s9, 1
    s_add_u32 s10, s9, s44
    s_and_b32 s8, s8, 7
    s_lshl_b32 s9, s42, 3
    s_add_u32 s11, s9, s8
    s_mul_i32 s8, s11, 44
    s_add_u32 s8, s8, s10
    s_lshl_b32 s8, s8, 9
    s_add_u32 s8, s8, 56623104
    s_cmp_lt_u32 s10, 43
    s_cselect_b32 s8, s8, 536870912
    buffer_load_dwordx2 v[44:45], v11, s[4:7], s8 offen sc1
    s_lshl_b32 s8, s11, 5
    buffer_load_ushort v56, v10, s[28:31], s8 offen
    s_mul_i32 s8, s11, 150
    s_lshr_b32 s9, s10, 1
    s_add_u32 s8, s8, s9
    s_lshl_b32 s8, s8, 10
    s_and_b32 s9, s10, 1
    s_lshl_b32 s9, s9, 3
    s_add_u32 s8, s8, s9
    s_add_u32 s8, s8, 35782656
    s_andn2_b32 s8, s8, 8
    s_cmp_lt_u32 s10, s45
    s_cselect_b32 s55, s8, 536870912
    v_mfma_f32_16x16x32_bf16 v[192:195], v[72:75], v[128:131], v[192:195]
    v_mfma_f32_16x16x32_bf16 v[196:199], v[72:75], v[132:135], v[196:199]
    v_mfma_f32_16x16x32_bf16 v[200:203], v[72:75], v[136:139], v[200:203]
    v_mfma_f32_16x16x32_bf16 v[204:207], v[72:75], v[140:143], v[204:207]
    v_mfma_f32_16x16x32_bf16 v[208:211], v[72:75], v[144:147], v[208:211]
    v_mfma_f32_16x16x32_bf16 v[212:215], v[72:75], v[148:151], v[212:215]
    v_mfma_f32_16x16x32_bf16 v[216:219], v[72:75], v[152:155], v[216:219]
    v_mfma_f32_16x16x32_bf16 v[220:223], v[72:75], v[156:159], v[220:223]
    s_add_u32 s8, s49, 1
    s_lshr_b32 s9, s8, 3
    s_lshl_b32 s9, s9, 1
    s_add_u32 s10, s9, s44
    s_and_b32 s8, s8, 7
    s_lshl_b32 s9, s42, 3
    s_add_u32 s11, s9, s8
    s_mul_i32 s8, s11, 44
    s_add_u32 s8, s8, s10
    s_lshl_b32 s8, s8, 9
    s_add_u32 s8, s8, 56623104
    s_cmp_lt_u32 s10, 43
    s_cselect_b32 s8, s8, 536870912
    buffer_load_dwordx2 v[46:47], v11, s[4:7], s8 offen sc1
    s_lshl_b32 s8, s11, 5
    buffer_load_ushort v57, v10, s[28:31], s8 offen
    s_mul_i32 s8, s11, 150
    s_lshr_b32 s9, s10, 1
    s_add_u32 s8, s8, s9
    s_lshl_b32 s8, s8, 10
    s_and_b32 s9, s10, 1
    s_lshl_b32 s9, s9, 3
    s_add_u32 s8, s8, s9
    s_add_u32 s8, s8, 35782656
    s_andn2_b32 s8, s8, 8
    s_cmp_lt_u32 s10, s45
    s_cselect_b32 s56, s8, 536870912
    v_mfma_f32_16x16x32_bf16 v[224:227], v[76:79], v[128:131], v[224:227]
    v_mfma_f32_16x16x32_bf16 v[228:231], v[76:79], v[132:135], v[228:231]
    v_mfma_f32_16x16x32_bf16 v[232:235], v[76:79], v[136:139], v[232:235]
    v_mfma_f32_16x16x32_bf16 v[236:239], v[76:79], v[140:143], v[236:239]
    v_mfma_f32_16x16x32_bf16 v[240:243], v[76:79], v[144:147], v[240:243]
    v_mfma_f32_16x16x32_bf16 v[244:247], v[76:79], v[148:151], v[244:247]
    v_mfma_f32_16x16x32_bf16 v[248:251], v[76:79], v[152:155], v[248:251]
    v_mfma_f32_16x16x32_bf16 v[252:255], v[76:79], v[156:159], v[252:255]
    s_add_u32 s8, s49, 2
    s_lshr_b32 s9, s8, 3
    s_lshl_b32 s9, s9, 1
    s_add_u32 s10, s9, s44
    s_and_b32 s8, s8, 7
    s_lshl_b32 s9, s42, 3
    s_add_u32 s11, s9, s8
    s_mul_i32 s8, s11, 44
    s_add_u32 s8, s8, s10
    s_lshl_b32 s8, s8, 9
    s_add_u32 s8, s8, 56623104
    s_cmp_lt_u32 s10, 43
    s_cselect_b32 s8, s8, 536870912
    buffer_load_dwordx2 v[48:49], v11, s[4:7], s8 offen sc1
    s_lshl_b32 s8, s11, 5
    buffer_load_ushort v58, v10, s[28:31], s8 offen
    s_mul_i32 s8, s11, 150
    s_lshr_b32 s9, s10, 1
    s_add_u32 s8, s8, s9
    s_lshl_b32 s8, s8, 10
    s_and_b32 s9, s10, 1
    s_lshl_b32 s9, s9, 3
    s_add_u32 s8, s8, s9
    s_add_u32 s8, s8, 35782656
    s_andn2_b32 s8, s8, 8
    s_cmp_lt_u32 s10, s45
    s_cselect_b32 s57, s8, 536870912
    s_waitcnt vmcnt(21) lgkmcnt(0)
    v_mfma_f32_16x16x32_bf16 v[160:163], v[80:83], v[96:99], v[160:163]
    ds_read_b128 v[128:131], v17 offset:16384
    v_mfma_f32_16x16x32_bf16 v[164:167], v[80:83], v[100:103], v[164:167]
    ds_read_b128 v[132:135], v17 offset:18432
    v_mfma_f32_16x16x32_bf16 v[168:171], v[80:83], v[104:107], v[168:171]
    ds_read_b128 v[136:139], v17 offset:20480
    v_mfma_f32_16x16x32_bf16 v[172:175], v[80:83], v[108:111], v[172:175]
    ds_read_b128 v[140:143], v17 offset:22528
    v_mfma_f32_16x16x32_bf16 v[176:179], v[80:83], v[112:115], v[176:179]
    ds_read_b128 v[144:147], v17 offset:24576
    v_mfma_f32_16x16x32_bf16 v[180:183], v[80:83], v[116:119], v[180:183]
    ds_read_b128 v[148:151], v17 offset:26624
    v_mfma_f32_16x16x32_bf16 v[184:187], v[80:83], v[120:123], v[184:187]
    ds_read_b128 v[152:155], v17 offset:28672
    v_mfma_f32_16x16x32_bf16 v[188:191], v[80:83], v[124:127], v[188:191]
    ds_read_b128 v[156:159], v17 offset:30720
    s_add_u32 s8, s49, 3
    s_lshr_b32 s9, s8, 3
    s_lshl_b32 s9, s9, 1
    s_add_u32 s10, s9, s44
    s_and_b32 s8, s8, 7
    s_lshl_b32 s9, s42, 3
    s_add_u32 s11, s9, s8
    s_mul_i32 s8, s11, 44
    s_add_u32 s8, s8, s10
    s_lshl_b32 s8, s8, 9
    s_add_u32 s8, s8, 56623104
    s_cmp_lt_u32 s10, 43
    s_cselect_b32 s8, s8, 536870912
    buffer_load_dwordx2 v[50:51], v11, s[4:7], s8 offen sc1
    s_lshl_b32 s8, s11, 5
    buffer_load_ushort v59, v10, s[28:31], s8 offen
    s_mul_i32 s8, s11, 150
    s_lshr_b32 s9, s10, 1
    s_add_u32 s8, s8, s9
    s_lshl_b32 s8, s8, 10
    s_and_b32 s9, s10, 1
    s_lshl_b32 s9, s9, 3
    s_add_u32 s8, s8, s9
    s_add_u32 s8, s8, 35782656
    s_andn2_b32 s8, s8, 8
    s_cmp_lt_u32 s10, s45
    s_cselect_b32 s58, s8, 536870912
    v_mfma_f32_16x16x32_bf16 v[192:195], v[84:87], v[96:99], v[192:195]
    v_mfma_f32_16x16x32_bf16 v[196:199], v[84:87], v[100:103], v[196:199]
    v_mfma_f32_16x16x32_bf16 v[200:203], v[84:87], v[104:107], v[200:203]
    v_mfma_f32_16x16x32_bf16 v[204:207], v[84:87], v[108:111], v[204:207]
    v_mfma_f32_16x16x32_bf16 v[208:211], v[84:87], v[112:115], v[208:211]
    v_mfma_f32_16x16x32_bf16 v[212:215], v[84:87], v[116:119], v[212:215]
    v_mfma_f32_16x16x32_bf16 v[216:219], v[84:87], v[120:123], v[216:219]
    v_mfma_f32_16x16x32_bf16 v[220:223], v[84:87], v[124:127], v[220:223]
    s_add_u32 s8, s49, 4
    s_lshr_b32 s9, s8, 3
    s_lshl_b32 s9, s9, 1
    s_add_u32 s10, s9, s44
    s_and_b32 s8, s8, 7
    s_lshl_b32 s9, s42, 3
    s_add_u32 s11, s9, s8
    s_mul_i32 s8, s11, 44
    s_add_u32 s8, s8, s10
    s_lshl_b32 s8, s8, 9
    s_add_u32 s8, s8, 56623104
    s_cmp_lt_u32 s10, 43
    s_cselect_b32 s8, s8, 536870912
    buffer_load_dwordx2 v[52:53], v11, s[4:7], s8 offen sc1
    s_lshl_b32 s8, s11, 5
    buffer_load_ushort v60, v10, s[28:31], s8 offen
    s_mul_i32 s8, s11, 150
    s_lshr_b32 s9, s10, 1
    s_add_u32 s8, s8, s9
    s_lshl_b32 s8, s8, 10
    s_and_b32 s9, s10, 1
    s_lshl_b32 s9, s9, 3
    s_add_u32 s8, s8, s9
    s_add_u32 s8, s8, 35782656
    s_andn2_b32 s8, s8, 8
    s_cmp_lt_u32 s10, s45
    s_cselect_b32 s59, s8, 536870912
    v_mfma_f32_16x16x32_bf16 v[224:227], v[88:91], v[96:99], v[224:227]
    v_mfma_f32_16x16x32_bf16 v[228:231], v[88:91], v[100:103], v[228:231]
    v_mfma_f32_16x16x32_bf16 v[232:235], v[88:91], v[104:107], v[232:235]
    v_mfma_f32_16x16x32_bf16 v[236:239], v[88:91], v[108:111], v[236:239]
    v_mfma_f32_16x16x32_bf16 v[240:243], v[88:91], v[112:115], v[240:243]
    v_mfma_f32_16x16x32_bf16 v[244:247], v[88:91], v[116:119], v[244:247]
    v_mfma_f32_16x16x32_bf16 v[248:251], v[88:91], v[120:123], v[248:251]
    v_mfma_f32_16x16x32_bf16 v[252:255], v[88:91], v[124:127], v[252:255]
    s_add_u32 s8, s49, 5
    s_lshr_b32 s9, s8, 3
    s_lshl_b32 s9, s9, 1
    s_add_u32 s10, s9, s44
    s_and_b32 s8, s8, 7
    s_lshl_b32 s9, s42, 3
    s_add_u32 s11, s9, s8
    s_mul_i32 s8, s11, 44
    s_add_u32 s8, s8, s10
    s_lshl_b32 s8, s8, 9
    s_add_u32 s8, s8, 56623104
    s_cmp_lt_u32 s10, 43
    s_cselect_b32 s8, s8, 536870912
    buffer_load_dwordx2 v[54:55], v11, s[4:7], s8 offen sc1
    s_lshl_b32 s8, s11, 5
    buffer_load_ushort v61, v10, s[28:31], s8 offen
    s_mul_i32 s8, s11, 150
    s_lshr_b32 s9, s10, 1
    s_add_u32 s8, s8, s9
    s_lshl_b32 s8, s8, 10
    s_and_b32 s9, s10, 1
    s_lshl_b32 s9, s9, 3
    s_add_u32 s8, s8, s9
    s_add_u32 s8, s8, 35782656
    s_andn2_b32 s8, s8, 8
    s_cmp_lt_u32 s10, s45
    s_cselect_b32 s48, s8, 536870912
    s_waitcnt vmcnt(24) lgkmcnt(0)
    v_mfma_f32_16x16x32_bf16 v[160:163], v[32:35], v[128:131], v[160:163]
    v_mfma_f32_16x16x32_bf16 v[164:167], v[32:35], v[132:135], v[164:167]
    v_mfma_f32_16x16x32_bf16 v[168:171], v[32:35], v[136:139], v[168:171]
    v_mfma_f32_16x16x32_bf16 v[172:175], v[32:35], v[140:143], v[172:175]
    v_mfma_f32_16x16x32_bf16 v[176:179], v[32:35], v[144:147], v[176:179]
    v_mfma_f32_16x16x32_bf16 v[180:183], v[32:35], v[148:151], v[180:183]
    v_mfma_f32_16x16x32_bf16 v[184:187], v[32:35], v[152:155], v[184:187]
    v_mfma_f32_16x16x32_bf16 v[188:191], v[32:35], v[156:159], v[188:191]
    v_mfma_f32_16x16x32_bf16 v[192:195], v[36:39], v[128:131], v[192:195]
    v_mfma_f32_16x16x32_bf16 v[196:199], v[36:39], v[132:135], v[196:199]
    v_mfma_f32_16x16x32_bf16 v[200:203], v[36:39], v[136:139], v[200:203]
    v_mfma_f32_16x16x32_bf16 v[204:207], v[36:39], v[140:143], v[204:207]
    v_mfma_f32_16x16x32_bf16 v[208:211], v[36:39], v[144:147], v[208:211]
    v_mfma_f32_16x16x32_bf16 v[212:215], v[36:39], v[148:151], v[212:215]
    v_mfma_f32_16x16x32_bf16 v[216:219], v[36:39], v[152:155], v[216:219]
    v_mfma_f32_16x16x32_bf16 v[220:223], v[36:39], v[156:159], v[220:223]
    v_mfma_f32_16x16x32_bf16 v[224:227], v[40:43], v[128:131], v[224:227]
    v_mfma_f32_16x16x32_bf16 v[228:231], v[40:43], v[132:135], v[228:231]
    v_mfma_f32_16x16x32_bf16 v[232:235], v[40:43], v[136:139], v[232:235]
    v_mfma_f32_16x16x32_bf16 v[236:239], v[40:43], v[140:143], v[236:239]
    v_mfma_f32_16x16x32_bf16 v[240:243], v[40:43], v[144:147], v[240:243]
    v_mfma_f32_16x16x32_bf16 v[244:247], v[40:43], v[148:151], v[244:247]
    v_mfma_f32_16x16x32_bf16 v[248:251], v[40:43], v[152:155], v[248:251]
    v_mfma_f32_16x16x32_bf16 v[252:255], v[40:43], v[156:159], v[252:255]
    s_barrier
    s_add_u32 m0, s101, 98304
    s_add_u32 s12, s100, 262144
    buffer_load_dwordx4 v27, s[24:27], s12 offen lds
    s_add_u32 m0, s101, 106496
    s_add_u32 s12, s100, 327680
    buffer_load_dwordx4 v27, s[24:27], s12 offen lds
    s_add_u32 m0, s101, 114688
    s_add_u32 s12, s100, 393216
    buffer_load_dwordx4 v27, s[24:27], s12 offen lds
    s_add_u32 m0, s101, 122880
    s_add_u32 s12, s100, 458752
    buffer_load_dwordx4 v27, s[24:27], s12 offen lds
    s_xor_b32 s8, s3, 0
    s_mul_i32 s8, s8, 12288
    v_add_u32 v12, s8, v2
    s_xor_b32 s8, s3, 4
    s_mul_i32 s8, s8, 12288
    v_add_u32_e64 v13, s8, v2
    s_and_b32 s9, s3, 4
    s_cbranch_scc1 parallel_sum__compressed_kv_cla__mixer_gmlp__prompt_kernel_sr0_hi
    ds_write_b128 v12, v[208:211] offset:0
    ds_write_b128 v12, v[212:215] offset:1024
    ds_write_b128 v12, v[216:219] offset:2048
    ds_write_b128 v12, v[220:223] offset:3072
    ds_write_b128 v12, v[224:227] offset:4096
    ds_write_b128 v12, v[228:231] offset:5120
    ds_write_b128 v12, v[232:235] offset:6144
    ds_write_b128 v12, v[236:239] offset:7168
    ds_write_b128 v12, v[240:243] offset:8192
    ds_write_b128 v12, v[244:247] offset:9216
    ds_write_b128 v12, v[248:251] offset:10240
    ds_write_b128 v12, v[252:255] offset:11264
    s_waitcnt lgkmcnt(0)
    s_barrier
    ds_read_b128 v[208:211], v13 offset:0
    ds_read_b128 v[212:215], v13 offset:1024
    ds_read_b128 v[216:219], v13 offset:2048
    ds_read_b128 v[220:223], v13 offset:3072
    ds_read_b128 v[224:227], v13 offset:4096
    ds_read_b128 v[228:231], v13 offset:5120
    ds_read_b128 v[232:235], v13 offset:6144
    ds_read_b128 v[236:239], v13 offset:7168
    ds_read_b128 v[240:243], v13 offset:8192
    ds_read_b128 v[244:247], v13 offset:9216
    ds_read_b128 v[248:251], v13 offset:10240
    ds_read_b128 v[252:255], v13 offset:11264
    s_waitcnt lgkmcnt(11)
    v_pk_add_f32 v[160:161], v[160:161], v[208:209]
    v_pk_add_f32 v[162:163], v[162:163], v[210:211]
    s_waitcnt lgkmcnt(10)
    v_pk_add_f32 v[164:165], v[164:165], v[212:213]
    v_pk_add_f32 v[166:167], v[166:167], v[214:215]
    s_waitcnt lgkmcnt(9)
    v_pk_add_f32 v[168:169], v[168:169], v[216:217]
    v_pk_add_f32 v[170:171], v[170:171], v[218:219]
    s_waitcnt lgkmcnt(8)
    v_pk_add_f32 v[172:173], v[172:173], v[220:221]
    v_pk_add_f32 v[174:175], v[174:175], v[222:223]
    s_waitcnt lgkmcnt(7)
    v_pk_add_f32 v[176:177], v[176:177], v[224:225]
    v_pk_add_f32 v[178:179], v[178:179], v[226:227]
    s_waitcnt lgkmcnt(6)
    v_pk_add_f32 v[180:181], v[180:181], v[228:229]
    v_pk_add_f32 v[182:183], v[182:183], v[230:231]
    s_waitcnt lgkmcnt(5)
    v_pk_add_f32 v[184:185], v[184:185], v[232:233]
    v_pk_add_f32 v[186:187], v[186:187], v[234:235]
    s_waitcnt lgkmcnt(4)
    v_pk_add_f32 v[188:189], v[188:189], v[236:237]
    v_pk_add_f32 v[190:191], v[190:191], v[238:239]
    s_waitcnt lgkmcnt(3)
    v_pk_add_f32 v[192:193], v[192:193], v[240:241]
    v_pk_add_f32 v[194:195], v[194:195], v[242:243]
    s_waitcnt lgkmcnt(2)
    v_pk_add_f32 v[196:197], v[196:197], v[244:245]
    v_pk_add_f32 v[198:199], v[198:199], v[246:247]
    s_waitcnt lgkmcnt(1)
    v_pk_add_f32 v[200:201], v[200:201], v[248:249]
    v_pk_add_f32 v[202:203], v[202:203], v[250:251]
    s_waitcnt lgkmcnt(0)
    v_pk_add_f32 v[204:205], v[204:205], v[252:253]
    v_pk_add_f32 v[206:207], v[206:207], v[254:255]
    s_branch parallel_sum__compressed_kv_cla__mixer_gmlp__prompt_kernel_sr0_j
parallel_sum__compressed_kv_cla__mixer_gmlp__prompt_kernel_sr0_hi:
    ds_write_b128 v12, v[160:163] offset:0
    ds_write_b128 v12, v[164:167] offset:1024
    ds_write_b128 v12, v[168:171] offset:2048
    ds_write_b128 v12, v[172:175] offset:3072
    ds_write_b128 v12, v[176:179] offset:4096
    ds_write_b128 v12, v[180:183] offset:5120
    ds_write_b128 v12, v[184:187] offset:6144
    ds_write_b128 v12, v[188:191] offset:7168
    ds_write_b128 v12, v[192:195] offset:8192
    ds_write_b128 v12, v[196:199] offset:9216
    ds_write_b128 v12, v[200:203] offset:10240
    ds_write_b128 v12, v[204:207] offset:11264
    s_waitcnt lgkmcnt(0)
    s_barrier
    ds_read_b128 v[160:163], v13 offset:0
    ds_read_b128 v[164:167], v13 offset:1024
    ds_read_b128 v[168:171], v13 offset:2048
    ds_read_b128 v[172:175], v13 offset:3072
    ds_read_b128 v[176:179], v13 offset:4096
    ds_read_b128 v[180:183], v13 offset:5120
    ds_read_b128 v[184:187], v13 offset:6144
    ds_read_b128 v[188:191], v13 offset:7168
    ds_read_b128 v[192:195], v13 offset:8192
    ds_read_b128 v[196:199], v13 offset:9216
    ds_read_b128 v[200:203], v13 offset:10240
    ds_read_b128 v[204:207], v13 offset:11264
    s_waitcnt lgkmcnt(11)
    v_pk_add_f32 v[160:161], v[208:209], v[160:161]
    v_pk_add_f32 v[162:163], v[210:211], v[162:163]
    s_waitcnt lgkmcnt(10)
    v_pk_add_f32 v[164:165], v[212:213], v[164:165]
    v_pk_add_f32 v[166:167], v[214:215], v[166:167]
    s_waitcnt lgkmcnt(9)
    v_pk_add_f32 v[168:169], v[216:217], v[168:169]
    v_pk_add_f32 v[170:171], v[218:219], v[170:171]
    s_waitcnt lgkmcnt(8)
    v_pk_add_f32 v[172:173], v[220:221], v[172:173]
    v_pk_add_f32 v[174:175], v[222:223], v[174:175]
    s_waitcnt lgkmcnt(7)
    v_pk_add_f32 v[176:177], v[224:225], v[176:177]
    v_pk_add_f32 v[178:179], v[226:227], v[178:179]
    s_waitcnt lgkmcnt(6)
    v_pk_add_f32 v[180:181], v[228:229], v[180:181]
    v_pk_add_f32 v[182:183], v[230:231], v[182:183]
    s_waitcnt lgkmcnt(5)
    v_pk_add_f32 v[184:185], v[232:233], v[184:185]
    v_pk_add_f32 v[186:187], v[234:235], v[186:187]
    s_waitcnt lgkmcnt(4)
    v_pk_add_f32 v[188:189], v[236:237], v[188:189]
    v_pk_add_f32 v[190:191], v[238:239], v[190:191]
    s_waitcnt lgkmcnt(3)
    v_pk_add_f32 v[192:193], v[240:241], v[192:193]
    v_pk_add_f32 v[194:195], v[242:243], v[194:195]
    s_waitcnt lgkmcnt(2)
    v_pk_add_f32 v[196:197], v[244:245], v[196:197]
    v_pk_add_f32 v[198:199], v[246:247], v[198:199]
    s_waitcnt lgkmcnt(1)
    v_pk_add_f32 v[200:201], v[248:249], v[200:201]
    v_pk_add_f32 v[202:203], v[250:251], v[202:203]
    s_waitcnt lgkmcnt(0)
    v_pk_add_f32 v[204:205], v[252:253], v[204:205]
    v_pk_add_f32 v[206:207], v[254:255], v[206:207]
parallel_sum__compressed_kv_cla__mixer_gmlp__prompt_kernel_sr0_j:
    s_xor_b32 s8, s3, 4
    s_mul_i32 s8, s8, 12288
    v_add_u32 v12, s8, v2
    s_xor_b32 s8, s3, 6
    s_mul_i32 s8, s8, 12288
    v_add_u32_e64 v13, s8, v2
    s_and_b32 s9, s3, 2
    s_cbranch_scc1 parallel_sum__compressed_kv_cla__mixer_gmlp__prompt_kernel_sr1_hi
    ds_write_b128 v12, v[184:187] offset:0
    ds_write_b128 v12, v[188:191] offset:1024
    ds_write_b128 v12, v[192:195] offset:2048
    ds_write_b128 v12, v[196:199] offset:3072
    ds_write_b128 v12, v[200:203] offset:4096
    ds_write_b128 v12, v[204:207] offset:5120
    s_waitcnt lgkmcnt(0)
    s_barrier
    ds_read_b128 v[184:187], v13 offset:0
    ds_read_b128 v[188:191], v13 offset:1024
    ds_read_b128 v[192:195], v13 offset:2048
    ds_read_b128 v[196:199], v13 offset:3072
    ds_read_b128 v[200:203], v13 offset:4096
    ds_read_b128 v[204:207], v13 offset:5120
    s_waitcnt lgkmcnt(5)
    v_pk_add_f32 v[160:161], v[160:161], v[184:185]
    v_pk_add_f32 v[162:163], v[162:163], v[186:187]
    s_waitcnt lgkmcnt(4)
    v_pk_add_f32 v[164:165], v[164:165], v[188:189]
    v_pk_add_f32 v[166:167], v[166:167], v[190:191]
    s_waitcnt lgkmcnt(3)
    v_pk_add_f32 v[168:169], v[168:169], v[192:193]
    v_pk_add_f32 v[170:171], v[170:171], v[194:195]
    s_waitcnt lgkmcnt(2)
    v_pk_add_f32 v[172:173], v[172:173], v[196:197]
    v_pk_add_f32 v[174:175], v[174:175], v[198:199]
    s_waitcnt lgkmcnt(1)
    v_pk_add_f32 v[176:177], v[176:177], v[200:201]
    v_pk_add_f32 v[178:179], v[178:179], v[202:203]
    s_waitcnt lgkmcnt(0)
    v_pk_add_f32 v[180:181], v[180:181], v[204:205]
    v_pk_add_f32 v[182:183], v[182:183], v[206:207]
    s_branch parallel_sum__compressed_kv_cla__mixer_gmlp__prompt_kernel_sr1_j
parallel_sum__compressed_kv_cla__mixer_gmlp__prompt_kernel_sr1_hi:
    ds_write_b128 v12, v[160:163] offset:0
    ds_write_b128 v12, v[164:167] offset:1024
    ds_write_b128 v12, v[168:171] offset:2048
    ds_write_b128 v12, v[172:175] offset:3072
    ds_write_b128 v12, v[176:179] offset:4096
    ds_write_b128 v12, v[180:183] offset:5120
    s_waitcnt lgkmcnt(0)
    s_barrier
    ds_read_b128 v[160:163], v13 offset:0
    ds_read_b128 v[164:167], v13 offset:1024
    ds_read_b128 v[168:171], v13 offset:2048
    ds_read_b128 v[172:175], v13 offset:3072
    ds_read_b128 v[176:179], v13 offset:4096
    ds_read_b128 v[180:183], v13 offset:5120
    s_waitcnt lgkmcnt(5)
    v_pk_add_f32 v[160:161], v[184:185], v[160:161]
    v_pk_add_f32 v[162:163], v[186:187], v[162:163]
    s_waitcnt lgkmcnt(4)
    v_pk_add_f32 v[164:165], v[188:189], v[164:165]
    v_pk_add_f32 v[166:167], v[190:191], v[166:167]
    s_waitcnt lgkmcnt(3)
    v_pk_add_f32 v[168:169], v[192:193], v[168:169]
    v_pk_add_f32 v[170:171], v[194:195], v[170:171]
    s_waitcnt lgkmcnt(2)
    v_pk_add_f32 v[172:173], v[196:197], v[172:173]
    v_pk_add_f32 v[174:175], v[198:199], v[174:175]
    s_waitcnt lgkmcnt(1)
    v_pk_add_f32 v[176:177], v[200:201], v[176:177]
    v_pk_add_f32 v[178:179], v[202:203], v[178:179]
    s_waitcnt lgkmcnt(0)
    v_pk_add_f32 v[180:181], v[204:205], v[180:181]
    v_pk_add_f32 v[182:183], v[206:207], v[182:183]
parallel_sum__compressed_kv_cla__mixer_gmlp__prompt_kernel_sr1_j:
    s_waitcnt vmcnt(4)
    v_lshlrev_b32 v56, 16, v56
    v_add_f32 v160, v160, v56
    v_add_f32 v161, v161, v56
    v_add_f32 v162, v162, v56
    v_add_f32 v163, v163, v56
    v_lshlrev_b32 v4, 16, v44
    v_and_b32 v5, 0xffff0000, v44
    v_mul_f32 v4, v4, v160
    v_mul_f32 v5, v5, v161
    v_cvt_pk_bf16_f32 v44, v4, v5
    v_lshlrev_b32_e64 v4, 16, v45
    v_and_b32 v5, 0xffff0000, v45
    v_mul_f32 v4, v4, v162
    v_mul_f32 v5, v5, v163
    v_cvt_pk_bf16_f32 v45, v4, v5
    v_lshlrev_b32 v57, 16, v57
    v_add_f32 v164, v164, v57
    v_add_f32 v165, v165, v57
    v_add_f32 v166, v166, v57
    v_add_f32 v167, v167, v57
    v_lshlrev_b32 v4, 16, v46
    v_and_b32 v5, 0xffff0000, v46
    v_mul_f32 v4, v4, v164
    v_mul_f32 v5, v5, v165
    v_cvt_pk_bf16_f32 v46, v4, v5
    v_lshlrev_b32_e64 v4, 16, v47
    v_and_b32 v5, 0xffff0000, v47
    v_mul_f32 v4, v4, v166
    v_mul_f32 v5, v5, v167
    v_cvt_pk_bf16_f32 v47, v4, v5
    v_lshlrev_b32 v58, 16, v58
    v_add_f32 v168, v168, v58
    v_add_f32 v169, v169, v58
    v_add_f32 v170, v170, v58
    v_add_f32 v171, v171, v58
    v_lshlrev_b32 v4, 16, v48
    v_and_b32 v5, 0xffff0000, v48
    v_mul_f32 v4, v4, v168
    v_mul_f32 v5, v5, v169
    v_cvt_pk_bf16_f32 v48, v4, v5
    v_lshlrev_b32_e64 v4, 16, v49
    v_and_b32 v5, 0xffff0000, v49
    v_mul_f32 v4, v4, v170
    v_mul_f32 v5, v5, v171
    v_cvt_pk_bf16_f32 v49, v4, v5
    v_lshlrev_b32 v59, 16, v59
    v_add_f32 v172, v172, v59
    v_add_f32 v173, v173, v59
    v_add_f32 v174, v174, v59
    v_add_f32 v175, v175, v59
    v_lshlrev_b32 v4, 16, v50
    v_and_b32 v5, 0xffff0000, v50
    v_mul_f32 v4, v4, v172
    v_mul_f32 v5, v5, v173
    v_cvt_pk_bf16_f32 v50, v4, v5
    v_lshlrev_b32_e64 v4, 16, v51
    v_and_b32 v5, 0xffff0000, v51
    v_mul_f32 v4, v4, v174
    v_mul_f32 v5, v5, v175
    v_cvt_pk_bf16_f32 v51, v4, v5
    v_lshlrev_b32 v60, 16, v60
    v_add_f32 v176, v176, v60
    v_add_f32 v177, v177, v60
    v_add_f32 v178, v178, v60
    v_add_f32 v179, v179, v60
    v_lshlrev_b32 v4, 16, v52
    v_and_b32 v5, 0xffff0000, v52
    v_mul_f32 v4, v4, v176
    v_mul_f32 v5, v5, v177
    v_cvt_pk_bf16_f32 v52, v4, v5
    v_lshlrev_b32_e64 v4, 16, v53
    v_and_b32 v5, 0xffff0000, v53
    v_mul_f32 v4, v4, v178
    v_mul_f32 v5, v5, v179
    v_cvt_pk_bf16_f32 v53, v4, v5
    v_lshlrev_b32 v61, 16, v61
    v_add_f32 v180, v180, v61
    v_add_f32 v181, v181, v61
    v_add_f32 v182, v182, v61
    v_add_f32 v183, v183, v61
    v_lshlrev_b32 v4, 16, v54
    v_and_b32 v5, 0xffff0000, v54
    v_mul_f32 v4, v4, v180
    v_mul_f32 v5, v5, v181
    v_cvt_pk_bf16_f32 v54, v4, v5
    v_lshlrev_b32_e64 v4, 16, v55
    v_and_b32 v5, 0xffff0000, v55
    v_mul_f32 v4, v4, v182
    v_mul_f32 v5, v5, v183
    v_cvt_pk_bf16_f32 v55, v4, v5
    v_lshrrev_b32_e64 v4, 1, v2
    s_mul_i32 s8, s3, 12288
    s_add_u32 s8, s8, 8192
    v_add_u32 v5, s8, v4
    s_xor_b32 s8, s3, 1
    s_mul_i32 s8, s8, 12288
    s_add_u32 s8, s8, 8192
    v_add_u32_e64 v6, s8, v4
    s_bitcmp1_b32 s3, 0
    s_cbranch_scc1 parallel_sum__compressed_kv_cla__mixer_gmlp__prompt_kernel_up1
    ds_write_b64 v5, v[50:51] offset:0
    ds_write_b64 v5, v[52:53] offset:512
    ds_write_b64 v5, v[54:55] offset:1024
    s_waitcnt lgkmcnt(0)
    s_barrier
    ds_read_b64 v[66:67], v6 offset:0
    v_mov_b32 v64, v44
    v_mov_b32 v65, v45
    ds_read_b64 v[70:71], v6 offset:512
    v_mov_b32 v68, v46
    v_mov_b32 v69, v47
    ds_read_b64 v[74:75], v6 offset:1024
    v_mov_b32_e64 v72, v48
    v_mov_b32 v73, v49
    s_waitcnt lgkmcnt(0)
    buffer_store_dwordx4 v[64:67], v2, s[4:7], s55 offen sc1
    buffer_store_dwordx4 v[68:71], v2, s[4:7], s56 offen sc1
    buffer_store_dwordx4 v[72:75], v2, s[4:7], s57 offen sc1
    s_branch parallel_sum__compressed_kv_cla__mixer_gmlp__prompt_kernel_up2
parallel_sum__compressed_kv_cla__mixer_gmlp__prompt_kernel_up1:
    ds_write_b64 v5, v[44:45] offset:0
    ds_write_b64 v5, v[46:47] offset:512
    ds_write_b64 v5, v[48:49] offset:1024
    s_waitcnt lgkmcnt(0)
    s_barrier
    ds_read_b64 v[64:65], v6 offset:0
    v_mov_b32 v66, v50
    v_mov_b32_e64 v67, v51
    ds_read_b64 v[68:69], v6 offset:512
    v_mov_b32 v70, v52
    v_mov_b32 v71, v53
    ds_read_b64 v[72:73], v6 offset:1024
    v_mov_b32_e64 v74, v54
    v_mov_b32 v75, v55
    s_waitcnt lgkmcnt(0)
    buffer_store_dwordx4 v[64:67], v2, s[4:7], s58 offen sc1
    buffer_store_dwordx4 v[68:71], v2, s[4:7], s59 offen sc1
    buffer_store_dwordx4 v[72:75], v2, s[4:7], s48 offen sc1
parallel_sum__compressed_kv_cla__mixer_gmlp__prompt_kernel_up2:
    s_waitcnt vmcnt(0)
    s_barrier
    s_add_u32 s8, s42, 160
    s_cmp_lg_u32 s3, 0
    s_cbranch_scc1 sig_172
    s_lshl_b32 s14, s8, 8
    s_add_u32 s14, s14, 117440512
    v_mov_b32 v8, 0
    v_mov_b32 v9, 1
    s_mov_b64 exec, 1
    buffer_atomic_add v9, v8, s[4:7], s14 offen sc1
    s_mov_b64 exec, -1
sig_172:
    s_add_u32 m0, s101, 0
    s_add_u32 s12, s100, 524288
    buffer_load_dwordx4 v27, s[24:27], s12 offen lds
    s_add_u32 m0, s101, 8192
    s_add_u32 s12, s100, 589824
    buffer_load_dwordx4 v27, s[24:27], s12 offen lds
    s_add_u32 m0, s101, 16384
    s_add_u32 s12, s100, 655360
    buffer_load_dwordx4 v27, s[24:27], s12 offen lds
    s_mov_b32 s40, 98304
    s_mov_b32 s41, 0
parallel_sum__compressed_kv_cla__mixer_gmlp__prompt_kernel_t_f:
    s_lshr_b32 s8, s33, 1
    s_add_u32 s45, s8, 160
    s_sub_u32 s9, 15, s8
    s_min_u32 s8, s8, s9
    s_lshr_b32 s8, s8, 1
    s_lshl_b32 s8, s8, 2
    s_lshr_b32 s9, s36, 1
    s_add_u32 s8, s8, s9
    s_add_u32 s42, s8, 192
    s_lshl_b32 s14, s45, 8
    s_add_u32 s14, s14, 117440512
    v_and_b32 v8, 0, v1
    v_lshlrev_b32_e64 v8, 8, v8
    buffer_load_dword v26, v8, s[4:7], s14 offen sc1
    s_lshl_b32 s38, s33, 2
    s_lshr_b32 s8, s3, 1
    s_add_u32 s38, s38, s8
    s_mul_i32 s43, s38, 150
    s_lshl_b32 s43, s43, 10
    s_add_u32 s43, s43, 35782656
    v_and_b32 v4, 15, v1
    v_lshlrev_b32 v4, 10, v4
    v_lshrrev_b32_e64 v5, 4, v1
    v_lshl_add_u32 v13, v5, 3, v4
    s_lshl_b32 s39, s38, 14
    s_lshl_b32 s8, s36, 7
    s_add_u32 s39, s39, s8
    s_and_b32 s8, s3, 1
    s_lshl_b32 s8, s8, 6
    s_add_u32 s39, s39, s8
    buffer_load_dwordx2 v[28:29], v13, s[64:67], s39 offen offset:0
    buffer_load_dwordx2 v[30:31], v13, s[64:67], s39 offen offset:32
    v_and_b32 v4, 15, v1
    v_lshrrev_b32 v6, 2, v4
    v_lshl_add_u32 v7, v5, 2, v6
    v_bfe_u32 v6, v7, 1, 2
    v_and_b32 v4, 3, v1
    v_lshlrev_b32 v4, 3, v4
    v_lshl_add_u32 v4, v7, 7, v4
    s_and_b32 s8, s3, 1
    s_lshl_b32 s8, s8, 1
    s_add_u32 s9, s8, 0
    v_xor_b32 v3, s9, v6
    v_lshl_add_u32 v3, v3, 5, v4
    v_add_u32 v14, 0x20000, v3
    v_add_u32 v16, s40, v3
    v_add_u32 v18, s41, v3
    s_add_u32 s9, s8, 1
    v_xor_b32 v3, s9, v6
    v_lshl_add_u32 v3, v3, 5, v4
    v_add_u32 v15, 0x20000, v3
    v_add_u32 v17, s40, v3
    v_add_u32 v19, s41, v3
    s_lshl_b32 s46, s38, 14
    s_lshl_b32 s9, s36, 1
    s_and_b32 s10, s3, 1
    s_add_u32 s9, s9, s10
    s_lshl_b32 s9, s9, 10
    s_add_u32 s46, s46, s9
    ds_read_b64_tr_b16 v[160:161], v14 offset:0
    ds_read_b64_tr_b16 v[162:163], v14 offset:2048
    ds_read_b64_tr_b16 v[164:165], v15 offset:0
    ds_read_b64_tr_b16 v[166:167], v15 offset:2048
    ds_read_b64_tr_b16 v[168:169], v14 offset:4096
    ds_read_b64_tr_b16 v[170:171], v14 offset:6144
    ds_read_b64_tr_b16 v[172:173], v15 offset:4096
    ds_read_b64_tr_b16 v[174:175], v15 offset:6144
    ds_read_b64_tr_b16 v[176:177], v14 offset:8192
    ds_read_b64_tr_b16 v[178:179], v14 offset:10240
    ds_read_b64_tr_b16 v[180:181], v15 offset:8192
    ds_read_b64_tr_b16 v[182:183], v15 offset:10240
    s_waitcnt vmcnt(0)
    s_barrier
    s_mov_b32 s15, 0x20000
poll_173:
    v_cmp_gt_u32 vcc, 8, v26
    s_cbranch_vccz polld_174
    s_sleep 2
    s_lshl_b32 s14, s45, 8
    s_add_u32 s14, s14, 117440512
    v_and_b32 v8, 0, v1
    v_lshlrev_b32 v8, 8, v8
    buffer_load_dword v26, v8, s[4:7], s14 offen sc1
    s_waitcnt vmcnt(0)
    s_sub_u32 s15, s15, 1
    s_cmp_lg_u32 s15, 0
    s_cbranch_scc1 poll_173
polld_174:
    s_lshl_b32 s14, s42, 8
    s_add_u32 s14, s14, 117440512
    v_and_b32 v8, 0, v1
    v_lshlrev_b32_e64 v8, 8, v8
    buffer_load_dword v26, v8, s[4:7], s14 offen sc1
    s_add_u32 s12, s43, 0
    buffer_load_dwordx4 v[64:67], v2, s[4:7], s12 offen offset:0 sc1
    buffer_load_dwordx4 v[68:71], v2, s[4:7], s12 offen offset:1024 sc1
    buffer_load_dwordx4 v[72:75], v2, s[4:7], s12 offen offset:2048 sc1
    buffer_load_dwordx4 v[76:79], v2, s[4:7], s12 offen offset:3072 sc1
    s_add_u32 s12, s43, 4096
    buffer_load_dwordx4 v[80:83], v2, s[4:7], s12 offen offset:0 sc1
    buffer_load_dwordx4 v[84:87], v2, s[4:7], s12 offen offset:1024 sc1
    buffer_load_dwordx4 v[88:91], v2, s[4:7], s12 offen offset:2048 sc1
    buffer_load_dwordx4 v[92:95], v2, s[4:7], s12 offen offset:3072 sc1
    s_add_u32 s12, s43, 8192
    buffer_load_dwordx4 v[96:99], v2, s[4:7], s12 offen offset:0 sc1
    buffer_load_dwordx4 v[100:103], v2, s[4:7], s12 offen offset:1024 sc1
    buffer_load_dwordx4 v[104:107], v2, s[4:7], s12 offen offset:2048 sc1
    buffer_load_dwordx4 v[108:111], v2, s[4:7], s12 offen offset:3072 sc1
    s_add_u32 s12, s43, 12288
    buffer_load_dwordx4 v[112:115], v2, s[4:7], s12 offen offset:0 sc1
    buffer_load_dwordx4 v[116:119], v2, s[4:7], s12 offen offset:1024 sc1
    buffer_load_dwordx4 v[120:123], v2, s[4:7], s12 offen offset:2048 sc1
    buffer_load_dwordx4 v[124:127], v2, s[4:7], s12 offen offset:3072 sc1
    s_add_u32 s12, s43, 16384
    buffer_load_dwordx4 v[128:131], v2, s[4:7], s12 offen offset:0 sc1
    buffer_load_dwordx4 v[132:135], v2, s[4:7], s12 offen offset:1024 sc1
    buffer_load_dwordx4 v[136:139], v2, s[4:7], s12 offen offset:2048 sc1
    buffer_load_dwordx4 v[140:143], v2, s[4:7], s12 offen offset:3072 sc1
    s_add_u32 s12, s43, 20480
    buffer_load_dwordx4 v[144:147], v2, s[4:7], s12 offen offset:0 sc1
    buffer_load_dwordx4 v[148:151], v2, s[4:7], s12 offen offset:1024 sc1
    s_waitcnt vmcnt(22)
    s_mov_b32 s15, 0x20000
poll_175:
    v_cmp_gt_u32 vcc, 8, v26
    s_cbranch_vccz polld_176
    s_sleep 2
    s_lshl_b32 s14, s42, 8
    s_add_u32 s14, s14, 117440512
    v_and_b32 v8, 0, v1
    v_lshlrev_b32 v8, 8, v8
    buffer_load_dword v26, v8, s[4:7], s14 offen sc1
    s_waitcnt vmcnt(0)
    s_sub_u32 s15, s15, 1
    s_cmp_lg_u32 s15, 0
    s_cbranch_scc1 poll_175
polld_176:
    s_add_u32 s12, s46, 69206016
    buffer_load_dwordx4 v[200:203], v2, s[4:7], s12 offen sc1
    s_add_u32 s12, s46, 71303168
    buffer_load_dwordx4 v[204:207], v2, s[4:7], s12 offen sc1
    s_add_u32 s12, s46, 73400320
    buffer_load_dwordx4 v[208:211], v2, s[4:7], s12 offen sc1
    s_add_u32 s12, s46, 75497472
    buffer_load_dwordx4 v[212:215], v2, s[4:7], s12 offen sc1
    s_add_u32 s12, s46, 77594624
    buffer_load_dwordx4 v[216:219], v2, s[4:7], s12 offen sc1
    s_add_u32 s12, s46, 79691776
    buffer_load_dwordx4 v[220:223], v2, s[4:7], s12 offen sc1
    s_add_u32 s12, s46, 81788928
    buffer_load_dwordx4 v[224:227], v2, s[4:7], s12 offen sc1
    s_add_u32 s12, s46, 83886080
    buffer_load_dwordx4 v[228:231], v2, s[4:7], s12 offen sc1
    v_lshlrev_b32_e64 v192, 16, v28
    v_and_b32 v193, 0xffff0000, v28
    v_lshlrev_b32_e64 v194, 16, v29
    v_and_b32 v195, 0xffff0000, v29
    v_lshlrev_b32_e64 v196, 16, v30
    v_and_b32 v197, 0xffff0000, v30
    v_lshlrev_b32_e64 v198, 16, v31
    v_and_b32 v199, 0xffff0000, v31
    s_waitcnt vmcnt(29) lgkmcnt(8)
    v_mfma_f32_16x16x32_bf16 v[192:195], v[160:163], v[64:67], v[192:195]
    v_mfma_f32_16x16x32_bf16 v[196:199], v[164:167], v[64:67], v[196:199]
    ds_read_b64_tr_b16 v[184:185], v14 offset:12288
    ds_read_b64_tr_b16 v[186:187], v14 offset:14336
    ds_read_b64_tr_b16 v[188:189], v15 offset:12288
    ds_read_b64_tr_b16 v[190:191], v15 offset:14336
    s_waitcnt vmcnt(28) lgkmcnt(8)
    v_mfma_f32_16x16x32_bf16 v[192:195], v[168:171], v[68:71], v[192:195]
    v_mfma_f32_16x16x32_bf16 v[196:199], v[172:175], v[68:71], v[196:199]
    ds_read_b64_tr_b16 v[160:161], v14 offset:16384
    ds_read_b64_tr_b16 v[162:163], v14 offset:18432
    ds_read_b64_tr_b16 v[164:165], v15 offset:16384
    ds_read_b64_tr_b16 v[166:167], v15 offset:18432
    s_waitcnt vmcnt(27) lgkmcnt(8)
    v_mfma_f32_16x16x32_bf16 v[192:195], v[176:179], v[72:75], v[192:195]
    v_mfma_f32_16x16x32_bf16 v[196:199], v[180:183], v[72:75], v[196:199]
    ds_read_b64_tr_b16 v[168:169], v14 offset:20480
    ds_read_b64_tr_b16 v[170:171], v14 offset:22528
    ds_read_b64_tr_b16 v[172:173], v15 offset:20480
    ds_read_b64_tr_b16 v[174:175], v15 offset:22528
    s_waitcnt vmcnt(26) lgkmcnt(8)
    v_mfma_f32_16x16x32_bf16 v[192:195], v[184:187], v[76:79], v[192:195]
    v_mfma_f32_16x16x32_bf16 v[196:199], v[188:191], v[76:79], v[196:199]
    ds_read_b64_tr_b16 v[176:177], v14 offset:24576
    ds_read_b64_tr_b16 v[178:179], v14 offset:26624
    ds_read_b64_tr_b16 v[180:181], v15 offset:24576
    ds_read_b64_tr_b16 v[182:183], v15 offset:26624
    s_waitcnt vmcnt(25) lgkmcnt(8)
    v_mfma_f32_16x16x32_bf16 v[192:195], v[160:163], v[80:83], v[192:195]
    v_mfma_f32_16x16x32_bf16 v[196:199], v[164:167], v[80:83], v[196:199]
    ds_read_b64_tr_b16 v[184:185], v14 offset:28672
    ds_read_b64_tr_b16 v[186:187], v14 offset:30720
    ds_read_b64_tr_b16 v[188:189], v15 offset:28672
    ds_read_b64_tr_b16 v[190:191], v15 offset:30720
    s_waitcnt vmcnt(24) lgkmcnt(8)
    v_mfma_f32_16x16x32_bf16 v[192:195], v[168:171], v[84:87], v[192:195]
    v_mfma_f32_16x16x32_bf16 v[196:199], v[172:175], v[84:87], v[196:199]
    ds_read_b64_tr_b16 v[160:161], v16 offset:0
    ds_read_b64_tr_b16 v[162:163], v16 offset:2048
    ds_read_b64_tr_b16 v[164:165], v17 offset:0
    ds_read_b64_tr_b16 v[166:167], v17 offset:2048
    s_waitcnt vmcnt(23) lgkmcnt(8)
    v_mfma_f32_16x16x32_bf16 v[192:195], v[176:179], v[88:91], v[192:195]
    v_mfma_f32_16x16x32_bf16 v[196:199], v[180:183], v[88:91], v[196:199]
    ds_read_b64_tr_b16 v[168:169], v16 offset:4096
    ds_read_b64_tr_b16 v[170:171], v16 offset:6144
    ds_read_b64_tr_b16 v[172:173], v17 offset:4096
    ds_read_b64_tr_b16 v[174:175], v17 offset:6144
    s_waitcnt vmcnt(22) lgkmcnt(8)
    v_mfma_f32_16x16x32_bf16 v[192:195], v[184:187], v[92:95], v[192:195]
    v_mfma_f32_16x16x32_bf16 v[196:199], v[188:191], v[92:95], v[196:199]
    ds_read_b64_tr_b16 v[176:177], v16 offset:8192
    ds_read_b64_tr_b16 v[178:179], v16 offset:10240
    ds_read_b64_tr_b16 v[180:181], v17 offset:8192
    ds_read_b64_tr_b16 v[182:183], v17 offset:10240
    s_waitcnt vmcnt(21) lgkmcnt(8)
    v_mfma_f32_16x16x32_bf16 v[192:195], v[160:163], v[96:99], v[192:195]
    v_mfma_f32_16x16x32_bf16 v[196:199], v[164:167], v[96:99], v[196:199]
    ds_read_b64_tr_b16 v[184:185], v16 offset:12288
    ds_read_b64_tr_b16 v[186:187], v16 offset:14336
    ds_read_b64_tr_b16 v[188:189], v17 offset:12288
    ds_read_b64_tr_b16 v[190:191], v17 offset:14336
    s_waitcnt vmcnt(20) lgkmcnt(8)
    v_mfma_f32_16x16x32_bf16 v[192:195], v[168:171], v[100:103], v[192:195]
    v_mfma_f32_16x16x32_bf16 v[196:199], v[172:175], v[100:103], v[196:199]
    ds_read_b64_tr_b16 v[160:161], v16 offset:16384
    ds_read_b64_tr_b16 v[162:163], v16 offset:18432
    ds_read_b64_tr_b16 v[164:165], v17 offset:16384
    ds_read_b64_tr_b16 v[166:167], v17 offset:18432
    s_waitcnt vmcnt(19) lgkmcnt(8)
    v_mfma_f32_16x16x32_bf16 v[192:195], v[176:179], v[104:107], v[192:195]
    v_mfma_f32_16x16x32_bf16 v[196:199], v[180:183], v[104:107], v[196:199]
    ds_read_b64_tr_b16 v[168:169], v16 offset:20480
    ds_read_b64_tr_b16 v[170:171], v16 offset:22528
    ds_read_b64_tr_b16 v[172:173], v17 offset:20480
    ds_read_b64_tr_b16 v[174:175], v17 offset:22528
    s_waitcnt vmcnt(18) lgkmcnt(8)
    v_mfma_f32_16x16x32_bf16 v[192:195], v[184:187], v[108:111], v[192:195]
    v_mfma_f32_16x16x32_bf16 v[196:199], v[188:191], v[108:111], v[196:199]
    ds_read_b64_tr_b16 v[176:177], v16 offset:24576
    ds_read_b64_tr_b16 v[178:179], v16 offset:26624
    ds_read_b64_tr_b16 v[180:181], v17 offset:24576
    ds_read_b64_tr_b16 v[182:183], v17 offset:26624
    s_waitcnt vmcnt(17) lgkmcnt(8)
    v_mfma_f32_16x16x32_bf16 v[192:195], v[160:163], v[112:115], v[192:195]
    v_mfma_f32_16x16x32_bf16 v[196:199], v[164:167], v[112:115], v[196:199]
    ds_read_b64_tr_b16 v[184:185], v16 offset:28672
    ds_read_b64_tr_b16 v[186:187], v16 offset:30720
    ds_read_b64_tr_b16 v[188:189], v17 offset:28672
    ds_read_b64_tr_b16 v[190:191], v17 offset:30720
    s_waitcnt vmcnt(16) lgkmcnt(8)
    v_mfma_f32_16x16x32_bf16 v[192:195], v[168:171], v[116:119], v[192:195]
    v_mfma_f32_16x16x32_bf16 v[196:199], v[172:175], v[116:119], v[196:199]
    ds_read_b64_tr_b16 v[160:161], v18 offset:0
    ds_read_b64_tr_b16 v[162:163], v18 offset:2048
    ds_read_b64_tr_b16 v[164:165], v19 offset:0
    ds_read_b64_tr_b16 v[166:167], v19 offset:2048
    s_waitcnt vmcnt(15) lgkmcnt(8)
    v_mfma_f32_16x16x32_bf16 v[192:195], v[176:179], v[120:123], v[192:195]
    v_mfma_f32_16x16x32_bf16 v[196:199], v[180:183], v[120:123], v[196:199]
    ds_read_b64_tr_b16 v[168:169], v18 offset:4096
    ds_read_b64_tr_b16 v[170:171], v18 offset:6144
    ds_read_b64_tr_b16 v[172:173], v19 offset:4096
    ds_read_b64_tr_b16 v[174:175], v19 offset:6144
    s_waitcnt vmcnt(14) lgkmcnt(8)
    v_mfma_f32_16x16x32_bf16 v[192:195], v[184:187], v[124:127], v[192:195]
    v_mfma_f32_16x16x32_bf16 v[196:199], v[188:191], v[124:127], v[196:199]
    ds_read_b64_tr_b16 v[176:177], v18 offset:8192
    ds_read_b64_tr_b16 v[178:179], v18 offset:10240
    ds_read_b64_tr_b16 v[180:181], v19 offset:8192
    ds_read_b64_tr_b16 v[182:183], v19 offset:10240
    s_waitcnt vmcnt(13) lgkmcnt(8)
    v_mfma_f32_16x16x32_bf16 v[192:195], v[160:163], v[128:131], v[192:195]
    v_mfma_f32_16x16x32_bf16 v[196:199], v[164:167], v[128:131], v[196:199]
    ds_read_b64_tr_b16 v[184:185], v18 offset:12288
    ds_read_b64_tr_b16 v[186:187], v18 offset:14336
    ds_read_b64_tr_b16 v[188:189], v19 offset:12288
    ds_read_b64_tr_b16 v[190:191], v19 offset:14336
    s_waitcnt vmcnt(12) lgkmcnt(8)
    v_mfma_f32_16x16x32_bf16 v[192:195], v[168:171], v[132:135], v[192:195]
    v_mfma_f32_16x16x32_bf16 v[196:199], v[172:175], v[132:135], v[196:199]
    ds_read_b64_tr_b16 v[160:161], v18 offset:16384
    ds_read_b64_tr_b16 v[162:163], v18 offset:18432
    ds_read_b64_tr_b16 v[164:165], v19 offset:16384
    ds_read_b64_tr_b16 v[166:167], v19 offset:18432
    s_waitcnt vmcnt(11) lgkmcnt(8)
    v_mfma_f32_16x16x32_bf16 v[192:195], v[176:179], v[136:139], v[192:195]
    v_mfma_f32_16x16x32_bf16 v[196:199], v[180:183], v[136:139], v[196:199]
    ds_read_b64_tr_b16 v[168:169], v18 offset:20480
    ds_read_b64_tr_b16 v[170:171], v18 offset:22528
    ds_read_b64_tr_b16 v[172:173], v19 offset:20480
    ds_read_b64_tr_b16 v[174:175], v19 offset:22528
    s_waitcnt vmcnt(10) lgkmcnt(8)
    v_mfma_f32_16x16x32_bf16 v[192:195], v[184:187], v[140:143], v[192:195]
    v_mfma_f32_16x16x32_bf16 v[196:199], v[188:191], v[140:143], v[196:199]
    s_waitcnt vmcnt(9) lgkmcnt(4)
    v_mfma_f32_16x16x32_bf16 v[192:195], v[160:163], v[144:147], v[192:195]
    v_mfma_f32_16x16x32_bf16 v[196:199], v[164:167], v[144:147], v[196:199]
    s_waitcnt vmcnt(8) lgkmcnt(0)
    v_mfma_f32_16x16x32_bf16 v[192:195], v[168:171], v[148:151], v[192:195]
    v_mfma_f32_16x16x32_bf16 v[196:199], v[172:175], v[148:151], v[196:199]
    s_waitcnt vmcnt(7)
    v_lshlrev_b32 v32, 16, v200
    v_and_b32 v33, 0xffff0000, v200
    v_lshlrev_b32_e64 v34, 16, v201
    v_and_b32 v35, 0xffff0000, v201
    v_lshlrev_b32_e64 v36, 16, v202
    v_and_b32 v37, 0xffff0000, v202
    v_lshlrev_b32_e64 v38, 16, v203
    v_and_b32 v39, 0xffff0000, v203
    s_waitcnt vmcnt(6)
    v_lshlrev_b32 v4, 16, v204
    v_and_b32 v5, 0xffff0000, v204
    v_pk_add_f32 v[32:33], v[32:33], v[4:5]
    v_lshlrev_b32_e64 v4, 16, v205
    v_and_b32 v5, 0xffff0000, v205
    v_pk_add_f32 v[34:35], v[34:35], v[4:5]
    v_lshlrev_b32_e64 v4, 16, v206
    v_and_b32 v5, 0xffff0000, v206
    v_pk_add_f32 v[36:37], v[36:37], v[4:5]
    v_lshlrev_b32_e64 v4, 16, v207
    v_and_b32 v5, 0xffff0000, v207
    v_pk_add_f32 v[38:39], v[38:39], v[4:5]
    s_waitcnt vmcnt(5)
    v_lshlrev_b32 v4, 16, v208
    v_and_b32 v5, 0xffff0000, v208
    v_pk_add_f32 v[32:33], v[32:33], v[4:5]
    v_lshlrev_b32_e64 v4, 16, v209
    v_and_b32 v5, 0xffff0000, v209
    v_pk_add_f32 v[34:35], v[34:35], v[4:5]
    v_lshlrev_b32_e64 v4, 16, v210
    v_and_b32 v5, 0xffff0000, v210
    v_pk_add_f32 v[36:37], v[36:37], v[4:5]
    v_lshlrev_b32_e64 v4, 16, v211
    v_and_b32 v5, 0xffff0000, v211
    v_pk_add_f32 v[38:39], v[38:39], v[4:5]
    s_waitcnt vmcnt(4)
    v_lshlrev_b32 v4, 16, v212
    v_and_b32 v5, 0xffff0000, v212
    v_pk_add_f32 v[32:33], v[32:33], v[4:5]
    v_lshlrev_b32_e64 v4, 16, v213
    v_and_b32 v5, 0xffff0000, v213
    v_pk_add_f32 v[34:35], v[34:35], v[4:5]
    v_lshlrev_b32_e64 v4, 16, v214
    v_and_b32 v5, 0xffff0000, v214
    v_pk_add_f32 v[36:37], v[36:37], v[4:5]
    v_lshlrev_b32_e64 v4, 16, v215
    v_and_b32 v5, 0xffff0000, v215
    v_pk_add_f32 v[38:39], v[38:39], v[4:5]
    s_waitcnt vmcnt(3)
    v_lshlrev_b32 v4, 16, v216
    v_and_b32 v5, 0xffff0000, v216
    v_pk_add_f32 v[32:33], v[32:33], v[4:5]
    v_lshlrev_b32_e64 v4, 16, v217
    v_and_b32 v5, 0xffff0000, v217
    v_pk_add_f32 v[34:35], v[34:35], v[4:5]
    v_lshlrev_b32_e64 v4, 16, v218
    v_and_b32 v5, 0xffff0000, v218
    v_pk_add_f32 v[36:37], v[36:37], v[4:5]
    v_lshlrev_b32_e64 v4, 16, v219
    v_and_b32 v5, 0xffff0000, v219
    v_pk_add_f32 v[38:39], v[38:39], v[4:5]
    s_waitcnt vmcnt(2)
    v_lshlrev_b32 v4, 16, v220
    v_and_b32 v5, 0xffff0000, v220
    v_pk_add_f32 v[32:33], v[32:33], v[4:5]
    v_lshlrev_b32_e64 v4, 16, v221
    v_and_b32 v5, 0xffff0000, v221
    v_pk_add_f32 v[34:35], v[34:35], v[4:5]
    v_lshlrev_b32_e64 v4, 16, v222
    v_and_b32 v5, 0xffff0000, v222
    v_pk_add_f32 v[36:37], v[36:37], v[4:5]
    v_lshlrev_b32_e64 v4, 16, v223
    v_and_b32 v5, 0xffff0000, v223
    v_pk_add_f32 v[38:39], v[38:39], v[4:5]
    s_waitcnt vmcnt(1)
    v_lshlrev_b32 v4, 16, v224
    v_and_b32 v5, 0xffff0000, v224
    v_pk_add_f32 v[32:33], v[32:33], v[4:5]
    v_lshlrev_b32_e64 v4, 16, v225
    v_and_b32 v5, 0xffff0000, v225
    v_pk_add_f32 v[34:35], v[34:35], v[4:5]
    v_lshlrev_b32_e64 v4, 16, v226
    v_and_b32 v5, 0xffff0000, v226
    v_pk_add_f32 v[36:37], v[36:37], v[4:5]
    v_lshlrev_b32_e64 v4, 16, v227
    v_and_b32 v5, 0xffff0000, v227
    v_pk_add_f32 v[38:39], v[38:39], v[4:5]
    s_waitcnt vmcnt(0)
    v_lshlrev_b32 v4, 16, v228
    v_and_b32 v5, 0xffff0000, v228
    v_pk_add_f32 v[32:33], v[32:33], v[4:5]
    v_lshlrev_b32_e64 v4, 16, v229
    v_and_b32 v5, 0xffff0000, v229
    v_pk_add_f32 v[34:35], v[34:35], v[4:5]
    v_lshlrev_b32_e64 v4, 16, v230
    v_and_b32 v5, 0xffff0000, v230
    v_pk_add_f32 v[36:37], v[36:37], v[4:5]
    v_lshlrev_b32_e64 v4, 16, v231
    v_and_b32 v5, 0xffff0000, v231
    v_pk_add_f32 v[38:39], v[38:39], v[4:5]
    v_pk_add_f32 v[192:193], v[192:193], v[32:33]
    v_pk_add_f32 v[194:195], v[194:195], v[34:35]
    v_pk_add_f32 v[196:197], v[196:197], v[36:37]
    v_pk_add_f32 v[198:199], v[198:199], v[38:39]
    v_cvt_pk_bf16_f32 v28, v192, v193
    v_cvt_pk_bf16_f32 v29, v194, v195
    buffer_store_dwordx2 v[28:29], v13, s[60:63], s39 offen offset:0
    v_cvt_pk_bf16_f32 v30, v196, v197
    v_cvt_pk_bf16_f32 v31, v198, v199
    buffer_store_dwordx2 v[30:31], v13, s[60:63], s39 offen offset:32
parallel_sum__compressed_kv_cla__mixer_gmlp__prompt_kernel_end:
    s_endpgm
.section .rodata,"a"
.p2align 6
.amdhsa_kernel parallel_sum__compressed_kv_cla__mixer_gmlp__prompt_kernel
  .amdhsa_next_free_vgpr 256
  .amdhsa_next_free_sgpr 102
  .amdhsa_accum_offset 256
  .amdhsa_group_segment_fixed_size 0
  .amdhsa_kernarg_size 112
  .amdhsa_user_sgpr_count 2
  .amdhsa_user_sgpr_kernarg_segment_ptr 1
  .amdhsa_system_sgpr_workgroup_id_x 1
.end_amdhsa_kernel
```
